```python
import torch

def _softmax(x, axis=-1):
    return torch.softmax(x, dim=axis)
def _gelu(x):
    return torch.nn.functional.gelu(x, approximate="tanh")
def _silu(x):
    return torch.nn.functional.silu(x)
def _sigmoid(x):
    return torch.sigmoid(x)
def _layernorm(x, axis=-1, eps=1e-5):
    m = x.mean(dim=axis, keepdim=True)
    v = x.var(dim=axis, keepdim=True, unbiased=False)
    return (x - m) / torch.sqrt(v + eps)
def _scatter_add(tgt, idx, src, axis=0):
    return tgt.clone().index_add_(axis, idx, src)
def _segment_sum(src, seg, n):
    out = torch.zeros((n,) + src.shape[1:], dtype=src.dtype)
    return out.index_add_(0, seg, src)
def _pad(x, pw):
    flat = tuple(v for pair in reversed(pw) for v in pair)
    return torch.nn.functional.pad(x, flat)

kernel_name = 'standalone__gqa_softmax__near_ridge'

def setup_inputs():

    _w = (lambda a: (lambda t: t.to(torch.bfloat16) if t.is_floating_point() else t)(torch.as_tensor(a)))
    B, Hq, Hkv, Sq, Sk, D = 16, 32, 32, 384, 384, 192
    return {
        "q": _w((lambda *s: torch.randn(*s, dtype=torch.bfloat16) * 0.8)(B, Hq, Sq, D)),
        "k": _w((lambda *s: torch.randn(*s, dtype=torch.bfloat16) * 0.8)(B, Hkv, Sk, D)),
        "v": _w((lambda *s: torch.randn(*s, dtype=torch.bfloat16) * 0.05)(B, Hkv, Sk, D)),
    }

def reference(q, k, v):
    B, Hq, Sq, D = q.shape
    Hkv = k.shape[1]
    rep = Hq // Hkv
    k = (lambda x, n, axis: torch.repeat_interleave(x, n, dim=axis))(k, rep, axis=1)
    v = (lambda x, n, axis: torch.repeat_interleave(x, n, dim=axis))(v, rep, axis=1)
    scale = D ** -0.5
    scores = torch.einsum("bhqd,bhkd->bhqk", q, k) * scale
    p = _softmax(scores, axis=-1)
    return torch.einsum("bhqk,bhkd->bhqd", p, v)
```

```asm
; @launch grid=(256,1,1) block=(256,1,1) lds=163840
.amdgcn_target "amdgcn-amd-amdhsa--gfx950"
.text
.globl standalone__gqa_softmax__near_ridge_kernel
.p2align 12
.p2align 8
.type standalone__gqa_softmax__near_ridge_kernel,@function
standalone__gqa_softmax__near_ridge_kernel:
  s_cmp_ge_u32 s2, 256
  s_cbranch_scc1 L_end
  s_load_dwordx4 s[4:7], s[0:1], 0
  s_load_dwordx4 s[8:11], s[0:1], 16
  v_lshrrev_b32 v1, 6, v0
  s_nop 1
  v_readfirstlane_b32 s3, v1
  s_nop 4
  s_mul_i32 s32, s3, 3072
  s_mul_i32 s28, s2, 147456
  s_add_u32 s29, s28, 37748736
  s_mul_i32 s40, s3, 36864
  s_add_u32 s34, s28, s40
  s_add_u32 s36, s28, s32
  s_mul_i32 s40, s3, 9216
  s_add_u32 s38, s28, s40
  s_mul_i32 s40, s3, 36864
  s_add_u32 s35, s29, s40
  s_add_u32 s37, s29, s32
  s_mul_i32 s40, s3, 9216
  s_add_u32 s39, s29, s40
  s_lshl_b32 s28, s3, 12
  s_add_u32 s28, s28, 147456
  s_mov_b32 s33, 0x3f803f80
  s_mov_b32 s29, 0
  s_mov_b32 s30, 0x3dd53b95
  s_mov_b32 s31, 0x41800000
  v_mbcnt_lo_u32_b32 v24, -1, 0
  v_mbcnt_hi_u32_b32 v24, -1, v24
  v_lshrrev_b32 v25, 3, v24
  v_add_u32 v25, 0, v25
  v_mul_u32_u24 v25, 43, v25
  v_lshrrev_b32 v25, 8, v25
  v_lshl_add_u32 v25, s3, 2, v25
  v_and_b32 v25, 7, v25
  v_xor_b32 v25, v25, v24
  v_lshlrev_b32 v12, 4, v25
  v_lshrrev_b32 v25, 3, v24
  v_add_u32 v25, 8, v25
  v_mul_u32_u24 v25, 43, v25
  v_lshrrev_b32 v25, 8, v25
  v_lshl_add_u32 v25, s3, 2, v25
  v_and_b32 v25, 7, v25
  v_xor_b32 v25, v25, v24
  v_lshlrev_b32 v13, 4, v25
  v_lshrrev_b32 v25, 3, v24
  v_add_u32 v25, 16, v25
  v_mul_u32_u24 v25, 43, v25
  v_lshrrev_b32 v25, 8, v25
  v_lshl_add_u32 v25, s3, 2, v25
  v_and_b32 v25, 7, v25
  v_xor_b32 v25, v25, v24
  v_lshlrev_b32 v14, 4, v25
  s_waitcnt lgkmcnt(0)
  s_mov_b32 s12, s4
  s_mov_b32 s13, s5
  s_mov_b32 s14, 75497472
  s_mov_b32 s15, 0x00020000
  s_mov_b32 s16, s6
  s_mov_b32 s17, s7
  s_mov_b32 s18, 75497472
  s_mov_b32 s19, 0x00020000
  s_mov_b32 s20, s8
  s_mov_b32 s21, s9
  s_mov_b32 s22, 75497472
  s_mov_b32 s23, 0x00020000
  s_mov_b32 s24, s10
  s_mov_b32 s25, s11
  s_mov_b32 s26, 75497472
  s_mov_b32 s27, 0x00020000
  s_mov_b32 s11, 0x53800000
  s_add_u32 m0, s32, 0
  s_add_u32 s40, s34, 0
  buffer_load_dwordx4 v12, s[12:15], s40 offen nt lds
  buffer_load_dwordx4 v13, s[12:15], s40 offen offset:1024 nt lds
  buffer_load_dwordx4 v14, s[12:15], s40 offen offset:2048 nt lds
  s_add_u32 m0, s32, 12288
  s_add_u32 s40, s34, 3072
  buffer_load_dwordx4 v12, s[12:15], s40 offen nt lds
  buffer_load_dwordx4 v13, s[12:15], s40 offen offset:1024 nt lds
  buffer_load_dwordx4 v14, s[12:15], s40 offen offset:2048 nt lds
  s_getpc_b64 s[4:5]
L_pc:
  v_lshlrev_b32 v16, 7, v0
  v_min_u32 v17, L_end-L_pc, v16
  global_load_dword v18, v17, s[4:5]
  v_add_u32 v16, 32768, v16
  v_min_u32 v17, L_end-L_pc, v16
  global_load_dword v19, v17, s[4:5]
  v_add_u32 v16, 32768, v16
  v_min_u32 v17, L_end-L_pc, v16
  global_load_dword v20, v17, s[4:5]
  s_add_u32 m0, s32, 24576
  s_add_u32 s40, s34, 6144
  buffer_load_dwordx4 v12, s[12:15], s40 offen nt lds
  buffer_load_dwordx4 v13, s[12:15], s40 offen offset:1024 nt lds
  buffer_load_dwordx4 v14, s[12:15], s40 offen offset:2048 nt lds
  s_add_u32 m0, s32, 36864
  s_add_u32 s40, s34, 9216
  buffer_load_dwordx4 v12, s[12:15], s40 offen nt lds
  buffer_load_dwordx4 v13, s[12:15], s40 offen offset:1024 nt lds
  buffer_load_dwordx4 v14, s[12:15], s40 offen offset:2048 nt lds
  s_add_u32 m0, s32, 49152
  s_add_u32 s40, s34, 12288
  buffer_load_dwordx4 v12, s[12:15], s40 offen nt lds
  buffer_load_dwordx4 v13, s[12:15], s40 offen offset:1024 nt lds
  buffer_load_dwordx4 v14, s[12:15], s40 offen offset:2048 nt lds
  s_add_u32 m0, s32, 61440
  s_add_u32 s40, s34, 15360
  buffer_load_dwordx4 v12, s[12:15], s40 offen nt lds
  buffer_load_dwordx4 v13, s[12:15], s40 offen offset:1024 nt lds
  buffer_load_dwordx4 v14, s[12:15], s40 offen offset:2048 nt lds
  s_add_u32 m0, s32, 73728
  s_add_u32 s40, s34, 18432
  buffer_load_dwordx4 v12, s[12:15], s40 offen nt lds
  buffer_load_dwordx4 v13, s[12:15], s40 offen offset:1024 nt lds
  buffer_load_dwordx4 v14, s[12:15], s40 offen offset:2048 nt lds
  s_add_u32 m0, s32, 86016
  s_add_u32 s40, s34, 21504
  buffer_load_dwordx4 v12, s[12:15], s40 offen nt lds
  buffer_load_dwordx4 v13, s[12:15], s40 offen offset:1024 nt lds
  buffer_load_dwordx4 v14, s[12:15], s40 offen offset:2048 nt lds
  v_mbcnt_lo_u32_b32 v24, -1, 0
  v_mbcnt_hi_u32_b32 v24, -1, v24
  v_lshrrev_b32 v25, 3, v24
  v_mul_u32_u24 v2, 384, v25
  v_and_b32 v25, 6, v25
  v_and_b32 v24, 7, v24
  v_xor_b32 v24, v24, v25
  v_lshl_add_u32 v2, v24, 4, v2
  v_mbcnt_lo_u32_b32 v24, -1, 0
  v_mbcnt_hi_u32_b32 v24, -1, v24
  v_bfe_u32 v25, v24, 3, 1
  v_mul_u32_u24 v144, 12288, v25
  v_and_b32 v25, 7, v24
  v_mul_u32_u24 v25, 384, v25
  v_add3_u32 v144, v144, v25, s32
  v_bfe_u32 v25, v24, 1, 2
  v_lshl_add_u32 v25, s3, 2, v25
  v_and_b32 v25, 7, v25
  v_lshrrev_b32 v24, 4, v24
  v_xor_b32 v24, v24, v25
  v_lshl_add_u32 v144, v24, 4, v144
  v_mbcnt_lo_u32_b32 v24, -1, 0
  v_mbcnt_hi_u32_b32 v24, -1, v24
  v_bfe_u32 v25, v24, 1, 3
  v_lshrrev_b32 v1, 4, v24
  v_xor_b32 v25, v25, v1
  v_and_b32 v24, 15, v24
  v_mul_u32_u24 v24, 384, v24
  v_lshl_add_u32 v0, v25, 4, v24
  v_xor_b32 v1, 64, v0
  s_waitcnt vmcnt(12)
  ds_read_b128 a[0:3], v144 offset:0
  ds_read_b128 a[24:27], v144 offset:24576
  ds_read_b128 a[8:11], v144 offset:128
  ds_read_b128 a[32:35], v144 offset:24704
  ds_read_b128 a[16:19], v144 offset:256
  ds_read_b128 a[40:43], v144 offset:24832
  v_xor_b32 v145, 64, v144
  ds_read_b128 a[4:7], v145 offset:0
  ds_read_b128 a[28:31], v145 offset:24576
  ds_read_b128 a[12:15], v145 offset:128
  ds_read_b128 a[36:39], v145 offset:24704
  ds_read_b128 a[20:23], v145 offset:256
  ds_read_b128 a[44:47], v145 offset:24832
  s_waitcnt lgkmcnt(0)
  s_add_u32 m0, s32, 0
  s_add_u32 s40, s36, 0
  buffer_load_dwordx4 v12, s[16:19], s40 offen nt lds
  buffer_load_dwordx4 v13, s[16:19], s40 offen offset:1024 nt lds
  buffer_load_dwordx4 v14, s[16:19], s40 offen offset:2048 nt lds
  s_mov_b64 exec, 0
  s_cmp_eq_u32 s3, 0
  s_cbranch_scc1 L_pad_0
  s_cmp_eq_u32 s3, 1
  s_cbranch_scc1 L_pad_1
  s_cmp_eq_u32 s3, 2
  s_cbranch_scc1 L_pad_2
  s_branch L_pad_3
L_padret:
  s_mov_b64 exec, -1
  s_add_u32 m0, s32, 98304
  s_add_u32 s40, s34, 24576
  buffer_load_dwordx4 v12, s[12:15], s40 offen nt lds
  buffer_load_dwordx4 v13, s[12:15], s40 offen offset:1024 nt lds
  buffer_load_dwordx4 v14, s[12:15], s40 offen offset:2048 nt lds
  s_add_u32 m0, s32, 110592
  s_add_u32 s40, s34, 27648
  buffer_load_dwordx4 v12, s[12:15], s40 offen nt lds
  buffer_load_dwordx4 v13, s[12:15], s40 offen offset:1024 nt lds
  buffer_load_dwordx4 v14, s[12:15], s40 offen offset:2048 nt lds
  s_add_u32 m0, s32, 122880
  s_add_u32 s40, s34, 30720
  buffer_load_dwordx4 v12, s[12:15], s40 offen nt lds
  buffer_load_dwordx4 v13, s[12:15], s40 offen offset:1024 nt lds
  buffer_load_dwordx4 v14, s[12:15], s40 offen offset:2048 nt lds
  s_add_u32 m0, s32, 135168
  s_add_u32 s40, s34, 33792
  buffer_load_dwordx4 v12, s[12:15], s40 offen nt lds
  buffer_load_dwordx4 v13, s[12:15], s40 offen offset:1024 nt lds
  buffer_load_dwordx4 v14, s[12:15], s40 offen offset:2048 nt lds
  s_waitcnt vmcnt(15)
  v_add_u32 v145, 49152, v144
  ds_read_b128 a[48:51], v145 offset:0
  ds_read_b128 a[72:75], v145 offset:24576
  ds_read_b128 a[56:59], v145 offset:128
  ds_read_b128 a[80:83], v145 offset:24704
  ds_read_b128 a[64:67], v145 offset:256
  ds_read_b128 a[88:91], v145 offset:24832
  v_xor_b32 v145, 64, v144
  v_add_u32 v145, 49152, v145
  ds_read_b128 a[52:55], v145 offset:0
  ds_read_b128 a[76:79], v145 offset:24576
  ds_read_b128 a[60:63], v145 offset:128
  ds_read_b128 a[84:87], v145 offset:24704
  ds_read_b128 a[68:71], v145 offset:256
  ds_read_b128 a[92:95], v145 offset:24832
  s_waitcnt vmcnt(12) lgkmcnt(0)
  s_barrier
  ds_read_b128 v[88:91], v0 offset:0
  ds_read_b128 v[92:95], v1 offset:0
  s_waitcnt lgkmcnt(1)
  v_mfma_f32_16x16x32_bf16 v[16:19], v[88:91], a[0:3], 0
  s_waitcnt lgkmcnt(0)
  ds_read_b128 v[96:99], v0 offset:128
  v_mfma_f32_16x16x32_bf16 v[16:19], v[92:95], a[4:7], v[16:19]
  v_mfma_f32_16x16x32_bf16 v[24:27], v[88:91], a[24:27], 0
  ds_read_b128 v[100:103], v1 offset:128
  v_mfma_f32_16x16x32_bf16 v[24:27], v[92:95], a[28:31], v[24:27]
  v_mfma_f32_16x16x32_bf16 v[32:35], v[88:91], a[48:51], 0
  ds_read_b128 v[104:107], v0 offset:256
  v_mfma_f32_16x16x32_bf16 v[32:35], v[92:95], a[52:55], v[32:35]
  v_mfma_f32_16x16x32_bf16 v[40:43], v[88:91], a[72:75], 0
  ds_read_b128 v[108:111], v1 offset:256
  v_mfma_f32_16x16x32_bf16 v[40:43], v[92:95], a[76:79], v[40:43]
  s_waitcnt lgkmcnt(3)
  v_mbcnt_lo_u32_b32 v10, -1, 0
  v_mfma_f32_16x16x32_bf16 v[16:19], v[96:99], a[8:11], v[16:19]
  s_waitcnt lgkmcnt(2)
  ds_read_b128 v[64:67], v0 offset:6144
  v_mfma_f32_16x16x32_bf16 v[16:19], v[100:103], a[12:15], v[16:19]
  v_mfma_f32_16x16x32_bf16 v[24:27], v[96:99], a[32:35], v[24:27]
  ds_read_b128 v[68:71], v1 offset:6144
  v_mfma_f32_16x16x32_bf16 v[24:27], v[100:103], a[36:39], v[24:27]
  v_mbcnt_hi_u32_b32 v10, -1, v10
  v_mfma_f32_16x16x32_bf16 v[32:35], v[96:99], a[56:59], v[32:35]
  ds_read_b128 v[72:75], v0 offset:6272
  v_mfma_f32_16x16x32_bf16 v[32:35], v[100:103], a[60:63], v[32:35]
  v_mfma_f32_16x16x32_bf16 v[40:43], v[96:99], a[80:83], v[40:43]
  ds_read_b128 v[76:79], v1 offset:6272
  v_mfma_f32_16x16x32_bf16 v[40:43], v[100:103], a[84:87], v[40:43]
  s_waitcnt lgkmcnt(4)
  v_min_u32 v10, 23, v10
  v_mfma_f32_16x16x32_bf16 v[16:19], v[104:107], a[16:19], v[16:19]
  ds_read_b128 v[80:83], v0 offset:6400
  v_mfma_f32_16x16x32_bf16 v[16:19], v[108:111], a[20:23], v[16:19]
  v_mfma_f32_16x16x32_bf16 v[24:27], v[104:107], a[40:43], v[24:27]
  ds_read_b128 v[84:87], v1 offset:6400
  v_mfma_f32_16x16x32_bf16 v[24:27], v[108:111], a[44:47], v[24:27]
  v_lshlrev_b32 v10, 7, v10
  v_mfma_f32_16x16x32_bf16 v[32:35], v[104:107], a[64:67], v[32:35]
  s_add_u32 m0, s32, 12288
  v_mfma_f32_16x16x32_bf16 v[32:35], v[108:111], a[68:71], v[32:35]
  s_add_u32 s40, s36, 12288
  v_mfma_f32_16x16x32_bf16 v[40:43], v[104:107], a[88:91], v[40:43]
  buffer_load_dwordx4 v12, s[16:19], s40 offen nt lds
  v_mfma_f32_16x16x32_bf16 v[40:43], v[108:111], a[92:95], v[40:43]
  s_waitcnt lgkmcnt(4)
  buffer_load_dwordx4 v13, s[16:19], s40 offen offset:1024 nt lds
  v_mfma_f32_16x16x32_bf16 v[20:23], v[64:67], a[0:3], 0
  buffer_load_dwordx4 v14, s[16:19], s40 offen offset:2048 nt lds
  v_mfma_f32_16x16x32_bf16 v[20:23], v[68:71], a[4:7], v[20:23]
  v_mfma_f32_16x16x32_bf16 v[28:31], v[64:67], a[24:27], 0
  v_mfma_f32_16x16x32_bf16 v[28:31], v[68:71], a[28:31], v[28:31]
  v_mfma_f32_16x16x32_bf16 v[36:39], v[64:67], a[48:51], 0
  v_mfma_f32_16x16x32_bf16 v[36:39], v[68:71], a[52:55], v[36:39]
  v_mfma_f32_16x16x32_bf16 v[44:47], v[64:67], a[72:75], 0
  v_mfma_f32_16x16x32_bf16 v[44:47], v[68:71], a[76:79], v[44:47]
  s_waitcnt lgkmcnt(2)
  v_mfma_f32_16x16x32_bf16 v[20:23], v[72:75], a[8:11], v[20:23]
  v_mfma_f32_16x16x32_bf16 v[20:23], v[76:79], a[12:15], v[20:23]
  v_mfma_f32_16x16x32_bf16 v[28:31], v[72:75], a[32:35], v[28:31]
  v_mfma_f32_16x16x32_bf16 v[28:31], v[76:79], a[36:39], v[28:31]
  v_mfma_f32_16x16x32_bf16 v[36:39], v[72:75], a[56:59], v[36:39]
  v_mfma_f32_16x16x32_bf16 v[36:39], v[76:79], a[60:63], v[36:39]
  v_mfma_f32_16x16x32_bf16 v[44:47], v[72:75], a[80:83], v[44:47]
  v_mfma_f32_16x16x32_bf16 v[44:47], v[76:79], a[84:87], v[44:47]
  s_waitcnt lgkmcnt(0)
  v_mfma_f32_16x16x32_bf16 v[20:23], v[80:83], a[16:19], v[20:23]
  v_mfma_f32_16x16x32_bf16 v[20:23], v[84:87], a[20:23], v[20:23]
  v_mfma_f32_16x16x32_bf16 v[28:31], v[80:83], a[40:43], v[28:31]
  v_mfma_f32_16x16x32_bf16 v[28:31], v[84:87], a[44:47], v[28:31]
  v_mfma_f32_16x16x32_bf16 v[36:39], v[80:83], a[64:67], v[36:39]
  v_mfma_f32_16x16x32_bf16 v[36:39], v[84:87], a[68:71], v[36:39]
  v_mfma_f32_16x16x32_bf16 v[44:47], v[80:83], a[88:91], v[44:47]
  v_mfma_f32_16x16x32_bf16 v[44:47], v[84:87], a[92:95], v[44:47]
  v_max3_f32 v4, v16, v17, v18
  s_nop 0
  v_max3_f32 v4, v4, v19, v20
  v_max3_f32 v4, v4, v21, v22
  v_max_f32 v4, v4, v23
  v_max3_f32 v5, v24, v25, v26
  v_max3_f32 v5, v5, v27, v28
  v_max3_f32 v5, v5, v29, v30
  v_max_f32 v5, v5, v31
  v_max3_f32 v6, v32, v33, v34
  v_max3_f32 v6, v6, v35, v36
  v_max3_f32 v6, v6, v37, v38
  v_max_f32 v6, v6, v39
  v_max3_f32 v7, v40, v41, v42
  v_max3_f32 v7, v7, v43, v44
  v_max3_f32 v7, v7, v45, v46
  v_max_f32 v7, v7, v47
  v_mov_b32 v148, v4
  v_mov_b32 v149, v5
  v_mov_b32 v150, v6
  v_mov_b32 v151, v7
  v_permlane32_swap_b32 v4, v148
  v_permlane32_swap_b32 v5, v149
  v_permlane32_swap_b32 v6, v150
  v_permlane32_swap_b32 v7, v151
  v_max_f32 v4, v4, v148
  v_max_f32 v5, v5, v149
  v_max_f32 v6, v6, v150
  v_max_f32 v7, v7, v151
  v_mov_b32 v148, v4
  v_mov_b32 v149, v5
  v_mov_b32 v150, v6
  v_mov_b32 v151, v7
  v_permlane16_swap_b32 v4, v148
  v_permlane16_swap_b32 v5, v149
  v_permlane16_swap_b32 v6, v150
  v_permlane16_swap_b32 v7, v151
  v_max_f32 v4, v4, v148
  v_max_f32 v5, v5, v149
  v_max_f32 v6, v6, v150
  v_max_f32 v7, v7, v151
  v_mul_f32 v4, s30, v4
  v_mul_f32 v5, s30, v5
  v_mul_f32 v6, s30, v6
  v_mul_f32 v7, s30, v7
  v_ceil_f32 v4, v4
  v_ceil_f32 v5, v5
  v_ceil_f32 v6, v6
  v_ceil_f32 v7, v7
  v_fma_f32 v16, v16, s30, -v4
  v_fma_f32 v17, v17, s30, -v4
  v_fma_f32 v18, v18, s30, -v4
  v_fma_f32 v19, v19, s30, -v4
  v_fma_f32 v20, v20, s30, -v4
  v_fma_f32 v21, v21, s30, -v4
  v_fma_f32 v22, v22, s30, -v4
  v_fma_f32 v23, v23, s30, -v4
  v_fma_f32 v24, v24, s30, -v5
  v_fma_f32 v25, v25, s30, -v5
  v_fma_f32 v26, v26, s30, -v5
  v_fma_f32 v27, v27, s30, -v5
  v_fma_f32 v28, v28, s30, -v5
  v_fma_f32 v29, v29, s30, -v5
  v_fma_f32 v30, v30, s30, -v5
  v_fma_f32 v31, v31, s30, -v5
  v_fma_f32 v32, v32, s30, -v6
  v_fma_f32 v33, v33, s30, -v6
  v_fma_f32 v34, v34, s30, -v6
  v_fma_f32 v35, v35, s30, -v6
  v_fma_f32 v36, v36, s30, -v6
  v_fma_f32 v37, v37, s30, -v6
  v_fma_f32 v38, v38, s30, -v6
  v_fma_f32 v39, v39, s30, -v6
  v_fma_f32 v40, v40, s30, -v7
  v_fma_f32 v41, v41, s30, -v7
  v_fma_f32 v42, v42, s30, -v7
  v_fma_f32 v43, v43, s30, -v7
  v_fma_f32 v44, v44, s30, -v7
  v_fma_f32 v45, v45, s30, -v7
  v_fma_f32 v46, v46, s30, -v7
  v_fma_f32 v47, v47, s30, -v7
  v_exp_f32 v16, v16
  v_exp_f32 v17, v17
  v_exp_f32 v18, v18
  v_exp_f32 v19, v19
  v_exp_f32 v20, v20
  v_cvt_pk_bf16_f32 v16, v16, v17
  v_exp_f32 v21, v21
  v_accvgpr_write_b32 a144, v16
  v_exp_f32 v22, v22
  v_cvt_pk_bf16_f32 v18, v18, v19
  v_exp_f32 v23, v23
  v_accvgpr_write_b32 a145, v18
  v_exp_f32 v24, v24
  v_cvt_pk_bf16_f32 v20, v20, v21
  v_exp_f32 v25, v25
  v_accvgpr_write_b32 a146, v20
  v_exp_f32 v26, v26
  v_cvt_pk_bf16_f32 v22, v22, v23
  v_exp_f32 v27, v27
  v_accvgpr_write_b32 a147, v22
  v_exp_f32 v28, v28
  v_cvt_pk_bf16_f32 v24, v24, v25
  v_exp_f32 v29, v29
  v_accvgpr_write_b32 a148, v24
  v_exp_f32 v30, v30
  v_cvt_pk_bf16_f32 v26, v26, v27
  v_exp_f32 v31, v31
  v_accvgpr_write_b32 a149, v26
  v_exp_f32 v32, v32
  v_cvt_pk_bf16_f32 v28, v28, v29
  v_exp_f32 v33, v33
  v_accvgpr_write_b32 a150, v28
  v_exp_f32 v34, v34
  v_cvt_pk_bf16_f32 v30, v30, v31
  v_exp_f32 v35, v35
  v_accvgpr_write_b32 a151, v30
  v_exp_f32 v36, v36
  v_cvt_pk_bf16_f32 v32, v32, v33
  v_exp_f32 v37, v37
  v_accvgpr_write_b32 a152, v32
  v_exp_f32 v38, v38
  v_cvt_pk_bf16_f32 v34, v34, v35
  v_exp_f32 v39, v39
  v_accvgpr_write_b32 a153, v34
  v_exp_f32 v40, v40
  v_cvt_pk_bf16_f32 v36, v36, v37
  v_exp_f32 v41, v41
  v_accvgpr_write_b32 a154, v36
  v_exp_f32 v42, v42
  v_cvt_pk_bf16_f32 v38, v38, v39
  v_exp_f32 v43, v43
  v_accvgpr_write_b32 a155, v38
  v_exp_f32 v44, v44
  v_cvt_pk_bf16_f32 v40, v40, v41
  v_exp_f32 v45, v45
  v_accvgpr_write_b32 a156, v40
  v_exp_f32 v46, v46
  v_cvt_pk_bf16_f32 v42, v42, v43
  v_exp_f32 v47, v47
  v_accvgpr_write_b32 a157, v42
  v_cvt_pk_bf16_f32 v44, v44, v45
  v_accvgpr_write_b32 a158, v44
  v_cvt_pk_bf16_f32 v46, v46, v47
  v_accvgpr_write_b32 a159, v46
  s_waitcnt vmcnt(3)
  v_add_u32 v145, 98304, v144
  ds_read_b128 a[96:99], v145 offset:0
  ds_read_b128 a[120:123], v145 offset:24576
  ds_read_b128 a[104:107], v145 offset:128
  ds_read_b128 a[128:131], v145 offset:24704
  ds_read_b128 a[112:115], v145 offset:256
  ds_read_b128 a[136:139], v145 offset:24832
  v_xor_b32 v145, 64, v144
  v_add_u32 v145, 98304, v145
  ds_read_b128 a[100:103], v145 offset:0
  ds_read_b128 a[124:127], v145 offset:24576
  ds_read_b128 a[108:111], v145 offset:128
  ds_read_b128 a[132:135], v145 offset:24704
  ds_read_b128 a[116:119], v145 offset:256
  ds_read_b128 a[140:143], v145 offset:24832
  s_waitcnt lgkmcnt(11)
  v_mfma_f32_16x16x32_bf16 v[48:51], v[88:91], a[96:99], 0
  s_waitcnt lgkmcnt(5)
  v_mfma_f32_16x16x32_bf16 v[48:51], v[92:95], a[100:103], v[48:51]
  v_mfma_f32_16x16x32_bf16 v[56:59], v[88:91], a[120:123], 0
  s_waitcnt lgkmcnt(4)
  v_mfma_f32_16x16x32_bf16 v[56:59], v[92:95], a[124:127], v[56:59]
  v_mfma_f32_16x16x32_bf16 v[48:51], v[96:99], a[104:107], v[48:51]
  s_waitcnt lgkmcnt(3)
  v_mfma_f32_16x16x32_bf16 v[48:51], v[100:103], a[108:111], v[48:51]
  v_mfma_f32_16x16x32_bf16 v[56:59], v[96:99], a[128:131], v[56:59]
  s_waitcnt lgkmcnt(0)
  v_mfma_f32_16x16x32_bf16 v[56:59], v[100:103], a[132:135], v[56:59]
  v_mfma_f32_16x16x32_bf16 v[48:51], v[104:107], a[112:115], v[48:51]
  v_mfma_f32_16x16x32_bf16 v[48:51], v[108:111], a[116:119], v[48:51]
  v_mfma_f32_16x16x32_bf16 v[56:59], v[104:107], a[136:139], v[56:59]
  v_mfma_f32_16x16x32_bf16 v[56:59], v[108:111], a[140:143], v[56:59]
  s_waitcnt vmcnt(0)
  s_barrier
  ds_read_b128 a[240:243], v0 offset:12288
  v_mfma_f32_16x16x32_bf16 v[52:55], v[64:67], a[96:99], 0
  ds_read_b128 a[244:247], v1 offset:12288
  v_mfma_f32_16x16x32_bf16 v[52:55], v[68:71], a[100:103], v[52:55]
  v_mfma_f32_16x16x32_bf16 v[60:63], v[64:67], a[120:123], 0
  v_mfma_f32_16x16x32_bf16 v[60:63], v[68:71], a[124:127], v[60:63]
  v_mfma_f32_16x16x32_bf16 v[52:55], v[72:75], a[104:107], v[52:55]
  s_add_u32 m0, s32, 24576
  v_mfma_f32_16x16x32_bf16 v[52:55], v[76:79], a[108:111], v[52:55]
  s_add_u32 s40, s36, 24576
  v_mfma_f32_16x16x32_bf16 v[60:63], v[72:75], a[128:131], v[60:63]
  buffer_load_dwordx4 v12, s[16:19], s40 offen nt lds
  v_mfma_f32_16x16x32_bf16 v[60:63], v[76:79], a[132:135], v[60:63]
  buffer_load_dwordx4 v13, s[16:19], s40 offen offset:1024 nt lds
  v_mfma_f32_16x16x32_bf16 v[52:55], v[80:83], a[112:115], v[52:55]
  buffer_load_dwordx4 v14, s[16:19], s40 offen offset:2048 nt lds
  v_mfma_f32_16x16x32_bf16 v[52:55], v[84:87], a[116:119], v[52:55]
  v_mfma_f32_16x16x32_bf16 v[60:63], v[80:83], a[136:139], v[60:63]
  v_mfma_f32_16x16x32_bf16 v[60:63], v[84:87], a[140:143], v[60:63]
  s_waitcnt lgkmcnt(0)
  v_mfma_f32_16x16x32_bf16 v[64:67], a[240:243], a[0:3], 0
  ds_read_b128 a[248:251], v0 offset:12416
  v_mfma_f32_16x16x32_bf16 v[64:67], a[244:247], a[4:7], v[64:67]
  ds_read_b128 a[252:255], v1 offset:12416
  v_mfma_f32_16x16x32_bf16 v[72:75], a[240:243], a[24:27], 0
  v_mfma_f32_16x16x32_bf16 v[72:75], a[244:247], a[28:31], v[72:75]
  v_mfma_f32_16x16x32_bf16 v[80:83], a[240:243], a[48:51], 0
  v_max3_f32 v8, v48, v49, v50
  v_mfma_f32_16x16x32_bf16 v[80:83], a[244:247], a[52:55], v[80:83]
  v_max3_f32 v8, v8, v51, v52
  v_max3_f32 v8, v8, v53, v54
  v_mfma_f32_16x16x32_bf16 v[88:91], a[240:243], a[72:75], 0
  v_max_f32 v8, v8, v55
  v_mfma_f32_16x16x32_bf16 v[88:91], a[244:247], a[76:79], v[88:91]
  v_max3_f32 v9, v56, v57, v58
  v_max3_f32 v9, v9, v59, v60
  v_mfma_f32_16x16x32_bf16 v[96:99], a[240:243], a[96:99], 0
  v_max3_f32 v9, v9, v61, v62
  v_mfma_f32_16x16x32_bf16 v[96:99], a[244:247], a[100:103], v[96:99]
  v_max_f32 v9, v9, v63
  v_mov_b32 v152, v8
  v_mfma_f32_16x16x32_bf16 v[104:107], a[240:243], a[120:123], 0
  v_mov_b32 v153, v9
  v_mfma_f32_16x16x32_bf16 v[104:107], a[244:247], a[124:127], v[104:107]
  s_waitcnt lgkmcnt(0)
  v_permlane32_swap_b32 v8, v152
  v_permlane32_swap_b32 v9, v153
  v_mfma_f32_16x16x32_bf16 v[64:67], a[248:251], a[8:11], v[64:67]
  ds_read_b128 a[240:243], v0 offset:12544
  v_mfma_f32_16x16x32_bf16 v[64:67], a[252:255], a[12:15], v[64:67]
  ds_read_b128 a[244:247], v1 offset:12544
  v_max_f32 v8, v8, v152
  v_mfma_f32_16x16x32_bf16 v[72:75], a[248:251], a[32:35], v[72:75]
  v_max_f32 v9, v9, v153
  v_mfma_f32_16x16x32_bf16 v[72:75], a[252:255], a[36:39], v[72:75]
  v_mov_b32 v152, v8
  v_mov_b32 v153, v9
  v_mfma_f32_16x16x32_bf16 v[80:83], a[248:251], a[56:59], v[80:83]
  v_permlane16_swap_b32 v8, v152
  v_mfma_f32_16x16x32_bf16 v[80:83], a[252:255], a[60:63], v[80:83]
  v_permlane16_swap_b32 v9, v153
  v_mfma_f32_16x16x32_bf16 v[88:91], a[248:251], a[80:83], v[88:91]
  v_max_f32 v8, v8, v152
  v_max_f32 v9, v9, v153
  v_mfma_f32_16x16x32_bf16 v[88:91], a[252:255], a[84:87], v[88:91]
  v_mul_f32 v8, s30, v8
  v_mfma_f32_16x16x32_bf16 v[96:99], a[248:251], a[104:107], v[96:99]
  v_mul_f32 v9, s30, v9
  v_ceil_f32 v8, v8
  v_mfma_f32_16x16x32_bf16 v[96:99], a[252:255], a[108:111], v[96:99]
  v_ceil_f32 v9, v9
  v_mfma_f32_16x16x32_bf16 v[104:107], a[248:251], a[128:131], v[104:107]
  v_fma_f32 v48, v48, s30, -v8
  v_fma_f32 v49, v49, s30, -v8
  v_mfma_f32_16x16x32_bf16 v[104:107], a[252:255], a[132:135], v[104:107]
  s_waitcnt lgkmcnt(0)
  v_fma_f32 v50, v50, s30, -v8
  v_mfma_f32_16x16x32_bf16 v[64:67], a[240:243], a[16:19], v[64:67]
  ds_read_b128 a[248:251], v0 offset:18432
  v_fma_f32 v51, v51, s30, -v8
  v_mfma_f32_16x16x32_bf16 v[64:67], a[244:247], a[20:23], v[64:67]
  ds_read_b128 a[252:255], v1 offset:18432
  v_mfma_f32_16x16x32_bf16 v[72:75], a[240:243], a[40:43], v[72:75]
  v_fma_f32 v52, v52, s30, -v8
  v_fma_f32 v53, v53, s30, -v8
  v_mfma_f32_16x16x32_bf16 v[72:75], a[244:247], a[44:47], v[72:75]
  v_fma_f32 v54, v54, s30, -v8
  v_mfma_f32_16x16x32_bf16 v[80:83], a[240:243], a[64:67], v[80:83]
  v_fma_f32 v55, v55, s30, -v8
  v_fma_f32 v56, v56, s30, -v9
  v_mfma_f32_16x16x32_bf16 v[80:83], a[244:247], a[68:71], v[80:83]
  v_fma_f32 v57, v57, s30, -v9
  v_mfma_f32_16x16x32_bf16 v[88:91], a[240:243], a[88:91], v[88:91]
  v_fma_f32 v58, v58, s30, -v9
  v_fma_f32 v59, v59, s30, -v9
  v_mfma_f32_16x16x32_bf16 v[88:91], a[244:247], a[92:95], v[88:91]
  v_fma_f32 v60, v60, s30, -v9
  v_mfma_f32_16x16x32_bf16 v[96:99], a[240:243], a[112:115], v[96:99]
  v_fma_f32 v61, v61, s30, -v9
  v_mfma_f32_16x16x32_bf16 v[96:99], a[244:247], a[116:119], v[96:99]
  v_fma_f32 v62, v62, s30, -v9
  v_fma_f32 v63, v63, s30, -v9
  v_mfma_f32_16x16x32_bf16 v[104:107], a[240:243], a[136:139], v[104:107]
  v_exp_f32 v48, v48
  v_mfma_f32_16x16x32_bf16 v[104:107], a[244:247], a[140:143], v[104:107]
  s_waitcnt lgkmcnt(0)
  v_mfma_f32_16x16x32_bf16 v[68:71], a[248:251], a[0:3], 0
  ds_read_b128 a[240:243], v0 offset:18560
  v_exp_f32 v49, v49
  v_mfma_f32_16x16x32_bf16 v[68:71], a[252:255], a[4:7], v[68:71]
  ds_read_b128 a[244:247], v1 offset:18560
  v_mfma_f32_16x16x32_bf16 v[76:79], a[248:251], a[24:27], 0
  v_exp_f32 v50, v50
  v_mfma_f32_16x16x32_bf16 v[76:79], a[252:255], a[28:31], v[76:79]
  v_mfma_f32_16x16x32_bf16 v[84:87], a[248:251], a[48:51], 0
  v_exp_f32 v51, v51
  v_mfma_f32_16x16x32_bf16 v[84:87], a[252:255], a[52:55], v[84:87]
  v_exp_f32 v52, v52
  v_mfma_f32_16x16x32_bf16 v[92:95], a[248:251], a[72:75], 0
  v_cvt_pk_bf16_f32 v48, v48, v49
  v_mfma_f32_16x16x32_bf16 v[92:95], a[252:255], a[76:79], v[92:95]
  v_exp_f32 v53, v53
  v_mfma_f32_16x16x32_bf16 v[100:103], a[248:251], a[96:99], 0
  v_accvgpr_write_b32 a160, v48
  v_mfma_f32_16x16x32_bf16 v[100:103], a[252:255], a[100:103], v[100:103]
  v_exp_f32 v54, v54
  v_mfma_f32_16x16x32_bf16 v[108:111], a[248:251], a[120:123], 0
  v_cvt_pk_bf16_f32 v50, v50, v51
  v_mfma_f32_16x16x32_bf16 v[108:111], a[252:255], a[124:127], v[108:111]
  s_waitcnt lgkmcnt(0)
  v_exp_f32 v55, v55
  v_mfma_f32_16x16x32_bf16 v[68:71], a[240:243], a[8:11], v[68:71]
  ds_read_b128 a[248:251], v0 offset:18688
  v_mfma_f32_16x16x32_bf16 v[68:71], a[244:247], a[12:15], v[68:71]
  ds_read_b128 a[252:255], v1 offset:18688
  v_accvgpr_write_b32 a161, v50
  v_mfma_f32_16x16x32_bf16 v[76:79], a[240:243], a[32:35], v[76:79]
L_pad_0:
  s_cbranch_execz L_pad_4
  v_exp_f32 v56, v56
  v_mfma_f32_16x16x32_bf16 v[76:79], a[244:247], a[36:39], v[76:79]
  v_cvt_pk_bf16_f32 v52, v52, v53
  v_mfma_f32_16x16x32_bf16 v[84:87], a[240:243], a[56:59], v[84:87]
  v_mfma_f32_16x16x32_bf16 v[84:87], a[244:247], a[60:63], v[84:87]
  v_exp_f32 v57, v57
  v_mfma_f32_16x16x32_bf16 v[92:95], a[240:243], a[80:83], v[92:95]
  v_accvgpr_write_b32 a162, v52
  v_mfma_f32_16x16x32_bf16 v[92:95], a[244:247], a[84:87], v[92:95]
  v_exp_f32 v58, v58
  v_mfma_f32_16x16x32_bf16 v[100:103], a[240:243], a[104:107], v[100:103]
  v_cvt_pk_bf16_f32 v54, v54, v55
  v_mfma_f32_16x16x32_bf16 v[100:103], a[244:247], a[108:111], v[100:103]
  v_exp_f32 v59, v59
  v_mfma_f32_16x16x32_bf16 v[108:111], a[240:243], a[128:131], v[108:111]
  v_accvgpr_write_b32 a163, v54
  v_mfma_f32_16x16x32_bf16 v[108:111], a[244:247], a[132:135], v[108:111]
  s_waitcnt vmcnt(0) lgkmcnt(0)
  s_barrier
  ds_read_b128 a[240:243], v0 offset:24576
  v_mfma_f32_16x16x32_bf16 v[68:71], a[248:251], a[16:19], v[68:71]
  ds_read_b128 a[244:247], v1 offset:24576
  v_exp_f32 v60, v60
  v_mfma_f32_16x16x32_bf16 v[68:71], a[252:255], a[20:23], v[68:71]
  v_cvt_pk_bf16_f32 v56, v56, v57
  v_mfma_f32_16x16x32_bf16 v[76:79], a[248:251], a[40:43], v[76:79]
  v_exp_f32 v61, v61
  v_mfma_f32_16x16x32_bf16 v[76:79], a[252:255], a[44:47], v[76:79]
  v_accvgpr_write_b32 a164, v56
  v_mfma_f32_16x16x32_bf16 v[84:87], a[248:251], a[64:67], v[84:87]
  s_add_u32 m0, s32, 36864
  v_mfma_f32_16x16x32_bf16 v[84:87], a[252:255], a[68:71], v[84:87]
  s_add_u32 s40, s36, 36864
  v_exp_f32 v62, v62
  v_mfma_f32_16x16x32_bf16 v[92:95], a[248:251], a[88:91], v[92:95]
  buffer_load_dwordx4 v12, s[16:19], s40 offen nt lds
  v_mfma_f32_16x16x32_bf16 v[92:95], a[252:255], a[92:95], v[92:95]
  buffer_load_dwordx4 v13, s[16:19], s40 offen offset:1024 nt lds
  v_mfma_f32_16x16x32_bf16 v[100:103], a[248:251], a[112:115], v[100:103]
  buffer_load_dwordx4 v14, s[16:19], s40 offen offset:2048 nt lds
  v_mfma_f32_16x16x32_bf16 v[100:103], a[252:255], a[116:119], v[100:103]
  v_cvt_pk_bf16_f32 v58, v58, v59
  v_mfma_f32_16x16x32_bf16 v[108:111], a[248:251], a[136:139], v[108:111]
  v_exp_f32 v63, v63
  v_mfma_f32_16x16x32_bf16 v[108:111], a[252:255], a[140:143], v[108:111]
  s_waitcnt lgkmcnt(0)
  v_accvgpr_write_b32 a165, v58
  v_mfma_f32_16x16x32_bf16 v[16:19], a[240:243], a[0:3], 0
  ds_read_b128 a[248:251], v0 offset:24704
  v_cvt_pk_bf16_f32 v60, v60, v61
  v_mfma_f32_16x16x32_bf16 v[16:19], a[244:247], a[4:7], v[16:19]
  ds_read_b128 a[252:255], v1 offset:24704
  v_mfma_f32_16x16x32_bf16 v[24:27], a[240:243], a[24:27], 0
  v_accvgpr_write_b32 a166, v60
  v_cvt_pk_bf16_f32 v62, v62, v63
  v_mfma_f32_16x16x32_bf16 v[24:27], a[244:247], a[28:31], v[24:27]
  v_accvgpr_write_b32 a167, v62
  v_mfma_f32_16x16x32_bf16 v[32:35], a[240:243], a[48:51], 0
  v_fma_f32 v64, v64, s30, -v4
  v_fma_f32 v65, v65, s30, -v4
  v_fma_f32 v66, v66, s30, -v4
  v_mfma_f32_16x16x32_bf16 v[32:35], a[244:247], a[52:55], v[32:35]
  v_max_f32 v3, v64, v65
  v_fma_f32 v67, v67, s30, -v4
  v_fma_f32 v68, v68, s30, -v4
  v_max3_f32 v3, v3, v66, v67
  v_mfma_f32_16x16x32_bf16 v[40:43], a[240:243], a[72:75], 0
  v_fma_f32 v69, v69, s30, -v4
  v_fma_f32 v70, v70, s30, -v4
  v_max3_f32 v3, v3, v68, v69
  v_mfma_f32_16x16x32_bf16 v[40:43], a[244:247], a[76:79], v[40:43]
  v_fma_f32 v71, v71, s30, -v4
  v_fma_f32 v72, v72, s30, -v5
  v_max3_f32 v3, v3, v70, v71
  v_fma_f32 v73, v73, s30, -v5
  v_mfma_f32_16x16x32_bf16 v[48:51], a[240:243], a[96:99], 0
  v_fma_f32 v74, v74, s30, -v5
  v_max3_f32 v3, v3, v72, v73
  v_fma_f32 v75, v75, s30, -v5
  v_mfma_f32_16x16x32_bf16 v[48:51], a[244:247], a[100:103], v[48:51]
  v_fma_f32 v76, v76, s30, -v5
  v_max3_f32 v3, v3, v74, v75
  v_fma_f32 v77, v77, s30, -v5
  v_mfma_f32_16x16x32_bf16 v[56:59], a[240:243], a[120:123], 0
  v_fma_f32 v78, v78, s30, -v5
  v_max3_f32 v3, v3, v76, v77
  v_fma_f32 v79, v79, s30, -v5
  v_fma_f32 v80, v80, s30, -v6
  v_mfma_f32_16x16x32_bf16 v[56:59], a[244:247], a[124:127], v[56:59]
  s_waitcnt lgkmcnt(0)
  v_max3_f32 v3, v3, v78, v79
  v_fma_f32 v81, v81, s30, -v6
  v_fma_f32 v82, v82, s30, -v6
  v_mfma_f32_16x16x32_bf16 v[16:19], a[248:251], a[8:11], v[16:19]
  ds_read_b128 a[240:243], v0 offset:24832
  v_max3_f32 v3, v3, v80, v81
  v_fma_f32 v83, v83, s30, -v6
  v_fma_f32 v84, v84, s30, -v6
  v_mfma_f32_16x16x32_bf16 v[16:19], a[252:255], a[12:15], v[16:19]
  ds_read_b128 a[244:247], v1 offset:24832
  v_max3_f32 v3, v3, v82, v83
  v_fma_f32 v85, v85, s30, -v6
  v_mfma_f32_16x16x32_bf16 v[24:27], a[248:251], a[32:35], v[24:27]
  v_fma_f32 v86, v86, s30, -v6
  v_max3_f32 v3, v3, v84, v85
  v_fma_f32 v87, v87, s30, -v6
  v_mfma_f32_16x16x32_bf16 v[24:27], a[252:255], a[36:39], v[24:27]
  v_fma_f32 v88, v88, s30, -v7
  v_max3_f32 v3, v3, v86, v87
  v_fma_f32 v89, v89, s30, -v7
  v_fma_f32 v90, v90, s30, -v7
  v_mfma_f32_16x16x32_bf16 v[32:35], a[248:251], a[56:59], v[32:35]
  v_max3_f32 v3, v3, v88, v89
  v_fma_f32 v91, v91, s30, -v7
  v_fma_f32 v92, v92, s30, -v7
  v_mfma_f32_16x16x32_bf16 v[32:35], a[252:255], a[60:63], v[32:35]
  v_max3_f32 v3, v3, v90, v91
  v_fma_f32 v93, v93, s30, -v7
  v_fma_f32 v94, v94, s30, -v7
  v_max3_f32 v3, v3, v92, v93
  v_mfma_f32_16x16x32_bf16 v[40:43], a[248:251], a[80:83], v[40:43]
  v_fma_f32 v95, v95, s30, -v7
  v_fma_f32 v96, v96, s30, -v8
  v_max3_f32 v3, v3, v94, v95
  v_mfma_f32_16x16x32_bf16 v[40:43], a[252:255], a[84:87], v[40:43]
  v_fma_f32 v97, v97, s30, -v8
  v_fma_f32 v98, v98, s30, -v8
  v_max3_f32 v3, v3, v96, v97
  v_mfma_f32_16x16x32_bf16 v[48:51], a[248:251], a[104:107], v[48:51]
  v_fma_f32 v99, v99, s30, -v8
  v_fma_f32 v100, v100, s30, -v8
  v_max3_f32 v3, v3, v98, v99
  v_fma_f32 v101, v101, s30, -v8
  v_mfma_f32_16x16x32_bf16 v[48:51], a[252:255], a[108:111], v[48:51]
  v_fma_f32 v102, v102, s30, -v8
  v_max3_f32 v3, v3, v100, v101
  v_fma_f32 v103, v103, s30, -v8
  v_mfma_f32_16x16x32_bf16 v[56:59], a[248:251], a[128:131], v[56:59]
  v_fma_f32 v104, v104, s30, -v9
  v_max3_f32 v3, v3, v102, v103
  v_fma_f32 v105, v105, s30, -v9
  v_mfma_f32_16x16x32_bf16 v[56:59], a[252:255], a[132:135], v[56:59]
  s_waitcnt lgkmcnt(0)
  v_fma_f32 v106, v106, s30, -v9
  v_max3_f32 v3, v3, v104, v105
  v_fma_f32 v107, v107, s30, -v9
  v_fma_f32 v108, v108, s30, -v9
  v_mfma_f32_16x16x32_bf16 v[16:19], a[240:243], a[16:19], v[16:19]
  ds_read_b128 a[248:251], v0 offset:30720
  v_max3_f32 v3, v3, v106, v107
  v_fma_f32 v109, v109, s30, -v9
  v_mfma_f32_16x16x32_bf16 v[16:19], a[244:247], a[20:23], v[16:19]
  ds_read_b128 a[252:255], v1 offset:30720
  v_fma_f32 v110, v110, s30, -v9
  v_max3_f32 v3, v3, v108, v109
  v_fma_f32 v111, v111, s30, -v9
  v_mfma_f32_16x16x32_bf16 v[24:27], a[240:243], a[40:43], v[24:27]
  s_add_u32 m0, s32, 49152
  v_max3_f32 v3, v3, v110, v111
  v_cmp_lt_f32 vcc, s31, v3
  v_mfma_f32_16x16x32_bf16 v[24:27], a[244:247], a[44:47], v[24:27]
  s_add_u32 s40, s36, 49152
  s_cbranch_vccnz L_slow_0_1
L_back_0_1:
  v_exp_f32 v64, v64
  v_mfma_f32_16x16x32_bf16 v[32:35], a[240:243], a[64:67], v[32:35]
  buffer_load_dwordx4 v12, s[16:19], s40 offen nt lds
  v_exp_f32 v65, v65
  v_mfma_f32_16x16x32_bf16 v[32:35], a[244:247], a[68:71], v[32:35]
  buffer_load_dwordx4 v13, s[16:19], s40 offen offset:1024 nt lds
  v_exp_f32 v66, v66
  v_mfma_f32_16x16x32_bf16 v[40:43], a[240:243], a[88:91], v[40:43]
  buffer_load_dwordx4 v14, s[16:19], s40 offen offset:2048 nt lds
  v_exp_f32 v67, v67
  v_mfma_f32_16x16x32_bf16 v[40:43], a[244:247], a[92:95], v[40:43]
  v_exp_f32 v68, v68
  v_cvt_pk_bf16_f32 v64, v64, v65
  v_mfma_f32_16x16x32_bf16 v[48:51], a[240:243], a[112:115], v[48:51]
  v_exp_f32 v69, v69
  v_accvgpr_write_b32 a168, v64
  v_mfma_f32_16x16x32_bf16 v[48:51], a[244:247], a[116:119], v[48:51]
  v_exp_f32 v70, v70
  v_cvt_pk_bf16_f32 v66, v66, v67
  v_mfma_f32_16x16x32_bf16 v[56:59], a[240:243], a[136:139], v[56:59]
  v_exp_f32 v71, v71
  v_accvgpr_write_b32 a169, v66
  v_mfma_f32_16x16x32_bf16 v[56:59], a[244:247], a[140:143], v[56:59]
  s_waitcnt lgkmcnt(0)
  v_exp_f32 v72, v72
  v_cvt_pk_bf16_f32 v68, v68, v69
  v_exp_f32 v73, v73
  v_mfma_f32_16x16x32_bf16 v[20:23], a[248:251], a[0:3], 0
  ds_read_b128 a[240:243], v0 offset:30848
  v_accvgpr_write_b32 a170, v68
  v_mfma_f32_16x16x32_bf16 v[20:23], a[252:255], a[4:7], v[20:23]
  ds_read_b128 a[244:247], v1 offset:30848
  v_exp_f32 v74, v74
  v_cvt_pk_bf16_f32 v70, v70, v71
  v_mfma_f32_16x16x32_bf16 v[28:31], a[248:251], a[24:27], 0
  v_exp_f32 v75, v75
  v_accvgpr_write_b32 a171, v70
  v_mfma_f32_16x16x32_bf16 v[28:31], a[252:255], a[28:31], v[28:31]
  v_exp_f32 v76, v76
  v_cvt_pk_bf16_f32 v72, v72, v73
  v_exp_f32 v77, v77
  v_mfma_f32_16x16x32_bf16 v[36:39], a[248:251], a[48:51], 0
  v_accvgpr_write_b32 a172, v72
  v_exp_f32 v78, v78
  v_mfma_f32_16x16x32_bf16 v[36:39], a[252:255], a[52:55], v[36:39]
  v_cvt_pk_bf16_f32 v74, v74, v75
  v_exp_f32 v79, v79
  v_mfma_f32_16x16x32_bf16 v[44:47], a[248:251], a[72:75], 0
  v_accvgpr_write_b32 a173, v74
  v_exp_f32 v80, v80
  v_mfma_f32_16x16x32_bf16 v[44:47], a[252:255], a[76:79], v[44:47]
  v_cvt_pk_bf16_f32 v76, v76, v77
  v_exp_f32 v81, v81
  v_accvgpr_write_b32 a174, v76
  v_mfma_f32_16x16x32_bf16 v[52:55], a[248:251], a[96:99], 0
  v_exp_f32 v82, v82
  v_cvt_pk_bf16_f32 v78, v78, v79
  v_mfma_f32_16x16x32_bf16 v[52:55], a[252:255], a[100:103], v[52:55]
  v_exp_f32 v83, v83
  v_accvgpr_write_b32 a175, v78
  v_mfma_f32_16x16x32_bf16 v[60:63], a[248:251], a[120:123], 0
  v_exp_f32 v84, v84
  v_cvt_pk_bf16_f32 v80, v80, v81
  v_mfma_f32_16x16x32_bf16 v[60:63], a[252:255], a[124:127], v[60:63]
  s_waitcnt lgkmcnt(0)
  v_exp_f32 v85, v85
  v_accvgpr_write_b32 a176, v80
  v_exp_f32 v86, v86
  v_mfma_f32_16x16x32_bf16 v[20:23], a[240:243], a[8:11], v[20:23]
  ds_read_b128 a[248:251], v0 offset:30976
  v_cvt_pk_bf16_f32 v82, v82, v83
  v_mfma_f32_16x16x32_bf16 v[20:23], a[244:247], a[12:15], v[20:23]
  ds_read_b128 a[252:255], v1 offset:30976
  v_exp_f32 v87, v87
  v_accvgpr_write_b32 a177, v82
  v_mfma_f32_16x16x32_bf16 v[28:31], a[240:243], a[32:35], v[28:31]
  v_exp_f32 v88, v88
  v_cvt_pk_bf16_f32 v84, v84, v85
  v_mfma_f32_16x16x32_bf16 v[28:31], a[244:247], a[36:39], v[28:31]
  v_exp_f32 v89, v89
  v_accvgpr_write_b32 a178, v84
  v_exp_f32 v90, v90
  v_mfma_f32_16x16x32_bf16 v[36:39], a[240:243], a[56:59], v[36:39]
  v_cvt_pk_bf16_f32 v86, v86, v87
  v_exp_f32 v91, v91
  v_mfma_f32_16x16x32_bf16 v[36:39], a[244:247], a[60:63], v[36:39]
  v_accvgpr_write_b32 a179, v86
  v_exp_f32 v92, v92
  v_mfma_f32_16x16x32_bf16 v[44:47], a[240:243], a[80:83], v[44:47]
  v_cvt_pk_bf16_f32 v88, v88, v89
  v_exp_f32 v93, v93
  v_mfma_f32_16x16x32_bf16 v[44:47], a[244:247], a[84:87], v[44:47]
  v_accvgpr_write_b32 a180, v88
  v_exp_f32 v94, v94
  v_cvt_pk_bf16_f32 v90, v90, v91
  v_mfma_f32_16x16x32_bf16 v[52:55], a[240:243], a[104:107], v[52:55]
  v_exp_f32 v95, v95
  v_accvgpr_write_b32 a181, v90
  v_mfma_f32_16x16x32_bf16 v[52:55], a[244:247], a[108:111], v[52:55]
  v_exp_f32 v96, v96
  v_cvt_pk_bf16_f32 v92, v92, v93
  v_mfma_f32_16x16x32_bf16 v[60:63], a[240:243], a[128:131], v[60:63]
  v_exp_f32 v97, v97
  v_accvgpr_write_b32 a182, v92
  v_mfma_f32_16x16x32_bf16 v[60:63], a[244:247], a[132:135], v[60:63]
  s_waitcnt vmcnt(3) lgkmcnt(0)
  s_barrier
  ds_read_b128 a[240:243], v0 offset:36864
  v_mfma_f32_16x16x32_bf16 v[20:23], a[248:251], a[16:19], v[20:23]
  ds_read_b128 a[244:247], v1 offset:36864
  v_exp_f32 v98, v98
  v_cvt_pk_bf16_f32 v94, v94, v95
  v_mfma_f32_16x16x32_bf16 v[20:23], a[252:255], a[20:23], v[20:23]
  v_exp_f32 v99, v99
  v_accvgpr_write_b32 a183, v94
  v_mfma_f32_16x16x32_bf16 v[28:31], a[248:251], a[40:43], v[28:31]
  v_exp_f32 v100, v100
  v_cvt_pk_bf16_f32 v96, v96, v97
  v_exp_f32 v101, v101
  v_mfma_f32_16x16x32_bf16 v[28:31], a[252:255], a[44:47], v[28:31]
  v_accvgpr_write_b32 a184, v96
  v_exp_f32 v102, v102
  v_mfma_f32_16x16x32_bf16 v[36:39], a[248:251], a[64:67], v[36:39]
  s_add_u32 m0, s32, 61440
  v_cvt_pk_bf16_f32 v98, v98, v99
  v_exp_f32 v103, v103
  v_mfma_f32_16x16x32_bf16 v[36:39], a[252:255], a[68:71], v[36:39]
  s_add_u32 s40, s36, 61440
  v_accvgpr_write_b32 a185, v98
  v_exp_f32 v104, v104
  v_mfma_f32_16x16x32_bf16 v[44:47], a[248:251], a[88:91], v[44:47]
  buffer_load_dwordx4 v12, s[16:19], s40 offen nt lds
  v_cvt_pk_bf16_f32 v100, v100, v101
  v_mfma_f32_16x16x32_bf16 v[44:47], a[252:255], a[92:95], v[44:47]
  buffer_load_dwordx4 v13, s[16:19], s40 offen offset:1024 nt lds
  v_exp_f32 v105, v105
  v_mfma_f32_16x16x32_bf16 v[52:55], a[248:251], a[112:115], v[52:55]
  buffer_load_dwordx4 v14, s[16:19], s40 offen offset:2048 nt lds
  v_accvgpr_write_b32 a186, v100
  v_mfma_f32_16x16x32_bf16 v[52:55], a[252:255], a[116:119], v[52:55]
  v_exp_f32 v106, v106
  v_cvt_pk_bf16_f32 v102, v102, v103
  v_mfma_f32_16x16x32_bf16 v[60:63], a[248:251], a[136:139], v[60:63]
  v_exp_f32 v107, v107
  v_accvgpr_write_b32 a187, v102
  v_mfma_f32_16x16x32_bf16 v[60:63], a[252:255], a[140:143], v[60:63]
  s_waitcnt lgkmcnt(0)
  v_exp_f32 v108, v108
  v_cvt_pk_bf16_f32 v104, v104, v105
  v_exp_f32 v109, v109
  v_mfma_f32_16x16x32_bf16 v[64:67], a[240:243], a[0:3], 0
  ds_read_b128 a[248:251], v0 offset:36992
  v_accvgpr_write_b32 a188, v104
  v_mfma_f32_16x16x32_bf16 v[64:67], a[244:247], a[4:7], v[64:67]
  ds_read_b128 a[252:255], v1 offset:36992
  v_exp_f32 v110, v110
  v_cvt_pk_bf16_f32 v106, v106, v107
  v_mfma_f32_16x16x32_bf16 v[72:75], a[240:243], a[24:27], 0
  v_exp_f32 v111, v111
  v_accvgpr_write_b32 a189, v106
  v_cvt_pk_bf16_f32 v108, v108, v109
  v_mfma_f32_16x16x32_bf16 v[72:75], a[244:247], a[28:31], v[72:75]
  v_accvgpr_write_b32 a190, v108
  v_cvt_pk_bf16_f32 v110, v110, v111
  v_accvgpr_write_b32 a191, v110
  v_mfma_f32_16x16x32_bf16 v[80:83], a[240:243], a[48:51], 0
  v_fma_f32 v16, v16, s30, -v4
  v_fma_f32 v17, v17, s30, -v4
  v_fma_f32 v18, v18, s30, -v4
  v_mfma_f32_16x16x32_bf16 v[80:83], a[244:247], a[52:55], v[80:83]
  v_max_f32 v3, v16, v17
  v_fma_f32 v19, v19, s30, -v4
  v_fma_f32 v20, v20, s30, -v4
  v_max3_f32 v3, v3, v18, v19
  v_mfma_f32_16x16x32_bf16 v[88:91], a[240:243], a[72:75], 0
  v_fma_f32 v21, v21, s30, -v4
  v_fma_f32 v22, v22, s30, -v4
  v_max3_f32 v3, v3, v20, v21
  v_mfma_f32_16x16x32_bf16 v[88:91], a[244:247], a[76:79], v[88:91]
  v_fma_f32 v23, v23, s30, -v4
  v_fma_f32 v24, v24, s30, -v5
  v_max3_f32 v3, v3, v22, v23
  v_fma_f32 v25, v25, s30, -v5
  v_mfma_f32_16x16x32_bf16 v[96:99], a[240:243], a[96:99], 0
  v_fma_f32 v26, v26, s30, -v5
  v_max3_f32 v3, v3, v24, v25
  v_fma_f32 v27, v27, s30, -v5
  v_mfma_f32_16x16x32_bf16 v[96:99], a[244:247], a[100:103], v[96:99]
  v_fma_f32 v28, v28, s30, -v5
  v_max3_f32 v3, v3, v26, v27
  v_fma_f32 v29, v29, s30, -v5
  v_mfma_f32_16x16x32_bf16 v[104:107], a[240:243], a[120:123], 0
  v_fma_f32 v30, v30, s30, -v5
  v_max3_f32 v3, v3, v28, v29
  v_fma_f32 v31, v31, s30, -v5
  v_fma_f32 v32, v32, s30, -v6
  v_mfma_f32_16x16x32_bf16 v[104:107], a[244:247], a[124:127], v[104:107]
  s_waitcnt lgkmcnt(0)
  v_max3_f32 v3, v3, v30, v31
  v_fma_f32 v33, v33, s30, -v6
  v_fma_f32 v34, v34, s30, -v6
  v_mfma_f32_16x16x32_bf16 v[64:67], a[248:251], a[8:11], v[64:67]
  ds_read_b128 a[240:243], v0 offset:37120
  v_max3_f32 v3, v3, v32, v33
  v_fma_f32 v35, v35, s30, -v6
  v_fma_f32 v36, v36, s30, -v6
  v_mfma_f32_16x16x32_bf16 v[64:67], a[252:255], a[12:15], v[64:67]
  ds_read_b128 a[244:247], v1 offset:37120
  v_max3_f32 v3, v3, v34, v35
  v_fma_f32 v37, v37, s30, -v6
  v_mfma_f32_16x16x32_bf16 v[72:75], a[248:251], a[32:35], v[72:75]
  v_fma_f32 v38, v38, s30, -v6
  v_max3_f32 v3, v3, v36, v37
  v_fma_f32 v39, v39, s30, -v6
  v_fma_f32 v40, v40, s30, -v7
  v_mfma_f32_16x16x32_bf16 v[72:75], a[252:255], a[36:39], v[72:75]
  v_max3_f32 v3, v3, v38, v39
  v_fma_f32 v41, v41, s30, -v7
  v_fma_f32 v42, v42, s30, -v7
  v_mfma_f32_16x16x32_bf16 v[80:83], a[248:251], a[56:59], v[80:83]
  v_max3_f32 v3, v3, v40, v41
  v_fma_f32 v43, v43, s30, -v7
  v_fma_f32 v44, v44, s30, -v7
  v_max3_f32 v3, v3, v42, v43
  v_mfma_f32_16x16x32_bf16 v[80:83], a[252:255], a[60:63], v[80:83]
  v_fma_f32 v45, v45, s30, -v7
  v_fma_f32 v46, v46, s30, -v7
  v_max3_f32 v3, v3, v44, v45
  v_mfma_f32_16x16x32_bf16 v[88:91], a[248:251], a[80:83], v[88:91]
  v_fma_f32 v47, v47, s30, -v7
  v_fma_f32 v48, v48, s30, -v8
  v_max3_f32 v3, v3, v46, v47
  v_mfma_f32_16x16x32_bf16 v[88:91], a[252:255], a[84:87], v[88:91]
  v_fma_f32 v49, v49, s30, -v8
  v_fma_f32 v50, v50, s30, -v8
  v_max3_f32 v3, v3, v48, v49
  v_fma_f32 v51, v51, s30, -v8
  v_mfma_f32_16x16x32_bf16 v[96:99], a[248:251], a[104:107], v[96:99]
  v_fma_f32 v52, v52, s30, -v8
  v_max3_f32 v3, v3, v50, v51
  v_fma_f32 v53, v53, s30, -v8
  v_mfma_f32_16x16x32_bf16 v[96:99], a[252:255], a[108:111], v[96:99]
  v_fma_f32 v54, v54, s30, -v8
  v_max3_f32 v3, v3, v52, v53
  v_fma_f32 v55, v55, s30, -v8
  v_fma_f32 v56, v56, s30, -v9
  v_mfma_f32_16x16x32_bf16 v[104:107], a[248:251], a[128:131], v[104:107]
  v_max3_f32 v3, v3, v54, v55
  v_fma_f32 v57, v57, s30, -v9
  v_fma_f32 v58, v58, s30, -v9
  v_mfma_f32_16x16x32_bf16 v[104:107], a[252:255], a[132:135], v[104:107]
  s_waitcnt lgkmcnt(0)
  v_max3_f32 v3, v3, v56, v57
  v_fma_f32 v59, v59, s30, -v9
  v_fma_f32 v60, v60, s30, -v9
  v_mfma_f32_16x16x32_bf16 v[64:67], a[240:243], a[16:19], v[64:67]
  ds_read_b128 a[248:251], v0 offset:43008
  v_max3_f32 v3, v3, v58, v59
  v_fma_f32 v61, v61, s30, -v9
  v_fma_f32 v62, v62, s30, -v9
  v_mfma_f32_16x16x32_bf16 v[64:67], a[244:247], a[20:23], v[64:67]
  ds_read_b128 a[252:255], v1 offset:43008
  v_max3_f32 v3, v3, v60, v61
  v_fma_f32 v63, v63, s30, -v9
  v_mfma_f32_16x16x32_bf16 v[72:75], a[240:243], a[40:43], v[72:75]
  s_add_u32 m0, s32, 73728
  v_max3_f32 v3, v3, v62, v63
  v_cmp_lt_f32 vcc, s31, v3
  v_mfma_f32_16x16x32_bf16 v[72:75], a[244:247], a[44:47], v[72:75]
  s_add_u32 s40, s36, 73728
  s_cbranch_vccnz L_slow_0_2
L_back_0_2:
  v_exp_f32 v16, v16
  v_exp_f32 v17, v17
  v_mfma_f32_16x16x32_bf16 v[80:83], a[240:243], a[64:67], v[80:83]
  buffer_load_dwordx4 v12, s[16:19], s40 offen nt lds
  v_mfma_f32_16x16x32_bf16 v[80:83], a[244:247], a[68:71], v[80:83]
  buffer_load_dwordx4 v13, s[16:19], s40 offen offset:1024 nt lds
  v_exp_f32 v18, v18
  v_mfma_f32_16x16x32_bf16 v[88:91], a[240:243], a[88:91], v[88:91]
  buffer_load_dwordx4 v14, s[16:19], s40 offen offset:2048 nt lds
  v_exp_f32 v19, v19
  v_mfma_f32_16x16x32_bf16 v[88:91], a[244:247], a[92:95], v[88:91]
  v_exp_f32 v20, v20
  v_cvt_pk_bf16_f32 v16, v16, v17
  v_mfma_f32_16x16x32_bf16 v[96:99], a[240:243], a[112:115], v[96:99]
  v_exp_f32 v21, v21
  v_accvgpr_write_b32 a192, v16
  v_mfma_f32_16x16x32_bf16 v[96:99], a[244:247], a[116:119], v[96:99]
  v_exp_f32 v22, v22
  v_cvt_pk_bf16_f32 v18, v18, v19
  v_exp_f32 v23, v23
  v_mfma_f32_16x16x32_bf16 v[104:107], a[240:243], a[136:139], v[104:107]
  v_accvgpr_write_b32 a193, v18
  v_exp_f32 v24, v24
  v_mfma_f32_16x16x32_bf16 v[104:107], a[244:247], a[140:143], v[104:107]
  s_waitcnt lgkmcnt(0)
  v_cvt_pk_bf16_f32 v20, v20, v21
  v_exp_f32 v25, v25
  v_mfma_f32_16x16x32_bf16 v[68:71], a[248:251], a[0:3], 0
  ds_read_b128 a[240:243], v0 offset:43136
  v_accvgpr_write_b32 a194, v20
  v_exp_f32 v26, v26
  v_mfma_f32_16x16x32_bf16 v[68:71], a[252:255], a[4:7], v[68:71]
  ds_read_b128 a[244:247], v1 offset:43136
  v_cvt_pk_bf16_f32 v22, v22, v23
  v_exp_f32 v27, v27
  v_mfma_f32_16x16x32_bf16 v[76:79], a[248:251], a[24:27], 0
  v_accvgpr_write_b32 a195, v22
  v_exp_f32 v28, v28
  v_mfma_f32_16x16x32_bf16 v[76:79], a[252:255], a[28:31], v[76:79]
  v_cvt_pk_bf16_f32 v24, v24, v25
  v_exp_f32 v29, v29
  v_mfma_f32_16x16x32_bf16 v[84:87], a[248:251], a[48:51], 0
  v_accvgpr_write_b32 a196, v24
  v_exp_f32 v30, v30
  v_mfma_f32_16x16x32_bf16 v[84:87], a[252:255], a[52:55], v[84:87]
  v_cvt_pk_bf16_f32 v26, v26, v27
  v_exp_f32 v31, v31
  v_accvgpr_write_b32 a197, v26
  v_mfma_f32_16x16x32_bf16 v[92:95], a[248:251], a[72:75], 0
  v_exp_f32 v32, v32
  v_cvt_pk_bf16_f32 v28, v28, v29
  v_mfma_f32_16x16x32_bf16 v[92:95], a[252:255], a[76:79], v[92:95]
  v_exp_f32 v33, v33
  v_accvgpr_write_b32 a198, v28
  v_mfma_f32_16x16x32_bf16 v[100:103], a[248:251], a[96:99], 0
  v_exp_f32 v34, v34
  v_cvt_pk_bf16_f32 v30, v30, v31
  v_exp_f32 v35, v35
  v_mfma_f32_16x16x32_bf16 v[100:103], a[252:255], a[100:103], v[100:103]
  v_accvgpr_write_b32 a199, v30
  v_exp_f32 v36, v36
  v_mfma_f32_16x16x32_bf16 v[108:111], a[248:251], a[120:123], 0
  v_cvt_pk_bf16_f32 v32, v32, v33
  v_exp_f32 v37, v37
  v_mfma_f32_16x16x32_bf16 v[108:111], a[252:255], a[124:127], v[108:111]
  s_waitcnt lgkmcnt(0)
  v_accvgpr_write_b32 a200, v32
  v_exp_f32 v38, v38
  v_cvt_pk_bf16_f32 v34, v34, v35
  v_mfma_f32_16x16x32_bf16 v[68:71], a[240:243], a[8:11], v[68:71]
  ds_read_b128 a[248:251], v0 offset:43264
  v_exp_f32 v39, v39
  v_mfma_f32_16x16x32_bf16 v[68:71], a[244:247], a[12:15], v[68:71]
  ds_read_b128 a[252:255], v1 offset:43264
  v_accvgpr_write_b32 a201, v34
  v_exp_f32 v40, v40
  v_mfma_f32_16x16x32_bf16 v[76:79], a[240:243], a[32:35], v[76:79]
  v_cvt_pk_bf16_f32 v36, v36, v37
  v_exp_f32 v41, v41
  v_mfma_f32_16x16x32_bf16 v[76:79], a[244:247], a[36:39], v[76:79]
  v_accvgpr_write_b32 a202, v36
  v_exp_f32 v42, v42
  v_mfma_f32_16x16x32_bf16 v[84:87], a[240:243], a[56:59], v[84:87]
  v_cvt_pk_bf16_f32 v38, v38, v39
  v_exp_f32 v43, v43
  v_accvgpr_write_b32 a203, v38
  v_mfma_f32_16x16x32_bf16 v[84:87], a[244:247], a[60:63], v[84:87]
  v_exp_f32 v44, v44
  v_cvt_pk_bf16_f32 v40, v40, v41
  v_mfma_f32_16x16x32_bf16 v[92:95], a[240:243], a[80:83], v[92:95]
  v_exp_f32 v45, v45
  v_accvgpr_write_b32 a204, v40
  v_mfma_f32_16x16x32_bf16 v[92:95], a[244:247], a[84:87], v[92:95]
  v_exp_f32 v46, v46
  v_cvt_pk_bf16_f32 v42, v42, v43
  v_exp_f32 v47, v47
  v_mfma_f32_16x16x32_bf16 v[100:103], a[240:243], a[104:107], v[100:103]
  v_add_u32 v0, 49152, v0
  v_accvgpr_write_b32 a205, v42
  v_mfma_f32_16x16x32_bf16 v[100:103], a[244:247], a[108:111], v[100:103]
  v_exp_f32 v48, v48
  v_cvt_pk_bf16_f32 v44, v44, v45
  v_exp_f32 v49, v49
  v_mfma_f32_16x16x32_bf16 v[108:111], a[240:243], a[128:131], v[108:111]
  v_add_u32 v1, 49152, v1
  v_accvgpr_write_b32 a206, v44
  v_mfma_f32_16x16x32_bf16 v[108:111], a[244:247], a[132:135], v[108:111]
  s_waitcnt vmcnt(6) lgkmcnt(0)
  s_barrier
  ds_read_b128 a[240:243], v0 offset:0
  v_mfma_f32_16x16x32_bf16 v[68:71], a[248:251], a[16:19], v[68:71]
  ds_read_b128 a[244:247], v1 offset:0
  v_exp_f32 v50, v50
  v_cvt_pk_bf16_f32 v46, v46, v47
  v_mfma_f32_16x16x32_bf16 v[68:71], a[252:255], a[20:23], v[68:71]
  v_exp_f32 v51, v51
  v_accvgpr_write_b32 a207, v46
  v_mfma_f32_16x16x32_bf16 v[76:79], a[248:251], a[40:43], v[76:79]
  v_exp_f32 v52, v52
  v_cvt_pk_bf16_f32 v48, v48, v49
  v_mfma_f32_16x16x32_bf16 v[76:79], a[252:255], a[44:47], v[76:79]
  v_exp_f32 v53, v53
  v_accvgpr_write_b32 a208, v48
  v_exp_f32 v54, v54
  v_mfma_f32_16x16x32_bf16 v[84:87], a[248:251], a[64:67], v[84:87]
  s_add_u32 m0, s32, 86016
  v_cvt_pk_bf16_f32 v50, v50, v51
  v_exp_f32 v55, v55
  v_mfma_f32_16x16x32_bf16 v[84:87], a[252:255], a[68:71], v[84:87]
  s_add_u32 s40, s36, 86016
  v_accvgpr_write_b32 a209, v50
  v_exp_f32 v56, v56
  v_mfma_f32_16x16x32_bf16 v[92:95], a[248:251], a[88:91], v[92:95]
  buffer_load_dwordx4 v12, s[16:19], s40 offen nt lds
  v_cvt_pk_bf16_f32 v52, v52, v53
  v_mfma_f32_16x16x32_bf16 v[92:95], a[252:255], a[92:95], v[92:95]
L_pad_1:
  s_cbranch_execz L_pad_5
  buffer_load_dwordx4 v13, s[16:19], s40 offen offset:1024 nt lds
  v_exp_f32 v57, v57
  v_mfma_f32_16x16x32_bf16 v[100:103], a[248:251], a[112:115], v[100:103]
  buffer_load_dwordx4 v14, s[16:19], s40 offen offset:2048 nt lds
  v_accvgpr_write_b32 a210, v52
  v_mfma_f32_16x16x32_bf16 v[100:103], a[252:255], a[116:119], v[100:103]
  v_exp_f32 v58, v58
  v_cvt_pk_bf16_f32 v54, v54, v55
  v_mfma_f32_16x16x32_bf16 v[108:111], a[248:251], a[136:139], v[108:111]
  v_exp_f32 v59, v59
  v_accvgpr_write_b32 a211, v54
  v_mfma_f32_16x16x32_bf16 v[108:111], a[252:255], a[140:143], v[108:111]
  s_waitcnt lgkmcnt(0)
  v_exp_f32 v60, v60
  v_cvt_pk_bf16_f32 v56, v56, v57
  v_exp_f32 v61, v61
  v_mfma_f32_16x16x32_bf16 v[16:19], a[240:243], a[0:3], 0
  ds_read_b128 a[248:251], v0 offset:128
  v_accvgpr_write_b32 a212, v56
  v_mfma_f32_16x16x32_bf16 v[16:19], a[244:247], a[4:7], v[16:19]
  ds_read_b128 a[252:255], v1 offset:128
  v_exp_f32 v62, v62
  v_cvt_pk_bf16_f32 v58, v58, v59
  v_mfma_f32_16x16x32_bf16 v[24:27], a[240:243], a[24:27], 0
  v_exp_f32 v63, v63
  v_accvgpr_write_b32 a213, v58
  v_cvt_pk_bf16_f32 v60, v60, v61
  v_mfma_f32_16x16x32_bf16 v[24:27], a[244:247], a[28:31], v[24:27]
  v_accvgpr_write_b32 a214, v60
  v_cvt_pk_bf16_f32 v62, v62, v63
  v_accvgpr_write_b32 a215, v62
  v_mfma_f32_16x16x32_bf16 v[32:35], a[240:243], a[48:51], 0
  v_fma_f32 v64, v64, s30, -v4
  v_fma_f32 v65, v65, s30, -v4
  v_fma_f32 v66, v66, s30, -v4
  v_mfma_f32_16x16x32_bf16 v[32:35], a[244:247], a[52:55], v[32:35]
  v_max_f32 v3, v64, v65
  v_fma_f32 v67, v67, s30, -v4
  v_fma_f32 v68, v68, s30, -v4
  v_max3_f32 v3, v3, v66, v67
  v_mfma_f32_16x16x32_bf16 v[40:43], a[240:243], a[72:75], 0
  v_fma_f32 v69, v69, s30, -v4
  v_fma_f32 v70, v70, s30, -v4
  v_max3_f32 v3, v3, v68, v69
  v_mfma_f32_16x16x32_bf16 v[40:43], a[244:247], a[76:79], v[40:43]
  v_fma_f32 v71, v71, s30, -v4
  v_fma_f32 v72, v72, s30, -v5
  v_max3_f32 v3, v3, v70, v71
  v_fma_f32 v73, v73, s30, -v5
  v_mfma_f32_16x16x32_bf16 v[48:51], a[240:243], a[96:99], 0
  v_fma_f32 v74, v74, s30, -v5
  v_max3_f32 v3, v3, v72, v73
  v_fma_f32 v75, v75, s30, -v5
  v_mfma_f32_16x16x32_bf16 v[48:51], a[244:247], a[100:103], v[48:51]
  v_fma_f32 v76, v76, s30, -v5
  v_max3_f32 v3, v3, v74, v75
  v_fma_f32 v77, v77, s30, -v5
  v_mfma_f32_16x16x32_bf16 v[56:59], a[240:243], a[120:123], 0
  v_fma_f32 v78, v78, s30, -v5
  v_max3_f32 v3, v3, v76, v77
  v_fma_f32 v79, v79, s30, -v5
  v_fma_f32 v80, v80, s30, -v6
  v_mfma_f32_16x16x32_bf16 v[56:59], a[244:247], a[124:127], v[56:59]
  s_waitcnt lgkmcnt(0)
  v_max3_f32 v3, v3, v78, v79
  v_fma_f32 v81, v81, s30, -v6
  v_fma_f32 v82, v82, s30, -v6
  v_mfma_f32_16x16x32_bf16 v[16:19], a[248:251], a[8:11], v[16:19]
  ds_read_b128 a[240:243], v0 offset:256
  v_max3_f32 v3, v3, v80, v81
  v_fma_f32 v83, v83, s30, -v6
  v_fma_f32 v84, v84, s30, -v6
  v_mfma_f32_16x16x32_bf16 v[16:19], a[252:255], a[12:15], v[16:19]
  ds_read_b128 a[244:247], v1 offset:256
  v_max3_f32 v3, v3, v82, v83
  v_fma_f32 v85, v85, s30, -v6
  v_mfma_f32_16x16x32_bf16 v[24:27], a[248:251], a[32:35], v[24:27]
  v_fma_f32 v86, v86, s30, -v6
  v_max3_f32 v3, v3, v84, v85
  v_fma_f32 v87, v87, s30, -v6
  v_mfma_f32_16x16x32_bf16 v[24:27], a[252:255], a[36:39], v[24:27]
  v_fma_f32 v88, v88, s30, -v7
  v_max3_f32 v3, v3, v86, v87
  v_fma_f32 v89, v89, s30, -v7
  v_fma_f32 v90, v90, s30, -v7
  v_mfma_f32_16x16x32_bf16 v[32:35], a[248:251], a[56:59], v[32:35]
  v_max3_f32 v3, v3, v88, v89
  v_fma_f32 v91, v91, s30, -v7
  v_fma_f32 v92, v92, s30, -v7
  v_mfma_f32_16x16x32_bf16 v[32:35], a[252:255], a[60:63], v[32:35]
  v_max3_f32 v3, v3, v90, v91
  v_fma_f32 v93, v93, s30, -v7
  v_fma_f32 v94, v94, s30, -v7
  v_max3_f32 v3, v3, v92, v93
  v_mfma_f32_16x16x32_bf16 v[40:43], a[248:251], a[80:83], v[40:43]
  v_fma_f32 v95, v95, s30, -v7
  v_fma_f32 v96, v96, s30, -v8
  v_max3_f32 v3, v3, v94, v95
  v_mfma_f32_16x16x32_bf16 v[40:43], a[252:255], a[84:87], v[40:43]
  v_fma_f32 v97, v97, s30, -v8
  v_fma_f32 v98, v98, s30, -v8
  v_max3_f32 v3, v3, v96, v97
  v_mfma_f32_16x16x32_bf16 v[48:51], a[248:251], a[104:107], v[48:51]
  v_fma_f32 v99, v99, s30, -v8
  v_fma_f32 v100, v100, s30, -v8
  v_max3_f32 v3, v3, v98, v99
  v_fma_f32 v101, v101, s30, -v8
  v_mfma_f32_16x16x32_bf16 v[48:51], a[252:255], a[108:111], v[48:51]
  v_fma_f32 v102, v102, s30, -v8
  v_max3_f32 v3, v3, v100, v101
  v_fma_f32 v103, v103, s30, -v8
  v_mfma_f32_16x16x32_bf16 v[56:59], a[248:251], a[128:131], v[56:59]
  v_fma_f32 v104, v104, s30, -v9
  v_max3_f32 v3, v3, v102, v103
  v_fma_f32 v105, v105, s30, -v9
  v_mfma_f32_16x16x32_bf16 v[56:59], a[252:255], a[132:135], v[56:59]
  s_waitcnt lgkmcnt(0)
  v_fma_f32 v106, v106, s30, -v9
  v_max3_f32 v3, v3, v104, v105
  v_fma_f32 v107, v107, s30, -v9
  v_fma_f32 v108, v108, s30, -v9
  v_mfma_f32_16x16x32_bf16 v[16:19], a[240:243], a[16:19], v[16:19]
  ds_read_b128 a[248:251], v0 offset:6144
  v_max3_f32 v3, v3, v106, v107
  v_fma_f32 v109, v109, s30, -v9
  v_mfma_f32_16x16x32_bf16 v[16:19], a[244:247], a[20:23], v[16:19]
  ds_read_b128 a[252:255], v1 offset:6144
  v_fma_f32 v110, v110, s30, -v9
  v_max3_f32 v3, v3, v108, v109
  v_fma_f32 v111, v111, s30, -v9
  v_mfma_f32_16x16x32_bf16 v[24:27], a[240:243], a[40:43], v[24:27]
  s_add_u32 m0, s32, 98304
  v_max3_f32 v3, v3, v110, v111
  v_cmp_lt_f32 vcc, s31, v3
  v_mfma_f32_16x16x32_bf16 v[24:27], a[244:247], a[44:47], v[24:27]
  s_add_u32 s40, s36, 98304
  s_cbranch_vccnz L_slow_0_3
L_back_0_3:
  v_exp_f32 v64, v64
  v_mfma_f32_16x16x32_bf16 v[32:35], a[240:243], a[64:67], v[32:35]
  buffer_load_dwordx4 v12, s[16:19], s40 offen nt lds
  v_exp_f32 v65, v65
  v_mfma_f32_16x16x32_bf16 v[32:35], a[244:247], a[68:71], v[32:35]
  buffer_load_dwordx4 v13, s[16:19], s40 offen offset:1024 nt lds
  v_exp_f32 v66, v66
  v_mfma_f32_16x16x32_bf16 v[40:43], a[240:243], a[88:91], v[40:43]
  buffer_load_dwordx4 v14, s[16:19], s40 offen offset:2048 nt lds
  v_exp_f32 v67, v67
  v_mfma_f32_16x16x32_bf16 v[40:43], a[244:247], a[92:95], v[40:43]
  v_exp_f32 v68, v68
  v_cvt_pk_bf16_f32 v64, v64, v65
  v_mfma_f32_16x16x32_bf16 v[48:51], a[240:243], a[112:115], v[48:51]
  v_exp_f32 v69, v69
  v_accvgpr_write_b32 a216, v64
  v_mfma_f32_16x16x32_bf16 v[48:51], a[244:247], a[116:119], v[48:51]
  v_exp_f32 v70, v70
  v_cvt_pk_bf16_f32 v66, v66, v67
  v_mfma_f32_16x16x32_bf16 v[56:59], a[240:243], a[136:139], v[56:59]
  v_exp_f32 v71, v71
  v_accvgpr_write_b32 a217, v66
  v_mfma_f32_16x16x32_bf16 v[56:59], a[244:247], a[140:143], v[56:59]
  s_waitcnt lgkmcnt(0)
  v_exp_f32 v72, v72
  v_cvt_pk_bf16_f32 v68, v68, v69
  v_exp_f32 v73, v73
  v_mfma_f32_16x16x32_bf16 v[20:23], a[248:251], a[0:3], 0
  ds_read_b128 a[240:243], v0 offset:6272
  v_accvgpr_write_b32 a218, v68
  v_mfma_f32_16x16x32_bf16 v[20:23], a[252:255], a[4:7], v[20:23]
  ds_read_b128 a[244:247], v1 offset:6272
  v_exp_f32 v74, v74
  v_cvt_pk_bf16_f32 v70, v70, v71
  v_mfma_f32_16x16x32_bf16 v[28:31], a[248:251], a[24:27], 0
  v_exp_f32 v75, v75
  v_accvgpr_write_b32 a219, v70
  v_mfma_f32_16x16x32_bf16 v[28:31], a[252:255], a[28:31], v[28:31]
  v_exp_f32 v76, v76
  v_cvt_pk_bf16_f32 v72, v72, v73
  v_exp_f32 v77, v77
  v_mfma_f32_16x16x32_bf16 v[36:39], a[248:251], a[48:51], 0
  v_accvgpr_write_b32 a220, v72
  v_exp_f32 v78, v78
  v_mfma_f32_16x16x32_bf16 v[36:39], a[252:255], a[52:55], v[36:39]
  v_cvt_pk_bf16_f32 v74, v74, v75
  v_exp_f32 v79, v79
  v_mfma_f32_16x16x32_bf16 v[44:47], a[248:251], a[72:75], 0
  v_accvgpr_write_b32 a221, v74
  v_exp_f32 v80, v80
  v_mfma_f32_16x16x32_bf16 v[44:47], a[252:255], a[76:79], v[44:47]
  v_cvt_pk_bf16_f32 v76, v76, v77
  v_exp_f32 v81, v81
  v_accvgpr_write_b32 a222, v76
  v_mfma_f32_16x16x32_bf16 v[52:55], a[248:251], a[96:99], 0
  v_exp_f32 v82, v82
  v_cvt_pk_bf16_f32 v78, v78, v79
  v_mfma_f32_16x16x32_bf16 v[52:55], a[252:255], a[100:103], v[52:55]
  v_exp_f32 v83, v83
  v_accvgpr_write_b32 a223, v78
  v_mfma_f32_16x16x32_bf16 v[60:63], a[248:251], a[120:123], 0
  v_exp_f32 v84, v84
  v_cvt_pk_bf16_f32 v80, v80, v81
  v_mfma_f32_16x16x32_bf16 v[60:63], a[252:255], a[124:127], v[60:63]
  s_waitcnt lgkmcnt(0)
  v_exp_f32 v85, v85
  v_accvgpr_write_b32 a224, v80
  v_exp_f32 v86, v86
  v_mfma_f32_16x16x32_bf16 v[20:23], a[240:243], a[8:11], v[20:23]
  ds_read_b128 a[248:251], v0 offset:6400
  v_cvt_pk_bf16_f32 v82, v82, v83
  v_mfma_f32_16x16x32_bf16 v[20:23], a[244:247], a[12:15], v[20:23]
  ds_read_b128 a[252:255], v1 offset:6400
  v_exp_f32 v87, v87
  v_accvgpr_write_b32 a225, v82
  v_mfma_f32_16x16x32_bf16 v[28:31], a[240:243], a[32:35], v[28:31]
  v_exp_f32 v88, v88
  v_cvt_pk_bf16_f32 v84, v84, v85
  v_mfma_f32_16x16x32_bf16 v[28:31], a[244:247], a[36:39], v[28:31]
  v_exp_f32 v89, v89
  v_accvgpr_write_b32 a226, v84
  v_exp_f32 v90, v90
  v_mfma_f32_16x16x32_bf16 v[36:39], a[240:243], a[56:59], v[36:39]
  v_cvt_pk_bf16_f32 v86, v86, v87
  v_exp_f32 v91, v91
  v_mfma_f32_16x16x32_bf16 v[36:39], a[244:247], a[60:63], v[36:39]
  v_accvgpr_write_b32 a227, v86
  v_exp_f32 v92, v92
  v_mfma_f32_16x16x32_bf16 v[44:47], a[240:243], a[80:83], v[44:47]
  v_cvt_pk_bf16_f32 v88, v88, v89
  v_exp_f32 v93, v93
  v_mfma_f32_16x16x32_bf16 v[44:47], a[244:247], a[84:87], v[44:47]
  v_accvgpr_write_b32 a228, v88
  v_exp_f32 v94, v94
  v_cvt_pk_bf16_f32 v90, v90, v91
  v_mfma_f32_16x16x32_bf16 v[52:55], a[240:243], a[104:107], v[52:55]
  v_exp_f32 v95, v95
  v_accvgpr_write_b32 a229, v90
  v_mfma_f32_16x16x32_bf16 v[52:55], a[244:247], a[108:111], v[52:55]
  v_exp_f32 v96, v96
  v_cvt_pk_bf16_f32 v92, v92, v93
  v_mfma_f32_16x16x32_bf16 v[60:63], a[240:243], a[128:131], v[60:63]
  v_exp_f32 v97, v97
  v_accvgpr_write_b32 a230, v92
  v_mfma_f32_16x16x32_bf16 v[60:63], a[244:247], a[132:135], v[60:63]
  s_waitcnt vmcnt(9) lgkmcnt(0)
  s_barrier
  ds_read_b128 a[240:243], v0 offset:12288
  v_mfma_f32_16x16x32_bf16 v[20:23], a[248:251], a[16:19], v[20:23]
  ds_read_b128 a[244:247], v1 offset:12288
  v_exp_f32 v98, v98
  v_cvt_pk_bf16_f32 v94, v94, v95
  v_mfma_f32_16x16x32_bf16 v[20:23], a[252:255], a[20:23], v[20:23]
  v_exp_f32 v99, v99
  v_accvgpr_write_b32 a231, v94
  v_mfma_f32_16x16x32_bf16 v[28:31], a[248:251], a[40:43], v[28:31]
  v_exp_f32 v100, v100
  v_cvt_pk_bf16_f32 v96, v96, v97
  v_exp_f32 v101, v101
  v_mfma_f32_16x16x32_bf16 v[28:31], a[252:255], a[44:47], v[28:31]
  v_accvgpr_write_b32 a232, v96
  v_exp_f32 v102, v102
  v_mfma_f32_16x16x32_bf16 v[36:39], a[248:251], a[64:67], v[36:39]
  s_add_u32 m0, s32, 110592
  v_cvt_pk_bf16_f32 v98, v98, v99
  v_exp_f32 v103, v103
  v_mfma_f32_16x16x32_bf16 v[36:39], a[252:255], a[68:71], v[36:39]
  s_add_u32 s40, s36, 110592
  v_accvgpr_write_b32 a233, v98
  v_exp_f32 v104, v104
  v_mfma_f32_16x16x32_bf16 v[44:47], a[248:251], a[88:91], v[44:47]
  buffer_load_dwordx4 v12, s[16:19], s40 offen nt lds
  v_cvt_pk_bf16_f32 v100, v100, v101
  v_mfma_f32_16x16x32_bf16 v[44:47], a[252:255], a[92:95], v[44:47]
  buffer_load_dwordx4 v13, s[16:19], s40 offen offset:1024 nt lds
  v_exp_f32 v105, v105
  v_mfma_f32_16x16x32_bf16 v[52:55], a[248:251], a[112:115], v[52:55]
  buffer_load_dwordx4 v14, s[16:19], s40 offen offset:2048 nt lds
  v_accvgpr_write_b32 a234, v100
  v_mfma_f32_16x16x32_bf16 v[52:55], a[252:255], a[116:119], v[52:55]
  v_exp_f32 v106, v106
  v_cvt_pk_bf16_f32 v102, v102, v103
  v_mfma_f32_16x16x32_bf16 v[60:63], a[248:251], a[136:139], v[60:63]
  v_exp_f32 v107, v107
  v_accvgpr_write_b32 a235, v102
  v_mfma_f32_16x16x32_bf16 v[60:63], a[252:255], a[140:143], v[60:63]
  s_waitcnt lgkmcnt(0)
  v_exp_f32 v108, v108
  v_cvt_pk_bf16_f32 v104, v104, v105
  v_exp_f32 v109, v109
  v_mfma_f32_16x16x32_bf16 v[64:67], a[240:243], a[0:3], 0
  ds_read_b128 a[248:251], v0 offset:12416
  v_accvgpr_write_b32 a236, v104
  v_mfma_f32_16x16x32_bf16 v[64:67], a[244:247], a[4:7], v[64:67]
  ds_read_b128 a[252:255], v1 offset:12416
  v_exp_f32 v110, v110
  v_cvt_pk_bf16_f32 v106, v106, v107
  v_mfma_f32_16x16x32_bf16 v[72:75], a[240:243], a[24:27], 0
  v_exp_f32 v111, v111
  v_accvgpr_write_b32 a237, v106
  v_cvt_pk_bf16_f32 v108, v108, v109
  v_mfma_f32_16x16x32_bf16 v[72:75], a[244:247], a[28:31], v[72:75]
  v_accvgpr_write_b32 a238, v108
  v_cvt_pk_bf16_f32 v110, v110, v111
  v_accvgpr_write_b32 a239, v110
  v_mfma_f32_16x16x32_bf16 v[80:83], a[240:243], a[48:51], 0
  v_fma_f32 v16, v16, s30, -v4
  v_fma_f32 v17, v17, s30, -v4
  v_fma_f32 v18, v18, s30, -v4
  v_mfma_f32_16x16x32_bf16 v[80:83], a[244:247], a[52:55], v[80:83]
  v_max_f32 v3, v16, v17
  v_fma_f32 v19, v19, s30, -v4
  v_fma_f32 v20, v20, s30, -v4
  v_mfma_f32_16x16x32_bf16 v[88:91], a[240:243], a[72:75], 0
  v_max3_f32 v3, v3, v18, v19
  v_fma_f32 v21, v21, s30, -v4
  v_fma_f32 v22, v22, s30, -v4
  v_mfma_f32_16x16x32_bf16 v[88:91], a[244:247], a[76:79], v[88:91]
  v_max3_f32 v3, v3, v20, v21
  v_fma_f32 v23, v23, s30, -v4
  v_fma_f32 v24, v24, s30, -v5
  v_mfma_f32_16x16x32_bf16 v[96:99], a[240:243], a[96:99], 0
  v_max3_f32 v3, v3, v22, v23
  v_fma_f32 v25, v25, s30, -v5
  v_fma_f32 v26, v26, s30, -v5
  v_mfma_f32_16x16x32_bf16 v[96:99], a[244:247], a[100:103], v[96:99]
  v_max3_f32 v3, v3, v24, v25
  v_fma_f32 v27, v27, s30, -v5
  v_fma_f32 v28, v28, s30, -v5
  v_mfma_f32_16x16x32_bf16 v[104:107], a[240:243], a[120:123], 0
  v_max3_f32 v3, v3, v26, v27
  v_fma_f32 v29, v29, s30, -v5
  v_fma_f32 v30, v30, s30, -v5
  v_mfma_f32_16x16x32_bf16 v[104:107], a[244:247], a[124:127], v[104:107]
  s_waitcnt lgkmcnt(0)
  v_max3_f32 v3, v3, v28, v29
  v_fma_f32 v31, v31, s30, -v5
  v_fma_f32 v32, v32, s30, -v6
  v_mfma_f32_16x16x32_bf16 v[64:67], a[248:251], a[8:11], v[64:67]
  ds_read_b128 a[240:243], v0 offset:12544
  v_max3_f32 v3, v3, v30, v31
  v_fma_f32 v33, v33, s30, -v6
  v_fma_f32 v34, v34, s30, -v6
  v_mfma_f32_16x16x32_bf16 v[64:67], a[252:255], a[12:15], v[64:67]
  ds_read_b128 a[244:247], v1 offset:12544
  v_max3_f32 v3, v3, v32, v33
  v_fma_f32 v35, v35, s30, -v6
  v_mfma_f32_16x16x32_bf16 v[72:75], a[248:251], a[32:35], v[72:75]
  v_fma_f32 v36, v36, s30, -v6
  v_max3_f32 v3, v3, v34, v35
  v_fma_f32 v37, v37, s30, -v6
  v_mfma_f32_16x16x32_bf16 v[72:75], a[252:255], a[36:39], v[72:75]
  v_fma_f32 v38, v38, s30, -v6
  v_max3_f32 v3, v3, v36, v37
  v_fma_f32 v39, v39, s30, -v6
  v_mfma_f32_16x16x32_bf16 v[80:83], a[248:251], a[56:59], v[80:83]
  v_fma_f32 v40, v40, s30, -v7
  v_max3_f32 v3, v3, v38, v39
  v_fma_f32 v41, v41, s30, -v7
  v_mfma_f32_16x16x32_bf16 v[80:83], a[252:255], a[60:63], v[80:83]
  v_fma_f32 v42, v42, s30, -v7
  v_max3_f32 v3, v3, v40, v41
  v_fma_f32 v43, v43, s30, -v7
  v_mfma_f32_16x16x32_bf16 v[88:91], a[248:251], a[80:83], v[88:91]
  v_fma_f32 v44, v44, s30, -v7
  v_max3_f32 v3, v3, v42, v43
  v_fma_f32 v45, v45, s30, -v7
  v_mfma_f32_16x16x32_bf16 v[88:91], a[252:255], a[84:87], v[88:91]
  v_fma_f32 v46, v46, s30, -v7
  v_max3_f32 v3, v3, v44, v45
  v_fma_f32 v47, v47, s30, -v7
  v_mfma_f32_16x16x32_bf16 v[96:99], a[248:251], a[104:107], v[96:99]
  v_fma_f32 v48, v48, s30, -v8
  v_max3_f32 v3, v3, v46, v47
  v_fma_f32 v49, v49, s30, -v8
  v_mfma_f32_16x16x32_bf16 v[96:99], a[252:255], a[108:111], v[96:99]
  v_fma_f32 v50, v50, s30, -v8
  v_max3_f32 v3, v3, v48, v49
  v_fma_f32 v51, v51, s30, -v8
  v_mfma_f32_16x16x32_bf16 v[104:107], a[248:251], a[128:131], v[104:107]
  v_fma_f32 v52, v52, s30, -v8
  v_max3_f32 v3, v3, v50, v51
  v_fma_f32 v53, v53, s30, -v8
  v_mfma_f32_16x16x32_bf16 v[104:107], a[252:255], a[132:135], v[104:107]
  s_waitcnt lgkmcnt(0)
  v_fma_f32 v54, v54, s30, -v8
  v_max3_f32 v3, v3, v52, v53
  v_fma_f32 v55, v55, s30, -v8
  v_mfma_f32_16x16x32_bf16 v[64:67], a[240:243], a[16:19], v[64:67]
  ds_read_b128 a[248:251], v0 offset:18432
  v_fma_f32 v56, v56, s30, -v9
  v_max3_f32 v3, v3, v54, v55
  v_mfma_f32_16x16x32_bf16 v[64:67], a[244:247], a[20:23], v[64:67]
  ds_read_b128 a[252:255], v1 offset:18432
  v_fma_f32 v57, v57, s30, -v9
  v_fma_f32 v58, v58, s30, -v9
  v_mfma_f32_16x16x32_bf16 v[72:75], a[240:243], a[40:43], v[72:75]
  s_add_u32 m0, s32, 122880
  v_max3_f32 v3, v3, v56, v57
  v_fma_f32 v59, v59, s30, -v9
  v_fma_f32 v60, v60, s30, -v9
  v_mfma_f32_16x16x32_bf16 v[72:75], a[244:247], a[44:47], v[72:75]
  s_add_u32 s40, s36, 122880
  v_max3_f32 v3, v3, v58, v59
  v_fma_f32 v61, v61, s30, -v9
  v_mfma_f32_16x16x32_bf16 v[80:83], a[240:243], a[64:67], v[80:83]
  buffer_load_dwordx4 v12, s[16:19], s40 offen nt lds
  v_fma_f32 v62, v62, s30, -v9
  v_max3_f32 v3, v3, v60, v61
  v_mfma_f32_16x16x32_bf16 v[80:83], a[244:247], a[68:71], v[80:83]
  buffer_load_dwordx4 v13, s[16:19], s40 offen offset:1024 nt lds
  v_fma_f32 v63, v63, s30, -v9
  v_mfma_f32_16x16x32_bf16 v[88:91], a[240:243], a[88:91], v[88:91]
  buffer_load_dwordx4 v14, s[16:19], s40 offen offset:2048 nt lds
  v_max3_f32 v3, v3, v62, v63
  v_mfma_f32_16x16x32_bf16 v[88:91], a[244:247], a[92:95], v[88:91]
  v_cmp_lt_f32 vcc, s31, v3
  v_mfma_f32_16x16x32_bf16 v[96:99], a[240:243], a[112:115], v[96:99]
  s_cbranch_vccnz L_slow_0_4
L_back_0_4:
  v_exp_f32 v16, v16
  v_exp_f32 v17, v17
  v_mfma_f32_16x16x32_bf16 v[96:99], a[244:247], a[116:119], v[96:99]
  v_exp_f32 v18, v18
  v_exp_f32 v19, v19
  v_mfma_f32_16x16x32_bf16 v[104:107], a[240:243], a[136:139], v[104:107]
  v_exp_f32 v20, v20
  v_mfma_f32_16x16x32_bf16 v[104:107], a[244:247], a[140:143], v[104:107]
  s_waitcnt lgkmcnt(0)
  v_cvt_pk_bf16_f32 v112, v16, v17
  v_exp_f32 v21, v21
  v_mfma_f32_16x16x32_bf16 v[68:71], a[248:251], a[0:3], 0
  ds_read_b128 a[240:243], v0 offset:18560
  v_exp_f32 v22, v22
  v_mfma_f32_16x16x32_bf16 v[68:71], a[252:255], a[4:7], v[68:71]
  ds_read_b128 a[244:247], v1 offset:18560
  v_cvt_pk_bf16_f32 v113, v18, v19
  v_exp_f32 v23, v23
  v_mfma_f32_16x16x32_bf16 v[76:79], a[248:251], a[24:27], 0
  v_exp_f32 v24, v24
  v_cvt_pk_bf16_f32 v114, v20, v21
  v_mfma_f32_16x16x32_bf16 v[76:79], a[252:255], a[28:31], v[76:79]
  v_exp_f32 v25, v25
  v_mfma_f32_16x16x32_bf16 v[84:87], a[248:251], a[48:51], 0
  v_exp_f32 v26, v26
  v_cvt_pk_bf16_f32 v115, v22, v23
  v_mfma_f32_16x16x32_bf16 v[84:87], a[252:255], a[52:55], v[84:87]
  v_exp_f32 v27, v27
  v_exp_f32 v28, v28
  v_mfma_f32_16x16x32_bf16 v[92:95], a[248:251], a[72:75], 0
  v_cvt_pk_bf16_f32 v116, v24, v25
  v_exp_f32 v29, v29
  v_mfma_f32_16x16x32_bf16 v[92:95], a[252:255], a[76:79], v[92:95]
  v_exp_f32 v30, v30
  v_cvt_pk_bf16_f32 v117, v26, v27
  v_mfma_f32_16x16x32_bf16 v[100:103], a[248:251], a[96:99], 0
  v_exp_f32 v31, v31
  v_exp_f32 v32, v32
  v_mfma_f32_16x16x32_bf16 v[100:103], a[252:255], a[100:103], v[100:103]
  v_cvt_pk_bf16_f32 v118, v28, v29
  v_exp_f32 v33, v33
  v_mfma_f32_16x16x32_bf16 v[108:111], a[248:251], a[120:123], 0
  v_exp_f32 v34, v34
  v_mfma_f32_16x16x32_bf16 v[108:111], a[252:255], a[124:127], v[108:111]
  s_waitcnt lgkmcnt(0)
  v_cvt_pk_bf16_f32 v119, v30, v31
  v_exp_f32 v35, v35
  v_mfma_f32_16x16x32_bf16 v[68:71], a[240:243], a[8:11], v[68:71]
  ds_read_b128 a[248:251], v0 offset:18688
  v_exp_f32 v36, v36
  v_cvt_pk_bf16_f32 v120, v32, v33
  v_mfma_f32_16x16x32_bf16 v[68:71], a[244:247], a[12:15], v[68:71]
  ds_read_b128 a[252:255], v1 offset:18688
  v_exp_f32 v37, v37
  v_mfma_f32_16x16x32_bf16 v[76:79], a[240:243], a[32:35], v[76:79]
  v_exp_f32 v38, v38
  v_cvt_pk_bf16_f32 v121, v34, v35
  v_mfma_f32_16x16x32_bf16 v[76:79], a[244:247], a[36:39], v[76:79]
  v_exp_f32 v39, v39
  v_mfma_f32_16x16x32_bf16 v[84:87], a[240:243], a[56:59], v[84:87]
  v_exp_f32 v40, v40
  v_cvt_pk_bf16_f32 v122, v36, v37
  v_mfma_f32_16x16x32_bf16 v[84:87], a[244:247], a[60:63], v[84:87]
  v_exp_f32 v41, v41
  v_exp_f32 v42, v42
  v_mfma_f32_16x16x32_bf16 v[92:95], a[240:243], a[80:83], v[92:95]
  v_cvt_pk_bf16_f32 v123, v38, v39
  v_exp_f32 v43, v43
  v_mfma_f32_16x16x32_bf16 v[92:95], a[244:247], a[84:87], v[92:95]
  v_exp_f32 v44, v44
  v_cvt_pk_bf16_f32 v124, v40, v41
  v_mfma_f32_16x16x32_bf16 v[100:103], a[240:243], a[104:107], v[100:103]
  v_exp_f32 v45, v45
  v_exp_f32 v46, v46
  v_mfma_f32_16x16x32_bf16 v[100:103], a[244:247], a[108:111], v[100:103]
  v_cvt_pk_bf16_f32 v125, v42, v43
  v_exp_f32 v47, v47
  v_mfma_f32_16x16x32_bf16 v[108:111], a[240:243], a[128:131], v[108:111]
  v_exp_f32 v48, v48
  v_mfma_f32_16x16x32_bf16 v[108:111], a[244:247], a[132:135], v[108:111]
  s_waitcnt vmcnt(12) lgkmcnt(0)
  s_barrier
  ds_read_b128 a[240:243], v0 offset:24576
  v_mfma_f32_16x16x32_bf16 v[68:71], a[248:251], a[16:19], v[68:71]
  ds_read_b128 a[244:247], v1 offset:24576
  v_cvt_pk_bf16_f32 v126, v44, v45
  v_exp_f32 v49, v49
  v_mfma_f32_16x16x32_bf16 v[68:71], a[252:255], a[20:23], v[68:71]
  v_exp_f32 v50, v50
  v_cvt_pk_bf16_f32 v127, v46, v47
  v_mfma_f32_16x16x32_bf16 v[76:79], a[248:251], a[40:43], v[76:79]
  v_exp_f32 v51, v51
  v_mfma_f32_16x16x32_bf16 v[76:79], a[252:255], a[44:47], v[76:79]
  v_exp_f32 v52, v52
  v_cvt_pk_bf16_f32 v128, v48, v49
  v_mfma_f32_16x16x32_bf16 v[84:87], a[248:251], a[64:67], v[84:87]
  s_add_u32 m0, s32, 135168
  v_exp_f32 v53, v53
  v_exp_f32 v54, v54
  v_mfma_f32_16x16x32_bf16 v[84:87], a[252:255], a[68:71], v[84:87]
  s_add_u32 s40, s36, 135168
  v_cvt_pk_bf16_f32 v129, v50, v51
  v_mfma_f32_16x16x32_bf16 v[92:95], a[248:251], a[88:91], v[92:95]
  buffer_load_dwordx4 v12, s[16:19], s40 offen nt lds
  v_exp_f32 v55, v55
  v_mfma_f32_16x16x32_bf16 v[92:95], a[252:255], a[92:95], v[92:95]
  buffer_load_dwordx4 v13, s[16:19], s40 offen offset:1024 nt lds
  v_exp_f32 v56, v56
  v_mfma_f32_16x16x32_bf16 v[100:103], a[248:251], a[112:115], v[100:103]
  buffer_load_dwordx4 v14, s[16:19], s40 offen offset:2048 nt lds
  v_mfma_f32_16x16x32_bf16 v[100:103], a[252:255], a[116:119], v[100:103]
  v_cvt_pk_bf16_f32 v130, v52, v53
  v_exp_f32 v57, v57
  v_mfma_f32_16x16x32_bf16 v[108:111], a[248:251], a[136:139], v[108:111]
  v_exp_f32 v58, v58
  v_cvt_pk_bf16_f32 v131, v54, v55
  v_mfma_f32_16x16x32_bf16 v[108:111], a[252:255], a[140:143], v[108:111]
  s_waitcnt lgkmcnt(0)
  v_exp_f32 v59, v59
  v_exp_f32 v60, v60
  v_mfma_f32_16x16x32_bf16 v[16:19], a[240:243], a[0:3], 0
  ds_read_b128 a[248:251], v0 offset:24704
  v_cvt_pk_bf16_f32 v132, v56, v57
  v_mfma_f32_16x16x32_bf16 v[16:19], a[244:247], a[4:7], v[16:19]
  ds_read_b128 a[252:255], v1 offset:24704
  v_exp_f32 v61, v61
  v_mfma_f32_16x16x32_bf16 v[24:27], a[240:243], a[24:27], 0
  v_exp_f32 v62, v62
  v_cvt_pk_bf16_f32 v133, v58, v59
  v_mfma_f32_16x16x32_bf16 v[24:27], a[244:247], a[28:31], v[24:27]
  v_exp_f32 v63, v63
  v_cvt_pk_bf16_f32 v134, v60, v61
  v_cvt_pk_bf16_f32 v135, v62, v63
  v_mfma_f32_16x16x32_bf16 v[32:35], a[240:243], a[48:51], 0
  v_fma_f32 v64, v64, s30, -v4
  v_fma_f32 v65, v65, s30, -v4
  v_fma_f32 v66, v66, s30, -v4
  v_mfma_f32_16x16x32_bf16 v[32:35], a[244:247], a[52:55], v[32:35]
  v_max_f32 v3, v64, v65
  v_fma_f32 v67, v67, s30, -v4
  v_fma_f32 v68, v68, s30, -v4
  v_mfma_f32_16x16x32_bf16 v[40:43], a[240:243], a[72:75], 0
  v_max3_f32 v3, v3, v66, v67
  v_fma_f32 v69, v69, s30, -v4
  v_fma_f32 v70, v70, s30, -v4
  v_mfma_f32_16x16x32_bf16 v[40:43], a[244:247], a[76:79], v[40:43]
  v_max3_f32 v3, v3, v68, v69
  v_fma_f32 v71, v71, s30, -v4
  v_fma_f32 v72, v72, s30, -v5
  v_mfma_f32_16x16x32_bf16 v[48:51], a[240:243], a[96:99], 0
  v_max3_f32 v3, v3, v70, v71
  v_fma_f32 v73, v73, s30, -v5
  v_fma_f32 v74, v74, s30, -v5
  v_mfma_f32_16x16x32_bf16 v[48:51], a[244:247], a[100:103], v[48:51]
  v_max3_f32 v3, v3, v72, v73
  v_fma_f32 v75, v75, s30, -v5
  v_fma_f32 v76, v76, s30, -v5
  v_mfma_f32_16x16x32_bf16 v[56:59], a[240:243], a[120:123], 0
L_pad_2:
  s_cbranch_execz L_pad_6
  v_max3_f32 v3, v3, v74, v75
  v_fma_f32 v77, v77, s30, -v5
  v_fma_f32 v78, v78, s30, -v5
  v_max3_f32 v3, v3, v76, v77
  v_mfma_f32_16x16x32_bf16 v[56:59], a[244:247], a[124:127], v[56:59]
  s_waitcnt lgkmcnt(0)
  v_fma_f32 v79, v79, s30, -v5
  v_fma_f32 v80, v80, s30, -v6
  v_max3_f32 v3, v3, v78, v79
  v_mfma_f32_16x16x32_bf16 v[16:19], a[248:251], a[8:11], v[16:19]
  ds_read_b128 a[240:243], v0 offset:24832
  v_fma_f32 v81, v81, s30, -v6
  v_fma_f32 v82, v82, s30, -v6
  v_mfma_f32_16x16x32_bf16 v[16:19], a[252:255], a[12:15], v[16:19]
  ds_read_b128 a[244:247], v1 offset:24832
  v_max3_f32 v3, v3, v80, v81
  v_fma_f32 v83, v83, s30, -v6
  v_mfma_f32_16x16x32_bf16 v[24:27], a[248:251], a[32:35], v[24:27]
  v_fma_f32 v84, v84, s30, -v6
  v_max3_f32 v3, v3, v82, v83
  v_fma_f32 v85, v85, s30, -v6
  v_mfma_f32_16x16x32_bf16 v[24:27], a[252:255], a[36:39], v[24:27]
  v_fma_f32 v86, v86, s30, -v6
  v_max3_f32 v3, v3, v84, v85
  v_fma_f32 v87, v87, s30, -v6
  v_mfma_f32_16x16x32_bf16 v[32:35], a[248:251], a[56:59], v[32:35]
  v_fma_f32 v88, v88, s30, -v7
  v_max3_f32 v3, v3, v86, v87
  v_fma_f32 v89, v89, s30, -v7
  v_mfma_f32_16x16x32_bf16 v[32:35], a[252:255], a[60:63], v[32:35]
  v_fma_f32 v90, v90, s30, -v7
  v_max3_f32 v3, v3, v88, v89
  v_fma_f32 v91, v91, s30, -v7
  v_mfma_f32_16x16x32_bf16 v[40:43], a[248:251], a[80:83], v[40:43]
  v_fma_f32 v92, v92, s30, -v7
  v_max3_f32 v3, v3, v90, v91
  v_fma_f32 v93, v93, s30, -v7
  v_mfma_f32_16x16x32_bf16 v[40:43], a[252:255], a[84:87], v[40:43]
  v_fma_f32 v94, v94, s30, -v7
  v_max3_f32 v3, v3, v92, v93
  v_fma_f32 v95, v95, s30, -v7
  v_mfma_f32_16x16x32_bf16 v[48:51], a[248:251], a[104:107], v[48:51]
  v_fma_f32 v96, v96, s30, -v8
  v_max3_f32 v3, v3, v94, v95
  v_fma_f32 v97, v97, s30, -v8
  v_mfma_f32_16x16x32_bf16 v[48:51], a[252:255], a[108:111], v[48:51]
  v_fma_f32 v98, v98, s30, -v8
  v_max3_f32 v3, v3, v96, v97
  v_fma_f32 v99, v99, s30, -v8
  v_mfma_f32_16x16x32_bf16 v[56:59], a[248:251], a[128:131], v[56:59]
  v_fma_f32 v100, v100, s30, -v8
  v_max3_f32 v3, v3, v98, v99
  v_fma_f32 v101, v101, s30, -v8
  v_fma_f32 v102, v102, s30, -v8
  v_mfma_f32_16x16x32_bf16 v[56:59], a[252:255], a[132:135], v[56:59]
  s_waitcnt lgkmcnt(0)
  v_max3_f32 v3, v3, v100, v101
  v_fma_f32 v103, v103, s30, -v8
  v_fma_f32 v104, v104, s30, -v9
  v_mfma_f32_16x16x32_bf16 v[16:19], a[240:243], a[16:19], v[16:19]
  ds_read_b128 a[248:251], v0 offset:30720
  v_max3_f32 v3, v3, v102, v103
  v_fma_f32 v105, v105, s30, -v9
  v_mfma_f32_16x16x32_bf16 v[16:19], a[244:247], a[20:23], v[16:19]
  ds_read_b128 a[252:255], v1 offset:30720
  v_fma_f32 v106, v106, s30, -v9
  v_max3_f32 v3, v3, v104, v105
  v_mfma_f32_16x16x32_bf16 v[24:27], a[240:243], a[40:43], v[24:27]
  s_add_u32 m0, s32, 0
  v_fma_f32 v107, v107, s30, -v9
  v_fma_f32 v108, v108, s30, -v9
  v_mfma_f32_16x16x32_bf16 v[24:27], a[244:247], a[44:47], v[24:27]
  s_add_u32 s40, s38, 0
  v_max3_f32 v3, v3, v106, v107
  v_fma_f32 v109, v109, s30, -v9
  v_fma_f32 v110, v110, s30, -v9
  v_mfma_f32_16x16x32_bf16 v[32:35], a[240:243], a[64:67], v[32:35]
  buffer_load_dwordx4 v2, s[20:23], s40 offen nt lds
  v_max3_f32 v3, v3, v108, v109
  v_mfma_f32_16x16x32_bf16 v[32:35], a[244:247], a[68:71], v[32:35]
  s_add_u32 s40, s38, 2048
  v_fma_f32 v111, v111, s30, -v9
  v_max3_f32 v3, v3, v110, v111
  v_cmp_lt_f32 vcc, s31, v3
  v_mfma_f32_16x16x32_bf16 v[40:43], a[240:243], a[88:91], v[40:43]
  buffer_load_dwordx4 v2, s[20:23], s40 offen offset:1024 nt lds
  s_cbranch_vccnz L_slow_0_5
L_back_0_5:
  v_mfma_f32_16x16x32_bf16 v[40:43], a[244:247], a[92:95], v[40:43]
  s_add_u32 s40, s38, 4096
  v_exp_f32 v64, v64
  v_mfma_f32_16x16x32_bf16 v[48:51], a[240:243], a[112:115], v[48:51]
  buffer_load_dwordx4 v2, s[20:23], s40 offen offset:2048 nt lds
  v_exp_f32 v65, v65
  v_mfma_f32_16x16x32_bf16 v[48:51], a[244:247], a[116:119], v[48:51]
  v_exp_f32 v66, v66
  v_exp_f32 v67, v67
  v_mfma_f32_16x16x32_bf16 v[56:59], a[240:243], a[136:139], v[56:59]
  v_exp_f32 v68, v68
  v_mfma_f32_16x16x32_bf16 v[56:59], a[244:247], a[140:143], v[56:59]
  s_waitcnt lgkmcnt(0)
  v_cvt_pk_bf16_f32 v136, v64, v65
  v_exp_f32 v69, v69
  v_mfma_f32_16x16x32_bf16 v[20:23], a[248:251], a[0:3], 0
  ds_read_b128 a[240:243], v0 offset:30848
  v_exp_f32 v70, v70
  v_mfma_f32_16x16x32_bf16 v[20:23], a[252:255], a[4:7], v[20:23]
  ds_read_b128 a[244:247], v1 offset:30848
  v_cvt_pk_bf16_f32 v137, v66, v67
  v_exp_f32 v71, v71
  v_mfma_f32_16x16x32_bf16 v[28:31], a[248:251], a[24:27], 0
  v_exp_f32 v72, v72
  v_cvt_pk_bf16_f32 v138, v68, v69
  v_mfma_f32_16x16x32_bf16 v[28:31], a[252:255], a[28:31], v[28:31]
  v_exp_f32 v73, v73
  v_mfma_f32_16x16x32_bf16 v[36:39], a[248:251], a[48:51], 0
  v_exp_f32 v74, v74
  v_cvt_pk_bf16_f32 v139, v70, v71
  v_mfma_f32_16x16x32_bf16 v[36:39], a[252:255], a[52:55], v[36:39]
  v_exp_f32 v75, v75
  v_exp_f32 v76, v76
  v_mfma_f32_16x16x32_bf16 v[44:47], a[248:251], a[72:75], 0
  v_cvt_pk_bf16_f32 v140, v72, v73
  v_exp_f32 v77, v77
  v_mfma_f32_16x16x32_bf16 v[44:47], a[252:255], a[76:79], v[44:47]
  v_exp_f32 v78, v78
  v_cvt_pk_bf16_f32 v141, v74, v75
  v_mfma_f32_16x16x32_bf16 v[52:55], a[248:251], a[96:99], 0
  v_exp_f32 v79, v79
  v_exp_f32 v80, v80
  v_mfma_f32_16x16x32_bf16 v[52:55], a[252:255], a[100:103], v[52:55]
  v_cvt_pk_bf16_f32 v142, v76, v77
  v_exp_f32 v81, v81
  v_mfma_f32_16x16x32_bf16 v[60:63], a[248:251], a[120:123], 0
  v_exp_f32 v82, v82
  v_cvt_pk_bf16_f32 v143, v78, v79
  v_mfma_f32_16x16x32_bf16 v[60:63], a[252:255], a[124:127], v[60:63]
  s_waitcnt lgkmcnt(0)
  v_exp_f32 v83, v83
  v_mfma_f32_16x16x32_bf16 v[20:23], a[240:243], a[8:11], v[20:23]
  ds_read_b128 a[248:251], v0 offset:30976
  v_exp_f32 v84, v84
  v_cvt_pk_bf16_f32 v144, v80, v81
  v_mfma_f32_16x16x32_bf16 v[20:23], a[244:247], a[12:15], v[20:23]
  ds_read_b128 a[252:255], v1 offset:30976
  v_exp_f32 v85, v85
  v_mfma_f32_16x16x32_bf16 v[28:31], a[240:243], a[32:35], v[28:31]
  v_exp_f32 v86, v86
  v_cvt_pk_bf16_f32 v145, v82, v83
  v_mfma_f32_16x16x32_bf16 v[28:31], a[244:247], a[36:39], v[28:31]
  v_exp_f32 v87, v87
  v_exp_f32 v88, v88
  v_mfma_f32_16x16x32_bf16 v[36:39], a[240:243], a[56:59], v[36:39]
  v_cvt_pk_bf16_f32 v146, v84, v85
  v_exp_f32 v89, v89
  v_mfma_f32_16x16x32_bf16 v[36:39], a[244:247], a[60:63], v[36:39]
  v_exp_f32 v90, v90
  v_mfma_f32_16x16x32_bf16 v[44:47], a[240:243], a[80:83], v[44:47]
  v_cvt_pk_bf16_f32 v147, v86, v87
  v_exp_f32 v91, v91
  v_mfma_f32_16x16x32_bf16 v[44:47], a[244:247], a[84:87], v[44:47]
  v_exp_f32 v92, v92
  v_cvt_pk_bf16_f32 v148, v88, v89
  v_mfma_f32_16x16x32_bf16 v[52:55], a[240:243], a[104:107], v[52:55]
  v_exp_f32 v93, v93
  v_exp_f32 v94, v94
  v_mfma_f32_16x16x32_bf16 v[52:55], a[244:247], a[108:111], v[52:55]
  v_cvt_pk_bf16_f32 v149, v90, v91
  v_exp_f32 v95, v95
  v_mfma_f32_16x16x32_bf16 v[60:63], a[240:243], a[128:131], v[60:63]
  v_exp_f32 v96, v96
  v_cvt_pk_bf16_f32 v150, v92, v93
  v_mfma_f32_16x16x32_bf16 v[60:63], a[244:247], a[132:135], v[60:63]
  s_waitcnt vmcnt(15) lgkmcnt(0)
  s_barrier
  ds_read_b128 a[240:243], v0 offset:36864
  v_mfma_f32_16x16x32_bf16 v[20:23], a[248:251], a[16:19], v[20:23]
  ds_read_b128 a[244:247], v1 offset:36864
  v_exp_f32 v97, v97
  v_mfma_f32_16x16x32_bf16 v[20:23], a[252:255], a[20:23], v[20:23]
  v_exp_f32 v98, v98
  v_cvt_pk_bf16_f32 v151, v94, v95
  v_mfma_f32_16x16x32_bf16 v[28:31], a[248:251], a[40:43], v[28:31]
  v_exp_f32 v99, v99
  v_exp_f32 v100, v100
  v_mfma_f32_16x16x32_bf16 v[28:31], a[252:255], a[44:47], v[28:31]
  v_cvt_pk_bf16_f32 v152, v96, v97
  v_exp_f32 v101, v101
  v_mfma_f32_16x16x32_bf16 v[36:39], a[248:251], a[64:67], v[36:39]
  s_add_u32 m0, s32, 12288
  v_exp_f32 v102, v102
  v_mfma_f32_16x16x32_bf16 v[36:39], a[252:255], a[68:71], v[36:39]
  s_add_u32 s40, s38, 36864
  v_cvt_pk_bf16_f32 v153, v98, v99
  v_exp_f32 v103, v103
  v_mfma_f32_16x16x32_bf16 v[44:47], a[248:251], a[88:91], v[44:47]
  buffer_load_dwordx4 v2, s[20:23], s40 offen nt lds
  v_mfma_f32_16x16x32_bf16 v[44:47], a[252:255], a[92:95], v[44:47]
  s_add_u32 s40, s38, 38912
  v_exp_f32 v104, v104
  v_cvt_pk_bf16_f32 v154, v100, v101
  v_mfma_f32_16x16x32_bf16 v[52:55], a[248:251], a[112:115], v[52:55]
  buffer_load_dwordx4 v2, s[20:23], s40 offen offset:1024 nt lds
  v_exp_f32 v105, v105
  v_mfma_f32_16x16x32_bf16 v[52:55], a[252:255], a[116:119], v[52:55]
  s_add_u32 s40, s38, 40960
  v_exp_f32 v106, v106
  v_mfma_f32_16x16x32_bf16 v[60:63], a[248:251], a[136:139], v[60:63]
  buffer_load_dwordx4 v2, s[20:23], s40 offen offset:2048 nt lds
  v_cvt_pk_bf16_f32 v155, v102, v103
  v_mfma_f32_16x16x32_bf16 v[60:63], a[252:255], a[140:143], v[60:63]
  s_waitcnt lgkmcnt(0)
  v_exp_f32 v107, v107
  v_exp_f32 v108, v108
  v_mfma_f32_16x16x32_bf16 v[64:67], a[240:243], a[0:3], 0
  ds_read_b128 a[248:251], v0 offset:36992
  v_cvt_pk_bf16_f32 v156, v104, v105
  v_mfma_f32_16x16x32_bf16 v[64:67], a[244:247], a[4:7], v[64:67]
  ds_read_b128 a[252:255], v1 offset:36992
  v_exp_f32 v109, v109
  v_mfma_f32_16x16x32_bf16 v[72:75], a[240:243], a[24:27], 0
  v_exp_f32 v110, v110
  v_cvt_pk_bf16_f32 v157, v106, v107
  v_mfma_f32_16x16x32_bf16 v[72:75], a[244:247], a[28:31], v[72:75]
  v_exp_f32 v111, v111
  v_cvt_pk_bf16_f32 v158, v108, v109
  v_cvt_pk_bf16_f32 v159, v110, v111
  v_mfma_f32_16x16x32_bf16 v[80:83], a[240:243], a[48:51], 0
  v_fma_f32 v16, v16, s30, -v4
  v_fma_f32 v17, v17, s30, -v4
  v_fma_f32 v18, v18, s30, -v4
  v_mfma_f32_16x16x32_bf16 v[80:83], a[244:247], a[52:55], v[80:83]
  v_max_f32 v3, v16, v17
  v_fma_f32 v19, v19, s30, -v4
  v_fma_f32 v20, v20, s30, -v4
  v_mfma_f32_16x16x32_bf16 v[88:91], a[240:243], a[72:75], 0
  v_max3_f32 v3, v3, v18, v19
  v_fma_f32 v21, v21, s30, -v4
  v_fma_f32 v22, v22, s30, -v4
  v_mfma_f32_16x16x32_bf16 v[88:91], a[244:247], a[76:79], v[88:91]
  v_max3_f32 v3, v3, v20, v21
  v_fma_f32 v23, v23, s30, -v4
  v_fma_f32 v24, v24, s30, -v5
  v_mfma_f32_16x16x32_bf16 v[96:99], a[240:243], a[96:99], 0
  v_max3_f32 v3, v3, v22, v23
  v_fma_f32 v25, v25, s30, -v5
  v_fma_f32 v26, v26, s30, -v5
  v_max3_f32 v3, v3, v24, v25
  v_mfma_f32_16x16x32_bf16 v[96:99], a[244:247], a[100:103], v[96:99]
  v_fma_f32 v27, v27, s30, -v5
  v_fma_f32 v28, v28, s30, -v5
  v_max3_f32 v3, v3, v26, v27
  v_mfma_f32_16x16x32_bf16 v[104:107], a[240:243], a[120:123], 0
  v_fma_f32 v29, v29, s30, -v5
  v_fma_f32 v30, v30, s30, -v5
  v_max3_f32 v3, v3, v28, v29
  v_mfma_f32_16x16x32_bf16 v[104:107], a[244:247], a[124:127], v[104:107]
  s_waitcnt lgkmcnt(0)
  v_fma_f32 v31, v31, s30, -v5
  v_fma_f32 v32, v32, s30, -v6
  v_max3_f32 v3, v3, v30, v31
  v_mfma_f32_16x16x32_bf16 v[64:67], a[248:251], a[8:11], v[64:67]
  ds_read_b128 a[240:243], v0 offset:37120
  v_fma_f32 v33, v33, s30, -v6
  v_fma_f32 v34, v34, s30, -v6
  v_mfma_f32_16x16x32_bf16 v[64:67], a[252:255], a[12:15], v[64:67]
  ds_read_b128 a[244:247], v1 offset:37120
  v_max3_f32 v3, v3, v32, v33
  v_fma_f32 v35, v35, s30, -v6
  v_mfma_f32_16x16x32_bf16 v[72:75], a[248:251], a[32:35], v[72:75]
  v_fma_f32 v36, v36, s30, -v6
  v_max3_f32 v3, v3, v34, v35
  v_fma_f32 v37, v37, s30, -v6
  v_mfma_f32_16x16x32_bf16 v[72:75], a[252:255], a[36:39], v[72:75]
  v_fma_f32 v38, v38, s30, -v6
  v_max3_f32 v3, v3, v36, v37
  v_fma_f32 v39, v39, s30, -v6
  v_mfma_f32_16x16x32_bf16 v[80:83], a[248:251], a[56:59], v[80:83]
  v_fma_f32 v40, v40, s30, -v7
  v_max3_f32 v3, v3, v38, v39
  v_fma_f32 v41, v41, s30, -v7
  v_mfma_f32_16x16x32_bf16 v[80:83], a[252:255], a[60:63], v[80:83]
  v_fma_f32 v42, v42, s30, -v7
  v_max3_f32 v3, v3, v40, v41
  v_fma_f32 v43, v43, s30, -v7
  v_fma_f32 v44, v44, s30, -v7
  v_mfma_f32_16x16x32_bf16 v[88:91], a[248:251], a[80:83], v[88:91]
  v_max3_f32 v3, v3, v42, v43
  v_fma_f32 v45, v45, s30, -v7
  v_fma_f32 v46, v46, s30, -v7
  v_mfma_f32_16x16x32_bf16 v[88:91], a[252:255], a[84:87], v[88:91]
  v_max3_f32 v3, v3, v44, v45
  v_fma_f32 v47, v47, s30, -v7
  v_fma_f32 v48, v48, s30, -v8
  v_mfma_f32_16x16x32_bf16 v[96:99], a[248:251], a[104:107], v[96:99]
  v_max3_f32 v3, v3, v46, v47
  v_fma_f32 v49, v49, s30, -v8
  v_fma_f32 v50, v50, s30, -v8
  v_mfma_f32_16x16x32_bf16 v[96:99], a[252:255], a[108:111], v[96:99]
  v_max3_f32 v3, v3, v48, v49
  v_fma_f32 v51, v51, s30, -v8
  v_fma_f32 v52, v52, s30, -v8
  v_mfma_f32_16x16x32_bf16 v[104:107], a[248:251], a[128:131], v[104:107]
  v_max3_f32 v3, v3, v50, v51
  v_fma_f32 v53, v53, s30, -v8
  v_fma_f32 v54, v54, s30, -v8
  v_mfma_f32_16x16x32_bf16 v[104:107], a[252:255], a[132:135], v[104:107]
  s_waitcnt lgkmcnt(0)
  v_max3_f32 v3, v3, v52, v53
  v_fma_f32 v55, v55, s30, -v8
  v_fma_f32 v56, v56, s30, -v9
  v_mfma_f32_16x16x32_bf16 v[64:67], a[240:243], a[16:19], v[64:67]
  ds_read_b128 a[248:251], v0 offset:43008
  v_max3_f32 v3, v3, v54, v55
  v_fma_f32 v57, v57, s30, -v9
  v_mfma_f32_16x16x32_bf16 v[64:67], a[244:247], a[20:23], v[64:67]
  ds_read_b128 a[252:255], v1 offset:43008
  v_fma_f32 v58, v58, s30, -v9
  v_max3_f32 v3, v3, v56, v57
  v_fma_f32 v59, v59, s30, -v9
  v_mfma_f32_16x16x32_bf16 v[72:75], a[240:243], a[40:43], v[72:75]
  s_add_u32 m0, s32, 24576
  v_fma_f32 v60, v60, s30, -v9
  v_max3_f32 v3, v3, v58, v59
  v_mfma_f32_16x16x32_bf16 v[72:75], a[244:247], a[44:47], v[72:75]
  s_add_u32 s40, s38, 73728
  v_fma_f32 v61, v61, s30, -v9
  v_fma_f32 v62, v62, s30, -v9
  v_max3_f32 v3, v3, v60, v61
  v_mfma_f32_16x16x32_bf16 v[80:83], a[240:243], a[64:67], v[80:83]
  buffer_load_dwordx4 v2, s[20:23], s40 offen nt lds
  v_fma_f32 v63, v63, s30, -v9
  v_mfma_f32_16x16x32_bf16 v[80:83], a[244:247], a[68:71], v[80:83]
  s_add_u32 s40, s38, 75776
  v_max3_f32 v3, v3, v62, v63
  v_cmp_lt_f32 vcc, s31, v3
  v_mfma_f32_16x16x32_bf16 v[88:91], a[240:243], a[88:91], v[88:91]
  buffer_load_dwordx4 v2, s[20:23], s40 offen offset:1024 nt lds
  s_cbranch_vccnz L_slow_0_6
L_back_0_6:
  v_mfma_f32_16x16x32_bf16 v[88:91], a[244:247], a[92:95], v[88:91]
  s_add_u32 s40, s38, 77824
  v_exp_f32 v16, v16
  v_exp_f32 v17, v17
  v_mfma_f32_16x16x32_bf16 v[96:99], a[240:243], a[112:115], v[96:99]
  buffer_load_dwordx4 v2, s[20:23], s40 offen offset:2048 nt lds
  v_mfma_f32_16x16x32_bf16 v[96:99], a[244:247], a[116:119], v[96:99]
  v_exp_f32 v18, v18
  v_exp_f32 v19, v19
  v_mfma_f32_16x16x32_bf16 v[104:107], a[240:243], a[136:139], v[104:107]
  v_exp_f32 v20, v20
  v_cvt_pk_bf16_f32 v160, v16, v17
  v_mfma_f32_16x16x32_bf16 v[104:107], a[244:247], a[140:143], v[104:107]
  s_waitcnt lgkmcnt(0)
  v_exp_f32 v21, v21
  v_exp_f32 v22, v22
  v_mfma_f32_16x16x32_bf16 v[68:71], a[248:251], a[0:3], 0
  ds_read_b128 a[240:243], v0 offset:43136
  v_cvt_pk_bf16_f32 v161, v18, v19
  v_mfma_f32_16x16x32_bf16 v[68:71], a[252:255], a[4:7], v[68:71]
  ds_read_b128 a[244:247], v1 offset:43136
  v_exp_f32 v23, v23
  v_mfma_f32_16x16x32_bf16 v[76:79], a[248:251], a[24:27], 0
  v_exp_f32 v24, v24
  v_cvt_pk_bf16_f32 v162, v20, v21
  v_mfma_f32_16x16x32_bf16 v[76:79], a[252:255], a[28:31], v[76:79]
  v_exp_f32 v25, v25
  v_exp_f32 v26, v26
  v_mfma_f32_16x16x32_bf16 v[84:87], a[248:251], a[48:51], 0
  v_cvt_pk_bf16_f32 v163, v22, v23
  v_exp_f32 v27, v27
  v_mfma_f32_16x16x32_bf16 v[84:87], a[252:255], a[52:55], v[84:87]
  v_exp_f32 v28, v28
  v_cvt_pk_bf16_f32 v164, v24, v25
  v_mfma_f32_16x16x32_bf16 v[92:95], a[248:251], a[72:75], 0
  v_exp_f32 v29, v29
  v_exp_f32 v30, v30
  v_mfma_f32_16x16x32_bf16 v[92:95], a[252:255], a[76:79], v[92:95]
  v_cvt_pk_bf16_f32 v165, v26, v27
  v_exp_f32 v31, v31
  v_mfma_f32_16x16x32_bf16 v[100:103], a[248:251], a[96:99], 0
  v_exp_f32 v32, v32
  v_mfma_f32_16x16x32_bf16 v[100:103], a[252:255], a[100:103], v[100:103]
  v_cvt_pk_bf16_f32 v166, v28, v29
  v_exp_f32 v33, v33
  v_mfma_f32_16x16x32_bf16 v[108:111], a[248:251], a[120:123], 0
  v_exp_f32 v34, v34
  v_cvt_pk_bf16_f32 v167, v30, v31
  v_mfma_f32_16x16x32_bf16 v[108:111], a[252:255], a[124:127], v[108:111]
  s_waitcnt lgkmcnt(0)
  v_exp_f32 v35, v35
  v_exp_f32 v36, v36
  v_mfma_f32_16x16x32_bf16 v[68:71], a[240:243], a[8:11], v[68:71]
  ds_read_b128 a[248:251], v0 offset:43264
  v_cvt_pk_bf16_f32 v168, v32, v33
  v_exp_f32 v37, v37
  v_mfma_f32_16x16x32_bf16 v[68:71], a[244:247], a[12:15], v[68:71]
  ds_read_b128 a[252:255], v1 offset:43264
  v_exp_f32 v38, v38
  v_mfma_f32_16x16x32_bf16 v[76:79], a[240:243], a[32:35], v[76:79]
  v_cvt_pk_bf16_f32 v169, v34, v35
  v_exp_f32 v39, v39
  v_mfma_f32_16x16x32_bf16 v[76:79], a[244:247], a[36:39], v[76:79]
  v_exp_f32 v40, v40
  v_cvt_pk_bf16_f32 v170, v36, v37
  v_mfma_f32_16x16x32_bf16 v[84:87], a[240:243], a[56:59], v[84:87]
  v_exp_f32 v41, v41
  v_mfma_f32_16x16x32_bf16 v[84:87], a[244:247], a[60:63], v[84:87]
  v_exp_f32 v42, v42
  v_cvt_pk_bf16_f32 v171, v38, v39
  v_mfma_f32_16x16x32_bf16 v[92:95], a[240:243], a[80:83], v[92:95]
  v_exp_f32 v43, v43
  v_exp_f32 v44, v44
  v_mfma_f32_16x16x32_bf16 v[92:95], a[244:247], a[84:87], v[92:95]
  v_cvt_pk_bf16_f32 v172, v40, v41
  v_exp_f32 v45, v45
  v_mfma_f32_16x16x32_bf16 v[100:103], a[240:243], a[104:107], v[100:103]
  v_add_u32 v0, 49152, v0
  v_exp_f32 v46, v46
  v_mfma_f32_16x16x32_bf16 v[100:103], a[244:247], a[108:111], v[100:103]
  v_cvt_pk_bf16_f32 v173, v42, v43
  v_exp_f32 v47, v47
  v_mfma_f32_16x16x32_bf16 v[108:111], a[240:243], a[128:131], v[108:111]
  v_add_u32 v1, 49152, v1
  v_exp_f32 v48, v48
  v_mfma_f32_16x16x32_bf16 v[108:111], a[244:247], a[132:135], v[108:111]
  s_waitcnt vmcnt(18) lgkmcnt(0)
  s_barrier
  ds_read_b128 a[240:243], v0 offset:0
  v_mfma_f32_16x16x32_bf16 v[68:71], a[248:251], a[16:19], v[68:71]
  ds_read_b128 a[244:247], v1 offset:0
  v_cvt_pk_bf16_f32 v174, v44, v45
  v_exp_f32 v49, v49
  v_mfma_f32_16x16x32_bf16 v[68:71], a[252:255], a[20:23], v[68:71]
  v_exp_f32 v50, v50
  v_cvt_pk_bf16_f32 v175, v46, v47
  v_mfma_f32_16x16x32_bf16 v[76:79], a[248:251], a[40:43], v[76:79]
  v_exp_f32 v51, v51
  v_mfma_f32_16x16x32_bf16 v[76:79], a[252:255], a[44:47], v[76:79]
  v_exp_f32 v52, v52
  v_cvt_pk_bf16_f32 v176, v48, v49
  v_exp_f32 v53, v53
  v_mfma_f32_16x16x32_bf16 v[84:87], a[248:251], a[64:67], v[84:87]
  s_add_u32 m0, s32, 36864
  v_exp_f32 v54, v54
  v_mfma_f32_16x16x32_bf16 v[84:87], a[252:255], a[68:71], v[84:87]
  s_add_u32 s40, s38, 110592
  v_cvt_pk_bf16_f32 v177, v50, v51
  v_exp_f32 v55, v55
  v_mfma_f32_16x16x32_bf16 v[92:95], a[248:251], a[88:91], v[92:95]
  buffer_load_dwordx4 v2, s[20:23], s40 offen nt lds
  v_mfma_f32_16x16x32_bf16 v[92:95], a[252:255], a[92:95], v[92:95]
  s_add_u32 s40, s38, 112640
  v_exp_f32 v56, v56
  v_cvt_pk_bf16_f32 v178, v52, v53
  v_mfma_f32_16x16x32_bf16 v[100:103], a[248:251], a[112:115], v[100:103]
  buffer_load_dwordx4 v2, s[20:23], s40 offen offset:1024 nt lds
  v_exp_f32 v57, v57
  v_mfma_f32_16x16x32_bf16 v[100:103], a[252:255], a[116:119], v[100:103]
  s_add_u32 s40, s38, 114688
  v_exp_f32 v58, v58
  v_mfma_f32_16x16x32_bf16 v[108:111], a[248:251], a[136:139], v[108:111]
  buffer_load_dwordx4 v2, s[20:23], s40 offen offset:2048 nt lds
  v_cvt_pk_bf16_f32 v179, v54, v55
  v_mfma_f32_16x16x32_bf16 v[108:111], a[252:255], a[140:143], v[108:111]
  s_waitcnt lgkmcnt(0)
  v_exp_f32 v59, v59
  v_exp_f32 v60, v60
  v_mfma_f32_16x16x32_bf16 v[16:19], a[240:243], a[0:3], 0
  ds_read_b128 a[248:251], v0 offset:128
  v_cvt_pk_bf16_f32 v180, v56, v57
  v_mfma_f32_16x16x32_bf16 v[16:19], a[244:247], a[4:7], v[16:19]
  ds_read_b128 a[252:255], v1 offset:128
  v_exp_f32 v61, v61
  v_mfma_f32_16x16x32_bf16 v[24:27], a[240:243], a[24:27], 0
  v_exp_f32 v62, v62
  v_cvt_pk_bf16_f32 v181, v58, v59
  v_mfma_f32_16x16x32_bf16 v[24:27], a[244:247], a[28:31], v[24:27]
  v_exp_f32 v63, v63
  v_cvt_pk_bf16_f32 v182, v60, v61
  v_cvt_pk_bf16_f32 v183, v62, v63
  v_mfma_f32_16x16x32_bf16 v[32:35], a[240:243], a[48:51], 0
  v_fma_f32 v64, v64, s30, -v4
  v_fma_f32 v65, v65, s30, -v4
  v_fma_f32 v66, v66, s30, -v4
  v_mfma_f32_16x16x32_bf16 v[32:35], a[244:247], a[52:55], v[32:35]
  v_max_f32 v3, v64, v65
  v_fma_f32 v67, v67, s30, -v4
  v_fma_f32 v68, v68, s30, -v4
  v_mfma_f32_16x16x32_bf16 v[40:43], a[240:243], a[72:75], 0
  v_max3_f32 v3, v3, v66, v67
  v_fma_f32 v69, v69, s30, -v4
  v_fma_f32 v70, v70, s30, -v4
  v_mfma_f32_16x16x32_bf16 v[40:43], a[244:247], a[76:79], v[40:43]
  v_max3_f32 v3, v3, v68, v69
  v_fma_f32 v71, v71, s30, -v4
  v_fma_f32 v72, v72, s30, -v5
  v_mfma_f32_16x16x32_bf16 v[48:51], a[240:243], a[96:99], 0
  v_max3_f32 v3, v3, v70, v71
  v_fma_f32 v73, v73, s30, -v5
  v_fma_f32 v74, v74, s30, -v5
  v_mfma_f32_16x16x32_bf16 v[48:51], a[244:247], a[100:103], v[48:51]
  v_max3_f32 v3, v3, v72, v73
  v_fma_f32 v75, v75, s30, -v5
  v_fma_f32 v76, v76, s30, -v5
  v_mfma_f32_16x16x32_bf16 v[56:59], a[240:243], a[120:123], 0
  v_max3_f32 v3, v3, v74, v75
  v_fma_f32 v77, v77, s30, -v5
  v_fma_f32 v78, v78, s30, -v5
  v_max3_f32 v3, v3, v76, v77
  v_mfma_f32_16x16x32_bf16 v[56:59], a[244:247], a[124:127], v[56:59]
  s_waitcnt lgkmcnt(0)
  v_fma_f32 v79, v79, s30, -v5
  v_fma_f32 v80, v80, s30, -v6
  v_max3_f32 v3, v3, v78, v79
  v_mfma_f32_16x16x32_bf16 v[16:19], a[248:251], a[8:11], v[16:19]
  ds_read_b128 a[240:243], v0 offset:256
  v_fma_f32 v81, v81, s30, -v6
  v_fma_f32 v82, v82, s30, -v6
  v_mfma_f32_16x16x32_bf16 v[16:19], a[252:255], a[12:15], v[16:19]
  ds_read_b128 a[244:247], v1 offset:256
  v_max3_f32 v3, v3, v80, v81
  v_fma_f32 v83, v83, s30, -v6
  v_mfma_f32_16x16x32_bf16 v[24:27], a[248:251], a[32:35], v[24:27]
  v_fma_f32 v84, v84, s30, -v6
  v_max3_f32 v3, v3, v82, v83
  v_fma_f32 v85, v85, s30, -v6
  v_mfma_f32_16x16x32_bf16 v[24:27], a[252:255], a[36:39], v[24:27]
  v_fma_f32 v86, v86, s30, -v6
  v_max3_f32 v3, v3, v84, v85
  v_fma_f32 v87, v87, s30, -v6
  v_mfma_f32_16x16x32_bf16 v[32:35], a[248:251], a[56:59], v[32:35]
  v_fma_f32 v88, v88, s30, -v7
  v_max3_f32 v3, v3, v86, v87
  v_fma_f32 v89, v89, s30, -v7
  v_mfma_f32_16x16x32_bf16 v[32:35], a[252:255], a[60:63], v[32:35]
  v_fma_f32 v90, v90, s30, -v7
  v_max3_f32 v3, v3, v88, v89
  v_fma_f32 v91, v91, s30, -v7
  v_mfma_f32_16x16x32_bf16 v[40:43], a[248:251], a[80:83], v[40:43]
  v_fma_f32 v92, v92, s30, -v7
  v_max3_f32 v3, v3, v90, v91
  v_fma_f32 v93, v93, s30, -v7
  v_mfma_f32_16x16x32_bf16 v[40:43], a[252:255], a[84:87], v[40:43]
  v_fma_f32 v94, v94, s30, -v7
  v_max3_f32 v3, v3, v92, v93
  v_fma_f32 v95, v95, s30, -v7
  v_mfma_f32_16x16x32_bf16 v[48:51], a[248:251], a[104:107], v[48:51]
  v_fma_f32 v96, v96, s30, -v8
  v_max3_f32 v3, v3, v94, v95
  v_fma_f32 v97, v97, s30, -v8
  v_mfma_f32_16x16x32_bf16 v[48:51], a[252:255], a[108:111], v[48:51]
  v_fma_f32 v98, v98, s30, -v8
  v_max3_f32 v3, v3, v96, v97
  v_fma_f32 v99, v99, s30, -v8
  v_mfma_f32_16x16x32_bf16 v[56:59], a[248:251], a[128:131], v[56:59]
  v_fma_f32 v100, v100, s30, -v8
  v_max3_f32 v3, v3, v98, v99
  v_fma_f32 v101, v101, s30, -v8
  v_fma_f32 v102, v102, s30, -v8
  v_mfma_f32_16x16x32_bf16 v[56:59], a[252:255], a[132:135], v[56:59]
  s_waitcnt lgkmcnt(0)
  v_max3_f32 v3, v3, v100, v101
  v_fma_f32 v103, v103, s30, -v8
  v_fma_f32 v104, v104, s30, -v9
  v_mfma_f32_16x16x32_bf16 v[16:19], a[240:243], a[16:19], v[16:19]
  ds_read_b128 a[248:251], v0 offset:6144
  v_max3_f32 v3, v3, v102, v103
  v_fma_f32 v105, v105, s30, -v9
  v_mfma_f32_16x16x32_bf16 v[16:19], a[244:247], a[20:23], v[16:19]
  ds_read_b128 a[252:255], v1 offset:6144
  v_fma_f32 v106, v106, s30, -v9
  v_max3_f32 v3, v3, v104, v105
  v_mfma_f32_16x16x32_bf16 v[24:27], a[240:243], a[40:43], v[24:27]
L_pad_3:
  s_cbranch_execz L_pad_7
  s_add_u32 m0, s32, 49152
  v_fma_f32 v107, v107, s30, -v9
  v_fma_f32 v108, v108, s30, -v9
  v_mfma_f32_16x16x32_bf16 v[24:27], a[244:247], a[44:47], v[24:27]
  s_add_u32 s40, s38, 128
  v_max3_f32 v3, v3, v106, v107
  v_fma_f32 v109, v109, s30, -v9
  v_fma_f32 v110, v110, s30, -v9
  v_mfma_f32_16x16x32_bf16 v[32:35], a[240:243], a[64:67], v[32:35]
  buffer_load_dwordx4 v2, s[20:23], s40 offen nt lds
  v_max3_f32 v3, v3, v108, v109
  v_mfma_f32_16x16x32_bf16 v[32:35], a[244:247], a[68:71], v[32:35]
  s_add_u32 s40, s38, 2176
  v_fma_f32 v111, v111, s30, -v9
  v_max3_f32 v3, v3, v110, v111
  v_cmp_lt_f32 vcc, s31, v3
  v_mfma_f32_16x16x32_bf16 v[40:43], a[240:243], a[88:91], v[40:43]
  buffer_load_dwordx4 v2, s[20:23], s40 offen offset:1024 nt lds
  s_cbranch_vccnz L_slow_0_7
L_back_0_7:
  v_mfma_f32_16x16x32_bf16 v[40:43], a[244:247], a[92:95], v[40:43]
  s_add_u32 s40, s38, 4224
  v_exp_f32 v64, v64
  v_mfma_f32_16x16x32_bf16 v[48:51], a[240:243], a[112:115], v[48:51]
  buffer_load_dwordx4 v2, s[20:23], s40 offen offset:2048 nt lds
  v_exp_f32 v65, v65
  v_mfma_f32_16x16x32_bf16 v[48:51], a[244:247], a[116:119], v[48:51]
  v_exp_f32 v66, v66
  v_exp_f32 v67, v67
  v_mfma_f32_16x16x32_bf16 v[56:59], a[240:243], a[136:139], v[56:59]
  v_exp_f32 v68, v68
  v_mfma_f32_16x16x32_bf16 v[56:59], a[244:247], a[140:143], v[56:59]
  s_waitcnt lgkmcnt(0)
  v_cvt_pk_bf16_f32 v184, v64, v65
  v_exp_f32 v69, v69
  v_mfma_f32_16x16x32_bf16 v[20:23], a[248:251], a[0:3], 0
  ds_read_b128 a[240:243], v0 offset:6272
  v_exp_f32 v70, v70
  v_mfma_f32_16x16x32_bf16 v[20:23], a[252:255], a[4:7], v[20:23]
  ds_read_b128 a[244:247], v1 offset:6272
  v_cvt_pk_bf16_f32 v185, v66, v67
  v_exp_f32 v71, v71
  v_mfma_f32_16x16x32_bf16 v[28:31], a[248:251], a[24:27], 0
  v_exp_f32 v72, v72
  v_cvt_pk_bf16_f32 v186, v68, v69
  v_mfma_f32_16x16x32_bf16 v[28:31], a[252:255], a[28:31], v[28:31]
  v_exp_f32 v73, v73
  v_mfma_f32_16x16x32_bf16 v[36:39], a[248:251], a[48:51], 0
  v_exp_f32 v74, v74
  v_cvt_pk_bf16_f32 v187, v70, v71
  v_mfma_f32_16x16x32_bf16 v[36:39], a[252:255], a[52:55], v[36:39]
  v_exp_f32 v75, v75
  v_exp_f32 v76, v76
  v_mfma_f32_16x16x32_bf16 v[44:47], a[248:251], a[72:75], 0
  v_cvt_pk_bf16_f32 v188, v72, v73
  v_exp_f32 v77, v77
  v_mfma_f32_16x16x32_bf16 v[44:47], a[252:255], a[76:79], v[44:47]
  v_exp_f32 v78, v78
  v_cvt_pk_bf16_f32 v189, v74, v75
  v_mfma_f32_16x16x32_bf16 v[52:55], a[248:251], a[96:99], 0
  v_exp_f32 v79, v79
  v_exp_f32 v80, v80
  v_mfma_f32_16x16x32_bf16 v[52:55], a[252:255], a[100:103], v[52:55]
  v_cvt_pk_bf16_f32 v190, v76, v77
  v_exp_f32 v81, v81
  v_mfma_f32_16x16x32_bf16 v[60:63], a[248:251], a[120:123], 0
  v_exp_f32 v82, v82
  v_cvt_pk_bf16_f32 v191, v78, v79
  v_mfma_f32_16x16x32_bf16 v[60:63], a[252:255], a[124:127], v[60:63]
  s_waitcnt lgkmcnt(0)
  v_exp_f32 v83, v83
  v_mfma_f32_16x16x32_bf16 v[20:23], a[240:243], a[8:11], v[20:23]
  ds_read_b128 a[248:251], v0 offset:6400
  v_exp_f32 v84, v84
  v_cvt_pk_bf16_f32 v192, v80, v81
  v_mfma_f32_16x16x32_bf16 v[20:23], a[244:247], a[12:15], v[20:23]
  ds_read_b128 a[252:255], v1 offset:6400
  v_exp_f32 v85, v85
  v_mfma_f32_16x16x32_bf16 v[28:31], a[240:243], a[32:35], v[28:31]
  v_exp_f32 v86, v86
  v_cvt_pk_bf16_f32 v193, v82, v83
  v_mfma_f32_16x16x32_bf16 v[28:31], a[244:247], a[36:39], v[28:31]
  v_exp_f32 v87, v87
  v_exp_f32 v88, v88
  v_mfma_f32_16x16x32_bf16 v[36:39], a[240:243], a[56:59], v[36:39]
  v_cvt_pk_bf16_f32 v194, v84, v85
  v_exp_f32 v89, v89
  v_mfma_f32_16x16x32_bf16 v[36:39], a[244:247], a[60:63], v[36:39]
  v_exp_f32 v90, v90
  v_mfma_f32_16x16x32_bf16 v[44:47], a[240:243], a[80:83], v[44:47]
  v_cvt_pk_bf16_f32 v195, v86, v87
  v_exp_f32 v91, v91
  v_mfma_f32_16x16x32_bf16 v[44:47], a[244:247], a[84:87], v[44:47]
  v_exp_f32 v92, v92
  v_cvt_pk_bf16_f32 v196, v88, v89
  v_mfma_f32_16x16x32_bf16 v[52:55], a[240:243], a[104:107], v[52:55]
  v_exp_f32 v93, v93
  v_exp_f32 v94, v94
  v_mfma_f32_16x16x32_bf16 v[52:55], a[244:247], a[108:111], v[52:55]
  v_cvt_pk_bf16_f32 v197, v90, v91
  v_exp_f32 v95, v95
  v_mfma_f32_16x16x32_bf16 v[60:63], a[240:243], a[128:131], v[60:63]
  v_exp_f32 v96, v96
  v_cvt_pk_bf16_f32 v198, v92, v93
  v_mfma_f32_16x16x32_bf16 v[60:63], a[244:247], a[132:135], v[60:63]
  s_waitcnt vmcnt(21) lgkmcnt(0)
  s_barrier
  ds_read_b128 a[240:243], v0 offset:12288
  v_mfma_f32_16x16x32_bf16 v[20:23], a[248:251], a[16:19], v[20:23]
  ds_read_b128 a[244:247], v1 offset:12288
  v_exp_f32 v97, v97
  v_mfma_f32_16x16x32_bf16 v[20:23], a[252:255], a[20:23], v[20:23]
  v_exp_f32 v98, v98
  v_cvt_pk_bf16_f32 v199, v94, v95
  v_mfma_f32_16x16x32_bf16 v[28:31], a[248:251], a[40:43], v[28:31]
  v_exp_f32 v99, v99
  v_exp_f32 v100, v100
  v_mfma_f32_16x16x32_bf16 v[28:31], a[252:255], a[44:47], v[28:31]
  v_cvt_pk_bf16_f32 v200, v96, v97
  v_exp_f32 v101, v101
  v_mfma_f32_16x16x32_bf16 v[36:39], a[248:251], a[64:67], v[36:39]
  s_add_u32 m0, s32, 61440
  v_exp_f32 v102, v102
  v_mfma_f32_16x16x32_bf16 v[36:39], a[252:255], a[68:71], v[36:39]
  s_add_u32 s40, s38, 36992
  v_cvt_pk_bf16_f32 v201, v98, v99
  v_exp_f32 v103, v103
  v_mfma_f32_16x16x32_bf16 v[44:47], a[248:251], a[88:91], v[44:47]
  buffer_load_dwordx4 v2, s[20:23], s40 offen nt lds
  v_mfma_f32_16x16x32_bf16 v[44:47], a[252:255], a[92:95], v[44:47]
  s_add_u32 s40, s38, 39040
  v_exp_f32 v104, v104
  v_cvt_pk_bf16_f32 v202, v100, v101
  v_mfma_f32_16x16x32_bf16 v[52:55], a[248:251], a[112:115], v[52:55]
  buffer_load_dwordx4 v2, s[20:23], s40 offen offset:1024 nt lds
  v_exp_f32 v105, v105
  v_mfma_f32_16x16x32_bf16 v[52:55], a[252:255], a[116:119], v[52:55]
  s_add_u32 s40, s38, 41088
  v_exp_f32 v106, v106
  v_mfma_f32_16x16x32_bf16 v[60:63], a[248:251], a[136:139], v[60:63]
  buffer_load_dwordx4 v2, s[20:23], s40 offen offset:2048 nt lds
  v_cvt_pk_bf16_f32 v203, v102, v103
  v_mfma_f32_16x16x32_bf16 v[60:63], a[252:255], a[140:143], v[60:63]
  s_waitcnt lgkmcnt(0)
  v_exp_f32 v107, v107
  v_exp_f32 v108, v108
  v_mfma_f32_16x16x32_bf16 v[64:67], a[240:243], a[0:3], 0
  ds_read_b128 a[248:251], v0 offset:12416
  v_cvt_pk_bf16_f32 v204, v104, v105
  v_mfma_f32_16x16x32_bf16 v[64:67], a[244:247], a[4:7], v[64:67]
  ds_read_b128 a[252:255], v1 offset:12416
  v_exp_f32 v109, v109
  v_mfma_f32_16x16x32_bf16 v[72:75], a[240:243], a[24:27], 0
  v_exp_f32 v110, v110
  v_cvt_pk_bf16_f32 v205, v106, v107
  v_mfma_f32_16x16x32_bf16 v[72:75], a[244:247], a[28:31], v[72:75]
  v_exp_f32 v111, v111
  v_cvt_pk_bf16_f32 v206, v108, v109
  v_cvt_pk_bf16_f32 v207, v110, v111
  v_mfma_f32_16x16x32_bf16 v[80:83], a[240:243], a[48:51], 0
  v_fma_f32 v16, v16, s30, -v4
  v_fma_f32 v17, v17, s30, -v4
  v_fma_f32 v18, v18, s30, -v4
  v_mfma_f32_16x16x32_bf16 v[80:83], a[244:247], a[52:55], v[80:83]
  v_max_f32 v3, v16, v17
  v_fma_f32 v19, v19, s30, -v4
  v_fma_f32 v20, v20, s30, -v4
  v_mfma_f32_16x16x32_bf16 v[88:91], a[240:243], a[72:75], 0
  v_max3_f32 v3, v3, v18, v19
  v_fma_f32 v21, v21, s30, -v4
  v_fma_f32 v22, v22, s30, -v4
  v_mfma_f32_16x16x32_bf16 v[88:91], a[244:247], a[76:79], v[88:91]
  v_max3_f32 v3, v3, v20, v21
  v_fma_f32 v23, v23, s30, -v4
  v_fma_f32 v24, v24, s30, -v5
  v_mfma_f32_16x16x32_bf16 v[96:99], a[240:243], a[96:99], 0
  v_max3_f32 v3, v3, v22, v23
  v_fma_f32 v25, v25, s30, -v5
  v_fma_f32 v26, v26, s30, -v5
  v_mfma_f32_16x16x32_bf16 v[96:99], a[244:247], a[100:103], v[96:99]
  v_max3_f32 v3, v3, v24, v25
  v_fma_f32 v27, v27, s30, -v5
  v_fma_f32 v28, v28, s30, -v5
  v_mfma_f32_16x16x32_bf16 v[104:107], a[240:243], a[120:123], 0
  v_max3_f32 v3, v3, v26, v27
  v_fma_f32 v29, v29, s30, -v5
  v_fma_f32 v30, v30, s30, -v5
  v_max3_f32 v3, v3, v28, v29
  v_mfma_f32_16x16x32_bf16 v[104:107], a[244:247], a[124:127], v[104:107]
  s_waitcnt lgkmcnt(0)
  v_fma_f32 v31, v31, s30, -v5
  v_fma_f32 v32, v32, s30, -v6
  v_max3_f32 v3, v3, v30, v31
  v_mfma_f32_16x16x32_bf16 v[64:67], a[248:251], a[8:11], v[64:67]
  ds_read_b128 a[240:243], v0 offset:12544
  v_fma_f32 v33, v33, s30, -v6
  v_fma_f32 v34, v34, s30, -v6
  v_mfma_f32_16x16x32_bf16 v[64:67], a[252:255], a[12:15], v[64:67]
  ds_read_b128 a[244:247], v1 offset:12544
  v_max3_f32 v3, v3, v32, v33
  v_fma_f32 v35, v35, s30, -v6
  v_mfma_f32_16x16x32_bf16 v[72:75], a[248:251], a[32:35], v[72:75]
  v_fma_f32 v36, v36, s30, -v6
  v_max3_f32 v3, v3, v34, v35
  v_fma_f32 v37, v37, s30, -v6
  v_mfma_f32_16x16x32_bf16 v[72:75], a[252:255], a[36:39], v[72:75]
  v_fma_f32 v38, v38, s30, -v6
  v_max3_f32 v3, v3, v36, v37
  v_fma_f32 v39, v39, s30, -v6
  v_mfma_f32_16x16x32_bf16 v[80:83], a[248:251], a[56:59], v[80:83]
  v_fma_f32 v40, v40, s30, -v7
  v_max3_f32 v3, v3, v38, v39
  v_fma_f32 v41, v41, s30, -v7
  v_mfma_f32_16x16x32_bf16 v[80:83], a[252:255], a[60:63], v[80:83]
  v_fma_f32 v42, v42, s30, -v7
  v_max3_f32 v3, v3, v40, v41
  v_fma_f32 v43, v43, s30, -v7
  v_mfma_f32_16x16x32_bf16 v[88:91], a[248:251], a[80:83], v[88:91]
  v_fma_f32 v44, v44, s30, -v7
  v_max3_f32 v3, v3, v42, v43
  v_fma_f32 v45, v45, s30, -v7
  v_mfma_f32_16x16x32_bf16 v[88:91], a[252:255], a[84:87], v[88:91]
  v_fma_f32 v46, v46, s30, -v7
  v_max3_f32 v3, v3, v44, v45
  v_fma_f32 v47, v47, s30, -v7
  v_mfma_f32_16x16x32_bf16 v[96:99], a[248:251], a[104:107], v[96:99]
  v_fma_f32 v48, v48, s30, -v8
  v_max3_f32 v3, v3, v46, v47
  v_fma_f32 v49, v49, s30, -v8
  v_mfma_f32_16x16x32_bf16 v[96:99], a[252:255], a[108:111], v[96:99]
  v_fma_f32 v50, v50, s30, -v8
  v_max3_f32 v3, v3, v48, v49
  v_fma_f32 v51, v51, s30, -v8
  v_mfma_f32_16x16x32_bf16 v[104:107], a[248:251], a[128:131], v[104:107]
  v_fma_f32 v52, v52, s30, -v8
  v_max3_f32 v3, v3, v50, v51
  v_fma_f32 v53, v53, s30, -v8
  v_fma_f32 v54, v54, s30, -v8
  v_mfma_f32_16x16x32_bf16 v[104:107], a[252:255], a[132:135], v[104:107]
  s_waitcnt lgkmcnt(0)
  v_max3_f32 v3, v3, v52, v53
  v_fma_f32 v55, v55, s30, -v8
  v_fma_f32 v56, v56, s30, -v9
  v_mfma_f32_16x16x32_bf16 v[64:67], a[240:243], a[16:19], v[64:67]
  ds_read_b128 a[248:251], v0 offset:18432
  v_max3_f32 v3, v3, v54, v55
  v_fma_f32 v57, v57, s30, -v9
  v_mfma_f32_16x16x32_bf16 v[64:67], a[244:247], a[20:23], v[64:67]
  ds_read_b128 a[252:255], v1 offset:18432
  v_fma_f32 v58, v58, s30, -v9
  v_max3_f32 v3, v3, v56, v57
  v_mfma_f32_16x16x32_bf16 v[72:75], a[240:243], a[40:43], v[72:75]
  s_add_u32 m0, s32, 73728
  v_fma_f32 v59, v59, s30, -v9
  v_fma_f32 v60, v60, s30, -v9
  v_mfma_f32_16x16x32_bf16 v[72:75], a[244:247], a[44:47], v[72:75]
  s_add_u32 s40, s38, 73856
  v_max3_f32 v3, v3, v58, v59
  v_fma_f32 v61, v61, s30, -v9
  v_fma_f32 v62, v62, s30, -v9
  v_mfma_f32_16x16x32_bf16 v[80:83], a[240:243], a[64:67], v[80:83]
  buffer_load_dwordx4 v2, s[20:23], s40 offen nt lds
  v_max3_f32 v3, v3, v60, v61
  v_mfma_f32_16x16x32_bf16 v[80:83], a[244:247], a[68:71], v[80:83]
  s_add_u32 s40, s38, 75904
  v_fma_f32 v63, v63, s30, -v9
  v_max3_f32 v3, v3, v62, v63
  v_cmp_lt_f32 vcc, s31, v3
  v_mfma_f32_16x16x32_bf16 v[88:91], a[240:243], a[88:91], v[88:91]
  buffer_load_dwordx4 v2, s[20:23], s40 offen offset:1024 nt lds
  s_cbranch_vccnz L_slow_0_8
L_back_0_8:
  v_mfma_f32_16x16x32_bf16 v[88:91], a[244:247], a[92:95], v[88:91]
  s_add_u32 s40, s38, 77952
  v_exp_f32 v16, v16
  v_mfma_f32_16x16x32_bf16 v[96:99], a[240:243], a[112:115], v[96:99]
  buffer_load_dwordx4 v2, s[20:23], s40 offen offset:2048 nt lds
  v_exp_f32 v17, v17
  v_mfma_f32_16x16x32_bf16 v[96:99], a[244:247], a[116:119], v[96:99]
  v_exp_f32 v18, v18
  v_exp_f32 v19, v19
  v_mfma_f32_16x16x32_bf16 v[104:107], a[240:243], a[136:139], v[104:107]
  v_exp_f32 v20, v20
  v_mfma_f32_16x16x32_bf16 v[104:107], a[244:247], a[140:143], v[104:107]
  s_waitcnt lgkmcnt(0)
  v_cvt_pk_bf16_f32 v208, v16, v17
  v_exp_f32 v21, v21
  v_mfma_f32_16x16x32_bf16 v[68:71], a[248:251], a[0:3], 0
  ds_read_b128 a[240:243], v0 offset:18560
  v_exp_f32 v22, v22
  v_mfma_f32_16x16x32_bf16 v[68:71], a[252:255], a[4:7], v[68:71]
  ds_read_b128 a[244:247], v1 offset:18560
  v_cvt_pk_bf16_f32 v209, v18, v19
  v_exp_f32 v23, v23
  v_mfma_f32_16x16x32_bf16 v[76:79], a[248:251], a[24:27], 0
  v_exp_f32 v24, v24
  v_cvt_pk_bf16_f32 v210, v20, v21
  v_mfma_f32_16x16x32_bf16 v[76:79], a[252:255], a[28:31], v[76:79]
  v_exp_f32 v25, v25
  v_mfma_f32_16x16x32_bf16 v[84:87], a[248:251], a[48:51], 0
  v_exp_f32 v26, v26
  v_cvt_pk_bf16_f32 v211, v22, v23
  v_mfma_f32_16x16x32_bf16 v[84:87], a[252:255], a[52:55], v[84:87]
  v_exp_f32 v27, v27
  v_exp_f32 v28, v28
  v_mfma_f32_16x16x32_bf16 v[92:95], a[248:251], a[72:75], 0
  v_cvt_pk_bf16_f32 v212, v24, v25
  v_exp_f32 v29, v29
  v_mfma_f32_16x16x32_bf16 v[92:95], a[252:255], a[76:79], v[92:95]
  v_exp_f32 v30, v30
  v_cvt_pk_bf16_f32 v213, v26, v27
  v_mfma_f32_16x16x32_bf16 v[100:103], a[248:251], a[96:99], 0
  v_exp_f32 v31, v31
  v_exp_f32 v32, v32
  v_mfma_f32_16x16x32_bf16 v[100:103], a[252:255], a[100:103], v[100:103]
  v_cvt_pk_bf16_f32 v214, v28, v29
  v_exp_f32 v33, v33
  v_mfma_f32_16x16x32_bf16 v[108:111], a[248:251], a[120:123], 0
  v_exp_f32 v34, v34
  v_cvt_pk_bf16_f32 v215, v30, v31
  v_mfma_f32_16x16x32_bf16 v[108:111], a[252:255], a[124:127], v[108:111]
  s_waitcnt lgkmcnt(0)
  v_exp_f32 v35, v35
  v_mfma_f32_16x16x32_bf16 v[68:71], a[240:243], a[8:11], v[68:71]
  ds_read_b128 a[248:251], v0 offset:18688
  v_exp_f32 v36, v36
  v_cvt_pk_bf16_f32 v216, v32, v33
  v_mfma_f32_16x16x32_bf16 v[68:71], a[244:247], a[12:15], v[68:71]
  ds_read_b128 a[252:255], v1 offset:18688
  v_exp_f32 v37, v37
  v_mfma_f32_16x16x32_bf16 v[76:79], a[240:243], a[32:35], v[76:79]
  v_exp_f32 v38, v38
  v_cvt_pk_bf16_f32 v217, v34, v35
  v_mfma_f32_16x16x32_bf16 v[76:79], a[244:247], a[36:39], v[76:79]
  v_exp_f32 v39, v39
  v_exp_f32 v40, v40
  v_mfma_f32_16x16x32_bf16 v[84:87], a[240:243], a[56:59], v[84:87]
  v_cvt_pk_bf16_f32 v218, v36, v37
  v_exp_f32 v41, v41
  v_mfma_f32_16x16x32_bf16 v[84:87], a[244:247], a[60:63], v[84:87]
  v_exp_f32 v42, v42
  v_mfma_f32_16x16x32_bf16 v[92:95], a[240:243], a[80:83], v[92:95]
  v_cvt_pk_bf16_f32 v219, v38, v39
  v_exp_f32 v43, v43
  v_mfma_f32_16x16x32_bf16 v[92:95], a[244:247], a[84:87], v[92:95]
  v_exp_f32 v44, v44
  v_cvt_pk_bf16_f32 v220, v40, v41
  v_mfma_f32_16x16x32_bf16 v[100:103], a[240:243], a[104:107], v[100:103]
  v_exp_f32 v45, v45
  v_exp_f32 v46, v46
  v_mfma_f32_16x16x32_bf16 v[100:103], a[244:247], a[108:111], v[100:103]
  v_cvt_pk_bf16_f32 v221, v42, v43
  v_exp_f32 v47, v47
  v_mfma_f32_16x16x32_bf16 v[108:111], a[240:243], a[128:131], v[108:111]
  v_exp_f32 v48, v48
  v_cvt_pk_bf16_f32 v222, v44, v45
  v_mfma_f32_16x16x32_bf16 v[108:111], a[244:247], a[132:135], v[108:111]
  s_waitcnt vmcnt(24) lgkmcnt(0)
  s_barrier
  ds_read_b128 a[240:243], v0 offset:24576
  v_mfma_f32_16x16x32_bf16 v[68:71], a[248:251], a[16:19], v[68:71]
  ds_read_b128 a[244:247], v1 offset:24576
  v_exp_f32 v49, v49
  v_mfma_f32_16x16x32_bf16 v[68:71], a[252:255], a[20:23], v[68:71]
  v_exp_f32 v50, v50
  v_cvt_pk_bf16_f32 v223, v46, v47
  v_mfma_f32_16x16x32_bf16 v[76:79], a[248:251], a[40:43], v[76:79]
  v_exp_f32 v51, v51
  v_exp_f32 v52, v52
  v_mfma_f32_16x16x32_bf16 v[76:79], a[252:255], a[44:47], v[76:79]
  v_cvt_pk_bf16_f32 v224, v48, v49
  v_exp_f32 v53, v53
  v_mfma_f32_16x16x32_bf16 v[84:87], a[248:251], a[64:67], v[84:87]
  s_add_u32 m0, s32, 86016
  v_exp_f32 v54, v54
  v_mfma_f32_16x16x32_bf16 v[84:87], a[252:255], a[68:71], v[84:87]
  s_add_u32 s40, s38, 110720
  v_cvt_pk_bf16_f32 v225, v50, v51
  v_exp_f32 v55, v55
  v_mfma_f32_16x16x32_bf16 v[92:95], a[248:251], a[88:91], v[92:95]
  buffer_load_dwordx4 v2, s[20:23], s40 offen nt lds
  v_mfma_f32_16x16x32_bf16 v[92:95], a[252:255], a[92:95], v[92:95]
  s_add_u32 s40, s38, 112768
  v_exp_f32 v56, v56
  v_cvt_pk_bf16_f32 v226, v52, v53
  v_mfma_f32_16x16x32_bf16 v[100:103], a[248:251], a[112:115], v[100:103]
  buffer_load_dwordx4 v2, s[20:23], s40 offen offset:1024 nt lds
  v_exp_f32 v57, v57
  v_mfma_f32_16x16x32_bf16 v[100:103], a[252:255], a[116:119], v[100:103]
  s_add_u32 s40, s38, 114816
  v_exp_f32 v58, v58
  v_mfma_f32_16x16x32_bf16 v[108:111], a[248:251], a[136:139], v[108:111]
  buffer_load_dwordx4 v2, s[20:23], s40 offen offset:2048 nt lds
  v_cvt_pk_bf16_f32 v227, v54, v55
  v_mfma_f32_16x16x32_bf16 v[108:111], a[252:255], a[140:143], v[108:111]
  s_waitcnt lgkmcnt(0)
  v_exp_f32 v59, v59
  v_exp_f32 v60, v60
  v_mfma_f32_16x16x32_bf16 v[16:19], a[240:243], a[0:3], 0
  ds_read_b128 a[248:251], v0 offset:24704
  v_cvt_pk_bf16_f32 v228, v56, v57
  v_mfma_f32_16x16x32_bf16 v[16:19], a[244:247], a[4:7], v[16:19]
  ds_read_b128 a[252:255], v1 offset:24704
  v_exp_f32 v61, v61
  v_mfma_f32_16x16x32_bf16 v[24:27], a[240:243], a[24:27], 0
  v_exp_f32 v62, v62
  v_cvt_pk_bf16_f32 v229, v58, v59
  v_mfma_f32_16x16x32_bf16 v[24:27], a[244:247], a[28:31], v[24:27]
  v_exp_f32 v63, v63
  v_cvt_pk_bf16_f32 v230, v60, v61
  v_cvt_pk_bf16_f32 v231, v62, v63
  v_mfma_f32_16x16x32_bf16 v[32:35], a[240:243], a[48:51], 0
  v_fma_f32 v64, v64, s30, -v4
  v_fma_f32 v65, v65, s30, -v4
  v_fma_f32 v66, v66, s30, -v4
  v_mfma_f32_16x16x32_bf16 v[32:35], a[244:247], a[52:55], v[32:35]
  v_max_f32 v3, v64, v65
  v_fma_f32 v67, v67, s30, -v4
  v_fma_f32 v68, v68, s30, -v4
  v_mfma_f32_16x16x32_bf16 v[40:43], a[240:243], a[72:75], 0
  v_max3_f32 v3, v3, v66, v67
  v_fma_f32 v69, v69, s30, -v4
  v_fma_f32 v70, v70, s30, -v4
  v_mfma_f32_16x16x32_bf16 v[40:43], a[244:247], a[76:79], v[40:43]
  v_max3_f32 v3, v3, v68, v69
  v_fma_f32 v71, v71, s30, -v4
  v_fma_f32 v72, v72, s30, -v5
  v_mfma_f32_16x16x32_bf16 v[48:51], a[240:243], a[96:99], 0
  v_max3_f32 v3, v3, v70, v71
  v_fma_f32 v73, v73, s30, -v5
  v_fma_f32 v74, v74, s30, -v5
  v_mfma_f32_16x16x32_bf16 v[48:51], a[244:247], a[100:103], v[48:51]
  v_max3_f32 v3, v3, v72, v73
  v_fma_f32 v75, v75, s30, -v5
  v_fma_f32 v76, v76, s30, -v5
  v_mfma_f32_16x16x32_bf16 v[56:59], a[240:243], a[120:123], 0
  v_max3_f32 v3, v3, v74, v75
  v_fma_f32 v77, v77, s30, -v5
  v_fma_f32 v78, v78, s30, -v5
  v_max3_f32 v3, v3, v76, v77
  v_mfma_f32_16x16x32_bf16 v[56:59], a[244:247], a[124:127], v[56:59]
  s_waitcnt lgkmcnt(0)
  v_fma_f32 v79, v79, s30, -v5
  v_fma_f32 v80, v80, s30, -v6
  v_max3_f32 v3, v3, v78, v79
  v_mfma_f32_16x16x32_bf16 v[16:19], a[248:251], a[8:11], v[16:19]
  ds_read_b128 a[240:243], v0 offset:24832
  v_fma_f32 v81, v81, s30, -v6
  v_fma_f32 v82, v82, s30, -v6
  v_mfma_f32_16x16x32_bf16 v[16:19], a[252:255], a[12:15], v[16:19]
  ds_read_b128 a[244:247], v1 offset:24832
  v_max3_f32 v3, v3, v80, v81
  v_fma_f32 v83, v83, s30, -v6
  v_mfma_f32_16x16x32_bf16 v[24:27], a[248:251], a[32:35], v[24:27]
  v_fma_f32 v84, v84, s30, -v6
  v_max3_f32 v3, v3, v82, v83
  v_fma_f32 v85, v85, s30, -v6
  v_mfma_f32_16x16x32_bf16 v[24:27], a[252:255], a[36:39], v[24:27]
  v_fma_f32 v86, v86, s30, -v6
  v_max3_f32 v3, v3, v84, v85
  v_fma_f32 v87, v87, s30, -v6
  v_mfma_f32_16x16x32_bf16 v[32:35], a[248:251], a[56:59], v[32:35]
  v_fma_f32 v88, v88, s30, -v7
  v_max3_f32 v3, v3, v86, v87
  v_fma_f32 v89, v89, s30, -v7
  v_mfma_f32_16x16x32_bf16 v[32:35], a[252:255], a[60:63], v[32:35]
  v_fma_f32 v90, v90, s30, -v7
  v_max3_f32 v3, v3, v88, v89
  v_fma_f32 v91, v91, s30, -v7
  v_mfma_f32_16x16x32_bf16 v[40:43], a[248:251], a[80:83], v[40:43]
  v_fma_f32 v92, v92, s30, -v7
  v_max3_f32 v3, v3, v90, v91
  v_fma_f32 v93, v93, s30, -v7
  v_mfma_f32_16x16x32_bf16 v[40:43], a[252:255], a[84:87], v[40:43]
  v_fma_f32 v94, v94, s30, -v7
  v_max3_f32 v3, v3, v92, v93
  v_fma_f32 v95, v95, s30, -v7
  v_mfma_f32_16x16x32_bf16 v[48:51], a[248:251], a[104:107], v[48:51]
  v_fma_f32 v96, v96, s30, -v8
  v_max3_f32 v3, v3, v94, v95
  v_fma_f32 v97, v97, s30, -v8
  v_mfma_f32_16x16x32_bf16 v[48:51], a[252:255], a[108:111], v[48:51]
  v_fma_f32 v98, v98, s30, -v8
  v_max3_f32 v3, v3, v96, v97
  v_fma_f32 v99, v99, s30, -v8
  v_mfma_f32_16x16x32_bf16 v[56:59], a[248:251], a[128:131], v[56:59]
  v_fma_f32 v100, v100, s30, -v8
  v_max3_f32 v3, v3, v98, v99
  v_fma_f32 v101, v101, s30, -v8
  v_fma_f32 v102, v102, s30, -v8
  v_mfma_f32_16x16x32_bf16 v[56:59], a[252:255], a[132:135], v[56:59]
  s_waitcnt lgkmcnt(0)
  v_max3_f32 v3, v3, v100, v101
  v_fma_f32 v103, v103, s30, -v8
  v_fma_f32 v104, v104, s30, -v9
  v_mfma_f32_16x16x32_bf16 v[16:19], a[240:243], a[16:19], v[16:19]
  ds_read_b128 a[248:251], v0 offset:30720
  v_max3_f32 v3, v3, v102, v103
  v_fma_f32 v105, v105, s30, -v9
  v_mfma_f32_16x16x32_bf16 v[16:19], a[244:247], a[20:23], v[16:19]
  ds_read_b128 a[252:255], v1 offset:30720
  v_fma_f32 v106, v106, s30, -v9
  v_max3_f32 v3, v3, v104, v105
  v_mfma_f32_16x16x32_bf16 v[24:27], a[240:243], a[40:43], v[24:27]
  s_add_u32 m0, s32, 98304
  v_fma_f32 v107, v107, s30, -v9
  v_fma_f32 v108, v108, s30, -v9
  v_mfma_f32_16x16x32_bf16 v[24:27], a[244:247], a[44:47], v[24:27]
  s_add_u32 s40, s38, 256
  v_max3_f32 v3, v3, v106, v107
  v_fma_f32 v109, v109, s30, -v9
  v_fma_f32 v110, v110, s30, -v9
  v_mfma_f32_16x16x32_bf16 v[32:35], a[240:243], a[64:67], v[32:35]
  buffer_load_dwordx4 v2, s[20:23], s40 offen nt lds
  v_max3_f32 v3, v3, v108, v109
  v_mfma_f32_16x16x32_bf16 v[32:35], a[244:247], a[68:71], v[32:35]
  s_add_u32 s40, s38, 2304
  v_fma_f32 v111, v111, s30, -v9
  v_max3_f32 v3, v3, v110, v111
  v_cmp_lt_f32 vcc, s31, v3
  v_mfma_f32_16x16x32_bf16 v[40:43], a[240:243], a[88:91], v[40:43]
  buffer_load_dwordx4 v2, s[20:23], s40 offen offset:1024 nt lds
  s_cbranch_vccnz L_slow_0_9
L_back_0_9:
  v_mfma_f32_16x16x32_bf16 v[40:43], a[244:247], a[92:95], v[40:43]
  s_add_u32 s40, s38, 4352
  v_exp_f32 v64, v64
  v_mfma_f32_16x16x32_bf16 v[48:51], a[240:243], a[112:115], v[48:51]
  buffer_load_dwordx4 v2, s[20:23], s40 offen offset:2048 nt lds
  v_exp_f32 v65, v65
  v_mfma_f32_16x16x32_bf16 v[48:51], a[244:247], a[116:119], v[48:51]
  v_exp_f32 v66, v66
  v_exp_f32 v67, v67
  v_mfma_f32_16x16x32_bf16 v[56:59], a[240:243], a[136:139], v[56:59]
  v_exp_f32 v68, v68
  v_mfma_f32_16x16x32_bf16 v[56:59], a[244:247], a[140:143], v[56:59]
  s_waitcnt lgkmcnt(0)
  v_cvt_pk_bf16_f32 v232, v64, v65
  v_exp_f32 v69, v69
  v_mfma_f32_16x16x32_bf16 v[20:23], a[248:251], a[0:3], 0
  ds_read_b128 a[240:243], v0 offset:30848
  v_exp_f32 v70, v70
  v_mfma_f32_16x16x32_bf16 v[20:23], a[252:255], a[4:7], v[20:23]
  ds_read_b128 a[244:247], v1 offset:30848
  v_cvt_pk_bf16_f32 v233, v66, v67
  v_exp_f32 v71, v71
  v_mfma_f32_16x16x32_bf16 v[28:31], a[248:251], a[24:27], 0
  v_exp_f32 v72, v72
  v_cvt_pk_bf16_f32 v234, v68, v69
  v_mfma_f32_16x16x32_bf16 v[28:31], a[252:255], a[28:31], v[28:31]
  v_exp_f32 v73, v73
  v_mfma_f32_16x16x32_bf16 v[36:39], a[248:251], a[48:51], 0
  v_exp_f32 v74, v74
  v_cvt_pk_bf16_f32 v235, v70, v71
  v_mfma_f32_16x16x32_bf16 v[36:39], a[252:255], a[52:55], v[36:39]
  v_exp_f32 v75, v75
  v_exp_f32 v76, v76
  v_mfma_f32_16x16x32_bf16 v[44:47], a[248:251], a[72:75], 0
  v_cvt_pk_bf16_f32 v236, v72, v73
  v_exp_f32 v77, v77
  v_mfma_f32_16x16x32_bf16 v[44:47], a[252:255], a[76:79], v[44:47]
  v_exp_f32 v78, v78
  v_cvt_pk_bf16_f32 v237, v74, v75
  v_mfma_f32_16x16x32_bf16 v[52:55], a[248:251], a[96:99], 0
  v_exp_f32 v79, v79
  v_exp_f32 v80, v80
  v_mfma_f32_16x16x32_bf16 v[52:55], a[252:255], a[100:103], v[52:55]
  v_cvt_pk_bf16_f32 v238, v76, v77
  v_exp_f32 v81, v81
  v_mfma_f32_16x16x32_bf16 v[60:63], a[248:251], a[120:123], 0
  v_exp_f32 v82, v82
  v_cvt_pk_bf16_f32 v239, v78, v79
  v_mfma_f32_16x16x32_bf16 v[60:63], a[252:255], a[124:127], v[60:63]
  s_waitcnt lgkmcnt(0)
  v_exp_f32 v83, v83
  v_mfma_f32_16x16x32_bf16 v[20:23], a[240:243], a[8:11], v[20:23]
  ds_read_b128 a[248:251], v0 offset:30976
  v_exp_f32 v84, v84
  v_cvt_pk_bf16_f32 v240, v80, v81
  v_mfma_f32_16x16x32_bf16 v[20:23], a[244:247], a[12:15], v[20:23]
  ds_read_b128 a[252:255], v1 offset:30976
  v_exp_f32 v85, v85
  v_mfma_f32_16x16x32_bf16 v[28:31], a[240:243], a[32:35], v[28:31]
  v_exp_f32 v86, v86
  v_cvt_pk_bf16_f32 v241, v82, v83
  v_mfma_f32_16x16x32_bf16 v[28:31], a[244:247], a[36:39], v[28:31]
L_pad_4:
  s_cbranch_execz L_pad_8
  v_exp_f32 v87, v87
  v_exp_f32 v88, v88
  v_mfma_f32_16x16x32_bf16 v[36:39], a[240:243], a[56:59], v[36:39]
  v_cvt_pk_bf16_f32 v242, v84, v85
  v_exp_f32 v89, v89
  v_mfma_f32_16x16x32_bf16 v[36:39], a[244:247], a[60:63], v[36:39]
  v_exp_f32 v90, v90
  v_mfma_f32_16x16x32_bf16 v[44:47], a[240:243], a[80:83], v[44:47]
  v_cvt_pk_bf16_f32 v243, v86, v87
  v_exp_f32 v91, v91
  v_mfma_f32_16x16x32_bf16 v[44:47], a[244:247], a[84:87], v[44:47]
  v_exp_f32 v92, v92
  v_cvt_pk_bf16_f32 v244, v88, v89
  v_mfma_f32_16x16x32_bf16 v[52:55], a[240:243], a[104:107], v[52:55]
  v_exp_f32 v93, v93
  v_exp_f32 v94, v94
  v_mfma_f32_16x16x32_bf16 v[52:55], a[244:247], a[108:111], v[52:55]
  v_cvt_pk_bf16_f32 v245, v90, v91
  v_exp_f32 v95, v95
  v_mfma_f32_16x16x32_bf16 v[60:63], a[240:243], a[128:131], v[60:63]
  v_exp_f32 v96, v96
  v_cvt_pk_bf16_f32 v246, v92, v93
  v_mfma_f32_16x16x32_bf16 v[60:63], a[244:247], a[132:135], v[60:63]
  s_waitcnt vmcnt(27) lgkmcnt(0)
  s_barrier
  ds_read_b128 a[240:243], v0 offset:36864
  v_mfma_f32_16x16x32_bf16 v[20:23], a[248:251], a[16:19], v[20:23]
  ds_read_b128 a[244:247], v1 offset:36864
  v_exp_f32 v97, v97
  v_mfma_f32_16x16x32_bf16 v[20:23], a[252:255], a[20:23], v[20:23]
  v_exp_f32 v98, v98
  v_cvt_pk_bf16_f32 v247, v94, v95
  v_mfma_f32_16x16x32_bf16 v[28:31], a[248:251], a[40:43], v[28:31]
  v_exp_f32 v99, v99
  v_exp_f32 v100, v100
  v_mfma_f32_16x16x32_bf16 v[28:31], a[252:255], a[44:47], v[28:31]
  v_cvt_pk_bf16_f32 v248, v96, v97
  v_exp_f32 v101, v101
  v_mfma_f32_16x16x32_bf16 v[36:39], a[248:251], a[64:67], v[36:39]
  s_add_u32 m0, s32, 110592
  v_exp_f32 v102, v102
  v_mfma_f32_16x16x32_bf16 v[36:39], a[252:255], a[68:71], v[36:39]
  s_add_u32 s40, s38, 37120
  v_cvt_pk_bf16_f32 v249, v98, v99
  v_exp_f32 v103, v103
  v_mfma_f32_16x16x32_bf16 v[44:47], a[248:251], a[88:91], v[44:47]
  buffer_load_dwordx4 v2, s[20:23], s40 offen nt lds
  v_mfma_f32_16x16x32_bf16 v[44:47], a[252:255], a[92:95], v[44:47]
  s_add_u32 s40, s38, 39168
  v_exp_f32 v104, v104
  v_cvt_pk_bf16_f32 v250, v100, v101
  v_mfma_f32_16x16x32_bf16 v[52:55], a[248:251], a[112:115], v[52:55]
  buffer_load_dwordx4 v2, s[20:23], s40 offen offset:1024 nt lds
  v_exp_f32 v105, v105
  v_mfma_f32_16x16x32_bf16 v[52:55], a[252:255], a[116:119], v[52:55]
  s_add_u32 s40, s38, 41216
  v_exp_f32 v106, v106
  v_mfma_f32_16x16x32_bf16 v[60:63], a[248:251], a[136:139], v[60:63]
  buffer_load_dwordx4 v2, s[20:23], s40 offen offset:2048 nt lds
  v_cvt_pk_bf16_f32 v251, v102, v103
  v_mfma_f32_16x16x32_bf16 v[60:63], a[252:255], a[140:143], v[60:63]
  s_waitcnt lgkmcnt(0)
  v_exp_f32 v107, v107
  v_exp_f32 v108, v108
  v_mfma_f32_16x16x32_bf16 v[64:67], a[240:243], a[0:3], 0
  ds_read_b128 a[248:251], v0 offset:36992
  v_cvt_pk_bf16_f32 v252, v104, v105
  v_mfma_f32_16x16x32_bf16 v[64:67], a[244:247], a[4:7], v[64:67]
  ds_read_b128 a[252:255], v1 offset:36992
  v_exp_f32 v109, v109
  v_mfma_f32_16x16x32_bf16 v[72:75], a[240:243], a[24:27], 0
  v_exp_f32 v110, v110
  v_cvt_pk_bf16_f32 v253, v106, v107
  v_mfma_f32_16x16x32_bf16 v[72:75], a[244:247], a[28:31], v[72:75]
  v_exp_f32 v111, v111
  v_cvt_pk_bf16_f32 v254, v108, v109
  v_cvt_pk_bf16_f32 v255, v110, v111
  v_mfma_f32_16x16x32_bf16 v[80:83], a[240:243], a[48:51], 0
  v_fma_f32 v16, v16, s30, -v4
  v_fma_f32 v17, v17, s30, -v4
  v_mfma_f32_16x16x32_bf16 v[80:83], a[244:247], a[52:55], v[80:83]
  v_fma_f32 v18, v18, s30, -v4
  v_max_f32 v3, v16, v17
  v_mfma_f32_16x16x32_bf16 v[88:91], a[240:243], a[72:75], 0
  v_fma_f32 v19, v19, s30, -v4
  v_mfma_f32_16x16x32_bf16 v[88:91], a[244:247], a[76:79], v[88:91]
  v_fma_f32 v20, v20, s30, -v4
  v_max3_f32 v3, v3, v18, v19
  v_mfma_f32_16x16x32_bf16 v[96:99], a[240:243], a[96:99], 0
  s_add_u32 m0, s28, 0
  v_fma_f32 v21, v21, s30, -v4
  v_mfma_f32_16x16x32_bf16 v[96:99], a[244:247], a[100:103], v[96:99]
  s_add_u32 s40, s37, 0
  v_fma_f32 v22, v22, s30, -v4
  v_max3_f32 v3, v3, v20, v21
  v_mfma_f32_16x16x32_bf16 v[104:107], a[240:243], a[120:123], 0
  buffer_load_dword v10, s[16:19], s40 offen lds
  v_mfma_f32_16x16x32_bf16 v[104:107], a[244:247], a[124:127], v[104:107]
  s_waitcnt lgkmcnt(0)
  v_fma_f32 v23, v23, s30, -v4
  v_fma_f32 v24, v24, s30, -v5
  v_mfma_f32_16x16x32_bf16 v[64:67], a[248:251], a[8:11], v[64:67]
  ds_read_b128 a[240:243], v0 offset:37120
  v_mfma_f32_16x16x32_bf16 v[64:67], a[252:255], a[12:15], v[64:67]
  ds_read_b128 a[244:247], v1 offset:37120
  v_max3_f32 v3, v3, v22, v23
  v_mfma_f32_16x16x32_bf16 v[72:75], a[248:251], a[32:35], v[72:75]
  v_fma_f32 v25, v25, s30, -v5
  v_fma_f32 v26, v26, s30, -v5
  v_mfma_f32_16x16x32_bf16 v[72:75], a[252:255], a[36:39], v[72:75]
  v_max3_f32 v3, v3, v24, v25
  v_fma_f32 v27, v27, s30, -v5
  v_mfma_f32_16x16x32_bf16 v[80:83], a[248:251], a[56:59], v[80:83]
  v_fma_f32 v28, v28, s30, -v5
  v_max3_f32 v3, v3, v26, v27
  v_mfma_f32_16x16x32_bf16 v[80:83], a[252:255], a[60:63], v[80:83]
  v_fma_f32 v29, v29, s30, -v5
  v_mfma_f32_16x16x32_bf16 v[88:91], a[248:251], a[80:83], v[88:91]
  v_fma_f32 v30, v30, s30, -v5
  v_max3_f32 v3, v3, v28, v29
  v_mfma_f32_16x16x32_bf16 v[88:91], a[252:255], a[84:87], v[88:91]
  v_fma_f32 v31, v31, s30, -v5
  v_fma_f32 v32, v32, s30, -v6
  v_mfma_f32_16x16x32_bf16 v[96:99], a[248:251], a[104:107], v[96:99]
  v_max3_f32 v3, v3, v30, v31
  v_fma_f32 v33, v33, s30, -v6
  v_mfma_f32_16x16x32_bf16 v[96:99], a[252:255], a[108:111], v[96:99]
  v_fma_f32 v34, v34, s30, -v6
  v_max3_f32 v3, v3, v32, v33
  v_mfma_f32_16x16x32_bf16 v[104:107], a[248:251], a[128:131], v[104:107]
  v_fma_f32 v35, v35, s30, -v6
  v_mfma_f32_16x16x32_bf16 v[104:107], a[252:255], a[132:135], v[104:107]
  s_waitcnt lgkmcnt(0)
  v_fma_f32 v36, v36, s30, -v6
  v_max3_f32 v3, v3, v34, v35
  v_mfma_f32_16x16x32_bf16 v[64:67], a[240:243], a[16:19], v[64:67]
  ds_read_b128 a[248:251], v0 offset:43008
  v_fma_f32 v37, v37, s30, -v6
  v_mfma_f32_16x16x32_bf16 v[64:67], a[244:247], a[20:23], v[64:67]
  ds_read_b128 a[252:255], v1 offset:43008
  v_fma_f32 v38, v38, s30, -v6
  v_mfma_f32_16x16x32_bf16 v[72:75], a[240:243], a[40:43], v[72:75]
  v_max3_f32 v3, v3, v36, v37
  v_fma_f32 v39, v39, s30, -v6
  v_mfma_f32_16x16x32_bf16 v[72:75], a[244:247], a[44:47], v[72:75]
  v_fma_f32 v40, v40, s30, -v7
  v_mfma_f32_16x16x32_bf16 v[80:83], a[240:243], a[64:67], v[80:83]
  v_max3_f32 v3, v3, v38, v39
  v_fma_f32 v41, v41, s30, -v7
  v_mfma_f32_16x16x32_bf16 v[80:83], a[244:247], a[68:71], v[80:83]
  v_fma_f32 v42, v42, s30, -v7
  v_max3_f32 v3, v3, v40, v41
  v_mfma_f32_16x16x32_bf16 v[88:91], a[240:243], a[88:91], v[88:91]
  v_fma_f32 v43, v43, s30, -v7
  v_fma_f32 v44, v44, s30, -v7
  v_mfma_f32_16x16x32_bf16 v[88:91], a[244:247], a[92:95], v[88:91]
  v_max3_f32 v3, v3, v42, v43
  v_fma_f32 v45, v45, s30, -v7
  v_mfma_f32_16x16x32_bf16 v[96:99], a[240:243], a[112:115], v[96:99]
  v_fma_f32 v46, v46, s30, -v7
  v_mfma_f32_16x16x32_bf16 v[96:99], a[244:247], a[116:119], v[96:99]
  v_max3_f32 v3, v3, v44, v45
  v_fma_f32 v47, v47, s30, -v7
  v_mfma_f32_16x16x32_bf16 v[104:107], a[240:243], a[136:139], v[104:107]
  v_fma_f32 v48, v48, s30, -v8
  v_max3_f32 v3, v3, v46, v47
  v_mfma_f32_16x16x32_bf16 v[104:107], a[244:247], a[140:143], v[104:107]
  s_waitcnt lgkmcnt(0)
  v_fma_f32 v49, v49, s30, -v8
  v_fma_f32 v50, v50, s30, -v8
  v_mfma_f32_16x16x32_bf16 v[68:71], a[248:251], a[0:3], 0
  ds_read_b128 a[240:243], v0 offset:43136
  v_max3_f32 v3, v3, v48, v49
  v_mfma_f32_16x16x32_bf16 v[68:71], a[252:255], a[4:7], v[68:71]
  ds_read_b128 a[244:247], v1 offset:43136
  v_fma_f32 v51, v51, s30, -v8
  v_mfma_f32_16x16x32_bf16 v[76:79], a[248:251], a[24:27], 0
  v_fma_f32 v52, v52, s30, -v8
  v_mfma_f32_16x16x32_bf16 v[76:79], a[252:255], a[28:31], v[76:79]
  v_max3_f32 v3, v3, v50, v51
  v_fma_f32 v53, v53, s30, -v8
  v_mfma_f32_16x16x32_bf16 v[84:87], a[248:251], a[48:51], 0
  v_fma_f32 v54, v54, s30, -v8
  v_max3_f32 v3, v3, v52, v53
  v_mfma_f32_16x16x32_bf16 v[84:87], a[252:255], a[52:55], v[84:87]
  v_fma_f32 v55, v55, s30, -v8
  v_fma_f32 v56, v56, s30, -v9
  v_mfma_f32_16x16x32_bf16 v[92:95], a[248:251], a[72:75], 0
  v_max3_f32 v3, v3, v54, v55
  v_mfma_f32_16x16x32_bf16 v[92:95], a[252:255], a[76:79], v[92:95]
  v_fma_f32 v57, v57, s30, -v9
  v_fma_f32 v58, v58, s30, -v9
  v_mfma_f32_16x16x32_bf16 v[100:103], a[248:251], a[96:99], 0
  v_max3_f32 v3, v3, v56, v57
  v_fma_f32 v59, v59, s30, -v9
  v_mfma_f32_16x16x32_bf16 v[100:103], a[252:255], a[100:103], v[100:103]
  v_fma_f32 v60, v60, s30, -v9
  v_max3_f32 v3, v3, v58, v59
  v_mfma_f32_16x16x32_bf16 v[108:111], a[248:251], a[120:123], 0
  v_fma_f32 v61, v61, s30, -v9
  v_fma_f32 v62, v62, s30, -v9
  v_mfma_f32_16x16x32_bf16 v[108:111], a[252:255], a[124:127], v[108:111]
  s_waitcnt lgkmcnt(0)
  v_max3_f32 v3, v3, v60, v61
  v_mfma_f32_16x16x32_bf16 v[68:71], a[240:243], a[8:11], v[68:71]
  ds_read_b128 a[248:251], v0 offset:43264
  v_fma_f32 v63, v63, s30, -v9
  v_mfma_f32_16x16x32_bf16 v[68:71], a[244:247], a[12:15], v[68:71]
  ds_read_b128 a[252:255], v1 offset:43264
  v_max3_f32 v3, v3, v62, v63
  v_mfma_f32_16x16x32_bf16 v[76:79], a[240:243], a[32:35], v[76:79]
  v_cmp_lt_f32 vcc, s31, v3
  s_nop 0
  s_cbranch_vccnz L_slow_0_10
L_back_0_10:
  v_mfma_f32_16x16x32_bf16 v[76:79], a[244:247], a[36:39], v[76:79]
  v_exp_f32 v16, v16
  v_mfma_f32_16x16x32_bf16 v[84:87], a[240:243], a[56:59], v[84:87]
  v_exp_f32 v17, v17
  v_exp_f32 v18, v18
  v_mfma_f32_16x16x32_bf16 v[84:87], a[244:247], a[60:63], v[84:87]
  v_exp_f32 v19, v19
  v_mfma_f32_16x16x32_bf16 v[92:95], a[240:243], a[80:83], v[92:95]
  v_mbcnt_lo_u32_b32 v1, -1, 0
  v_exp_f32 v20, v20
  v_mfma_f32_16x16x32_bf16 v[92:95], a[244:247], a[84:87], v[92:95]
  v_mbcnt_hi_u32_b32 v1, -1, v1
  v_lshrrev_b32 v3, 2, v1
  v_mfma_f32_16x16x32_bf16 v[100:103], a[240:243], a[104:107], v[100:103]
  v_lshlrev_b32 v0, 7, v3
  v_cvt_pk_bf16_f32 v16, v16, v17
  v_mfma_f32_16x16x32_bf16 v[100:103], a[244:247], a[108:111], v[100:103]
  v_bfe_u32 v3, v1, 3, 2
  v_lshl_add_u32 v0, v3, 5, v0
  v_exp_f32 v21, v21
  v_mfma_f32_16x16x32_bf16 v[108:111], a[240:243], a[128:131], v[108:111]
  v_and_b32 v3, 3, v1
  v_lshl_add_u32 v0, v3, 3, v0
  v_mfma_f32_16x16x32_bf16 v[108:111], a[244:247], a[132:135], v[108:111]
  s_waitcnt vmcnt(28) lgkmcnt(0)
  s_barrier
  ds_read_b64_tr_b16 a[240:241], v0 offset:0
  v_mfma_f32_16x16x32_bf16 v[68:71], a[248:251], a[16:19], v[68:71]
  ds_read_b64_tr_b16 a[242:243], v0 offset:2048
  v_exp_f32 v22, v22
  v_mfma_f32_16x16x32_bf16 v[68:71], a[252:255], a[20:23], v[68:71]
  ds_read_b64_tr_b16 a[244:245], v0 offset:4096
  v_cvt_pk_bf16_f32 v17, v18, v19
  v_mfma_f32_16x16x32_bf16 v[76:79], a[248:251], a[40:43], v[76:79]
  ds_read_b64_tr_b16 a[246:247], v0 offset:6144
  v_exp_f32 v23, v23
  v_mfma_f32_16x16x32_bf16 v[76:79], a[252:255], a[44:47], v[76:79]
  v_exp_f32 v24, v24
  v_mfma_f32_16x16x32_bf16 v[84:87], a[248:251], a[64:67], v[84:87]
  s_add_u32 m0, s32, 122880
  v_cvt_pk_bf16_f32 v18, v20, v21
  v_exp_f32 v25, v25
  v_mfma_f32_16x16x32_bf16 v[84:87], a[252:255], a[68:71], v[84:87]
  s_add_u32 s40, s38, 73984
  v_exp_f32 v26, v26
  v_mfma_f32_16x16x32_bf16 v[92:95], a[248:251], a[88:91], v[92:95]
  buffer_load_dwordx4 v2, s[20:23], s40 offen nt lds
  v_mfma_f32_16x16x32_bf16 v[92:95], a[252:255], a[92:95], v[92:95]
  s_add_u32 s40, s38, 76032
  v_cvt_pk_bf16_f32 v19, v22, v23
  v_exp_f32 v27, v27
  v_mfma_f32_16x16x32_bf16 v[100:103], a[248:251], a[112:115], v[100:103]
  buffer_load_dwordx4 v2, s[20:23], s40 offen offset:1024 nt lds
  v_mfma_f32_16x16x32_bf16 v[100:103], a[252:255], a[116:119], v[100:103]
  s_add_u32 s40, s38, 78080
  v_exp_f32 v28, v28
  v_mfma_f32_16x16x32_bf16 v[108:111], a[248:251], a[136:139], v[108:111]
  buffer_load_dwordx4 v2, s[20:23], s40 offen offset:2048 nt lds
  v_cvt_pk_bf16_f32 v20, v24, v25
  v_mfma_f32_16x16x32_bf16 v[108:111], a[252:255], a[140:143], v[108:111]
  s_waitcnt lgkmcnt(0)
  v_exp_f32 v29, v29
  v_mfma_f32_16x16x32_bf16 a[0:3], a[240:243], a[144:147], 0
  ds_read_b64_tr_b16 a[248:249], v0 offset:8192
  v_exp_f32 v30, v30
  v_mfma_f32_16x16x32_bf16 a[0:3], a[244:247], a[168:171], a[0:3]
  ds_read_b64_tr_b16 a[250:251], v0 offset:10240
  v_cvt_pk_bf16_f32 v21, v26, v27
  v_mfma_f32_16x16x32_bf16 a[4:7], a[240:243], a[148:151], 0
  v_xor_b32 v0, 32, v0
  v_exp_f32 v31, v31
  v_mfma_f32_16x16x32_bf16 a[4:7], a[244:247], a[172:175], a[4:7]
  ds_read_b64_tr_b16 a[252:253], v0 offset:0
  v_cvt_pk_bf16_f32 v22, v28, v29
  v_cvt_pk_bf16_f32 v23, v30, v31
  v_mfma_f32_16x16x32_bf16 a[8:11], a[240:243], a[152:155], 0
  ds_read_b64_tr_b16 a[254:255], v0 offset:2048
  v_fma_f32 v64, v64, s30, -v4
  v_fma_f32 v65, v65, s30, -v4
  v_mfma_f32_16x16x32_bf16 a[8:11], a[244:247], a[176:179], a[8:11]
  v_fma_f32 v66, v66, s30, -v4
  v_max_f32 v3, v64, v65
  v_fma_f32 v67, v67, s30, -v4
  v_mfma_f32_16x16x32_bf16 a[12:15], a[240:243], a[156:159], 0
  v_fma_f32 v68, v68, s30, -v4
  v_max3_f32 v3, v3, v66, v67
  v_fma_f32 v69, v69, s30, -v4
  v_mfma_f32_16x16x32_bf16 a[12:15], a[244:247], a[180:183], a[12:15]
  v_fma_f32 v70, v70, s30, -v4
  v_max3_f32 v3, v3, v68, v69
  v_fma_f32 v71, v71, s30, -v4
  v_mfma_f32_16x16x32_bf16 a[16:19], a[240:243], a[160:163], 0
  v_fma_f32 v72, v72, s30, -v5
  v_max3_f32 v3, v3, v70, v71
  v_fma_f32 v73, v73, s30, -v5
  v_mfma_f32_16x16x32_bf16 a[16:19], a[244:247], a[184:187], a[16:19]
  v_fma_f32 v74, v74, s30, -v5
  v_max3_f32 v3, v3, v72, v73
  v_fma_f32 v75, v75, s30, -v5
  v_mfma_f32_16x16x32_bf16 a[20:23], a[240:243], a[164:167], 0
  v_fma_f32 v76, v76, s30, -v5
  v_max3_f32 v3, v3, v74, v75
  v_fma_f32 v77, v77, s30, -v5
  v_mfma_f32_16x16x32_bf16 a[20:23], a[244:247], a[188:191], a[20:23]
  s_waitcnt lgkmcnt(0)
  v_fma_f32 v78, v78, s30, -v5
  v_max3_f32 v3, v3, v76, v77
  v_fma_f32 v79, v79, s30, -v5
  v_accvgpr_write_b32 a120, s33
  v_mfma_f32_16x16x32_bf16 a[0:3], a[248:251], a[192:195], a[0:3]
  ds_read_b64_tr_b16 a[240:241], v0 offset:4096
  v_fma_f32 v80, v80, s30, -v6
  v_max3_f32 v3, v3, v78, v79
  v_mfma_f32_16x16x32_bf16 a[24:27], a[252:255], a[144:147], 0
  ds_read_b64_tr_b16 a[242:243], v0 offset:6144
  v_fma_f32 v81, v81, s30, -v6
  v_fma_f32 v82, v82, s30, -v6
  v_mfma_f32_16x16x32_bf16 a[4:7], a[248:251], a[196:199], a[4:7]
  ds_read_b64_tr_b16 a[244:245], v0 offset:8192
  v_max3_f32 v3, v3, v80, v81
  v_fma_f32 v83, v83, s30, -v6
  v_mfma_f32_16x16x32_bf16 a[28:31], a[252:255], a[148:151], 0
  ds_read_b64_tr_b16 a[246:247], v0 offset:10240
  v_fma_f32 v84, v84, s30, -v6
  v_max3_f32 v3, v3, v82, v83
  v_mfma_f32_16x16x32_bf16 a[8:11], a[248:251], a[200:203], a[8:11]
  v_xor_b32 v0, 96, v0
  v_fma_f32 v85, v85, s30, -v6
  v_accvgpr_write_b32 a121, s33
  v_mfma_f32_16x16x32_bf16 a[32:35], a[252:255], a[152:155], 0
  v_fma_f32 v86, v86, s30, -v6
  v_max3_f32 v3, v3, v84, v85
  v_fma_f32 v87, v87, s30, -v6
  v_mfma_f32_16x16x32_bf16 a[12:15], a[248:251], a[204:207], a[12:15]
  v_fma_f32 v88, v88, s30, -v7
  v_max3_f32 v3, v3, v86, v87
  v_fma_f32 v89, v89, s30, -v7
  v_mfma_f32_16x16x32_bf16 a[36:39], a[252:255], a[156:159], 0
  v_fma_f32 v90, v90, s30, -v7
  v_max3_f32 v3, v3, v88, v89
  v_fma_f32 v91, v91, s30, -v7
  v_mfma_f32_16x16x32_bf16 a[16:19], a[248:251], a[208:211], a[16:19]
  v_fma_f32 v92, v92, s30, -v7
  v_max3_f32 v3, v3, v90, v91
  v_fma_f32 v93, v93, s30, -v7
  v_mfma_f32_16x16x32_bf16 a[40:43], a[252:255], a[160:163], 0
  v_fma_f32 v94, v94, s30, -v7
  v_max3_f32 v3, v3, v92, v93
  v_fma_f32 v95, v95, s30, -v7
  v_mfma_f32_16x16x32_bf16 a[20:23], a[248:251], a[212:215], a[20:23]
  v_fma_f32 v96, v96, s30, -v8
  v_max3_f32 v3, v3, v94, v95
  v_fma_f32 v97, v97, s30, -v8
  v_mfma_f32_16x16x32_bf16 a[44:47], a[252:255], a[164:167], 0
  s_waitcnt lgkmcnt(0)
  v_fma_f32 v98, v98, s30, -v8
  v_max3_f32 v3, v3, v96, v97
  v_fma_f32 v99, v99, s30, -v8
  v_mfma_f32_16x16x32_bf16 a[24:27], a[240:243], a[168:171], a[24:27]
  ds_read_b64_tr_b16 a[248:249], v0 offset:0
  v_fma_f32 v100, v100, s30, -v8
  v_max3_f32 v3, v3, v98, v99
  v_accvgpr_write_b32 a122, s33
  v_mfma_f32_16x16x32_bf16 a[24:27], a[244:247], a[192:195], a[24:27]
  ds_read_b64_tr_b16 a[250:251], v0 offset:2048
  v_fma_f32 v101, v101, s30, -v8
  v_fma_f32 v102, v102, s30, -v8
  v_mfma_f32_16x16x32_bf16 a[28:31], a[240:243], a[172:175], a[28:31]
  ds_read_b64_tr_b16 a[252:253], v0 offset:4096
  s_add_u32 m0, s32, 135168
  v_max3_f32 v3, v3, v100, v101
  v_mfma_f32_16x16x32_bf16 a[28:31], a[244:247], a[196:199], a[28:31]
  ds_read_b64_tr_b16 a[254:255], v0 offset:6144
  s_add_u32 s40, s38, 110848
  v_fma_f32 v103, v103, s30, -v8
  v_fma_f32 v104, v104, s30, -v9
  v_mfma_f32_16x16x32_bf16 a[32:35], a[240:243], a[176:179], a[32:35]
  buffer_load_dwordx4 v2, s[20:23], s40 offen nt lds
  v_max3_f32 v3, v3, v102, v103
  v_mfma_f32_16x16x32_bf16 a[32:35], a[244:247], a[200:203], a[32:35]
  s_add_u32 s40, s38, 112896
  v_fma_f32 v105, v105, s30, -v9
  v_fma_f32 v106, v106, s30, -v9
  v_accvgpr_write_b32 a123, s33
  v_mfma_f32_16x16x32_bf16 a[36:39], a[240:243], a[180:183], a[36:39]
  buffer_load_dwordx4 v2, s[20:23], s40 offen offset:1024 nt lds
  v_max3_f32 v3, v3, v104, v105
  v_fma_f32 v107, v107, s30, -v9
  v_mfma_f32_16x16x32_bf16 a[36:39], a[244:247], a[204:207], a[36:39]
  s_add_u32 s40, s38, 114944
  v_fma_f32 v108, v108, s30, -v9
  v_max3_f32 v3, v3, v106, v107
  v_mfma_f32_16x16x32_bf16 a[40:43], a[240:243], a[184:187], a[40:43]
  buffer_load_dwordx4 v2, s[20:23], s40 offen offset:2048 nt lds
  v_fma_f32 v109, v109, s30, -v9
  v_mfma_f32_16x16x32_bf16 a[40:43], a[244:247], a[208:211], a[40:43]
  v_fma_f32 v110, v110, s30, -v9
  v_max3_f32 v3, v3, v108, v109
  v_fma_f32 v111, v111, s30, -v9
  v_mfma_f32_16x16x32_bf16 a[44:47], a[240:243], a[188:191], a[44:47]
  v_max3_f32 v3, v3, v110, v111
  v_cmp_lt_f32 vcc, s31, v3
  s_nop 0
  s_cbranch_vccnz L_slow_0_11
L_back_0_11:
  v_mfma_f32_16x16x32_bf16 a[44:47], a[244:247], a[212:215], a[44:47]
  s_waitcnt lgkmcnt(0)
  v_mbcnt_lo_u32_b32 v1, -1, 0
  v_mfma_f32_16x16x32_bf16 a[48:51], a[248:251], a[144:147], 0
  ds_read_b64_tr_b16 a[240:241], v0 offset:8192
  v_mfma_f32_16x16x32_bf16 a[48:51], a[252:255], a[168:171], a[48:51]
  ds_read_b64_tr_b16 a[242:243], v0 offset:10240
  v_mfma_f32_16x16x32_bf16 a[96:99], a[120:123], a[144:147], 0
  v_xor_b32 v0, 32, v0
  v_exp_f32 v32, v32
  v_mfma_f32_16x16x32_bf16 a[96:99], a[120:123], a[168:171], a[96:99]
  ds_read_b64_tr_b16 a[244:245], v0 offset:0
  v_mfma_f32_16x16x32_bf16 a[52:55], a[248:251], a[148:151], 0
  ds_read_b64_tr_b16 a[246:247], v0 offset:2048
  v_mfma_f32_16x16x32_bf16 a[52:55], a[252:255], a[172:175], a[52:55]
  v_mbcnt_hi_u32_b32 v1, -1, v1
  v_mfma_f32_16x16x32_bf16 a[56:59], a[248:251], a[152:155], 0
  v_lshrrev_b32 v3, 3, v1
  v_add_u32 v3, 0, v3
  v_mfma_f32_16x16x32_bf16 a[56:59], a[252:255], a[176:179], a[56:59]
  v_mul_u32_u24 v3, 43, v3
  v_mfma_f32_16x16x32_bf16 a[100:103], a[120:123], a[148:151], 0
  v_lshrrev_b32 v3, 8, v3
  v_mfma_f32_16x16x32_bf16 a[100:103], a[120:123], a[172:175], a[100:103]
  v_lshl_add_u32 v3, s3, 2, v3
  v_exp_f32 v33, v33
  v_mfma_f32_16x16x32_bf16 a[60:63], a[248:251], a[156:159], 0
  v_and_b32 v3, 7, v3
  v_mfma_f32_16x16x32_bf16 a[60:63], a[252:255], a[180:183], a[60:63]
  v_xor_b32 v3, v3, v1
  v_mfma_f32_16x16x32_bf16 a[64:67], a[248:251], a[160:163], 0
  v_lshlrev_b32 v4, 4, v3
  v_mfma_f32_16x16x32_bf16 a[64:67], a[252:255], a[184:187], a[64:67]
  v_lshrrev_b32 v3, 3, v1
  v_mfma_f32_16x16x32_bf16 a[68:71], a[248:251], a[164:167], 0
  v_add_u32 v3, 8, v3
  v_mfma_f32_16x16x32_bf16 a[68:71], a[252:255], a[188:191], a[68:71]
  v_mul_u32_u24 v3, 43, v3
  v_mfma_f32_16x16x32_bf16 a[104:107], a[120:123], a[152:155], 0
  v_lshrrev_b32 v3, 8, v3
  v_mfma_f32_16x16x32_bf16 a[104:107], a[120:123], a[176:179], a[104:107]
  s_waitcnt lgkmcnt(0)
  v_lshl_add_u32 v3, s3, 2, v3
  v_exp_f32 v34, v34
  v_mfma_f32_16x16x32_bf16 a[48:51], a[240:243], a[192:195], a[48:51]
  ds_read_b64_tr_b16 a[248:249], v0 offset:4096
  v_mfma_f32_16x16x32_bf16 a[72:75], a[244:247], a[144:147], 0
  ds_read_b64_tr_b16 a[250:251], v0 offset:6144
  v_mfma_f32_16x16x32_bf16 a[52:55], a[240:243], a[196:199], a[52:55]
  ds_read_b64_tr_b16 a[252:253], v0 offset:8192
  v_mfma_f32_16x16x32_bf16 a[76:79], a[244:247], a[148:151], 0
  ds_read_b64_tr_b16 a[254:255], v0 offset:10240
  v_mfma_f32_16x16x32_bf16 a[56:59], a[240:243], a[200:203], a[56:59]
  v_xor_b32 v0, 96, v0
  v_mfma_f32_16x16x32_bf16 a[80:83], a[244:247], a[152:155], 0
  v_and_b32 v3, 7, v3
  v_exp_f32 v35, v35
  v_mfma_f32_16x16x32_bf16 a[108:111], a[120:123], a[156:159], 0
  v_xor_b32 v3, v3, v1
  v_mfma_f32_16x16x32_bf16 a[108:111], a[120:123], a[180:183], a[108:111]
  v_lshlrev_b32 v5, 4, v3
  v_mfma_f32_16x16x32_bf16 a[60:63], a[240:243], a[204:207], a[60:63]
  v_lshrrev_b32 v3, 3, v1
  v_mfma_f32_16x16x32_bf16 a[84:87], a[244:247], a[156:159], 0
  v_add_u32 v3, 16, v3
  v_mul_u32_u24 v3, 43, v3
  v_mfma_f32_16x16x32_bf16 a[64:67], a[240:243], a[208:211], a[64:67]
  v_lshrrev_b32 v3, 8, v3
  v_mfma_f32_16x16x32_bf16 a[88:91], a[244:247], a[160:163], 0
  v_lshl_add_u32 v3, s3, 2, v3
  v_mfma_f32_16x16x32_bf16 a[68:71], a[240:243], a[212:215], a[68:71]
  v_and_b32 v3, 7, v3
  v_mfma_f32_16x16x32_bf16 a[92:95], a[244:247], a[164:167], 0
  s_waitcnt vmcnt(31) lgkmcnt(0)
  s_barrier
  ds_read_b64_tr_b16 a[240:241], v0 offset:12288
  v_mfma_f32_16x16x32_bf16 a[112:115], a[120:123], a[160:163], 0
  ds_read_b64_tr_b16 a[242:243], v0 offset:14336
  v_exp_f32 v36, v36
  v_mfma_f32_16x16x32_bf16 a[112:115], a[120:123], a[184:187], a[112:115]
  ds_read_b64_tr_b16 a[244:245], v0 offset:16384
  v_mfma_f32_16x16x32_bf16 a[72:75], a[248:251], a[168:171], a[72:75]
  ds_read_b64_tr_b16 a[246:247], v0 offset:18432
  v_mfma_f32_16x16x32_bf16 a[72:75], a[252:255], a[192:195], a[72:75]
  v_xor_b32 v3, v3, v1
  v_mfma_f32_16x16x32_bf16 a[76:79], a[248:251], a[172:175], a[76:79]
  v_lshlrev_b32 v6, 4, v3
  v_mfma_f32_16x16x32_bf16 a[76:79], a[252:255], a[196:199], a[76:79]
  v_cvt_pk_bf16_f32 v24, v32, v33
  v_mfma_f32_16x16x32_bf16 a[80:83], a[248:251], a[176:179], a[80:83]
  s_add_u32 m0, s32, 0
  v_exp_f32 v37, v37
  v_mfma_f32_16x16x32_bf16 a[80:83], a[252:255], a[200:203], a[80:83]
  s_add_u32 s40, s35, 0
  v_mfma_f32_16x16x32_bf16 a[116:119], a[120:123], a[164:167], 0
  buffer_load_dwordx4 v4, s[12:15], s40 offen nt lds
  v_mfma_f32_16x16x32_bf16 a[116:119], a[120:123], a[188:191], a[116:119]
  buffer_load_dwordx4 v5, s[12:15], s40 offen offset:1024 nt lds
  v_mfma_f32_16x16x32_bf16 a[84:87], a[248:251], a[180:183], a[84:87]
  buffer_load_dwordx4 v6, s[12:15], s40 offen offset:2048 nt lds
  v_mfma_f32_16x16x32_bf16 a[84:87], a[252:255], a[204:207], a[84:87]
  v_exp_f32 v38, v38
  v_mfma_f32_16x16x32_bf16 a[88:91], a[248:251], a[184:187], a[88:91]
  v_cvt_pk_bf16_f32 v25, v34, v35
  v_mfma_f32_16x16x32_bf16 a[88:91], a[252:255], a[208:211], a[88:91]
  v_exp_f32 v39, v39
  v_mfma_f32_16x16x32_bf16 a[92:95], a[248:251], a[188:191], a[92:95]
  v_mfma_f32_16x16x32_bf16 a[92:95], a[252:255], a[212:215], a[92:95]
  v_exp_f32 v40, v40
  v_mfma_f32_16x16x32_bf16 a[96:99], a[120:123], a[192:195], a[96:99]
  v_cvt_pk_bf16_f32 v26, v36, v37
  v_mfma_f32_16x16x32_bf16 a[96:99], a[120:123], a[216:219], a[96:99]
  s_waitcnt lgkmcnt(0)
  v_exp_f32 v41, v41
  v_mfma_f32_16x16x32_bf16 a[0:3], a[240:243], a[216:219], a[0:3]
  ds_read_b64_tr_b16 a[248:249], v0 offset:20480
  v_mfma_f32_16x16x32_bf16 a[0:3], a[244:247], v[112:115], a[0:3]
  ds_read_b64_tr_b16 a[250:251], v0 offset:22528
  v_mfma_f32_16x16x32_bf16 a[4:7], a[240:243], a[220:223], a[4:7]
  v_xor_b32 v0, 32, v0
  v_mfma_f32_16x16x32_bf16 a[4:7], a[244:247], v[116:119], a[4:7]
  ds_read_b64_tr_b16 a[252:253], v0 offset:12288
  v_mfma_f32_16x16x32_bf16 a[8:11], a[240:243], a[224:227], a[8:11]
  ds_read_b64_tr_b16 a[254:255], v0 offset:14336
  v_mfma_f32_16x16x32_bf16 a[8:11], a[244:247], v[120:123], a[8:11]
  v_exp_f32 v42, v42
  v_mfma_f32_16x16x32_bf16 a[100:103], a[120:123], a[196:199], a[100:103]
  v_cvt_pk_bf16_f32 v27, v38, v39
  v_mfma_f32_16x16x32_bf16 a[100:103], a[120:123], a[220:223], a[100:103]
  v_exp_f32 v43, v43
  v_mfma_f32_16x16x32_bf16 a[12:15], a[240:243], a[228:231], a[12:15]
  v_exp_f32 v44, v44
  v_mfma_f32_16x16x32_bf16 a[12:15], a[244:247], v[124:127], a[12:15]
  v_mfma_f32_16x16x32_bf16 a[16:19], a[240:243], a[232:235], a[16:19]
  s_add_u32 m0, s28, 0
  v_cvt_pk_bf16_f32 v28, v40, v41
  v_mfma_f32_16x16x32_bf16 a[16:19], a[244:247], v[128:131], a[16:19]
  s_add_u32 s40, s35, 24576
  v_mfma_f32_16x16x32_bf16 a[20:23], a[240:243], a[236:239], a[20:23]
  buffer_load_dword v10, s[12:15], s40 offen lds
  v_mfma_f32_16x16x32_bf16 a[20:23], a[244:247], v[132:135], a[20:23]
  v_exp_f32 v45, v45
  v_mfma_f32_16x16x32_bf16 a[104:107], a[120:123], a[200:203], a[104:107]
  v_exp_f32 v46, v46
  v_mfma_f32_16x16x32_bf16 a[104:107], a[120:123], a[224:227], a[104:107]
  s_waitcnt lgkmcnt(0)
  v_cvt_pk_bf16_f32 v29, v42, v43
  v_mfma_f32_16x16x32_bf16 a[0:3], a[248:251], v[136:139], a[0:3]
  ds_read_b64_tr_b16 a[240:241], v0 offset:16384
  v_mfma_f32_16x16x32_bf16 a[24:27], a[252:255], a[216:219], a[24:27]
L_pad_5:
  s_cbranch_execz L_pad_9
  ds_read_b64_tr_b16 a[242:243], v0 offset:18432
  v_mfma_f32_16x16x32_bf16 a[4:7], a[248:251], v[140:143], a[4:7]
  ds_read_b64_tr_b16 a[244:245], v0 offset:20480
  v_mfma_f32_16x16x32_bf16 a[28:31], a[252:255], a[220:223], a[28:31]
  ds_read_b64_tr_b16 a[246:247], v0 offset:22528
  v_exp_f32 v47, v47
  v_mfma_f32_16x16x32_bf16 a[8:11], a[248:251], v[144:147], a[8:11]
  v_xor_b32 v0, 96, v0
  v_mfma_f32_16x16x32_bf16 a[32:35], a[252:255], a[224:227], a[32:35]
  v_mfma_f32_16x16x32_bf16 a[108:111], a[120:123], a[204:207], a[108:111]
  v_exp_f32 v48, v48
  v_mfma_f32_16x16x32_bf16 a[108:111], a[120:123], a[228:231], a[108:111]
  v_cvt_pk_bf16_f32 v30, v44, v45
  v_mfma_f32_16x16x32_bf16 a[12:15], a[248:251], v[148:151], a[12:15]
  v_exp_f32 v49, v49
  v_mfma_f32_16x16x32_bf16 a[36:39], a[252:255], a[228:231], a[36:39]
  v_mfma_f32_16x16x32_bf16 a[16:19], a[248:251], v[152:155], a[16:19]
  v_exp_f32 v50, v50
  v_mfma_f32_16x16x32_bf16 a[40:43], a[252:255], a[232:235], a[40:43]
  v_cvt_pk_bf16_f32 v31, v46, v47
  v_mfma_f32_16x16x32_bf16 a[20:23], a[248:251], v[156:159], a[20:23]
  v_exp_f32 v51, v51
  v_mfma_f32_16x16x32_bf16 a[44:47], a[252:255], a[236:239], a[44:47]
  v_exp_f32 v52, v52
  v_mfma_f32_16x16x32_bf16 a[112:115], a[120:123], a[208:211], a[112:115]
  v_mfma_f32_16x16x32_bf16 a[112:115], a[120:123], a[232:235], a[112:115]
  s_waitcnt lgkmcnt(0)
  v_cvt_pk_bf16_f32 v32, v48, v49
  v_mfma_f32_16x16x32_bf16 a[24:27], a[240:243], v[112:115], a[24:27]
  ds_read_b64_tr_b16 a[248:249], v0 offset:12288
  v_mfma_f32_16x16x32_bf16 a[24:27], a[244:247], v[136:139], a[24:27]
  ds_read_b64_tr_b16 a[250:251], v0 offset:14336
  v_exp_f32 v53, v53
  v_mfma_f32_16x16x32_bf16 a[28:31], a[240:243], v[116:119], a[28:31]
  ds_read_b64_tr_b16 a[252:253], v0 offset:16384
  v_mfma_f32_16x16x32_bf16 a[28:31], a[244:247], v[140:143], a[28:31]
  ds_read_b64_tr_b16 a[254:255], v0 offset:18432
  v_mfma_f32_16x16x32_bf16 a[32:35], a[240:243], v[120:123], a[32:35]
  v_exp_f32 v54, v54
  v_mfma_f32_16x16x32_bf16 a[32:35], a[244:247], v[144:147], a[32:35]
  v_cvt_pk_bf16_f32 v33, v50, v51
  v_mfma_f32_16x16x32_bf16 a[116:119], a[120:123], a[212:215], a[116:119]
  v_mfma_f32_16x16x32_bf16 a[116:119], a[120:123], a[236:239], a[116:119]
  v_exp_f32 v55, v55
  v_mfma_f32_16x16x32_bf16 a[36:39], a[240:243], v[124:127], a[36:39]
  v_exp_f32 v56, v56
  v_mfma_f32_16x16x32_bf16 a[36:39], a[244:247], v[148:151], a[36:39]
  v_cvt_pk_bf16_f32 v34, v52, v53
  v_mfma_f32_16x16x32_bf16 a[40:43], a[240:243], v[128:131], a[40:43]
  v_mfma_f32_16x16x32_bf16 a[40:43], a[244:247], v[152:155], a[40:43]
  v_exp_f32 v57, v57
  v_mfma_f32_16x16x32_bf16 a[44:47], a[240:243], v[132:135], a[44:47]
  v_exp_f32 v58, v58
  v_mfma_f32_16x16x32_bf16 a[44:47], a[244:247], v[156:159], a[44:47]
  v_cvt_pk_bf16_f32 v35, v54, v55
  v_mfma_f32_16x16x32_bf16 a[96:99], a[120:123], v[112:115], a[96:99]
  v_exp_f32 v59, v59
  v_mfma_f32_16x16x32_bf16 a[96:99], a[120:123], v[136:139], a[96:99]
  s_waitcnt lgkmcnt(0)
  v_mfma_f32_16x16x32_bf16 a[48:51], a[248:251], a[216:219], a[48:51]
  ds_read_b64_tr_b16 a[240:241], v0 offset:20480
  v_mfma_f32_16x16x32_bf16 a[48:51], a[252:255], v[112:115], a[48:51]
  ds_read_b64_tr_b16 a[242:243], v0 offset:22528
  v_exp_f32 v60, v60
  v_mfma_f32_16x16x32_bf16 a[52:55], a[248:251], a[220:223], a[52:55]
  v_xor_b32 v0, 32, v0
  v_mfma_f32_16x16x32_bf16 a[52:55], a[252:255], v[116:119], a[52:55]
  ds_read_b64_tr_b16 a[244:245], v0 offset:12288
  v_mfma_f32_16x16x32_bf16 a[56:59], a[248:251], a[224:227], a[56:59]
  ds_read_b64_tr_b16 a[246:247], v0 offset:14336
  v_mfma_f32_16x16x32_bf16 a[56:59], a[252:255], v[120:123], a[56:59]
  v_cvt_pk_bf16_f32 v36, v56, v57
  v_mfma_f32_16x16x32_bf16 a[100:103], a[120:123], v[116:119], a[100:103]
  v_exp_f32 v61, v61
  v_mfma_f32_16x16x32_bf16 a[100:103], a[120:123], v[140:143], a[100:103]
  v_mfma_f32_16x16x32_bf16 a[60:63], a[248:251], a[228:231], a[60:63]
  v_exp_f32 v62, v62
  v_mfma_f32_16x16x32_bf16 a[60:63], a[252:255], v[124:127], a[60:63]
  v_cvt_pk_bf16_f32 v37, v58, v59
  v_mfma_f32_16x16x32_bf16 a[64:67], a[248:251], a[232:235], a[64:67]
  v_exp_f32 v63, v63
  v_mfma_f32_16x16x32_bf16 a[64:67], a[252:255], v[128:131], a[64:67]
  v_cvt_pk_bf16_f32 v38, v60, v61
  v_mfma_f32_16x16x32_bf16 a[68:71], a[248:251], a[236:239], a[68:71]
  v_cvt_pk_bf16_f32 v39, v62, v63
  v_mfma_f32_16x16x32_bf16 a[68:71], a[252:255], v[132:135], a[68:71]
  v_exp_f32 v64, v64
  v_mfma_f32_16x16x32_bf16 a[104:107], a[120:123], v[120:123], a[104:107]
  v_mfma_f32_16x16x32_bf16 a[104:107], a[120:123], v[144:147], a[104:107]
  s_waitcnt lgkmcnt(0)
  v_exp_f32 v65, v65
  v_mfma_f32_16x16x32_bf16 a[48:51], a[240:243], v[136:139], a[48:51]
  ds_read_b64_tr_b16 a[248:249], v0 offset:16384
  v_mfma_f32_16x16x32_bf16 a[72:75], a[244:247], a[216:219], a[72:75]
  ds_read_b64_tr_b16 a[250:251], v0 offset:18432
  v_mfma_f32_16x16x32_bf16 a[52:55], a[240:243], v[140:143], a[52:55]
  ds_read_b64_tr_b16 a[252:253], v0 offset:20480
  v_exp_f32 v66, v66
  v_mfma_f32_16x16x32_bf16 a[76:79], a[244:247], a[220:223], a[76:79]
  ds_read_b64_tr_b16 a[254:255], v0 offset:22528
  v_mfma_f32_16x16x32_bf16 a[56:59], a[240:243], v[144:147], a[56:59]
  v_xor_b32 v0, 96, v0
  v_mfma_f32_16x16x32_bf16 a[80:83], a[244:247], a[224:227], a[80:83]
  v_exp_f32 v67, v67
  v_mfma_f32_16x16x32_bf16 a[108:111], a[120:123], v[124:127], a[108:111]
  v_mfma_f32_16x16x32_bf16 a[108:111], a[120:123], v[148:151], a[108:111]
  v_exp_f32 v68, v68
  v_mfma_f32_16x16x32_bf16 a[60:63], a[240:243], v[148:151], a[60:63]
  v_cvt_pk_bf16_f32 v64, v64, v65
  v_mfma_f32_16x16x32_bf16 a[84:87], a[244:247], a[228:231], a[84:87]
  v_exp_f32 v69, v69
  v_mfma_f32_16x16x32_bf16 a[64:67], a[240:243], v[152:155], a[64:67]
  v_mfma_f32_16x16x32_bf16 a[88:91], a[244:247], a[232:235], a[88:91]
  v_exp_f32 v70, v70
  v_mfma_f32_16x16x32_bf16 a[68:71], a[240:243], v[156:159], a[68:71]
  v_cvt_pk_bf16_f32 v65, v66, v67
  v_mfma_f32_16x16x32_bf16 a[92:95], a[244:247], a[236:239], a[92:95]
  s_waitcnt vmcnt(32) lgkmcnt(0)
  s_barrier
  ds_read_b64_tr_b16 a[240:241], v0 offset:24576
  v_mfma_f32_16x16x32_bf16 a[112:115], a[120:123], v[128:131], a[112:115]
  ds_read_b64_tr_b16 a[242:243], v0 offset:26624
  v_mfma_f32_16x16x32_bf16 a[112:115], a[120:123], v[152:155], a[112:115]
  ds_read_b64_tr_b16 a[244:245], v0 offset:28672
  v_mfma_f32_16x16x32_bf16 a[72:75], a[248:251], v[112:115], a[72:75]
  ds_read_b64_tr_b16 a[246:247], v0 offset:30720
  v_exp_f32 v71, v71
  v_mfma_f32_16x16x32_bf16 a[72:75], a[252:255], v[136:139], a[72:75]
  v_mfma_f32_16x16x32_bf16 a[76:79], a[248:251], v[116:119], a[76:79]
  v_exp_f32 v72, v72
  v_mfma_f32_16x16x32_bf16 a[76:79], a[252:255], v[140:143], a[76:79]
  v_cvt_pk_bf16_f32 v66, v68, v69
  v_mfma_f32_16x16x32_bf16 a[80:83], a[248:251], v[120:123], a[80:83]
  s_add_u32 m0, s32, 12288
  v_mfma_f32_16x16x32_bf16 a[80:83], a[252:255], v[144:147], a[80:83]
  s_add_u32 s40, s35, 3072
  v_exp_f32 v73, v73
  v_mfma_f32_16x16x32_bf16 a[116:119], a[120:123], v[132:135], a[116:119]
  buffer_load_dwordx4 v4, s[12:15], s40 offen nt lds
  v_mfma_f32_16x16x32_bf16 a[116:119], a[120:123], v[156:159], a[116:119]
  buffer_load_dwordx4 v5, s[12:15], s40 offen offset:1024 nt lds
  v_mfma_f32_16x16x32_bf16 a[84:87], a[248:251], v[124:127], a[84:87]
  buffer_load_dwordx4 v6, s[12:15], s40 offen offset:2048 nt lds
  v_mfma_f32_16x16x32_bf16 a[84:87], a[252:255], v[148:151], a[84:87]
  v_mfma_f32_16x16x32_bf16 a[88:91], a[248:251], v[128:131], a[88:91]
  v_exp_f32 v74, v74
  v_mfma_f32_16x16x32_bf16 a[88:91], a[252:255], v[152:155], a[88:91]
  v_cvt_pk_bf16_f32 v67, v70, v71
  v_mfma_f32_16x16x32_bf16 a[92:95], a[248:251], v[132:135], a[92:95]
  v_exp_f32 v75, v75
  v_mfma_f32_16x16x32_bf16 a[92:95], a[252:255], v[156:159], a[92:95]
  v_exp_f32 v76, v76
  v_mfma_f32_16x16x32_bf16 a[96:99], a[120:123], v[160:163], a[96:99]
  v_mfma_f32_16x16x32_bf16 a[96:99], a[120:123], v[184:187], a[96:99]
  s_waitcnt lgkmcnt(0)
  v_cvt_pk_bf16_f32 v68, v72, v73
  v_mfma_f32_16x16x32_bf16 a[0:3], a[240:243], v[160:163], a[0:3]
  ds_read_b64_tr_b16 a[248:249], v0 offset:32768
  v_mfma_f32_16x16x32_bf16 a[0:3], a[244:247], v[184:187], a[0:3]
  ds_read_b64_tr_b16 a[250:251], v0 offset:34816
  v_exp_f32 v77, v77
  v_mfma_f32_16x16x32_bf16 a[4:7], a[240:243], v[164:167], a[4:7]
  v_xor_b32 v0, 32, v0
  v_mfma_f32_16x16x32_bf16 a[4:7], a[244:247], v[188:191], a[4:7]
  ds_read_b64_tr_b16 a[252:253], v0 offset:24576
  v_mfma_f32_16x16x32_bf16 a[8:11], a[240:243], v[168:171], a[8:11]
  ds_read_b64_tr_b16 a[254:255], v0 offset:26624
  v_mfma_f32_16x16x32_bf16 a[8:11], a[244:247], v[192:195], a[8:11]
  v_exp_f32 v78, v78
  v_mfma_f32_16x16x32_bf16 a[100:103], a[120:123], v[164:167], a[100:103]
  v_cvt_pk_bf16_f32 v69, v74, v75
  v_mfma_f32_16x16x32_bf16 a[100:103], a[120:123], v[188:191], a[100:103]
  v_exp_f32 v79, v79
  v_mfma_f32_16x16x32_bf16 a[12:15], a[240:243], v[172:175], a[12:15]
  v_mfma_f32_16x16x32_bf16 a[12:15], a[244:247], v[196:199], a[12:15]
  v_exp_f32 v80, v80
  v_mfma_f32_16x16x32_bf16 a[16:19], a[240:243], v[176:179], a[16:19]
  s_add_u32 m0, s28, 0
  v_cvt_pk_bf16_f32 v70, v76, v77
  v_mfma_f32_16x16x32_bf16 a[16:19], a[244:247], v[200:203], a[16:19]
  s_add_u32 s40, s35, 27648
  v_mfma_f32_16x16x32_bf16 a[20:23], a[240:243], v[180:183], a[20:23]
  buffer_load_dword v10, s[12:15], s40 offen lds
  v_mfma_f32_16x16x32_bf16 a[20:23], a[244:247], v[204:207], a[20:23]
  v_exp_f32 v81, v81
  v_mfma_f32_16x16x32_bf16 a[104:107], a[120:123], v[168:171], a[104:107]
  v_mfma_f32_16x16x32_bf16 a[104:107], a[120:123], v[192:195], a[104:107]
  s_waitcnt lgkmcnt(0)
  v_exp_f32 v82, v82
  v_mfma_f32_16x16x32_bf16 a[0:3], a[248:251], v[208:211], a[0:3]
  ds_read_b64_tr_b16 a[240:241], v0 offset:28672
  v_cvt_pk_bf16_f32 v71, v78, v79
  v_mfma_f32_16x16x32_bf16 a[24:27], a[252:255], v[160:163], a[24:27]
  ds_read_b64_tr_b16 a[242:243], v0 offset:30720
  v_mfma_f32_16x16x32_bf16 a[4:7], a[248:251], v[212:215], a[4:7]
  ds_read_b64_tr_b16 a[244:245], v0 offset:32768
  v_mfma_f32_16x16x32_bf16 a[28:31], a[252:255], v[164:167], a[28:31]
  ds_read_b64_tr_b16 a[246:247], v0 offset:34816
  v_mfma_f32_16x16x32_bf16 a[8:11], a[248:251], v[216:219], a[8:11]
  v_xor_b32 v0, 96, v0
  v_mfma_f32_16x16x32_bf16 a[32:35], a[252:255], v[168:171], a[32:35]
  v_exp_f32 v83, v83
  v_mfma_f32_16x16x32_bf16 a[108:111], a[120:123], v[172:175], a[108:111]
  v_exp_f32 v84, v84
  v_mfma_f32_16x16x32_bf16 a[108:111], a[120:123], v[196:199], a[108:111]
  v_cvt_pk_bf16_f32 v72, v80, v81
  v_mfma_f32_16x16x32_bf16 a[12:15], a[248:251], v[220:223], a[12:15]
  v_mfma_f32_16x16x32_bf16 a[36:39], a[252:255], v[172:175], a[36:39]
  v_exp_f32 v85, v85
  v_mfma_f32_16x16x32_bf16 a[16:19], a[248:251], v[224:227], a[16:19]
  v_exp_f32 v86, v86
  v_mfma_f32_16x16x32_bf16 a[40:43], a[252:255], v[176:179], a[40:43]
  v_cvt_pk_bf16_f32 v73, v82, v83
  v_mfma_f32_16x16x32_bf16 a[20:23], a[248:251], v[228:231], a[20:23]
  v_exp_f32 v87, v87
  v_mfma_f32_16x16x32_bf16 a[44:47], a[252:255], v[180:183], a[44:47]
  v_mfma_f32_16x16x32_bf16 a[112:115], a[120:123], v[176:179], a[112:115]
  v_exp_f32 v88, v88
  v_mfma_f32_16x16x32_bf16 a[112:115], a[120:123], v[200:203], a[112:115]
  s_waitcnt lgkmcnt(0)
  v_cvt_pk_bf16_f32 v74, v84, v85
  v_mfma_f32_16x16x32_bf16 a[24:27], a[240:243], v[184:187], a[24:27]
  ds_read_b64_tr_b16 a[248:249], v0 offset:24576
  v_mfma_f32_16x16x32_bf16 a[24:27], a[244:247], v[208:211], a[24:27]
  ds_read_b64_tr_b16 a[250:251], v0 offset:26624
  v_mfma_f32_16x16x32_bf16 a[28:31], a[240:243], v[188:191], a[28:31]
  ds_read_b64_tr_b16 a[252:253], v0 offset:28672
  v_mfma_f32_16x16x32_bf16 a[28:31], a[244:247], v[212:215], a[28:31]
  ds_read_b64_tr_b16 a[254:255], v0 offset:30720
  v_exp_f32 v89, v89
  v_mfma_f32_16x16x32_bf16 a[32:35], a[240:243], v[192:195], a[32:35]
  v_mfma_f32_16x16x32_bf16 a[32:35], a[244:247], v[216:219], a[32:35]
  v_exp_f32 v90, v90
  v_mfma_f32_16x16x32_bf16 a[116:119], a[120:123], v[180:183], a[116:119]
  v_cvt_pk_bf16_f32 v75, v86, v87
  v_mfma_f32_16x16x32_bf16 a[116:119], a[120:123], v[204:207], a[116:119]
  v_exp_f32 v91, v91
  v_mfma_f32_16x16x32_bf16 a[36:39], a[240:243], v[196:199], a[36:39]
  v_mfma_f32_16x16x32_bf16 a[36:39], a[244:247], v[220:223], a[36:39]
  v_exp_f32 v92, v92
  v_mfma_f32_16x16x32_bf16 a[40:43], a[240:243], v[200:203], a[40:43]
  v_cvt_pk_bf16_f32 v76, v88, v89
  v_mfma_f32_16x16x32_bf16 a[40:43], a[244:247], v[224:227], a[40:43]
  v_exp_f32 v93, v93
  v_mfma_f32_16x16x32_bf16 a[44:47], a[240:243], v[204:207], a[44:47]
  v_mfma_f32_16x16x32_bf16 a[44:47], a[244:247], v[228:231], a[44:47]
  v_exp_f32 v94, v94
  v_mfma_f32_16x16x32_bf16 a[96:99], a[120:123], v[208:211], a[96:99]
  v_cvt_pk_bf16_f32 v77, v90, v91
  v_mfma_f32_16x16x32_bf16 a[96:99], a[120:123], v[232:235], a[96:99]
  s_waitcnt lgkmcnt(0)
  v_exp_f32 v95, v95
  v_mfma_f32_16x16x32_bf16 a[48:51], a[248:251], v[160:163], a[48:51]
  ds_read_b64_tr_b16 a[240:241], v0 offset:32768
  v_mfma_f32_16x16x32_bf16 a[48:51], a[252:255], v[184:187], a[48:51]
  ds_read_b64_tr_b16 a[242:243], v0 offset:34816
  v_mfma_f32_16x16x32_bf16 a[52:55], a[248:251], v[164:167], a[52:55]
  v_xor_b32 v0, 32, v0
  v_mfma_f32_16x16x32_bf16 a[52:55], a[252:255], v[188:191], a[52:55]
  ds_read_b64_tr_b16 a[244:245], v0 offset:24576
  v_exp_f32 v96, v96
  v_mfma_f32_16x16x32_bf16 a[56:59], a[248:251], v[168:171], a[56:59]
  ds_read_b64_tr_b16 a[246:247], v0 offset:26624
  v_mfma_f32_16x16x32_bf16 a[56:59], a[252:255], v[192:195], a[56:59]
  v_cvt_pk_bf16_f32 v78, v92, v93
  v_mfma_f32_16x16x32_bf16 a[100:103], a[120:123], v[212:215], a[100:103]
  v_mfma_f32_16x16x32_bf16 a[100:103], a[120:123], v[236:239], a[100:103]
  v_exp_f32 v97, v97
  v_mfma_f32_16x16x32_bf16 a[60:63], a[248:251], v[172:175], a[60:63]
  v_exp_f32 v98, v98
  v_mfma_f32_16x16x32_bf16 a[60:63], a[252:255], v[196:199], a[60:63]
  v_cvt_pk_bf16_f32 v79, v94, v95
  v_mfma_f32_16x16x32_bf16 a[64:67], a[248:251], v[176:179], a[64:67]
  v_exp_f32 v99, v99
  v_mfma_f32_16x16x32_bf16 a[64:67], a[252:255], v[200:203], a[64:67]
  v_mfma_f32_16x16x32_bf16 a[68:71], a[248:251], v[180:183], a[68:71]
  v_exp_f32 v100, v100
  v_mfma_f32_16x16x32_bf16 a[68:71], a[252:255], v[204:207], a[68:71]
  v_cvt_pk_bf16_f32 v80, v96, v97
  v_mfma_f32_16x16x32_bf16 a[104:107], a[120:123], v[216:219], a[104:107]
  v_exp_f32 v101, v101
  v_mfma_f32_16x16x32_bf16 a[104:107], a[120:123], v[240:243], a[104:107]
  s_waitcnt lgkmcnt(0)
  v_mfma_f32_16x16x32_bf16 a[48:51], a[240:243], v[208:211], a[48:51]
  ds_read_b64_tr_b16 a[248:249], v0 offset:28672
  v_mfma_f32_16x16x32_bf16 a[72:75], a[244:247], v[160:163], a[72:75]
  ds_read_b64_tr_b16 a[250:251], v0 offset:30720
  v_exp_f32 v102, v102
  v_mfma_f32_16x16x32_bf16 a[52:55], a[240:243], v[212:215], a[52:55]
  ds_read_b64_tr_b16 a[252:253], v0 offset:32768
  v_mfma_f32_16x16x32_bf16 a[76:79], a[244:247], v[164:167], a[76:79]
  ds_read_b64_tr_b16 a[254:255], v0 offset:34816
  v_mfma_f32_16x16x32_bf16 a[56:59], a[240:243], v[216:219], a[56:59]
  v_xor_b32 v0, 96, v0
  v_mfma_f32_16x16x32_bf16 a[80:83], a[244:247], v[168:171], a[80:83]
  v_cvt_pk_bf16_f32 v81, v98, v99
  v_mfma_f32_16x16x32_bf16 a[108:111], a[120:123], v[220:223], a[108:111]
  v_exp_f32 v103, v103
  v_mfma_f32_16x16x32_bf16 a[108:111], a[120:123], v[244:247], a[108:111]
  v_exp_f32 v104, v104
  v_mfma_f32_16x16x32_bf16 a[60:63], a[240:243], v[220:223], a[60:63]
  v_mfma_f32_16x16x32_bf16 a[84:87], a[244:247], v[172:175], a[84:87]
  v_cvt_pk_bf16_f32 v82, v100, v101
  v_mfma_f32_16x16x32_bf16 a[64:67], a[240:243], v[224:227], a[64:67]
  v_exp_f32 v105, v105
  v_mfma_f32_16x16x32_bf16 a[88:91], a[244:247], v[176:179], a[88:91]
  v_exp_f32 v106, v106
  v_mfma_f32_16x16x32_bf16 a[68:71], a[240:243], v[228:231], a[68:71]
  v_mfma_f32_16x16x32_bf16 a[92:95], a[244:247], v[180:183], a[92:95]
  s_waitcnt vmcnt(33) lgkmcnt(0)
  s_barrier
  ds_read_b64_tr_b16 a[240:241], v0 offset:36864
  v_mfma_f32_16x16x32_bf16 a[112:115], a[120:123], v[224:227], a[112:115]
  ds_read_b64_tr_b16 a[242:243], v0 offset:38912
  v_cvt_pk_bf16_f32 v83, v102, v103
  v_mfma_f32_16x16x32_bf16 a[112:115], a[120:123], v[248:251], a[112:115]
  ds_read_b64_tr_b16 a[244:245], v0 offset:40960
  v_mfma_f32_16x16x32_bf16 a[72:75], a[248:251], v[184:187], a[72:75]
  ds_read_b64_tr_b16 a[246:247], v0 offset:43008
  v_mfma_f32_16x16x32_bf16 a[72:75], a[252:255], v[208:211], a[72:75]
  v_exp_f32 v107, v107
  v_mfma_f32_16x16x32_bf16 a[76:79], a[248:251], v[188:191], a[76:79]
  v_exp_f32 v108, v108
  v_mfma_f32_16x16x32_bf16 a[76:79], a[252:255], v[212:215], a[76:79]
  v_mfma_f32_16x16x32_bf16 a[80:83], a[248:251], v[192:195], a[80:83]
  s_add_u32 m0, s32, 24576
  v_cvt_pk_bf16_f32 v84, v104, v105
  v_mfma_f32_16x16x32_bf16 a[80:83], a[252:255], v[216:219], a[80:83]
  s_add_u32 s40, s35, 6144
  v_mfma_f32_16x16x32_bf16 a[116:119], a[120:123], v[228:231], a[116:119]
  buffer_load_dwordx4 v4, s[12:15], s40 offen nt lds
  v_mfma_f32_16x16x32_bf16 a[116:119], a[120:123], v[252:255], a[116:119]
  buffer_load_dwordx4 v5, s[12:15], s40 offen offset:1024 nt lds
  v_mfma_f32_16x16x32_bf16 a[84:87], a[248:251], v[196:199], a[84:87]
  buffer_load_dwordx4 v6, s[12:15], s40 offen offset:2048 nt lds
  v_mfma_f32_16x16x32_bf16 a[84:87], a[252:255], v[220:223], a[84:87]
  v_exp_f32 v109, v109
  v_mfma_f32_16x16x32_bf16 a[88:91], a[248:251], v[200:203], a[88:91]
  v_exp_f32 v110, v110
  v_mfma_f32_16x16x32_bf16 a[88:91], a[252:255], v[224:227], a[88:91]
  v_cvt_pk_bf16_f32 v85, v106, v107
  v_mfma_f32_16x16x32_bf16 a[92:95], a[248:251], v[204:207], a[92:95]
  v_exp_f32 v111, v111
  v_mfma_f32_16x16x32_bf16 a[92:95], a[252:255], v[228:231], a[92:95]
  s_waitcnt lgkmcnt(0)
  v_mfma_f32_16x16x32_bf16 a[0:3], a[240:243], v[232:235], a[0:3]
  ds_read_b64_tr_b16 a[248:249], v0 offset:45056
  v_cvt_pk_bf16_f32 v86, v108, v109
  v_mfma_f32_16x16x32_bf16 a[0:3], a[244:247], v[16:19], a[0:3]
  ds_read_b64_tr_b16 a[250:251], v0 offset:47104
  v_mfma_f32_16x16x32_bf16 a[4:7], a[240:243], v[236:239], a[4:7]
  v_xor_b32 v0, 32, v0
  v_mfma_f32_16x16x32_bf16 a[4:7], a[244:247], v[20:23], a[4:7]
  ds_read_b64_tr_b16 a[252:253], v0 offset:36864
  v_cvt_pk_bf16_f32 v87, v110, v111
  v_mfma_f32_16x16x32_bf16 a[8:11], a[240:243], v[240:243], a[8:11]
  ds_read_b64_tr_b16 a[254:255], v0 offset:38912
  v_mfma_f32_16x16x32_bf16 a[8:11], a[244:247], v[24:27], a[8:11]
  v_mbcnt_lo_u32_b32 v90, -1, 0
  v_mfma_f32_16x16x32_bf16 a[12:15], a[240:243], v[244:247], a[12:15]
  v_mbcnt_lo_u32_b32 v88, -1, 0
  v_mfma_f32_16x16x32_bf16 a[12:15], a[244:247], v[28:31], a[12:15]
  v_mbcnt_hi_u32_b32 v90, -1, v90
  v_mfma_f32_16x16x32_bf16 a[96:99], a[120:123], v[16:19], a[96:99]
  v_mbcnt_hi_u32_b32 v88, -1, v88
  v_mfma_f32_16x16x32_bf16 a[96:99], a[120:123], v[64:67], a[96:99]
  v_and_b32 v91, 15, v90
  v_mfma_f32_16x16x32_bf16 a[16:19], a[240:243], v[248:251], a[16:19]
  s_add_u32 m0, s28, 0
  v_bfe_u32 v89, v88, 3, 1
  v_mfma_f32_16x16x32_bf16 a[16:19], a[244:247], v[32:35], a[16:19]
  s_add_u32 s40, s35, 30720
  v_mfma_f32_16x16x32_bf16 a[20:23], a[240:243], v[252:255], a[20:23]
  buffer_load_dword v10, s[12:15], s40 offen lds
  v_mfma_f32_16x16x32_bf16 a[20:23], a[244:247], v[36:39], a[20:23]
  v_lshl_add_u32 v7, v91, 7, s28
  v_mfma_f32_16x16x32_bf16 a[100:103], a[120:123], v[20:23], a[100:103]
  v_mul_u32_u24 v1, 12288, v89
  v_mfma_f32_16x16x32_bf16 a[100:103], a[120:123], v[68:71], a[100:103]
  s_waitcnt lgkmcnt(0)
  v_bfe_u32 v91, v90, 4, 1
  v_mfma_f32_16x16x32_bf16 a[0:3], a[248:251], v[64:67], a[0:3]
  ds_read_b64_tr_b16 a[240:241], v0 offset:40960
  v_mfma_f32_16x16x32_bf16 a[24:27], a[252:255], v[232:235], a[24:27]
  ds_read_b64_tr_b16 a[242:243], v0 offset:43008
  v_mfma_f32_16x16x32_bf16 a[4:7], a[248:251], v[68:71], a[4:7]
  ds_read_b64_tr_b16 a[244:245], v0 offset:45056
  v_mfma_f32_16x16x32_bf16 a[28:31], a[252:255], v[236:239], a[28:31]
  ds_read_b64_tr_b16 a[246:247], v0 offset:47104
  v_mfma_f32_16x16x32_bf16 a[104:107], a[120:123], v[24:27], a[104:107]
  v_xor_b32 v0, 96, v0
  v_mfma_f32_16x16x32_bf16 a[104:107], a[120:123], v[72:75], a[104:107]
  v_lshl_add_u32 v7, v91, 3, v7
  v_mfma_f32_16x16x32_bf16 a[8:11], a[248:251], v[72:75], a[8:11]
  v_and_b32 v89, 7, v88
  v_mfma_f32_16x16x32_bf16 a[32:35], a[252:255], v[240:243], a[32:35]
  v_and_b32 v91, 7, v90
  v_mul_u32_u24 v89, 384, v89
  v_mfma_f32_16x16x32_bf16 a[12:15], a[248:251], v[76:79], a[12:15]
  v_add3_u32 v1, v1, v89, s32
  v_mfma_f32_16x16x32_bf16 a[36:39], a[252:255], v[244:247], a[36:39]
  v_lshlrev_b32 v9, 4, v91
  v_mfma_f32_16x16x32_bf16 a[108:111], a[120:123], v[28:31], a[108:111]
  v_lshrrev_b32 v8, 5, v90
  v_mfma_f32_16x16x32_bf16 a[108:111], a[120:123], v[76:79], a[108:111]
  v_bfe_u32 v89, v88, 1, 2
  v_mfma_f32_16x16x32_bf16 a[16:19], a[248:251], v[80:83], a[16:19]
  v_xor_b32 v8, v8, v91
  v_mfma_f32_16x16x32_bf16 a[40:43], a[252:255], v[248:251], a[40:43]
  v_lshl_add_u32 v89, s3, 2, v89
  v_mfma_f32_16x16x32_bf16 a[20:23], a[248:251], v[84:87], a[20:23]
  v_lshl_add_u32 v7, v8, 4, v7
  v_mfma_f32_16x16x32_bf16 a[44:47], a[252:255], v[252:255], a[44:47]
  v_lshrrev_b32 v90, 3, v90
  v_mfma_f32_16x16x32_bf16 a[112:115], a[120:123], v[32:35], a[112:115]
  v_and_b32 v89, 7, v89
  v_mfma_f32_16x16x32_bf16 a[112:115], a[120:123], v[80:83], a[112:115]
  s_waitcnt lgkmcnt(0)
  v_xor_b32 v91, v91, v90
  v_mfma_f32_16x16x32_bf16 a[24:27], a[240:243], v[16:19], a[24:27]
  ds_read_b64_tr_b16 a[248:249], v0 offset:36864
  v_mfma_f32_16x16x32_bf16 a[24:27], a[244:247], v[64:67], a[24:27]
  ds_read_b64_tr_b16 a[250:251], v0 offset:38912
  v_mfma_f32_16x16x32_bf16 a[28:31], a[240:243], v[20:23], a[28:31]
  ds_read_b64_tr_b16 a[252:253], v0 offset:40960
  v_mfma_f32_16x16x32_bf16 a[28:31], a[244:247], v[68:71], a[28:31]
  ds_read_b64_tr_b16 a[254:255], v0 offset:43008
  v_mfma_f32_16x16x32_bf16 a[116:119], a[120:123], v[36:39], a[116:119]
  v_lshrrev_b32 v88, 4, v88
  v_mfma_f32_16x16x32_bf16 a[116:119], a[120:123], v[84:87], a[116:119]
  v_lshl_add_u32 v8, v90, 7, s28
  v_mfma_f32_16x16x32_bf16 a[32:35], a[240:243], v[24:27], a[32:35]
  v_lshl_add_u32 v8, v91, 4, v8
  v_mfma_f32_16x16x32_bf16 a[32:35], a[244:247], v[72:75], a[32:35]
  v_xor_b32 v88, v88, v89
  v_mfma_f32_16x16x32_bf16 a[36:39], a[240:243], v[28:31], a[36:39]
  v_mul_u32_u24 v90, 384, v90
  v_mfma_f32_16x16x32_bf16 a[36:39], a[244:247], v[76:79], a[36:39]
  v_lshl_add_u32 v1, v88, 4, v1
  v_mfma_f32_16x16x32_bf16 a[40:43], a[240:243], v[32:35], a[40:43]
  v_add_u32 v9, v9, v90
  v_mfma_f32_16x16x32_bf16 a[40:43], a[244:247], v[80:83], a[40:43]
  v_accvgpr_read_b32 v10, a96
  v_accvgpr_read_b32 v11, a100
  v_accvgpr_read_b32 v12, a104
  v_mfma_f32_16x16x32_bf16 a[44:47], a[240:243], v[36:39], a[44:47]
  v_accvgpr_read_b32 v13, a108
  v_accvgpr_read_b32 v14, a112
  v_accvgpr_read_b32 v15, a116
  v_mfma_f32_16x16x32_bf16 a[44:47], a[244:247], v[84:87], a[44:47]
  s_waitcnt lgkmcnt(0)
  v_rcp_f32 v10, v10
  v_rcp_f32 v11, v11
  v_mfma_f32_16x16x32_bf16 a[48:51], a[248:251], v[232:235], a[48:51]
  ds_read_b64_tr_b16 a[240:241], v0 offset:45056
  v_rcp_f32 v12, v12
  v_mfma_f32_16x16x32_bf16 a[48:51], a[252:255], v[16:19], a[48:51]
  ds_read_b64_tr_b16 a[242:243], v0 offset:47104
  v_rcp_f32 v13, v13
  v_mfma_f32_16x16x32_bf16 a[52:55], a[248:251], v[236:239], a[52:55]
  v_xor_b32 v0, 32, v0
  v_rcp_f32 v14, v14
  v_mfma_f32_16x16x32_bf16 a[52:55], a[252:255], v[20:23], a[52:55]
  ds_read_b64_tr_b16 a[244:245], v0 offset:36864
  v_rcp_f32 v15, v15
  v_mfma_f32_16x16x32_bf16 a[56:59], a[248:251], v[240:243], a[56:59]
  ds_read_b64_tr_b16 a[246:247], v0 offset:38912
  v_accvgpr_read_b32 v40, a0
  v_mfma_f32_16x16x32_bf16 a[56:59], a[252:255], v[24:27], a[56:59]
  v_accvgpr_read_b32 v41, a1
  v_accvgpr_read_b32 v42, a2
  v_accvgpr_read_b32 v43, a3
  v_mfma_f32_16x16x32_bf16 a[60:63], a[248:251], v[244:247], a[60:63]
  v_mul_f32 v40, v10, v40
  v_mul_f32 v41, v10, v41
  v_mfma_f32_16x16x32_bf16 a[60:63], a[252:255], v[28:31], a[60:63]
  v_mul_f32 v42, v10, v42
  v_mul_f32 v43, v10, v43
  v_mfma_f32_16x16x32_bf16 a[64:67], a[248:251], v[248:251], a[64:67]
  v_cvt_pk_bf16_f32 v40, v40, v41
  v_cvt_pk_bf16_f32 v41, v42, v43
  v_mfma_f32_16x16x32_bf16 a[64:67], a[252:255], v[32:35], a[64:67]
  v_accvgpr_read_b32 v42, a4
  v_accvgpr_read_b32 v43, a5
  v_mfma_f32_16x16x32_bf16 a[68:71], a[248:251], v[252:255], a[68:71]
  v_accvgpr_read_b32 v44, a6
  v_accvgpr_read_b32 v45, a7
  v_mul_f32 v42, v11, v42
  v_mfma_f32_16x16x32_bf16 a[68:71], a[252:255], v[36:39], a[68:71]
  s_waitcnt lgkmcnt(0)
  v_mul_f32 v43, v11, v43
  v_mul_f32 v44, v11, v44
  v_mfma_f32_16x16x32_bf16 a[48:51], a[240:243], v[64:67], a[48:51]
  ds_read_b64_tr_b16 a[248:249], v0 offset:40960
  v_mul_f32 v45, v11, v45
  v_mfma_f32_16x16x32_bf16 a[72:75], a[244:247], v[232:235], a[72:75]
  ds_read_b64_tr_b16 a[250:251], v0 offset:43008
  v_cvt_pk_bf16_f32 v42, v42, v43
  v_mfma_f32_16x16x32_bf16 a[52:55], a[240:243], v[68:71], a[52:55]
  ds_read_b64_tr_b16 a[252:253], v0 offset:45056
  v_cvt_pk_bf16_f32 v43, v44, v45
  v_accvgpr_read_b32 v44, a24
  v_mfma_f32_16x16x32_bf16 a[76:79], a[244:247], v[236:239], a[76:79]
  ds_read_b64_tr_b16 a[254:255], v0 offset:47104
  v_accvgpr_read_b32 v45, a25
  v_mfma_f32_16x16x32_bf16 a[56:59], a[240:243], v[72:75], a[56:59]
  v_xor_b32 v0, 96, v0
  v_accvgpr_read_b32 v46, a26
  v_mfma_f32_16x16x32_bf16 a[80:83], a[244:247], v[240:243], a[80:83]
  v_accvgpr_read_b32 v47, a27
  v_mul_f32 v44, v10, v44
  v_mul_f32 v45, v10, v45
  v_mfma_f32_16x16x32_bf16 a[60:63], a[240:243], v[76:79], a[60:63]
  v_mul_f32 v46, v10, v46
  v_mul_f32 v47, v10, v47
  v_mfma_f32_16x16x32_bf16 a[84:87], a[244:247], v[244:247], a[84:87]
  v_cvt_pk_bf16_f32 v44, v44, v45
  v_cvt_pk_bf16_f32 v45, v46, v47
  v_mfma_f32_16x16x32_bf16 a[64:67], a[240:243], v[80:83], a[64:67]
  v_accvgpr_read_b32 v46, a28
  v_accvgpr_read_b32 v47, a29
  v_mfma_f32_16x16x32_bf16 a[88:91], a[244:247], v[248:251], a[88:91]
  v_accvgpr_read_b32 v3, a31
  v_mul_f32 v46, v11, v46
  v_mfma_f32_16x16x32_bf16 a[68:71], a[240:243], v[84:87], a[68:71]
  v_add_u32 v0, 49152, v0
  v_mul_f32 v47, v11, v47
  v_mul_f32 v3, v11, v3
  v_mfma_f32_16x16x32_bf16 a[92:95], a[244:247], v[252:255], a[92:95]
  s_waitcnt vmcnt(34) lgkmcnt(0)
  s_barrier
  ds_read_b64_tr_b16 a[240:241], v0 offset:0
  v_mfma_f32_16x16x32_bf16 a[72:75], a[248:251], v[16:19], a[72:75]
  ds_read_b64_tr_b16 a[242:243], v0 offset:2048
  v_cvt_pk_bf16_f32 v46, v46, v47
  v_mfma_f32_16x16x32_bf16 a[72:75], a[252:255], v[64:67], a[72:75]
  ds_read_b64_tr_b16 a[244:245], v0 offset:4096
  v_accvgpr_read_b32 v47, a30
  v_mfma_f32_16x16x32_bf16 a[76:79], a[248:251], v[20:23], a[76:79]
  ds_read_b64_tr_b16 a[246:247], v0 offset:6144
  v_mul_f32 v47, v11, v47
  v_cvt_pk_bf16_f32 v47, v47, v3
  v_mfma_f32_16x16x32_bf16 a[76:79], a[252:255], v[68:71], a[76:79]
  v_accvgpr_read_b32 v48, a8
  v_accvgpr_read_b32 v49, a9
  v_mfma_f32_16x16x32_bf16 a[80:83], a[248:251], v[24:27], a[80:83]
  s_add_u32 m0, s32, 36864
  v_accvgpr_read_b32 v50, a10
  v_accvgpr_read_b32 v51, a11
  v_mfma_f32_16x16x32_bf16 a[80:83], a[252:255], v[72:75], a[80:83]
  s_add_u32 s40, s35, 9216
  v_mul_f32 v48, v12, v48
  v_mfma_f32_16x16x32_bf16 a[84:87], a[248:251], v[28:31], a[84:87]
  buffer_load_dwordx4 v4, s[12:15], s40 offen nt lds
  v_mul_f32 v49, v12, v49
  v_mfma_f32_16x16x32_bf16 a[84:87], a[252:255], v[76:79], a[84:87]
  buffer_load_dwordx4 v5, s[12:15], s40 offen offset:1024 nt lds
  v_mfma_f32_16x16x32_bf16 a[88:91], a[248:251], v[32:35], a[88:91]
  buffer_load_dwordx4 v6, s[12:15], s40 offen offset:2048 nt lds
  v_mfma_f32_16x16x32_bf16 a[88:91], a[252:255], v[80:83], a[88:91]
  v_mul_f32 v50, v12, v50
  v_mul_f32 v51, v12, v51
  v_cvt_pk_bf16_f32 v48, v48, v49
  v_mfma_f32_16x16x32_bf16 a[92:95], a[248:251], v[36:39], a[92:95]
  v_cvt_pk_bf16_f32 v49, v50, v51
  v_accvgpr_read_b32 v50, a12
  v_mfma_f32_16x16x32_bf16 a[92:95], a[252:255], v[84:87], a[92:95]
  s_waitcnt lgkmcnt(0)
  v_accvgpr_read_b32 v51, a13
  v_accvgpr_read_b32 v52, a14
  v_mfma_f32_16x16x32_bf16 a[96:99], a[240:243], a[144:147], 0
  ds_read_b64_tr_b16 a[248:249], v0 offset:8192
  v_accvgpr_read_b32 v53, a15
  v_mfma_f32_16x16x32_bf16 a[96:99], a[244:247], a[168:171], a[96:99]
  ds_read_b64_tr_b16 a[250:251], v0 offset:10240
  v_mul_f32 v50, v13, v50
  v_mul_f32 v51, v13, v51
  v_mfma_f32_16x16x32_bf16 a[100:103], a[240:243], a[148:151], 0
L_pad_6:
  s_cbranch_execz L_pad_10
  v_xor_b32 v0, 32, v0
  v_mul_f32 v52, v13, v52
  v_mfma_f32_16x16x32_bf16 a[100:103], a[244:247], a[172:175], a[100:103]
  ds_read_b64_tr_b16 a[252:253], v0 offset:0
  v_mul_f32 v53, v13, v53
  v_mfma_f32_16x16x32_bf16 a[104:107], a[240:243], a[152:155], 0
  ds_read_b64_tr_b16 a[254:255], v0 offset:2048
  v_cvt_pk_bf16_f32 v50, v50, v51
  v_mfma_f32_16x16x32_bf16 a[104:107], a[244:247], a[176:179], a[104:107]
  v_cvt_pk_bf16_f32 v51, v52, v53
  v_accvgpr_read_b32 v52, a32
  v_accvgpr_read_b32 v53, a33
  v_mfma_f32_16x16x32_bf16 a[108:111], a[240:243], a[156:159], 0
  v_accvgpr_read_b32 v54, a34
  v_accvgpr_read_b32 v55, a35
  v_mfma_f32_16x16x32_bf16 a[108:111], a[244:247], a[180:183], a[108:111]
  v_mul_f32 v52, v12, v52
  v_mul_f32 v53, v12, v53
  v_mfma_f32_16x16x32_bf16 a[112:115], a[240:243], a[160:163], 0
  v_mul_f32 v54, v12, v54
  v_mul_f32 v55, v12, v55
  v_mfma_f32_16x16x32_bf16 a[112:115], a[244:247], a[184:187], a[112:115]
  v_cvt_pk_bf16_f32 v52, v52, v53
  v_cvt_pk_bf16_f32 v53, v54, v55
  v_accvgpr_read_b32 v54, a36
  v_mfma_f32_16x16x32_bf16 a[116:119], a[240:243], a[164:167], 0
  v_accvgpr_read_b32 v55, a37
  v_accvgpr_read_b32 v3, a39
  v_mfma_f32_16x16x32_bf16 a[116:119], a[244:247], a[188:191], a[116:119]
  s_waitcnt lgkmcnt(0)
  v_mul_f32 v54, v13, v54
  v_mul_f32 v55, v13, v55
  v_mfma_f32_16x16x32_bf16 a[96:99], a[248:251], a[192:195], a[96:99]
  ds_read_b64_tr_b16 a[240:241], v0 offset:4096
  v_mul_f32 v3, v13, v3
  v_mfma_f32_16x16x32_bf16 a[120:123], a[252:255], a[144:147], 0
  ds_read_b64_tr_b16 a[242:243], v0 offset:6144
  v_cvt_pk_bf16_f32 v54, v54, v55
  v_accvgpr_read_b32 v55, a38
  v_mfma_f32_16x16x32_bf16 a[100:103], a[248:251], a[196:199], a[100:103]
  ds_read_b64_tr_b16 a[244:245], v0 offset:8192
  v_mul_f32 v55, v13, v55
  v_mfma_f32_16x16x32_bf16 a[124:127], a[252:255], a[148:151], 0
  ds_read_b64_tr_b16 a[246:247], v0 offset:10240
  v_cvt_pk_bf16_f32 v55, v55, v3
  v_mfma_f32_16x16x32_bf16 a[104:107], a[248:251], a[200:203], a[104:107]
  v_xor_b32 v0, 96, v0
  v_accvgpr_read_b32 v56, a16
  v_mfma_f32_16x16x32_bf16 a[128:131], a[252:255], a[152:155], 0
  v_accvgpr_read_b32 v57, a17
  v_accvgpr_read_b32 v58, a18
  v_accvgpr_read_b32 v59, a19
  v_mfma_f32_16x16x32_bf16 a[108:111], a[248:251], a[204:207], a[108:111]
  v_mul_f32 v56, v14, v56
  v_mul_f32 v57, v14, v57
  v_mfma_f32_16x16x32_bf16 a[132:135], a[252:255], a[156:159], 0
  v_mul_f32 v58, v14, v58
  v_mul_f32 v59, v14, v59
  v_mfma_f32_16x16x32_bf16 a[112:115], a[248:251], a[208:211], a[112:115]
  v_cvt_pk_bf16_f32 v56, v56, v57
  v_cvt_pk_bf16_f32 v57, v58, v59
  v_mfma_f32_16x16x32_bf16 a[136:139], a[252:255], a[160:163], 0
  v_accvgpr_read_b32 v58, a20
  v_accvgpr_read_b32 v59, a21
  v_accvgpr_read_b32 v60, a22
  v_mfma_f32_16x16x32_bf16 a[116:119], a[248:251], a[212:215], a[116:119]
  v_accvgpr_read_b32 v61, a23
  v_mul_f32 v58, v15, v58
  v_mfma_f32_16x16x32_bf16 a[140:143], a[252:255], a[164:167], 0
  s_waitcnt lgkmcnt(0)
  v_mul_f32 v59, v15, v59
  v_mul_f32 v60, v15, v60
  v_mfma_f32_16x16x32_bf16 a[120:123], a[240:243], a[168:171], a[120:123]
  ds_read_b64_tr_b16 a[248:249], v0 offset:0
  v_mul_f32 v61, v15, v61
  v_mfma_f32_16x16x32_bf16 a[120:123], a[244:247], a[192:195], a[120:123]
  ds_read_b64_tr_b16 a[250:251], v0 offset:2048
  v_cvt_pk_bf16_f32 v58, v58, v59
  v_cvt_pk_bf16_f32 v59, v60, v61
  v_mfma_f32_16x16x32_bf16 a[124:127], a[240:243], a[172:175], a[124:127]
  ds_read_b64_tr_b16 a[252:253], v0 offset:4096
  v_accvgpr_read_b32 v60, a40
  v_mfma_f32_16x16x32_bf16 a[124:127], a[244:247], a[196:199], a[124:127]
  ds_read_b64_tr_b16 a[254:255], v0 offset:6144
  v_accvgpr_read_b32 v61, a41
  v_mfma_f32_16x16x32_bf16 a[128:131], a[240:243], a[176:179], a[128:131]
  v_accvgpr_read_b32 v62, a42
  v_accvgpr_read_b32 v63, a43
  v_mfma_f32_16x16x32_bf16 a[128:131], a[244:247], a[200:203], a[128:131]
  v_mul_f32 v60, v14, v60
  v_mul_f32 v61, v14, v61
  v_mul_f32 v62, v14, v62
  v_mfma_f32_16x16x32_bf16 a[132:135], a[240:243], a[180:183], a[132:135]
  v_mul_f32 v63, v14, v63
  v_cvt_pk_bf16_f32 v60, v60, v61
  v_mfma_f32_16x16x32_bf16 a[132:135], a[244:247], a[204:207], a[132:135]
  v_cvt_pk_bf16_f32 v61, v62, v63
  v_accvgpr_read_b32 v62, a44
  v_mfma_f32_16x16x32_bf16 a[136:139], a[240:243], a[184:187], a[136:139]
  v_accvgpr_read_b32 v63, a45
  v_accvgpr_read_b32 v3, a47
  v_mfma_f32_16x16x32_bf16 a[136:139], a[244:247], a[208:211], a[136:139]
  v_mul_f32 v62, v15, v62
  v_mul_f32 v63, v15, v63
  v_mul_f32 v3, v15, v3
  v_mfma_f32_16x16x32_bf16 a[140:143], a[240:243], a[188:191], a[140:143]
  v_cvt_pk_bf16_f32 v62, v62, v63
  v_accvgpr_read_b32 v63, a46
  v_mfma_f32_16x16x32_bf16 a[140:143], a[244:247], a[212:215], a[140:143]
  s_waitcnt lgkmcnt(0)
  v_mul_f32 v63, v15, v63
  v_cvt_pk_bf16_f32 v63, v63, v3
  v_mfma_f32_16x16x32_bf16 a[0:3], a[248:251], a[144:147], 0
  ds_read_b64_tr_b16 a[240:241], v0 offset:8192
  v_accvgpr_read_b32 v88, a48
  v_mfma_f32_16x16x32_bf16 a[0:3], a[252:255], a[168:171], a[0:3]
  ds_read_b64_tr_b16 a[242:243], v0 offset:10240
  v_accvgpr_read_b32 v89, a49
  v_mfma_f32_16x16x32_bf16 a[4:7], a[248:251], a[148:151], 0
  v_xor_b32 v0, 32, v0
  v_accvgpr_read_b32 v90, a50
  v_mfma_f32_16x16x32_bf16 a[4:7], a[252:255], a[172:175], a[4:7]
  ds_read_b64_tr_b16 a[244:245], v0 offset:0
  v_accvgpr_read_b32 v91, a51
  v_mul_f32 v88, v10, v88
  v_mfma_f32_16x16x32_bf16 a[8:11], a[248:251], a[152:155], 0
  ds_read_b64_tr_b16 a[246:247], v0 offset:2048
  v_mul_f32 v89, v10, v89
  v_mfma_f32_16x16x32_bf16 a[8:11], a[252:255], a[176:179], a[8:11]
  v_mul_f32 v90, v10, v90
  v_mul_f32 v91, v10, v91
  v_mfma_f32_16x16x32_bf16 a[12:15], a[248:251], a[156:159], 0
  v_cvt_pk_bf16_f32 v88, v88, v89
  v_cvt_pk_bf16_f32 v89, v90, v91
  v_mfma_f32_16x16x32_bf16 a[12:15], a[252:255], a[180:183], a[12:15]
  v_accvgpr_read_b32 v90, a52
  v_accvgpr_read_b32 v91, a53
  v_mfma_f32_16x16x32_bf16 a[16:19], a[248:251], a[160:163], 0
  v_accvgpr_read_b32 v92, a54
  v_accvgpr_read_b32 v93, a55
  v_mfma_f32_16x16x32_bf16 a[16:19], a[252:255], a[184:187], a[16:19]
  v_mul_f32 v90, v11, v90
  v_mul_f32 v91, v11, v91
  v_mul_f32 v92, v11, v92
  v_mfma_f32_16x16x32_bf16 a[20:23], a[248:251], a[164:167], 0
  v_mul_f32 v93, v11, v93
  v_cvt_pk_bf16_f32 v90, v90, v91
  v_mfma_f32_16x16x32_bf16 a[20:23], a[252:255], a[188:191], a[20:23]
  s_waitcnt lgkmcnt(0)
  v_cvt_pk_bf16_f32 v91, v92, v93
  v_accvgpr_read_b32 v92, a72
  v_mfma_f32_16x16x32_bf16 a[0:3], a[240:243], a[192:195], a[0:3]
  ds_read_b64_tr_b16 a[248:249], v0 offset:4096
  v_accvgpr_read_b32 v93, a73
  v_mfma_f32_16x16x32_bf16 a[24:27], a[244:247], a[144:147], 0
  ds_read_b64_tr_b16 a[250:251], v0 offset:6144
  v_accvgpr_read_b32 v94, a74
  v_mfma_f32_16x16x32_bf16 a[4:7], a[240:243], a[196:199], a[4:7]
  ds_read_b64_tr_b16 a[252:253], v0 offset:8192
  v_accvgpr_read_b32 v95, a75
  v_mfma_f32_16x16x32_bf16 a[28:31], a[244:247], a[148:151], 0
  ds_read_b64_tr_b16 a[254:255], v0 offset:10240
  v_mul_f32 v92, v10, v92
  v_mul_f32 v93, v10, v93
  v_mfma_f32_16x16x32_bf16 a[8:11], a[240:243], a[200:203], a[8:11]
  v_xor_b32 v0, 96, v0
  v_mul_f32 v94, v10, v94
  v_mfma_f32_16x16x32_bf16 a[32:35], a[244:247], a[152:155], 0
  v_mul_f32 v95, v10, v95
  v_cvt_pk_bf16_f32 v92, v92, v93
  v_mfma_f32_16x16x32_bf16 a[12:15], a[240:243], a[204:207], a[12:15]
  v_cvt_pk_bf16_f32 v93, v94, v95
  v_accvgpr_read_b32 v94, a76
  v_mfma_f32_16x16x32_bf16 a[36:39], a[244:247], a[156:159], 0
  v_accvgpr_read_b32 v95, a77
  v_accvgpr_read_b32 v3, a79
  v_mfma_f32_16x16x32_bf16 a[16:19], a[240:243], a[208:211], a[16:19]
  s_waitcnt vmcnt(3)
  v_mul_f32 v94, v11, v94
  v_mfma_f32_16x16x32_bf16 a[40:43], a[244:247], a[160:163], 0
  v_mul_f32 v95, v11, v95
  v_mul_f32 v3, v11, v3
  v_mfma_f32_16x16x32_bf16 a[20:23], a[240:243], a[212:215], a[20:23]
  v_cvt_pk_bf16_f32 v94, v94, v95
  v_accvgpr_read_b32 v95, a78
  v_mfma_f32_16x16x32_bf16 a[44:47], a[244:247], a[164:167], 0
  s_waitcnt lgkmcnt(0)
  s_barrier
  ds_read_b64_tr_b16 a[240:241], v0 offset:12288
  v_mfma_f32_16x16x32_bf16 a[24:27], a[248:251], a[168:171], a[24:27]
  ds_read_b64_tr_b16 a[242:243], v0 offset:14336
  v_mul_f32 v95, v11, v95
  v_cvt_pk_bf16_f32 v95, v95, v3
  v_mfma_f32_16x16x32_bf16 a[24:27], a[252:255], a[192:195], a[24:27]
  ds_read_b64_tr_b16 a[244:245], v0 offset:16384
  ds_write_b64 v7, v[40:41] offset:0
  v_mfma_f32_16x16x32_bf16 a[28:31], a[248:251], a[172:175], a[28:31]
  ds_read_b64_tr_b16 a[246:247], v0 offset:18432
  v_mfma_f32_16x16x32_bf16 a[28:31], a[252:255], a[196:199], a[28:31]
  ds_write_b64 v7, v[42:43] offset:2048
  v_xor_b32 v7, 32, v7
  v_mfma_f32_16x16x32_bf16 a[32:35], a[248:251], a[176:179], a[32:35]
  s_add_u32 m0, s32, 49152
  ds_write_b64 v7, v[44:45] offset:0
  v_mfma_f32_16x16x32_bf16 a[32:35], a[252:255], a[200:203], a[32:35]
  s_add_u32 s40, s35, 12288
  ds_write_b64 v7, v[46:47] offset:2048
  v_xor_b32 v7, 96, v7
  v_mfma_f32_16x16x32_bf16 a[36:39], a[248:251], a[180:183], a[36:39]
  buffer_load_dwordx4 v4, s[12:15], s40 offen nt lds
  v_mfma_f32_16x16x32_bf16 a[36:39], a[252:255], a[204:207], a[36:39]
  buffer_load_dwordx4 v5, s[12:15], s40 offen offset:1024 nt lds
  v_mfma_f32_16x16x32_bf16 a[40:43], a[248:251], a[184:187], a[40:43]
  buffer_load_dwordx4 v6, s[12:15], s40 offen offset:2048 nt lds
  v_mfma_f32_16x16x32_bf16 a[40:43], a[252:255], a[208:211], a[40:43]
  ds_write_b64 v7, v[88:89] offset:0
  ds_write_b64 v7, v[90:91] offset:2048
  v_mfma_f32_16x16x32_bf16 a[44:47], a[248:251], a[188:191], a[44:47]
  v_xor_b32 v7, 32, v7
  v_mfma_f32_16x16x32_bf16 a[44:47], a[252:255], a[212:215], a[44:47]
  s_waitcnt lgkmcnt(5)
  ds_write_b64 v7, v[92:93] offset:0
  ds_write_b64 v7, v[94:95] offset:2048
  v_mfma_f32_16x16x32_bf16 a[96:99], a[240:243], a[216:219], a[96:99]
  ds_read_b64_tr_b16 a[248:249], v0 offset:20480
  v_xor_b32 v7, 96, v7
  v_mfma_f32_16x16x32_bf16 a[96:99], a[244:247], v[112:115], a[96:99]
  ds_read_b64_tr_b16 a[250:251], v0 offset:22528
  ds_read_b128 v[40:43], v8 offset:0
  ds_read_b128 v[44:47], v8 offset:1024
  v_mfma_f32_16x16x32_bf16 a[100:103], a[240:243], a[220:223], a[100:103]
  v_xor_b32 v0, 32, v0
  v_mfma_f32_16x16x32_bf16 a[100:103], a[244:247], v[116:119], a[100:103]
  ds_read_b64_tr_b16 a[252:253], v0 offset:12288
  ds_read_b128 v[88:91], v8 offset:2048
  ds_read_b128 v[92:95], v8 offset:3072
  v_mfma_f32_16x16x32_bf16 a[104:107], a[240:243], a[224:227], a[104:107]
  ds_read_b64_tr_b16 a[254:255], v0 offset:14336
  v_accvgpr_read_b32 v96, a56
  v_mfma_f32_16x16x32_bf16 a[104:107], a[244:247], v[120:123], a[104:107]
  v_accvgpr_read_b32 v97, a57
  v_accvgpr_read_b32 v98, a58
  v_mfma_f32_16x16x32_bf16 a[108:111], a[240:243], a[228:231], a[108:111]
  v_accvgpr_read_b32 v99, a59
  v_mul_f32 v96, v12, v96
  v_mfma_f32_16x16x32_bf16 a[108:111], a[244:247], v[124:127], a[108:111]
  v_mul_f32 v97, v12, v97
  v_mul_f32 v98, v12, v98
  v_mfma_f32_16x16x32_bf16 a[112:115], a[240:243], a[232:235], a[112:115]
  s_add_u32 s46, s34, 0
  s_waitcnt lgkmcnt(5)
  buffer_store_dwordx4 v[40:43], v9, s[24:27], s46 offen sc1
  v_mfma_f32_16x16x32_bf16 a[112:115], a[244:247], v[128:131], a[112:115]
  v_mul_f32 v99, v12, v99
  v_cvt_pk_bf16_f32 v96, v96, v97
  v_mfma_f32_16x16x32_bf16 a[116:119], a[240:243], a[236:239], a[116:119]
  v_cvt_pk_bf16_f32 v97, v98, v99
  v_accvgpr_read_b32 v98, a60
  v_mfma_f32_16x16x32_bf16 a[116:119], a[244:247], v[132:135], a[116:119]
  v_accvgpr_read_b32 v99, a61
  v_mfma_f32_16x16x32_bf16 a[96:99], a[248:251], v[136:139], a[96:99]
  s_waitcnt lgkmcnt(0)
  ds_read_b64_tr_b16 a[240:241], v0 offset:16384
  v_accvgpr_read_b32 v100, a62
  v_mfma_f32_16x16x32_bf16 a[120:123], a[252:255], a[216:219], a[120:123]
  ds_read_b64_tr_b16 a[242:243], v0 offset:18432
  v_accvgpr_read_b32 v101, a63
  v_mfma_f32_16x16x32_bf16 a[100:103], a[248:251], v[140:143], a[100:103]
  ds_read_b64_tr_b16 a[244:245], v0 offset:20480
  v_mul_f32 v98, v13, v98
  v_mfma_f32_16x16x32_bf16 a[124:127], a[252:255], a[220:223], a[124:127]
  ds_read_b64_tr_b16 a[246:247], v0 offset:22528
  v_mul_f32 v99, v13, v99
  v_mfma_f32_16x16x32_bf16 a[104:107], a[248:251], v[144:147], a[104:107]
  v_xor_b32 v0, 96, v0
  v_mul_f32 v100, v13, v100
  v_mfma_f32_16x16x32_bf16 a[128:131], a[252:255], a[224:227], a[128:131]
  v_mul_f32 v101, v13, v101
  v_cvt_pk_bf16_f32 v98, v98, v99
  v_mfma_f32_16x16x32_bf16 a[108:111], a[248:251], v[148:151], a[108:111]
  v_cvt_pk_bf16_f32 v99, v100, v101
  v_accvgpr_read_b32 v100, a80
  v_mfma_f32_16x16x32_bf16 a[132:135], a[252:255], a[228:231], a[132:135]
  v_accvgpr_read_b32 v101, a81
  v_accvgpr_read_b32 v102, a82
  v_mfma_f32_16x16x32_bf16 a[112:115], a[248:251], v[152:155], a[112:115]
  v_accvgpr_read_b32 v103, a83
  v_mul_f32 v100, v12, v100
  v_mfma_f32_16x16x32_bf16 a[136:139], a[252:255], a[232:235], a[136:139]
  v_mul_f32 v101, v12, v101
  v_mul_f32 v102, v12, v102
  v_mfma_f32_16x16x32_bf16 a[116:119], a[248:251], v[156:159], a[116:119]
  v_mul_f32 v103, v12, v103
  v_cvt_pk_bf16_f32 v100, v100, v101
  v_mfma_f32_16x16x32_bf16 a[140:143], a[252:255], a[236:239], a[140:143]
  s_waitcnt lgkmcnt(0)
  v_cvt_pk_bf16_f32 v101, v102, v103
  v_accvgpr_read_b32 v102, a84
  v_mfma_f32_16x16x32_bf16 a[120:123], a[240:243], v[112:115], a[120:123]
  ds_read_b64_tr_b16 a[248:249], v0 offset:12288
  v_accvgpr_read_b32 v103, a85
  v_mfma_f32_16x16x32_bf16 a[120:123], a[244:247], v[136:139], a[120:123]
  ds_read_b64_tr_b16 a[250:251], v0 offset:14336
  v_mfma_f32_16x16x32_bf16 a[124:127], a[240:243], v[116:119], a[124:127]
  ds_read_b64_tr_b16 a[252:253], v0 offset:16384
  buffer_store_dwordx4 v[44:47], v9, s[24:27], s46 offen offset:3072 sc1
  v_mfma_f32_16x16x32_bf16 a[124:127], a[244:247], v[140:143], a[124:127]
  ds_read_b64_tr_b16 a[254:255], v0 offset:18432
  v_accvgpr_read_b32 v3, a87
  v_mfma_f32_16x16x32_bf16 a[128:131], a[240:243], v[120:123], a[128:131]
  v_mul_f32 v102, v13, v102
  v_mul_f32 v103, v13, v103
  v_mfma_f32_16x16x32_bf16 a[128:131], a[244:247], v[144:147], a[128:131]
  v_mul_f32 v3, v13, v3
  v_cvt_pk_bf16_f32 v102, v102, v103
  v_mfma_f32_16x16x32_bf16 a[132:135], a[240:243], v[124:127], a[132:135]
  v_accvgpr_read_b32 v103, a86
  v_mul_f32 v103, v13, v103
  v_mfma_f32_16x16x32_bf16 a[132:135], a[244:247], v[148:151], a[132:135]
  v_cvt_pk_bf16_f32 v103, v103, v3
  v_mfma_f32_16x16x32_bf16 a[136:139], a[240:243], v[128:131], a[136:139]
  ds_write_b64 v7, v[48:49] offset:0
  ds_write_b64 v7, v[50:51] offset:2048
  v_mfma_f32_16x16x32_bf16 a[136:139], a[244:247], v[152:155], a[136:139]
  v_xor_b32 v7, 32, v7
  v_mfma_f32_16x16x32_bf16 a[140:143], a[240:243], v[132:135], a[140:143]
  ds_write_b64 v7, v[52:53] offset:0
  ds_write_b64 v7, v[54:55] offset:2048
  v_mfma_f32_16x16x32_bf16 a[140:143], a[244:247], v[156:159], a[140:143]
  s_waitcnt lgkmcnt(4)
  v_xor_b32 v7, 96, v7
  v_mfma_f32_16x16x32_bf16 a[0:3], a[248:251], a[216:219], a[0:3]
  ds_read_b64_tr_b16 a[240:241], v0 offset:20480
  ds_write_b64 v7, v[96:97] offset:0
  v_mfma_f32_16x16x32_bf16 a[0:3], a[252:255], v[112:115], a[0:3]
  ds_read_b64_tr_b16 a[242:243], v0 offset:22528
  ds_write_b64 v7, v[98:99] offset:2048
  v_mfma_f32_16x16x32_bf16 a[4:7], a[248:251], a[220:223], a[4:7]
  v_xor_b32 v0, 32, v0
  v_xor_b32 v7, 32, v7
  v_mfma_f32_16x16x32_bf16 a[4:7], a[252:255], v[116:119], a[4:7]
  ds_read_b64_tr_b16 a[244:245], v0 offset:12288
  ds_write_b64 v7, v[100:101] offset:0
  v_mfma_f32_16x16x32_bf16 a[8:11], a[248:251], a[224:227], a[8:11]
  ds_read_b64_tr_b16 a[246:247], v0 offset:14336
  v_mfma_f32_16x16x32_bf16 a[8:11], a[252:255], v[120:123], a[8:11]
  ds_write_b64 v7, v[102:103] offset:2048
  v_xor_b32 v7, 96, v7
  v_mfma_f32_16x16x32_bf16 a[12:15], a[248:251], a[228:231], a[12:15]
  ds_read_b128 v[48:51], v8 offset:0
  ds_read_b128 v[52:55], v8 offset:1024
  v_mfma_f32_16x16x32_bf16 a[12:15], a[252:255], v[124:127], a[12:15]
  ds_read_b128 v[96:99], v8 offset:2048
  ds_read_b128 v[100:103], v8 offset:3072
  v_mfma_f32_16x16x32_bf16 a[16:19], a[248:251], a[232:235], a[16:19]
  s_add_u32 s46, s34, 6144
  buffer_store_dwordx4 v[88:91], v9, s[24:27], s46 offen sc1
  v_mfma_f32_16x16x32_bf16 a[16:19], a[252:255], v[128:131], a[16:19]
  v_accvgpr_read_b32 v104, a64
  v_accvgpr_read_b32 v105, a65
  v_mfma_f32_16x16x32_bf16 a[20:23], a[248:251], a[236:239], a[20:23]
  v_accvgpr_read_b32 v106, a66
  v_accvgpr_read_b32 v107, a67
  v_mfma_f32_16x16x32_bf16 a[20:23], a[252:255], v[132:135], a[20:23]
  s_waitcnt lgkmcnt(5)
  v_mul_f32 v104, v14, v104
  v_mul_f32 v105, v14, v105
  v_mfma_f32_16x16x32_bf16 a[0:3], a[240:243], v[136:139], a[0:3]
  ds_read_b64_tr_b16 a[248:249], v0 offset:16384
  v_mul_f32 v106, v14, v106
  v_mul_f32 v107, v14, v107
  v_mfma_f32_16x16x32_bf16 a[24:27], a[244:247], a[216:219], a[24:27]
  ds_read_b64_tr_b16 a[250:251], v0 offset:18432
  v_cvt_pk_bf16_f32 v104, v104, v105
  v_mfma_f32_16x16x32_bf16 a[4:7], a[240:243], v[140:143], a[4:7]
  ds_read_b64_tr_b16 a[252:253], v0 offset:20480
  v_cvt_pk_bf16_f32 v105, v106, v107
  v_mfma_f32_16x16x32_bf16 a[28:31], a[244:247], a[220:223], a[28:31]
  ds_read_b64_tr_b16 a[254:255], v0 offset:22528
  v_accvgpr_read_b32 v106, a68
  v_mfma_f32_16x16x32_bf16 a[8:11], a[240:243], v[144:147], a[8:11]
  v_xor_b32 v0, 96, v0
  v_accvgpr_read_b32 v107, a69
  v_mfma_f32_16x16x32_bf16 a[32:35], a[244:247], a[224:227], a[32:35]
  v_accvgpr_read_b32 v108, a70
  v_accvgpr_read_b32 v109, a71
  v_mul_f32 v106, v15, v106
  v_mfma_f32_16x16x32_bf16 a[12:15], a[240:243], v[148:151], a[12:15]
  v_mul_f32 v107, v15, v107
  v_mul_f32 v108, v15, v108
  v_mfma_f32_16x16x32_bf16 a[36:39], a[244:247], a[228:231], a[36:39]
  v_mul_f32 v109, v15, v109
  v_cvt_pk_bf16_f32 v106, v106, v107
  v_mfma_f32_16x16x32_bf16 a[16:19], a[240:243], v[152:155], a[16:19]
  v_cvt_pk_bf16_f32 v107, v108, v109
  v_accvgpr_read_b32 v108, a88
  v_mfma_f32_16x16x32_bf16 a[40:43], a[244:247], a[232:235], a[40:43]
  v_accvgpr_read_b32 v109, a89
  v_accvgpr_read_b32 v110, a90
  v_mfma_f32_16x16x32_bf16 a[20:23], a[240:243], v[156:159], a[20:23]
  v_accvgpr_read_b32 v111, a91
  v_mul_f32 v108, v14, v108
  v_mfma_f32_16x16x32_bf16 a[44:47], a[244:247], a[236:239], a[44:47]
  s_waitcnt lgkmcnt(0)
  s_barrier
  ds_read_b64_tr_b16 a[240:241], v0 offset:24576
  v_mfma_f32_16x16x32_bf16 a[24:27], a[248:251], v[112:115], a[24:27]
  ds_read_b64_tr_b16 a[242:243], v0 offset:26624
  v_mul_f32 v109, v14, v109
  v_mul_f32 v110, v14, v110
  v_mfma_f32_16x16x32_bf16 a[24:27], a[252:255], v[136:139], a[24:27]
  ds_read_b64_tr_b16 a[244:245], v0 offset:28672
  v_mul_f32 v111, v14, v111
  v_mfma_f32_16x16x32_bf16 a[28:31], a[248:251], v[116:119], a[28:31]
  ds_read_b64_tr_b16 a[246:247], v0 offset:30720
  buffer_store_dwordx4 v[92:95], v9, s[24:27], s46 offen offset:3072 sc1
  v_mfma_f32_16x16x32_bf16 a[28:31], a[252:255], v[140:143], a[28:31]
  v_cvt_pk_bf16_f32 v108, v108, v109
  v_cvt_pk_bf16_f32 v109, v110, v111
  v_mfma_f32_16x16x32_bf16 a[32:35], a[248:251], v[120:123], a[32:35]
  s_add_u32 m0, s32, 61440
  v_accvgpr_read_b32 v110, a92
  v_accvgpr_read_b32 v111, a93
  v_mfma_f32_16x16x32_bf16 a[32:35], a[252:255], v[144:147], a[32:35]
  s_add_u32 s40, s35, 15360
  v_accvgpr_read_b32 v3, a95
  v_mfma_f32_16x16x32_bf16 a[36:39], a[248:251], v[124:127], a[36:39]
  buffer_load_dwordx4 v4, s[12:15], s40 offen nt lds
  v_mfma_f32_16x16x32_bf16 a[36:39], a[252:255], v[148:151], a[36:39]
  buffer_load_dwordx4 v5, s[12:15], s40 offen offset:1024 nt lds
  v_mul_f32 v110, v15, v110
  v_mfma_f32_16x16x32_bf16 a[40:43], a[248:251], v[128:131], a[40:43]
  buffer_load_dwordx4 v6, s[12:15], s40 offen offset:2048 nt lds
  v_mfma_f32_16x16x32_bf16 a[40:43], a[252:255], v[152:155], a[40:43]
  v_mul_f32 v111, v15, v111
  v_mul_f32 v3, v15, v3
  v_mfma_f32_16x16x32_bf16 a[44:47], a[248:251], v[132:135], a[44:47]
  v_cvt_pk_bf16_f32 v110, v110, v111
  v_accvgpr_read_b32 v111, a94
  v_mfma_f32_16x16x32_bf16 a[44:47], a[252:255], v[156:159], a[44:47]
  s_waitcnt lgkmcnt(0)
  v_mul_f32 v111, v15, v111
  v_cvt_pk_bf16_f32 v111, v111, v3
  v_mfma_f32_16x16x32_bf16 a[96:99], a[240:243], v[160:163], a[96:99]
  ds_read_b64_tr_b16 a[248:249], v0 offset:32768
  ds_write_b64 v7, v[56:57] offset:0
  v_mfma_f32_16x16x32_bf16 a[96:99], a[244:247], v[184:187], a[96:99]
  ds_read_b64_tr_b16 a[250:251], v0 offset:34816
  ds_write_b64 v7, v[58:59] offset:2048
  v_mfma_f32_16x16x32_bf16 a[100:103], a[240:243], v[164:167], a[100:103]
  v_xor_b32 v0, 32, v0
  v_xor_b32 v7, 32, v7
  v_mfma_f32_16x16x32_bf16 a[100:103], a[244:247], v[188:191], a[100:103]
  ds_read_b64_tr_b16 a[252:253], v0 offset:24576
  ds_write_b64 v7, v[60:61] offset:0
  v_mfma_f32_16x16x32_bf16 a[104:107], a[240:243], v[168:171], a[104:107]
  ds_read_b64_tr_b16 a[254:255], v0 offset:26624
  ds_write_b64 v7, v[62:63] offset:2048
  v_mfma_f32_16x16x32_bf16 a[104:107], a[244:247], v[192:195], a[104:107]
  v_xor_b32 v7, 96, v7
  v_mfma_f32_16x16x32_bf16 a[108:111], a[240:243], v[172:175], a[108:111]
  ds_write_b64 v7, v[104:105] offset:0
  ds_write_b64 v7, v[106:107] offset:2048
  v_mfma_f32_16x16x32_bf16 a[108:111], a[244:247], v[196:199], a[108:111]
  v_xor_b32 v7, 32, v7
  v_mfma_f32_16x16x32_bf16 a[112:115], a[240:243], v[176:179], a[112:115]
  s_add_u32 s46, s34, 12288
  buffer_store_dwordx4 v[48:51], v9, s[24:27], s46 offen sc1
  ds_write_b64 v7, v[108:109] offset:0
  v_mfma_f32_16x16x32_bf16 a[112:115], a[244:247], v[200:203], a[112:115]
  ds_write_b64 v7, v[110:111] offset:2048
  v_xor_b32 v7, 96, v7
  v_mfma_f32_16x16x32_bf16 a[116:119], a[240:243], v[180:183], a[116:119]
  ds_read_b128 v[56:59], v8 offset:0
  ds_read_b128 v[60:63], v8 offset:1024
  v_mfma_f32_16x16x32_bf16 a[116:119], a[244:247], v[204:207], a[116:119]
  s_waitcnt lgkmcnt(7)
  ds_read_b128 v[104:107], v8 offset:2048
  ds_read_b128 v[108:111], v8 offset:3072
  v_mfma_f32_16x16x32_bf16 a[96:99], a[248:251], v[208:211], a[96:99]
  ds_read_b64_tr_b16 a[240:241], v0 offset:28672
  v_mfma_f32_16x16x32_bf16 a[120:123], a[252:255], v[160:163], a[120:123]
  ds_read_b64_tr_b16 a[242:243], v0 offset:30720
  v_mfma_f32_16x16x32_bf16 a[100:103], a[248:251], v[212:215], a[100:103]
  ds_read_b64_tr_b16 a[244:245], v0 offset:32768
  v_mfma_f32_16x16x32_bf16 a[124:127], a[252:255], v[164:167], a[124:127]
  ds_read_b64_tr_b16 a[246:247], v0 offset:34816
  v_mfma_f32_16x16x32_bf16 a[104:107], a[248:251], v[216:219], a[104:107]
  v_xor_b32 v0, 96, v0
  v_mfma_f32_16x16x32_bf16 a[128:131], a[252:255], v[168:171], a[128:131]
  v_mfma_f32_16x16x32_bf16 a[108:111], a[248:251], v[220:223], a[108:111]
  v_mfma_f32_16x16x32_bf16 a[132:135], a[252:255], v[172:175], a[132:135]
  v_mfma_f32_16x16x32_bf16 a[112:115], a[248:251], v[224:227], a[112:115]
  v_mfma_f32_16x16x32_bf16 a[136:139], a[252:255], v[176:179], a[136:139]
  v_mfma_f32_16x16x32_bf16 a[116:119], a[248:251], v[228:231], a[116:119]
  v_mfma_f32_16x16x32_bf16 a[140:143], a[252:255], v[180:183], a[140:143]
  s_waitcnt lgkmcnt(0)
  v_mfma_f32_16x16x32_bf16 a[120:123], a[240:243], v[184:187], a[120:123]
  ds_read_b64_tr_b16 a[248:249], v0 offset:24576
  v_mfma_f32_16x16x32_bf16 a[120:123], a[244:247], v[208:211], a[120:123]
  ds_read_b64_tr_b16 a[250:251], v0 offset:26624
  v_mfma_f32_16x16x32_bf16 a[124:127], a[240:243], v[188:191], a[124:127]
  ds_read_b64_tr_b16 a[252:253], v0 offset:28672
  buffer_store_dwordx4 v[52:55], v9, s[24:27], s46 offen offset:3072 sc1
  v_mfma_f32_16x16x32_bf16 a[124:127], a[244:247], v[212:215], a[124:127]
  ds_read_b64_tr_b16 a[254:255], v0 offset:30720
  v_mfma_f32_16x16x32_bf16 a[128:131], a[240:243], v[192:195], a[128:131]
  v_mfma_f32_16x16x32_bf16 a[128:131], a[244:247], v[216:219], a[128:131]
  v_mfma_f32_16x16x32_bf16 a[132:135], a[240:243], v[196:199], a[132:135]
  v_mfma_f32_16x16x32_bf16 a[132:135], a[244:247], v[220:223], a[132:135]
  v_mfma_f32_16x16x32_bf16 a[136:139], a[240:243], v[200:203], a[136:139]
  v_mfma_f32_16x16x32_bf16 a[136:139], a[244:247], v[224:227], a[136:139]
  v_mfma_f32_16x16x32_bf16 a[140:143], a[240:243], v[204:207], a[140:143]
  v_mfma_f32_16x16x32_bf16 a[140:143], a[244:247], v[228:231], a[140:143]
  s_waitcnt lgkmcnt(0)
  v_mfma_f32_16x16x32_bf16 a[0:3], a[248:251], v[160:163], a[0:3]
  ds_read_b64_tr_b16 a[240:241], v0 offset:32768
  v_mfma_f32_16x16x32_bf16 a[0:3], a[252:255], v[184:187], a[0:3]
  ds_read_b64_tr_b16 a[242:243], v0 offset:34816
  v_mfma_f32_16x16x32_bf16 a[4:7], a[248:251], v[164:167], a[4:7]
  v_xor_b32 v0, 32, v0
  v_mfma_f32_16x16x32_bf16 a[4:7], a[252:255], v[188:191], a[4:7]
  ds_read_b64_tr_b16 a[244:245], v0 offset:24576
  v_mfma_f32_16x16x32_bf16 a[8:11], a[248:251], v[168:171], a[8:11]
  ds_read_b64_tr_b16 a[246:247], v0 offset:26624
  v_mfma_f32_16x16x32_bf16 a[8:11], a[252:255], v[192:195], a[8:11]
  v_mfma_f32_16x16x32_bf16 a[12:15], a[248:251], v[172:175], a[12:15]
  v_mfma_f32_16x16x32_bf16 a[12:15], a[252:255], v[196:199], a[12:15]
  v_mfma_f32_16x16x32_bf16 a[16:19], a[248:251], v[176:179], a[16:19]
  s_add_u32 s46, s34, 18432
  buffer_store_dwordx4 v[96:99], v9, s[24:27], s46 offen sc1
  v_mfma_f32_16x16x32_bf16 a[16:19], a[252:255], v[200:203], a[16:19]
  v_mfma_f32_16x16x32_bf16 a[20:23], a[248:251], v[180:183], a[20:23]
  v_mfma_f32_16x16x32_bf16 a[20:23], a[252:255], v[204:207], a[20:23]
  s_waitcnt lgkmcnt(0)
  v_mfma_f32_16x16x32_bf16 a[0:3], a[240:243], v[208:211], a[0:3]
  ds_read_b64_tr_b16 a[248:249], v0 offset:28672
  v_mfma_f32_16x16x32_bf16 a[24:27], a[244:247], v[160:163], a[24:27]
  ds_read_b64_tr_b16 a[250:251], v0 offset:30720
  v_mfma_f32_16x16x32_bf16 a[4:7], a[240:243], v[212:215], a[4:7]
  ds_read_b64_tr_b16 a[252:253], v0 offset:32768
  v_mfma_f32_16x16x32_bf16 a[28:31], a[244:247], v[164:167], a[28:31]
  ds_read_b64_tr_b16 a[254:255], v0 offset:34816
  v_mfma_f32_16x16x32_bf16 a[8:11], a[240:243], v[216:219], a[8:11]
  v_xor_b32 v0, 96, v0
  v_mfma_f32_16x16x32_bf16 a[32:35], a[244:247], v[168:171], a[32:35]
  v_mfma_f32_16x16x32_bf16 a[12:15], a[240:243], v[220:223], a[12:15]
  v_mfma_f32_16x16x32_bf16 a[36:39], a[244:247], v[172:175], a[36:39]
  v_mfma_f32_16x16x32_bf16 a[16:19], a[240:243], v[224:227], a[16:19]
  v_mfma_f32_16x16x32_bf16 a[40:43], a[244:247], v[176:179], a[40:43]
  v_mfma_f32_16x16x32_bf16 a[20:23], a[240:243], v[228:231], a[20:23]
  v_mfma_f32_16x16x32_bf16 a[44:47], a[244:247], v[180:183], a[44:47]
  s_waitcnt lgkmcnt(0)
  s_barrier
  ds_read_b64_tr_b16 a[240:241], v0 offset:36864
  v_mfma_f32_16x16x32_bf16 a[24:27], a[248:251], v[184:187], a[24:27]
  ds_read_b64_tr_b16 a[242:243], v0 offset:38912
  v_mfma_f32_16x16x32_bf16 a[24:27], a[252:255], v[208:211], a[24:27]
  ds_read_b64_tr_b16 a[244:245], v0 offset:40960
  v_mfma_f32_16x16x32_bf16 a[28:31], a[248:251], v[188:191], a[28:31]
  ds_read_b64_tr_b16 a[246:247], v0 offset:43008
  buffer_store_dwordx4 v[100:103], v9, s[24:27], s46 offen offset:3072 sc1
  v_mfma_f32_16x16x32_bf16 a[28:31], a[252:255], v[212:215], a[28:31]
  v_mfma_f32_16x16x32_bf16 a[32:35], a[248:251], v[192:195], a[32:35]
  s_add_u32 m0, s32, 73728
  v_mfma_f32_16x16x32_bf16 a[32:35], a[252:255], v[216:219], a[32:35]
L_pad_7:
  s_cbranch_execz L_padret
  s_add_u32 s40, s35, 18432
  v_mfma_f32_16x16x32_bf16 a[36:39], a[248:251], v[196:199], a[36:39]
  buffer_load_dwordx4 v4, s[12:15], s40 offen nt lds
  v_mfma_f32_16x16x32_bf16 a[36:39], a[252:255], v[220:223], a[36:39]
  buffer_load_dwordx4 v5, s[12:15], s40 offen offset:1024 nt lds
  v_mfma_f32_16x16x32_bf16 a[40:43], a[248:251], v[200:203], a[40:43]
  buffer_load_dwordx4 v6, s[12:15], s40 offen offset:2048 nt lds
  v_mfma_f32_16x16x32_bf16 a[40:43], a[252:255], v[224:227], a[40:43]
  v_mfma_f32_16x16x32_bf16 a[44:47], a[248:251], v[204:207], a[44:47]
  v_mfma_f32_16x16x32_bf16 a[44:47], a[252:255], v[228:231], a[44:47]
  s_waitcnt lgkmcnt(0)
  v_mfma_f32_16x16x32_bf16 a[96:99], a[240:243], v[232:235], a[96:99]
  ds_read_b64_tr_b16 a[248:249], v0 offset:45056
  v_mfma_f32_16x16x32_bf16 a[96:99], a[244:247], v[16:19], a[96:99]
  ds_read_b64_tr_b16 a[250:251], v0 offset:47104
  v_mfma_f32_16x16x32_bf16 a[100:103], a[240:243], v[236:239], a[100:103]
  v_xor_b32 v0, 32, v0
  v_mfma_f32_16x16x32_bf16 a[100:103], a[244:247], v[20:23], a[100:103]
  ds_read_b64_tr_b16 a[252:253], v0 offset:36864
  v_mfma_f32_16x16x32_bf16 a[104:107], a[240:243], v[240:243], a[104:107]
  ds_read_b64_tr_b16 a[254:255], v0 offset:38912
  v_mfma_f32_16x16x32_bf16 a[104:107], a[244:247], v[24:27], a[104:107]
  v_mfma_f32_16x16x32_bf16 a[108:111], a[240:243], v[244:247], a[108:111]
  v_mfma_f32_16x16x32_bf16 a[108:111], a[244:247], v[28:31], a[108:111]
  v_mfma_f32_16x16x32_bf16 a[112:115], a[240:243], v[248:251], a[112:115]
  s_add_u32 s46, s34, 24576
  buffer_store_dwordx4 v[56:59], v9, s[24:27], s46 offen sc1
  v_mfma_f32_16x16x32_bf16 a[112:115], a[244:247], v[32:35], a[112:115]
  v_mfma_f32_16x16x32_bf16 a[116:119], a[240:243], v[252:255], a[116:119]
  v_mfma_f32_16x16x32_bf16 a[116:119], a[244:247], v[36:39], a[116:119]
  s_waitcnt lgkmcnt(0)
  v_mfma_f32_16x16x32_bf16 a[96:99], a[248:251], v[64:67], a[96:99]
  ds_read_b64_tr_b16 a[240:241], v0 offset:40960
  v_mfma_f32_16x16x32_bf16 a[120:123], a[252:255], v[232:235], a[120:123]
  ds_read_b64_tr_b16 a[242:243], v0 offset:43008
  v_mfma_f32_16x16x32_bf16 a[100:103], a[248:251], v[68:71], a[100:103]
  ds_read_b64_tr_b16 a[244:245], v0 offset:45056
  v_mfma_f32_16x16x32_bf16 a[124:127], a[252:255], v[236:239], a[124:127]
  ds_read_b64_tr_b16 a[246:247], v0 offset:47104
  v_mfma_f32_16x16x32_bf16 a[104:107], a[248:251], v[72:75], a[104:107]
  v_xor_b32 v0, 96, v0
  v_mfma_f32_16x16x32_bf16 a[128:131], a[252:255], v[240:243], a[128:131]
  v_mfma_f32_16x16x32_bf16 a[108:111], a[248:251], v[76:79], a[108:111]
  v_mfma_f32_16x16x32_bf16 a[132:135], a[252:255], v[244:247], a[132:135]
  v_mfma_f32_16x16x32_bf16 a[112:115], a[248:251], v[80:83], a[112:115]
  v_mfma_f32_16x16x32_bf16 a[136:139], a[252:255], v[248:251], a[136:139]
  v_mfma_f32_16x16x32_bf16 a[116:119], a[248:251], v[84:87], a[116:119]
  v_mfma_f32_16x16x32_bf16 a[140:143], a[252:255], v[252:255], a[140:143]
  s_waitcnt lgkmcnt(0)
  v_mfma_f32_16x16x32_bf16 a[120:123], a[240:243], v[16:19], a[120:123]
  ds_read_b64_tr_b16 a[248:249], v0 offset:36864
  v_mfma_f32_16x16x32_bf16 a[120:123], a[244:247], v[64:67], a[120:123]
  ds_read_b64_tr_b16 a[250:251], v0 offset:38912
  v_mfma_f32_16x16x32_bf16 a[124:127], a[240:243], v[20:23], a[124:127]
  ds_read_b64_tr_b16 a[252:253], v0 offset:40960
  buffer_store_dwordx4 v[60:63], v9, s[24:27], s46 offen offset:3072 sc1
  v_mfma_f32_16x16x32_bf16 a[124:127], a[244:247], v[68:71], a[124:127]
  ds_read_b64_tr_b16 a[254:255], v0 offset:43008
  v_mfma_f32_16x16x32_bf16 a[128:131], a[240:243], v[24:27], a[128:131]
  v_mfma_f32_16x16x32_bf16 a[128:131], a[244:247], v[72:75], a[128:131]
  v_mfma_f32_16x16x32_bf16 a[132:135], a[240:243], v[28:31], a[132:135]
  v_mfma_f32_16x16x32_bf16 a[132:135], a[244:247], v[76:79], a[132:135]
  v_mfma_f32_16x16x32_bf16 a[136:139], a[240:243], v[32:35], a[136:139]
  v_mfma_f32_16x16x32_bf16 a[136:139], a[244:247], v[80:83], a[136:139]
  v_mfma_f32_16x16x32_bf16 a[140:143], a[240:243], v[36:39], a[140:143]
  v_mfma_f32_16x16x32_bf16 a[140:143], a[244:247], v[84:87], a[140:143]
  s_waitcnt lgkmcnt(0)
  v_mfma_f32_16x16x32_bf16 a[0:3], a[248:251], v[232:235], a[0:3]
  ds_read_b64_tr_b16 a[240:241], v0 offset:45056
  v_mfma_f32_16x16x32_bf16 a[0:3], a[252:255], v[16:19], a[0:3]
  ds_read_b64_tr_b16 a[242:243], v0 offset:47104
  v_mfma_f32_16x16x32_bf16 a[4:7], a[248:251], v[236:239], a[4:7]
  v_xor_b32 v0, 32, v0
  v_mfma_f32_16x16x32_bf16 a[4:7], a[252:255], v[20:23], a[4:7]
  ds_read_b64_tr_b16 a[244:245], v0 offset:36864
  v_mfma_f32_16x16x32_bf16 a[8:11], a[248:251], v[240:243], a[8:11]
  ds_read_b64_tr_b16 a[246:247], v0 offset:38912
  v_accvgpr_read_b32 v40, a96
  v_mfma_f32_16x16x32_bf16 a[8:11], a[252:255], v[24:27], a[8:11]
  v_accvgpr_read_b32 v41, a97
  v_accvgpr_read_b32 v42, a98
  v_accvgpr_read_b32 v43, a99
  v_mfma_f32_16x16x32_bf16 a[12:15], a[248:251], v[244:247], a[12:15]
  v_mul_f32 v40, v10, v40
  v_mul_f32 v41, v10, v41
  v_mfma_f32_16x16x32_bf16 a[12:15], a[252:255], v[28:31], a[12:15]
  v_mul_f32 v42, v10, v42
  v_mul_f32 v43, v10, v43
  v_mfma_f32_16x16x32_bf16 a[16:19], a[248:251], v[248:251], a[16:19]
  s_add_u32 s46, s34, 30720
  buffer_store_dwordx4 v[104:107], v9, s[24:27], s46 offen sc1
  v_mfma_f32_16x16x32_bf16 a[16:19], a[252:255], v[32:35], a[16:19]
  v_cvt_pk_bf16_f32 v40, v40, v41
  v_cvt_pk_bf16_f32 v41, v42, v43
  v_mfma_f32_16x16x32_bf16 a[20:23], a[248:251], v[252:255], a[20:23]
  v_accvgpr_read_b32 v42, a100
  v_accvgpr_read_b32 v43, a101
  v_accvgpr_read_b32 v44, a102
  v_mfma_f32_16x16x32_bf16 a[20:23], a[252:255], v[36:39], a[20:23]
  s_waitcnt lgkmcnt(0)
  v_accvgpr_read_b32 v45, a103
  v_mul_f32 v42, v11, v42
  v_mfma_f32_16x16x32_bf16 a[0:3], a[240:243], v[64:67], a[0:3]
  ds_read_b64_tr_b16 a[248:249], v0 offset:40960
  v_mul_f32 v43, v11, v43
  v_mfma_f32_16x16x32_bf16 a[24:27], a[244:247], v[232:235], a[24:27]
  ds_read_b64_tr_b16 a[250:251], v0 offset:43008
  v_mul_f32 v44, v11, v44
  v_mul_f32 v45, v11, v45
  v_mfma_f32_16x16x32_bf16 a[4:7], a[240:243], v[68:71], a[4:7]
  ds_read_b64_tr_b16 a[252:253], v0 offset:45056
  v_cvt_pk_bf16_f32 v42, v42, v43
  v_mfma_f32_16x16x32_bf16 a[28:31], a[244:247], v[236:239], a[28:31]
  ds_read_b64_tr_b16 a[254:255], v0 offset:47104
  v_cvt_pk_bf16_f32 v43, v44, v45
  v_mfma_f32_16x16x32_bf16 a[8:11], a[240:243], v[72:75], a[8:11]
  v_xor_b32 v0, 96, v0
  v_accvgpr_read_b32 v44, a120
  v_accvgpr_read_b32 v45, a121
  v_mfma_f32_16x16x32_bf16 a[32:35], a[244:247], v[240:243], a[32:35]
  v_accvgpr_read_b32 v46, a122
  v_accvgpr_read_b32 v47, a123
  v_mfma_f32_16x16x32_bf16 a[12:15], a[240:243], v[76:79], a[12:15]
  v_mul_f32 v44, v10, v44
  v_mul_f32 v45, v10, v45
  v_mfma_f32_16x16x32_bf16 a[36:39], a[244:247], v[244:247], a[36:39]
  v_mul_f32 v46, v10, v46
  v_mul_f32 v47, v10, v47
  v_cvt_pk_bf16_f32 v44, v44, v45
  v_mfma_f32_16x16x32_bf16 a[16:19], a[240:243], v[80:83], a[16:19]
  v_cvt_pk_bf16_f32 v45, v46, v47
  v_accvgpr_read_b32 v46, a124
  v_mfma_f32_16x16x32_bf16 a[40:43], a[244:247], v[248:251], a[40:43]
  v_accvgpr_read_b32 v47, a125
  v_accvgpr_read_b32 v3, a127
  v_mfma_f32_16x16x32_bf16 a[20:23], a[240:243], v[84:87], a[20:23]
  v_add_u32 v0, 49152, v0
  v_mul_f32 v46, v11, v46
  v_mfma_f32_16x16x32_bf16 a[44:47], a[244:247], v[252:255], a[44:47]
  s_waitcnt lgkmcnt(0)
  s_barrier
  ds_read_b64_tr_b16 a[240:241], v0 offset:0
  v_mfma_f32_16x16x32_bf16 a[24:27], a[248:251], v[16:19], a[24:27]
  ds_read_b64_tr_b16 a[242:243], v0 offset:2048
  v_mul_f32 v47, v11, v47
  v_mul_f32 v3, v11, v3
  v_mfma_f32_16x16x32_bf16 a[24:27], a[252:255], v[64:67], a[24:27]
  ds_read_b64_tr_b16 a[244:245], v0 offset:4096
  v_cvt_pk_bf16_f32 v46, v46, v47
  v_mfma_f32_16x16x32_bf16 a[28:31], a[248:251], v[20:23], a[28:31]
  ds_read_b64_tr_b16 a[246:247], v0 offset:6144
  buffer_store_dwordx4 v[108:111], v9, s[24:27], s46 offen offset:3072 sc1
  v_mfma_f32_16x16x32_bf16 a[28:31], a[252:255], v[68:71], a[28:31]
  v_accvgpr_read_b32 v47, a126
  v_mul_f32 v47, v11, v47
  v_mfma_f32_16x16x32_bf16 a[32:35], a[248:251], v[24:27], a[32:35]
  s_add_u32 m0, s32, 86016
  v_cvt_pk_bf16_f32 v47, v47, v3
  v_accvgpr_read_b32 v48, a104
  v_mfma_f32_16x16x32_bf16 a[32:35], a[252:255], v[72:75], a[32:35]
  s_add_u32 s40, s35, 21504
  v_accvgpr_read_b32 v49, a105
  v_accvgpr_read_b32 v50, a106
  v_mfma_f32_16x16x32_bf16 a[36:39], a[248:251], v[28:31], a[36:39]
  buffer_load_dwordx4 v4, s[12:15], s40 offen nt lds
  v_mfma_f32_16x16x32_bf16 a[36:39], a[252:255], v[76:79], a[36:39]
  buffer_load_dwordx4 v5, s[12:15], s40 offen offset:1024 nt lds
  v_accvgpr_read_b32 v51, a107
  v_mfma_f32_16x16x32_bf16 a[40:43], a[248:251], v[32:35], a[40:43]
  buffer_load_dwordx4 v6, s[12:15], s40 offen offset:2048 nt lds
  v_mfma_f32_16x16x32_bf16 a[40:43], a[252:255], v[80:83], a[40:43]
  v_mul_f32 v48, v12, v48
  v_mul_f32 v49, v12, v49
  v_mfma_f32_16x16x32_bf16 a[44:47], a[248:251], v[36:39], a[44:47]
  v_mul_f32 v50, v12, v50
  v_mul_f32 v51, v12, v51
  v_cvt_pk_bf16_f32 v48, v48, v49
  v_mfma_f32_16x16x32_bf16 a[44:47], a[252:255], v[84:87], a[44:47]
  s_waitcnt lgkmcnt(0)
  v_cvt_pk_bf16_f32 v49, v50, v51
  v_accvgpr_read_b32 v50, a108
  v_mfma_f32_16x16x32_bf16 a[48:51], a[240:243], a[144:147], 0
  ds_read_b64_tr_b16 a[248:249], v0 offset:8192
  v_accvgpr_read_b32 v51, a109
  v_mfma_f32_16x16x32_bf16 a[48:51], a[244:247], a[168:171], a[48:51]
  ds_read_b64_tr_b16 a[250:251], v0 offset:10240
  v_accvgpr_read_b32 v52, a110
  v_accvgpr_read_b32 v53, a111
  v_mfma_f32_16x16x32_bf16 a[52:55], a[240:243], a[148:151], 0
  v_xor_b32 v0, 32, v0
  v_mul_f32 v50, v13, v50
  v_mfma_f32_16x16x32_bf16 a[52:55], a[244:247], a[172:175], a[52:55]
  ds_read_b64_tr_b16 a[252:253], v0 offset:0
  v_mul_f32 v51, v13, v51
  v_mfma_f32_16x16x32_bf16 a[56:59], a[240:243], a[152:155], 0
  ds_read_b64_tr_b16 a[254:255], v0 offset:2048
  v_mul_f32 v52, v13, v52
  v_mul_f32 v53, v13, v53
  v_mfma_f32_16x16x32_bf16 a[56:59], a[244:247], a[176:179], a[56:59]
  v_cvt_pk_bf16_f32 v50, v50, v51
  v_cvt_pk_bf16_f32 v51, v52, v53
  v_mfma_f32_16x16x32_bf16 a[60:63], a[240:243], a[156:159], 0
  v_accvgpr_read_b32 v52, a128
  v_accvgpr_read_b32 v53, a129
  v_mfma_f32_16x16x32_bf16 a[60:63], a[244:247], a[180:183], a[60:63]
  v_accvgpr_read_b32 v54, a130
  v_accvgpr_read_b32 v55, a131
  v_mul_f32 v52, v12, v52
  v_mfma_f32_16x16x32_bf16 a[64:67], a[240:243], a[160:163], 0
  v_mul_f32 v53, v12, v53
  v_mul_f32 v54, v12, v54
  v_mfma_f32_16x16x32_bf16 a[64:67], a[244:247], a[184:187], a[64:67]
  v_mul_f32 v55, v12, v55
  v_cvt_pk_bf16_f32 v52, v52, v53
  v_mfma_f32_16x16x32_bf16 a[68:71], a[240:243], a[164:167], 0
  v_cvt_pk_bf16_f32 v53, v54, v55
  v_accvgpr_read_b32 v54, a132
  v_mfma_f32_16x16x32_bf16 a[68:71], a[244:247], a[188:191], a[68:71]
  s_waitcnt lgkmcnt(0)
  v_accvgpr_read_b32 v55, a133
  v_accvgpr_read_b32 v3, a135
  v_mul_f32 v54, v13, v54
  v_mfma_f32_16x16x32_bf16 a[48:51], a[248:251], a[192:195], a[48:51]
  ds_read_b64_tr_b16 a[240:241], v0 offset:4096
  v_mul_f32 v55, v13, v55
  v_mfma_f32_16x16x32_bf16 a[72:75], a[252:255], a[144:147], 0
  ds_read_b64_tr_b16 a[242:243], v0 offset:6144
  v_mul_f32 v3, v13, v3
  v_mfma_f32_16x16x32_bf16 a[52:55], a[248:251], a[196:199], a[52:55]
  ds_read_b64_tr_b16 a[244:245], v0 offset:8192
  v_cvt_pk_bf16_f32 v54, v54, v55
  v_accvgpr_read_b32 v55, a134
  v_mfma_f32_16x16x32_bf16 a[76:79], a[252:255], a[148:151], 0
  ds_read_b64_tr_b16 a[246:247], v0 offset:10240
  v_mul_f32 v55, v13, v55
  v_mfma_f32_16x16x32_bf16 a[56:59], a[248:251], a[200:203], a[56:59]
  v_xor_b32 v0, 96, v0
  v_cvt_pk_bf16_f32 v55, v55, v3
  v_mfma_f32_16x16x32_bf16 a[80:83], a[252:255], a[152:155], 0
  v_accvgpr_read_b32 v56, a112
  v_accvgpr_read_b32 v57, a113
  v_accvgpr_read_b32 v58, a114
  v_mfma_f32_16x16x32_bf16 a[60:63], a[248:251], a[204:207], a[60:63]
  v_accvgpr_read_b32 v59, a115
  v_mul_f32 v56, v14, v56
  v_mfma_f32_16x16x32_bf16 a[84:87], a[252:255], a[156:159], 0
  v_mul_f32 v57, v14, v57
  v_mul_f32 v58, v14, v58
  v_mfma_f32_16x16x32_bf16 a[64:67], a[248:251], a[208:211], a[64:67]
  v_mul_f32 v59, v14, v59
  v_cvt_pk_bf16_f32 v56, v56, v57
  v_mfma_f32_16x16x32_bf16 a[88:91], a[252:255], a[160:163], 0
  v_cvt_pk_bf16_f32 v57, v58, v59
  v_accvgpr_read_b32 v58, a116
  v_accvgpr_read_b32 v59, a117
  v_mfma_f32_16x16x32_bf16 a[68:71], a[248:251], a[212:215], a[68:71]
  v_accvgpr_read_b32 v60, a118
  v_accvgpr_read_b32 v61, a119
  v_mfma_f32_16x16x32_bf16 a[92:95], a[252:255], a[164:167], 0
  s_waitcnt lgkmcnt(0)
  v_mul_f32 v58, v15, v58
  v_mul_f32 v59, v15, v59
  v_mfma_f32_16x16x32_bf16 a[72:75], a[240:243], a[168:171], a[72:75]
  ds_read_b64_tr_b16 a[248:249], v0 offset:0
  v_mul_f32 v60, v15, v60
  v_mul_f32 v61, v15, v61
  v_mfma_f32_16x16x32_bf16 a[72:75], a[244:247], a[192:195], a[72:75]
  ds_read_b64_tr_b16 a[250:251], v0 offset:2048
  v_cvt_pk_bf16_f32 v58, v58, v59
  v_mfma_f32_16x16x32_bf16 a[76:79], a[240:243], a[172:175], a[76:79]
  ds_read_b64_tr_b16 a[252:253], v0 offset:4096
  v_cvt_pk_bf16_f32 v59, v60, v61
  v_mfma_f32_16x16x32_bf16 a[76:79], a[244:247], a[196:199], a[76:79]
  ds_read_b64_tr_b16 a[254:255], v0 offset:6144
  v_accvgpr_read_b32 v60, a136
  v_accvgpr_read_b32 v61, a137
  v_mfma_f32_16x16x32_bf16 a[80:83], a[240:243], a[176:179], a[80:83]
  v_accvgpr_read_b32 v62, a138
  v_accvgpr_read_b32 v63, a139
  v_mfma_f32_16x16x32_bf16 a[80:83], a[244:247], a[200:203], a[80:83]
  v_mul_f32 v60, v14, v60
  v_mul_f32 v61, v14, v61
  v_mfma_f32_16x16x32_bf16 a[84:87], a[240:243], a[180:183], a[84:87]
  v_mul_f32 v62, v14, v62
  v_mul_f32 v63, v14, v63
  v_cvt_pk_bf16_f32 v60, v60, v61
  v_mfma_f32_16x16x32_bf16 a[84:87], a[244:247], a[204:207], a[84:87]
  v_cvt_pk_bf16_f32 v61, v62, v63
  v_accvgpr_read_b32 v62, a140
  v_mfma_f32_16x16x32_bf16 a[88:91], a[240:243], a[184:187], a[88:91]
  v_accvgpr_read_b32 v63, a141
  v_accvgpr_read_b32 v3, a143
  v_mfma_f32_16x16x32_bf16 a[88:91], a[244:247], a[208:211], a[88:91]
  v_mul_f32 v62, v15, v62
  v_mul_f32 v63, v15, v63
  v_mfma_f32_16x16x32_bf16 a[92:95], a[240:243], a[188:191], a[92:95]
  v_mul_f32 v3, v15, v3
  v_cvt_pk_bf16_f32 v62, v62, v63
  v_accvgpr_read_b32 v63, a142
  v_mfma_f32_16x16x32_bf16 a[92:95], a[244:247], a[212:215], a[92:95]
  s_waitcnt lgkmcnt(0)
  v_mul_f32 v63, v15, v63
  v_cvt_pk_bf16_f32 v63, v63, v3
  v_mfma_f32_16x16x32_bf16 a[96:99], a[248:251], a[144:147], 0
  ds_read_b64_tr_b16 a[240:241], v0 offset:8192
  v_accvgpr_read_b32 v88, a0
  v_mfma_f32_16x16x32_bf16 a[96:99], a[252:255], a[168:171], a[96:99]
  ds_read_b64_tr_b16 a[242:243], v0 offset:10240
  v_accvgpr_read_b32 v89, a1
  v_mfma_f32_16x16x32_bf16 a[100:103], a[248:251], a[148:151], 0
  v_xor_b32 v0, 32, v0
  v_accvgpr_read_b32 v90, a2
  v_mfma_f32_16x16x32_bf16 a[100:103], a[252:255], a[172:175], a[100:103]
  ds_read_b64_tr_b16 a[244:245], v0 offset:0
  v_accvgpr_read_b32 v91, a3
  v_mul_f32 v88, v10, v88
  v_mfma_f32_16x16x32_bf16 a[104:107], a[248:251], a[152:155], 0
  ds_read_b64_tr_b16 a[246:247], v0 offset:2048
  v_mul_f32 v89, v10, v89
  v_mfma_f32_16x16x32_bf16 a[104:107], a[252:255], a[176:179], a[104:107]
  v_mul_f32 v90, v10, v90
  v_mul_f32 v91, v10, v91
  v_mfma_f32_16x16x32_bf16 a[108:111], a[248:251], a[156:159], 0
  v_cvt_pk_bf16_f32 v88, v88, v89
  v_cvt_pk_bf16_f32 v89, v90, v91
  v_mfma_f32_16x16x32_bf16 a[108:111], a[252:255], a[180:183], a[108:111]
  v_accvgpr_read_b32 v90, a4
  v_accvgpr_read_b32 v91, a5
  v_mfma_f32_16x16x32_bf16 a[112:115], a[248:251], a[160:163], 0
  v_accvgpr_read_b32 v92, a6
  v_accvgpr_read_b32 v93, a7
  v_mfma_f32_16x16x32_bf16 a[112:115], a[252:255], a[184:187], a[112:115]
  v_mul_f32 v90, v11, v90
  v_mul_f32 v91, v11, v91
  v_mfma_f32_16x16x32_bf16 a[116:119], a[248:251], a[164:167], 0
  v_mul_f32 v92, v11, v92
  v_mul_f32 v93, v11, v93
  v_mfma_f32_16x16x32_bf16 a[116:119], a[252:255], a[188:191], a[116:119]
  s_waitcnt lgkmcnt(0)
  v_cvt_pk_bf16_f32 v90, v90, v91
  v_cvt_pk_bf16_f32 v91, v92, v93
  v_mfma_f32_16x16x32_bf16 a[96:99], a[240:243], a[192:195], a[96:99]
  ds_read_b64_tr_b16 a[248:249], v0 offset:4096
  v_accvgpr_read_b32 v92, a24
  v_accvgpr_read_b32 v93, a25
  v_mfma_f32_16x16x32_bf16 a[120:123], a[244:247], a[144:147], 0
  ds_read_b64_tr_b16 a[250:251], v0 offset:6144
  v_accvgpr_read_b32 v94, a26
  v_mfma_f32_16x16x32_bf16 a[100:103], a[240:243], a[196:199], a[100:103]
  ds_read_b64_tr_b16 a[252:253], v0 offset:8192
  v_accvgpr_read_b32 v95, a27
  v_mfma_f32_16x16x32_bf16 a[124:127], a[244:247], a[148:151], 0
  ds_read_b64_tr_b16 a[254:255], v0 offset:10240
  v_mul_f32 v92, v10, v92
  v_mfma_f32_16x16x32_bf16 a[104:107], a[240:243], a[200:203], a[104:107]
  v_xor_b32 v0, 96, v0
  v_mul_f32 v93, v10, v93
  v_mfma_f32_16x16x32_bf16 a[128:131], a[244:247], a[152:155], 0
  v_mul_f32 v94, v10, v94
  v_mul_f32 v95, v10, v95
  v_mfma_f32_16x16x32_bf16 a[108:111], a[240:243], a[204:207], a[108:111]
  v_cvt_pk_bf16_f32 v92, v92, v93
  v_cvt_pk_bf16_f32 v93, v94, v95
  v_mfma_f32_16x16x32_bf16 a[132:135], a[244:247], a[156:159], 0
  v_accvgpr_read_b32 v94, a28
  v_accvgpr_read_b32 v95, a29
  v_accvgpr_read_b32 v3, a31
  v_mfma_f32_16x16x32_bf16 a[112:115], a[240:243], a[208:211], a[112:115]
  v_mul_f32 v94, v11, v94
  v_mul_f32 v95, v11, v95
  v_mfma_f32_16x16x32_bf16 a[136:139], a[244:247], a[160:163], 0
  v_mul_f32 v3, v11, v3
  v_cvt_pk_bf16_f32 v94, v94, v95
  v_mfma_f32_16x16x32_bf16 a[116:119], a[240:243], a[212:215], a[116:119]
  v_accvgpr_read_b32 v95, a30
  v_mul_f32 v95, v11, v95
  v_mfma_f32_16x16x32_bf16 a[140:143], a[244:247], a[164:167], 0
  s_waitcnt lgkmcnt(0)
  s_barrier
  ds_read_b64_tr_b16 a[240:241], v0 offset:12288
  v_mfma_f32_16x16x32_bf16 a[120:123], a[248:251], a[168:171], a[120:123]
  ds_read_b64_tr_b16 a[242:243], v0 offset:14336
  v_cvt_pk_bf16_f32 v95, v95, v3
  v_mfma_f32_16x16x32_bf16 a[120:123], a[252:255], a[192:195], a[120:123]
  ds_read_b64_tr_b16 a[244:245], v0 offset:16384
  ds_write_b64 v7, v[40:41] offset:0
  v_mfma_f32_16x16x32_bf16 a[124:127], a[248:251], a[172:175], a[124:127]
  ds_read_b64_tr_b16 a[246:247], v0 offset:18432
  ds_write_b64 v7, v[42:43] offset:2048
  v_mfma_f32_16x16x32_bf16 a[124:127], a[252:255], a[196:199], a[124:127]
  v_xor_b32 v7, 32, v7
  v_mfma_f32_16x16x32_bf16 a[128:131], a[248:251], a[176:179], a[128:131]
  s_add_u32 m0, s32, 98304
  ds_write_b64 v7, v[44:45] offset:0
  ds_write_b64 v7, v[46:47] offset:2048
  v_mfma_f32_16x16x32_bf16 a[128:131], a[252:255], a[200:203], a[128:131]
  s_add_u32 s40, s37, 0
  v_xor_b32 v7, 96, v7
  v_mfma_f32_16x16x32_bf16 a[132:135], a[248:251], a[180:183], a[132:135]
  buffer_load_dwordx4 v4, s[16:19], s40 offen nt lds
  v_mfma_f32_16x16x32_bf16 a[132:135], a[252:255], a[204:207], a[132:135]
  buffer_load_dwordx4 v5, s[16:19], s40 offen offset:1024 nt lds
  v_mfma_f32_16x16x32_bf16 a[136:139], a[248:251], a[184:187], a[136:139]
  buffer_load_dwordx4 v6, s[16:19], s40 offen offset:2048 nt lds
  v_mfma_f32_16x16x32_bf16 a[136:139], a[252:255], a[208:211], a[136:139]
  ds_write_b64 v7, v[88:89] offset:0
  ds_write_b64 v7, v[90:91] offset:2048
  v_mfma_f32_16x16x32_bf16 a[140:143], a[248:251], a[188:191], a[140:143]
  v_xor_b32 v7, 32, v7
  v_mfma_f32_16x16x32_bf16 a[140:143], a[252:255], a[212:215], a[140:143]
  s_waitcnt lgkmcnt(5)
  ds_write_b64 v7, v[92:93] offset:0
  ds_write_b64 v7, v[94:95] offset:2048
  v_mfma_f32_16x16x32_bf16 a[48:51], a[240:243], a[216:219], a[48:51]
  ds_read_b64_tr_b16 a[248:249], v0 offset:20480
  v_xor_b32 v7, 96, v7
  s_waitcnt vmcnt(27)
  v_mfma_f32_16x16x32_bf16 a[48:51], a[244:247], v[112:115], a[48:51]
  ds_read_b64_tr_b16 a[250:251], v0 offset:22528
  ds_read_b128 v[40:43], v8 offset:0
  ds_read_b128 v[44:47], v8 offset:1024
  v_mfma_f32_16x16x32_bf16 a[52:55], a[240:243], a[220:223], a[52:55]
  v_xor_b32 v0, 32, v0
  v_mfma_f32_16x16x32_bf16 a[52:55], a[244:247], v[116:119], a[52:55]
  ds_read_b64_tr_b16 a[252:253], v0 offset:12288
  ds_read_b128 v[88:91], v8 offset:2048
  ds_read_b128 v[92:95], v8 offset:3072
  ds_read_b128 a[144:147], v1 offset:0
  ds_read_b128 a[168:171], v1 offset:24576
  ds_read_b128 a[152:155], v1 offset:128
  v_mfma_f32_16x16x32_bf16 a[56:59], a[240:243], a[224:227], a[56:59]
  ds_read_b64_tr_b16 a[254:255], v0 offset:14336
  v_accvgpr_read_b32 v96, a8
  v_mfma_f32_16x16x32_bf16 a[56:59], a[244:247], v[120:123], a[56:59]
  v_accvgpr_read_b32 v97, a9
  v_accvgpr_read_b32 v98, a10
  v_mfma_f32_16x16x32_bf16 a[60:63], a[240:243], a[228:231], a[60:63]
  v_accvgpr_read_b32 v99, a11
  v_mul_f32 v96, v12, v96
  v_mul_f32 v97, v12, v97
  v_mfma_f32_16x16x32_bf16 a[60:63], a[244:247], v[124:127], a[60:63]
  v_mul_f32 v98, v12, v98
  v_mul_f32 v99, v12, v99
  v_mfma_f32_16x16x32_bf16 a[64:67], a[240:243], a[232:235], a[64:67]
  s_add_u32 s47, s34, 128
  s_waitcnt lgkmcnt(8)
  buffer_store_dwordx4 v[40:43], v9, s[24:27], s47 offen sc1
  ds_read_b128 a[176:179], v1 offset:24704
  ds_read_b128 a[160:163], v1 offset:256
  ds_read_b128 a[184:187], v1 offset:24832
  v_mfma_f32_16x16x32_bf16 a[64:67], a[244:247], v[128:131], a[64:67]
  v_cvt_pk_bf16_f32 v96, v96, v97
  v_cvt_pk_bf16_f32 v97, v98, v99
  v_xor_b32 v1, 64, v1
  v_mfma_f32_16x16x32_bf16 a[68:71], a[240:243], a[236:239], a[68:71]
  v_accvgpr_read_b32 v98, a12
  v_accvgpr_read_b32 v99, a13
  v_mfma_f32_16x16x32_bf16 a[68:71], a[244:247], v[132:135], a[68:71]
  v_accvgpr_read_b32 v100, a14
  v_accvgpr_read_b32 v101, a15
  v_mfma_f32_16x16x32_bf16 a[48:51], a[248:251], v[136:139], a[48:51]
  s_waitcnt lgkmcnt(3)
  ds_read_b64_tr_b16 a[240:241], v0 offset:16384
  v_mul_f32 v98, v13, v98
  v_mul_f32 v99, v13, v99
  v_mfma_f32_16x16x32_bf16 a[72:75], a[252:255], a[216:219], a[72:75]
  ds_read_b64_tr_b16 a[242:243], v0 offset:18432
  v_mul_f32 v100, v13, v100
  v_mfma_f32_16x16x32_bf16 a[52:55], a[248:251], v[140:143], a[52:55]
  ds_read_b64_tr_b16 a[244:245], v0 offset:20480
  v_mul_f32 v101, v13, v101
  v_mfma_f32_16x16x32_bf16 a[76:79], a[252:255], a[220:223], a[76:79]
  ds_read_b64_tr_b16 a[246:247], v0 offset:22528
  v_cvt_pk_bf16_f32 v98, v98, v99
  v_mfma_f32_16x16x32_bf16 a[56:59], a[248:251], v[144:147], a[56:59]
  v_xor_b32 v0, 96, v0
  v_cvt_pk_bf16_f32 v99, v100, v101
  v_mfma_f32_16x16x32_bf16 a[80:83], a[252:255], a[224:227], a[80:83]
  v_accvgpr_read_b32 v100, a32
  v_accvgpr_read_b32 v101, a33
  v_accvgpr_read_b32 v102, a34
  ds_read_b128 a[148:151], v1 offset:0
  ds_read_b128 a[172:175], v1 offset:24576
  ds_read_b128 a[156:159], v1 offset:128
  ds_read_b128 a[180:183], v1 offset:24704
  ds_read_b128 a[164:167], v1 offset:256
  ds_read_b128 a[188:191], v1 offset:24832
  v_xor_b32 v1, 64, v1
  v_mfma_f32_16x16x32_bf16 a[60:63], a[248:251], v[148:151], a[60:63]
  v_accvgpr_read_b32 v103, a35
  v_mul_f32 v100, v12, v100
  v_mfma_f32_16x16x32_bf16 a[84:87], a[252:255], a[228:231], a[84:87]
  v_mul_f32 v101, v12, v101
  v_mul_f32 v102, v12, v102
  v_mfma_f32_16x16x32_bf16 a[64:67], a[248:251], v[152:155], a[64:67]
  v_mul_f32 v103, v12, v103
  v_cvt_pk_bf16_f32 v100, v100, v101
  v_mfma_f32_16x16x32_bf16 a[88:91], a[252:255], a[232:235], a[88:91]
  v_cvt_pk_bf16_f32 v101, v102, v103
  v_accvgpr_read_b32 v102, a36
  v_mfma_f32_16x16x32_bf16 a[68:71], a[248:251], v[156:159], a[68:71]
  s_waitcnt lgkmcnt(0)
  v_accvgpr_read_b32 v103, a37
  v_accvgpr_read_b32 v3, a39
  v_mfma_f32_16x16x32_bf16 a[92:95], a[252:255], a[236:239], a[92:95]
  s_add_u32 m0, s32, 0
  v_mul_f32 v102, v13, v102
  v_mfma_f32_16x16x32_bf16 a[72:75], a[240:243], v[112:115], a[72:75]
  ds_read_b64_tr_b16 a[248:249], v0 offset:12288
  s_add_u32 s40, s35, 24576
  v_mul_f32 v103, v13, v103
  v_mfma_f32_16x16x32_bf16 a[72:75], a[244:247], v[136:139], a[72:75]
  ds_read_b64_tr_b16 a[250:251], v0 offset:14336
  buffer_load_dwordx4 v4, s[12:15], s40 offen nt lds
  v_mfma_f32_16x16x32_bf16 a[76:79], a[240:243], v[116:119], a[76:79]
  ds_read_b64_tr_b16 a[252:253], v0 offset:16384
  buffer_load_dwordx4 v5, s[12:15], s40 offen offset:1024 nt lds
  buffer_store_dwordx4 v[44:47], v9, s[24:27], s47 offen offset:3072 sc1
  v_mfma_f32_16x16x32_bf16 a[76:79], a[244:247], v[140:143], a[76:79]
  ds_read_b64_tr_b16 a[254:255], v0 offset:18432
  buffer_load_dwordx4 v6, s[12:15], s40 offen offset:2048 nt lds
  v_mfma_f32_16x16x32_bf16 a[80:83], a[240:243], v[120:123], a[80:83]
  v_mul_f32 v3, v13, v3
  v_cvt_pk_bf16_f32 v102, v102, v103
  v_mfma_f32_16x16x32_bf16 a[80:83], a[244:247], v[144:147], a[80:83]
  v_accvgpr_read_b32 v103, a38
  v_mul_f32 v103, v13, v103
  v_mfma_f32_16x16x32_bf16 a[84:87], a[240:243], v[124:127], a[84:87]
  v_cvt_pk_bf16_f32 v103, v103, v3
  v_mfma_f32_16x16x32_bf16 a[84:87], a[244:247], v[148:151], a[84:87]
  ds_write_b64 v7, v[48:49] offset:0
  ds_write_b64 v7, v[50:51] offset:2048
  v_xor_b32 v7, 32, v7
  v_mfma_f32_16x16x32_bf16 a[88:91], a[240:243], v[128:131], a[88:91]
  ds_write_b64 v7, v[52:53] offset:0
  ds_write_b64 v7, v[54:55] offset:2048
  v_mfma_f32_16x16x32_bf16 a[88:91], a[244:247], v[152:155], a[88:91]
  v_xor_b32 v7, 96, v7
  v_mfma_f32_16x16x32_bf16 a[92:95], a[240:243], v[132:135], a[92:95]
  ds_write_b64 v7, v[96:97] offset:0
  ds_write_b64 v7, v[98:99] offset:2048
  v_mfma_f32_16x16x32_bf16 a[92:95], a[244:247], v[156:159], a[92:95]
  s_waitcnt lgkmcnt(6)
  v_xor_b32 v7, 32, v7
  v_mfma_f32_16x16x32_bf16 a[96:99], a[248:251], a[216:219], a[96:99]
  ds_read_b64_tr_b16 a[240:241], v0 offset:20480
  ds_write_b64 v7, v[100:101] offset:0
  ds_write_b64 v7, v[102:103] offset:2048
  v_mfma_f32_16x16x32_bf16 a[96:99], a[252:255], v[112:115], a[96:99]
  ds_read_b64_tr_b16 a[242:243], v0 offset:22528
  v_xor_b32 v7, 96, v7
  v_mfma_f32_16x16x32_bf16 a[100:103], a[248:251], a[220:223], a[100:103]
  v_xor_b32 v0, 32, v0
  s_add_u32 m0, s32, 12288
  v_mfma_f32_16x16x32_bf16 a[100:103], a[252:255], v[116:119], a[100:103]
  ds_read_b64_tr_b16 a[244:245], v0 offset:12288
  s_add_u32 s40, s35, 27648
  ds_read_b128 v[48:51], v8 offset:0
  v_mfma_f32_16x16x32_bf16 a[104:107], a[248:251], a[224:227], a[104:107]
  ds_read_b64_tr_b16 a[246:247], v0 offset:14336
  buffer_load_dwordx4 v4, s[12:15], s40 offen nt lds
  v_mfma_f32_16x16x32_bf16 a[104:107], a[252:255], v[120:123], a[104:107]
  buffer_load_dwordx4 v5, s[12:15], s40 offen offset:1024 nt lds
  v_mfma_f32_16x16x32_bf16 a[108:111], a[248:251], a[228:231], a[108:111]
  buffer_load_dwordx4 v6, s[12:15], s40 offen offset:2048 nt lds
  ds_read_b128 v[52:55], v8 offset:1024
  v_mfma_f32_16x16x32_bf16 a[108:111], a[252:255], v[124:127], a[108:111]
L_pad_8:
  s_cbranch_execz L_padret
  ds_read_b128 v[96:99], v8 offset:2048
  ds_read_b128 v[100:103], v8 offset:3072
  v_mfma_f32_16x16x32_bf16 a[112:115], a[248:251], a[232:235], a[112:115]
  s_add_u32 s47, s34, 6272
  buffer_store_dwordx4 v[88:91], v9, s[24:27], s47 offen sc1
  v_mfma_f32_16x16x32_bf16 a[112:115], a[252:255], v[128:131], a[112:115]
  v_accvgpr_read_b32 v104, a16
  v_accvgpr_read_b32 v105, a17
  v_mfma_f32_16x16x32_bf16 a[116:119], a[248:251], a[236:239], a[116:119]
  v_accvgpr_read_b32 v106, a18
  v_accvgpr_read_b32 v107, a19
  v_mfma_f32_16x16x32_bf16 a[116:119], a[252:255], v[132:135], a[116:119]
  s_waitcnt lgkmcnt(3)
  v_mul_f32 v104, v14, v104
  v_mul_f32 v105, v14, v105
  v_mfma_f32_16x16x32_bf16 a[96:99], a[240:243], v[136:139], a[96:99]
  ds_read_b64_tr_b16 a[248:249], v0 offset:16384
  v_mul_f32 v106, v14, v106
  v_mul_f32 v107, v14, v107
  v_mfma_f32_16x16x32_bf16 a[120:123], a[244:247], a[216:219], a[120:123]
  ds_read_b64_tr_b16 a[250:251], v0 offset:18432
  v_cvt_pk_bf16_f32 v104, v104, v105
  v_mfma_f32_16x16x32_bf16 a[100:103], a[240:243], v[140:143], a[100:103]
  ds_read_b64_tr_b16 a[252:253], v0 offset:20480
  v_cvt_pk_bf16_f32 v105, v106, v107
  v_mfma_f32_16x16x32_bf16 a[124:127], a[244:247], a[220:223], a[124:127]
  ds_read_b64_tr_b16 a[254:255], v0 offset:22528
  v_accvgpr_read_b32 v106, a20
  v_mfma_f32_16x16x32_bf16 a[104:107], a[240:243], v[144:147], a[104:107]
  v_xor_b32 v0, 96, v0
  v_accvgpr_read_b32 v107, a21
  v_mfma_f32_16x16x32_bf16 a[128:131], a[244:247], a[224:227], a[128:131]
  v_accvgpr_read_b32 v108, a22
  v_accvgpr_read_b32 v109, a23
  v_mul_f32 v106, v15, v106
  v_mfma_f32_16x16x32_bf16 a[108:111], a[240:243], v[148:151], a[108:111]
  v_mul_f32 v107, v15, v107
  v_mul_f32 v108, v15, v108
  v_mfma_f32_16x16x32_bf16 a[132:135], a[244:247], a[228:231], a[132:135]
  v_mul_f32 v109, v15, v109
  v_cvt_pk_bf16_f32 v106, v106, v107
  v_mfma_f32_16x16x32_bf16 a[112:115], a[240:243], v[152:155], a[112:115]
  v_cvt_pk_bf16_f32 v107, v108, v109
  v_accvgpr_read_b32 v108, a40
  v_mfma_f32_16x16x32_bf16 a[136:139], a[244:247], a[232:235], a[136:139]
  v_accvgpr_read_b32 v109, a41
  v_accvgpr_read_b32 v110, a42
  v_mfma_f32_16x16x32_bf16 a[116:119], a[240:243], v[156:159], a[116:119]
  v_accvgpr_read_b32 v111, a43
  v_mul_f32 v108, v14, v108
  v_mfma_f32_16x16x32_bf16 a[140:143], a[244:247], a[236:239], a[140:143]
  s_waitcnt lgkmcnt(0)
  s_barrier
  ds_read_b64_tr_b16 a[240:241], v0 offset:24576
  v_mfma_f32_16x16x32_bf16 a[120:123], a[248:251], v[112:115], a[120:123]
  ds_read_b64_tr_b16 a[242:243], v0 offset:26624
  v_mul_f32 v109, v14, v109
  v_mul_f32 v110, v14, v110
  v_mfma_f32_16x16x32_bf16 a[120:123], a[252:255], v[136:139], a[120:123]
  ds_read_b64_tr_b16 a[244:245], v0 offset:28672
  v_mul_f32 v111, v14, v111
  v_mfma_f32_16x16x32_bf16 a[124:127], a[248:251], v[116:119], a[124:127]
  ds_read_b64_tr_b16 a[246:247], v0 offset:30720
  buffer_store_dwordx4 v[92:95], v9, s[24:27], s47 offen offset:3072 sc1
  v_mfma_f32_16x16x32_bf16 a[124:127], a[252:255], v[140:143], a[124:127]
  v_cvt_pk_bf16_f32 v108, v108, v109
  v_cvt_pk_bf16_f32 v109, v110, v111
  v_mfma_f32_16x16x32_bf16 a[128:131], a[248:251], v[120:123], a[128:131]
  s_add_u32 m0, s32, 24576
  v_accvgpr_read_b32 v110, a44
  v_accvgpr_read_b32 v111, a45
  v_mfma_f32_16x16x32_bf16 a[128:131], a[252:255], v[144:147], a[128:131]
  s_add_u32 s40, s35, 30720
  v_accvgpr_read_b32 v3, a47
  v_mfma_f32_16x16x32_bf16 a[132:135], a[248:251], v[124:127], a[132:135]
  buffer_load_dwordx4 v4, s[12:15], s40 offen nt lds
  v_mfma_f32_16x16x32_bf16 a[132:135], a[252:255], v[148:151], a[132:135]
  buffer_load_dwordx4 v5, s[12:15], s40 offen offset:1024 nt lds
  v_mul_f32 v110, v15, v110
  v_mfma_f32_16x16x32_bf16 a[136:139], a[248:251], v[128:131], a[136:139]
  buffer_load_dwordx4 v6, s[12:15], s40 offen offset:2048 nt lds
  v_mfma_f32_16x16x32_bf16 a[136:139], a[252:255], v[152:155], a[136:139]
  v_mul_f32 v111, v15, v111
  v_mul_f32 v3, v15, v3
  v_mfma_f32_16x16x32_bf16 a[140:143], a[248:251], v[132:135], a[140:143]
  v_cvt_pk_bf16_f32 v110, v110, v111
  v_accvgpr_read_b32 v111, a46
  v_mfma_f32_16x16x32_bf16 a[140:143], a[252:255], v[156:159], a[140:143]
  s_waitcnt lgkmcnt(0)
  v_mul_f32 v111, v15, v111
  v_cvt_pk_bf16_f32 v111, v111, v3
  v_mfma_f32_16x16x32_bf16 a[48:51], a[240:243], v[160:163], a[48:51]
  ds_read_b64_tr_b16 a[248:249], v0 offset:32768
  ds_write_b64 v7, v[56:57] offset:0
  v_mfma_f32_16x16x32_bf16 a[48:51], a[244:247], v[184:187], a[48:51]
  ds_read_b64_tr_b16 a[250:251], v0 offset:34816
  ds_write_b64 v7, v[58:59] offset:2048
  v_mfma_f32_16x16x32_bf16 a[52:55], a[240:243], v[164:167], a[52:55]
  v_xor_b32 v0, 32, v0
  v_xor_b32 v7, 32, v7
  v_mfma_f32_16x16x32_bf16 a[52:55], a[244:247], v[188:191], a[52:55]
  ds_read_b64_tr_b16 a[252:253], v0 offset:24576
  ds_write_b64 v7, v[60:61] offset:0
  v_mfma_f32_16x16x32_bf16 a[56:59], a[240:243], v[168:171], a[56:59]
  ds_read_b64_tr_b16 a[254:255], v0 offset:26624
  ds_write_b64 v7, v[62:63] offset:2048
  v_mfma_f32_16x16x32_bf16 a[56:59], a[244:247], v[192:195], a[56:59]
  v_xor_b32 v7, 96, v7
  v_mov_b32 v144, v1
  v_mfma_f32_16x16x32_bf16 a[60:63], a[240:243], v[172:175], a[60:63]
  ds_write_b64 v7, v[104:105] offset:0
  ds_write_b64 v7, v[106:107] offset:2048
  v_mfma_f32_16x16x32_bf16 a[60:63], a[244:247], v[196:199], a[60:63]
  v_xor_b32 v7, 32, v7
  s_waitcnt vmcnt(16)
  v_mfma_f32_16x16x32_bf16 a[64:67], a[240:243], v[176:179], a[64:67]
  s_add_u32 s47, s34, 12416
  buffer_store_dwordx4 v[48:51], v9, s[24:27], s47 offen sc1
  ds_write_b64 v7, v[108:109] offset:0
  v_mfma_f32_16x16x32_bf16 a[64:67], a[244:247], v[200:203], a[64:67]
  ds_write_b64 v7, v[110:111] offset:2048
  v_xor_b32 v7, 96, v7
  v_mfma_f32_16x16x32_bf16 a[68:71], a[240:243], v[180:183], a[68:71]
  ds_read_b128 v[56:59], v8 offset:0
  ds_read_b128 v[60:63], v8 offset:1024
  v_mfma_f32_16x16x32_bf16 a[68:71], a[244:247], v[204:207], a[68:71]
  s_waitcnt lgkmcnt(7)
  ds_read_b128 v[104:107], v8 offset:2048
  ds_read_b128 v[108:111], v8 offset:3072
  v_mfma_f32_16x16x32_bf16 a[48:51], a[248:251], v[208:211], a[48:51]
  ds_read_b64_tr_b16 a[240:241], v0 offset:28672
  v_add_u32 v145, 49152, v144
  v_mfma_f32_16x16x32_bf16 a[72:75], a[252:255], v[160:163], a[72:75]
  ds_read_b64_tr_b16 a[242:243], v0 offset:30720
  ds_read_b128 a[192:195], v145 offset:0
  v_mfma_f32_16x16x32_bf16 a[52:55], a[248:251], v[212:215], a[52:55]
  ds_read_b64_tr_b16 a[244:245], v0 offset:32768
  s_add_u32 m0, s32, 36864
  ds_read_b128 a[216:219], v145 offset:24576
  v_mfma_f32_16x16x32_bf16 a[76:79], a[252:255], v[164:167], a[76:79]
  ds_read_b64_tr_b16 a[246:247], v0 offset:34816
  s_add_u32 s40, s35, 33792
  v_mfma_f32_16x16x32_bf16 a[56:59], a[248:251], v[216:219], a[56:59]
  v_xor_b32 v0, 96, v0
  buffer_load_dwordx4 v4, s[12:15], s40 offen nt lds
  v_mfma_f32_16x16x32_bf16 a[80:83], a[252:255], v[168:171], a[80:83]
  buffer_load_dwordx4 v5, s[12:15], s40 offen offset:1024 nt lds
  ds_read_b128 a[200:203], v145 offset:128
  v_mfma_f32_16x16x32_bf16 a[60:63], a[248:251], v[220:223], a[60:63]
  buffer_load_dwordx4 v6, s[12:15], s40 offen offset:2048 nt lds
  v_mfma_f32_16x16x32_bf16 a[84:87], a[252:255], v[172:175], a[84:87]
  ds_read_b128 a[224:227], v145 offset:24704
  ds_read_b128 a[208:211], v145 offset:256
  v_mfma_f32_16x16x32_bf16 a[64:67], a[248:251], v[224:227], a[64:67]
  ds_read_b128 a[232:235], v145 offset:24832
  v_xor_b32 v145, 64, v144
  v_mfma_f32_16x16x32_bf16 a[88:91], a[252:255], v[176:179], a[88:91]
  v_add_u32 v145, 49152, v145
  v_mfma_f32_16x16x32_bf16 a[68:71], a[248:251], v[228:231], a[68:71]
  ds_read_b128 a[196:199], v145 offset:0
  ds_read_b128 a[220:223], v145 offset:24576
  ds_read_b128 a[204:207], v145 offset:128
  v_mfma_f32_16x16x32_bf16 a[92:95], a[252:255], v[180:183], a[92:95]
  s_waitcnt lgkmcnt(7)
  ds_read_b128 a[228:231], v145 offset:24704
  ds_read_b128 a[212:215], v145 offset:256
  v_mfma_f32_16x16x32_bf16 a[72:75], a[240:243], v[184:187], a[72:75]
  ds_read_b64_tr_b16 a[248:249], v0 offset:24576
  ds_read_b128 a[236:239], v145 offset:24832
  v_mfma_f32_16x16x32_bf16 a[72:75], a[244:247], v[208:211], a[72:75]
  ds_read_b64_tr_b16 a[250:251], v0 offset:26624
  v_mfma_f32_16x16x32_bf16 a[76:79], a[240:243], v[188:191], a[76:79]
  ds_read_b64_tr_b16 a[252:253], v0 offset:28672
  buffer_store_dwordx4 v[52:55], v9, s[24:27], s47 offen offset:3072 sc1
  v_mfma_f32_16x16x32_bf16 a[76:79], a[244:247], v[212:215], a[76:79]
  ds_read_b64_tr_b16 a[254:255], v0 offset:30720
  v_mfma_f32_16x16x32_bf16 a[80:83], a[240:243], v[192:195], a[80:83]
  v_mfma_f32_16x16x32_bf16 a[80:83], a[244:247], v[216:219], a[80:83]
  v_mfma_f32_16x16x32_bf16 a[84:87], a[240:243], v[196:199], a[84:87]
  v_mfma_f32_16x16x32_bf16 a[84:87], a[244:247], v[220:223], a[84:87]
  v_mfma_f32_16x16x32_bf16 a[88:91], a[240:243], v[200:203], a[88:91]
  v_mfma_f32_16x16x32_bf16 a[88:91], a[244:247], v[224:227], a[88:91]
  v_mfma_f32_16x16x32_bf16 a[92:95], a[240:243], v[204:207], a[92:95]
  v_mfma_f32_16x16x32_bf16 a[92:95], a[244:247], v[228:231], a[92:95]
  s_waitcnt lgkmcnt(0)
  v_mfma_f32_16x16x32_bf16 a[96:99], a[248:251], v[160:163], a[96:99]
  ds_read_b64_tr_b16 a[240:241], v0 offset:32768
  v_mfma_f32_16x16x32_bf16 a[96:99], a[252:255], v[184:187], a[96:99]
  ds_read_b64_tr_b16 a[242:243], v0 offset:34816
  v_mfma_f32_16x16x32_bf16 a[100:103], a[248:251], v[164:167], a[100:103]
  v_xor_b32 v0, 32, v0
  v_mfma_f32_16x16x32_bf16 a[100:103], a[252:255], v[188:191], a[100:103]
  ds_read_b64_tr_b16 a[244:245], v0 offset:24576
  v_mfma_f32_16x16x32_bf16 a[104:107], a[248:251], v[168:171], a[104:107]
  ds_read_b64_tr_b16 a[246:247], v0 offset:26624
  v_mfma_f32_16x16x32_bf16 a[104:107], a[252:255], v[192:195], a[104:107]
  v_mfma_f32_16x16x32_bf16 a[108:111], a[248:251], v[172:175], a[108:111]
  v_mfma_f32_16x16x32_bf16 a[108:111], a[252:255], v[196:199], a[108:111]
  v_mfma_f32_16x16x32_bf16 a[112:115], a[248:251], v[176:179], a[112:115]
  s_add_u32 s47, s34, 18560
  buffer_store_dwordx4 v[96:99], v9, s[24:27], s47 offen sc1
  v_mfma_f32_16x16x32_bf16 a[112:115], a[252:255], v[200:203], a[112:115]
  v_mfma_f32_16x16x32_bf16 a[116:119], a[248:251], v[180:183], a[116:119]
  v_mfma_f32_16x16x32_bf16 a[116:119], a[252:255], v[204:207], a[116:119]
  s_waitcnt lgkmcnt(0)
  v_mfma_f32_16x16x32_bf16 a[96:99], a[240:243], v[208:211], a[96:99]
  ds_read_b64_tr_b16 a[248:249], v0 offset:28672
  v_mfma_f32_16x16x32_bf16 a[120:123], a[244:247], v[160:163], a[120:123]
  ds_read_b64_tr_b16 a[250:251], v0 offset:30720
  v_mfma_f32_16x16x32_bf16 a[100:103], a[240:243], v[212:215], a[100:103]
  ds_read_b64_tr_b16 a[252:253], v0 offset:32768
  v_mfma_f32_16x16x32_bf16 a[124:127], a[244:247], v[164:167], a[124:127]
  ds_read_b64_tr_b16 a[254:255], v0 offset:34816
  v_mfma_f32_16x16x32_bf16 a[104:107], a[240:243], v[216:219], a[104:107]
  v_xor_b32 v0, 96, v0
  v_mfma_f32_16x16x32_bf16 a[128:131], a[244:247], v[168:171], a[128:131]
  v_mfma_f32_16x16x32_bf16 a[108:111], a[240:243], v[220:223], a[108:111]
  v_mfma_f32_16x16x32_bf16 a[132:135], a[244:247], v[172:175], a[132:135]
  v_mfma_f32_16x16x32_bf16 a[112:115], a[240:243], v[224:227], a[112:115]
  v_mfma_f32_16x16x32_bf16 a[136:139], a[244:247], v[176:179], a[136:139]
  v_mfma_f32_16x16x32_bf16 a[116:119], a[240:243], v[228:231], a[116:119]
  v_mfma_f32_16x16x32_bf16 a[140:143], a[244:247], v[180:183], a[140:143]
  s_waitcnt lgkmcnt(0)
  s_barrier
  ds_read_b64_tr_b16 a[240:241], v0 offset:36864
  v_mfma_f32_16x16x32_bf16 a[120:123], a[248:251], v[184:187], a[120:123]
  ds_read_b64_tr_b16 a[242:243], v0 offset:38912
  v_mfma_f32_16x16x32_bf16 a[120:123], a[252:255], v[208:211], a[120:123]
  ds_read_b64_tr_b16 a[244:245], v0 offset:40960
  v_mfma_f32_16x16x32_bf16 a[124:127], a[248:251], v[188:191], a[124:127]
  ds_read_b64_tr_b16 a[246:247], v0 offset:43008
  buffer_store_dwordx4 v[100:103], v9, s[24:27], s47 offen offset:3072 sc1
  v_mfma_f32_16x16x32_bf16 a[124:127], a[252:255], v[212:215], a[124:127]
  v_mfma_f32_16x16x32_bf16 a[128:131], a[248:251], v[192:195], a[128:131]
  s_add_u32 m0, s32, 110592
  v_mfma_f32_16x16x32_bf16 a[128:131], a[252:255], v[216:219], a[128:131]
  s_add_u32 s40, s37, 12288
  v_mfma_f32_16x16x32_bf16 a[132:135], a[248:251], v[196:199], a[132:135]
  buffer_load_dwordx4 v4, s[16:19], s40 offen nt lds
  v_mfma_f32_16x16x32_bf16 a[132:135], a[252:255], v[220:223], a[132:135]
  buffer_load_dwordx4 v5, s[16:19], s40 offen offset:1024 nt lds
  v_mfma_f32_16x16x32_bf16 a[136:139], a[248:251], v[200:203], a[136:139]
  buffer_load_dwordx4 v6, s[16:19], s40 offen offset:2048 nt lds
  v_mfma_f32_16x16x32_bf16 a[136:139], a[252:255], v[224:227], a[136:139]
  v_mfma_f32_16x16x32_bf16 a[140:143], a[248:251], v[204:207], a[140:143]
  v_mfma_f32_16x16x32_bf16 a[140:143], a[252:255], v[228:231], a[140:143]
  s_waitcnt lgkmcnt(0)
  v_mfma_f32_16x16x32_bf16 a[48:51], a[240:243], v[232:235], a[48:51]
  ds_read_b64_tr_b16 a[248:249], v0 offset:45056
  v_mfma_f32_16x16x32_bf16 a[48:51], a[244:247], v[16:19], a[48:51]
  ds_read_b64_tr_b16 a[250:251], v0 offset:47104
  v_mfma_f32_16x16x32_bf16 a[52:55], a[240:243], v[236:239], a[52:55]
  v_xor_b32 v0, 32, v0
  v_mfma_f32_16x16x32_bf16 a[52:55], a[244:247], v[20:23], a[52:55]
  ds_read_b64_tr_b16 a[252:253], v0 offset:36864
  v_mfma_f32_16x16x32_bf16 a[56:59], a[240:243], v[240:243], a[56:59]
  ds_read_b64_tr_b16 a[254:255], v0 offset:38912
  v_mfma_f32_16x16x32_bf16 a[56:59], a[244:247], v[24:27], a[56:59]
  v_mfma_f32_16x16x32_bf16 a[60:63], a[240:243], v[244:247], a[60:63]
  v_mfma_f32_16x16x32_bf16 a[60:63], a[244:247], v[28:31], a[60:63]
  v_mfma_f32_16x16x32_bf16 a[64:67], a[240:243], v[248:251], a[64:67]
  s_add_u32 s47, s34, 24704
  buffer_store_dwordx4 v[56:59], v9, s[24:27], s47 offen sc1
  v_mfma_f32_16x16x32_bf16 a[64:67], a[244:247], v[32:35], a[64:67]
  v_mfma_f32_16x16x32_bf16 a[68:71], a[240:243], v[252:255], a[68:71]
  v_mfma_f32_16x16x32_bf16 a[68:71], a[244:247], v[36:39], a[68:71]
  s_waitcnt lgkmcnt(0)
  v_mfma_f32_16x16x32_bf16 a[48:51], a[248:251], v[64:67], a[48:51]
  ds_read_b64_tr_b16 a[240:241], v0 offset:40960
  v_mfma_f32_16x16x32_bf16 a[72:75], a[252:255], v[232:235], a[72:75]
  ds_read_b64_tr_b16 a[242:243], v0 offset:43008
  v_mfma_f32_16x16x32_bf16 a[52:55], a[248:251], v[68:71], a[52:55]
  ds_read_b64_tr_b16 a[244:245], v0 offset:45056
  s_add_u32 m0, s32, 122880
  v_mfma_f32_16x16x32_bf16 a[76:79], a[252:255], v[236:239], a[76:79]
  ds_read_b64_tr_b16 a[246:247], v0 offset:47104
  s_add_u32 s40, s37, 24576
  v_mfma_f32_16x16x32_bf16 a[56:59], a[248:251], v[72:75], a[56:59]
  v_xor_b32 v0, 96, v0
  buffer_load_dwordx4 v4, s[16:19], s40 offen nt lds
  v_mfma_f32_16x16x32_bf16 a[80:83], a[252:255], v[240:243], a[80:83]
  buffer_load_dwordx4 v5, s[16:19], s40 offen offset:1024 nt lds
  v_mfma_f32_16x16x32_bf16 a[60:63], a[248:251], v[76:79], a[60:63]
  buffer_load_dwordx4 v6, s[16:19], s40 offen offset:2048 nt lds
  v_mfma_f32_16x16x32_bf16 a[84:87], a[252:255], v[244:247], a[84:87]
  v_mfma_f32_16x16x32_bf16 a[64:67], a[248:251], v[80:83], a[64:67]
  v_mfma_f32_16x16x32_bf16 a[88:91], a[252:255], v[248:251], a[88:91]
  v_mfma_f32_16x16x32_bf16 a[68:71], a[248:251], v[84:87], a[68:71]
  v_mfma_f32_16x16x32_bf16 a[92:95], a[252:255], v[252:255], a[92:95]
  s_waitcnt lgkmcnt(0)
  v_mfma_f32_16x16x32_bf16 a[72:75], a[240:243], v[16:19], a[72:75]
  ds_read_b64_tr_b16 a[248:249], v0 offset:36864
  v_mfma_f32_16x16x32_bf16 a[72:75], a[244:247], v[64:67], a[72:75]
  ds_read_b64_tr_b16 a[250:251], v0 offset:38912
  v_mfma_f32_16x16x32_bf16 a[76:79], a[240:243], v[20:23], a[76:79]
  ds_read_b64_tr_b16 a[252:253], v0 offset:40960
  buffer_store_dwordx4 v[60:63], v9, s[24:27], s47 offen offset:3072 sc1
  v_mfma_f32_16x16x32_bf16 a[76:79], a[244:247], v[68:71], a[76:79]
  ds_read_b64_tr_b16 a[254:255], v0 offset:43008
  v_mfma_f32_16x16x32_bf16 a[80:83], a[240:243], v[24:27], a[80:83]
  v_mfma_f32_16x16x32_bf16 a[80:83], a[244:247], v[72:75], a[80:83]
  v_mfma_f32_16x16x32_bf16 a[84:87], a[240:243], v[28:31], a[84:87]
  v_mfma_f32_16x16x32_bf16 a[84:87], a[244:247], v[76:79], a[84:87]
  v_mfma_f32_16x16x32_bf16 a[88:91], a[240:243], v[32:35], a[88:91]
  v_mfma_f32_16x16x32_bf16 a[88:91], a[244:247], v[80:83], a[88:91]
  v_mfma_f32_16x16x32_bf16 a[92:95], a[240:243], v[36:39], a[92:95]
  v_mfma_f32_16x16x32_bf16 a[92:95], a[244:247], v[84:87], a[92:95]
  s_waitcnt lgkmcnt(0)
  v_mfma_f32_16x16x32_bf16 a[96:99], a[248:251], v[232:235], a[96:99]
  ds_read_b64_tr_b16 a[240:241], v0 offset:45056
  v_mfma_f32_16x16x32_bf16 a[96:99], a[252:255], v[16:19], a[96:99]
  ds_read_b64_tr_b16 a[242:243], v0 offset:47104
  v_mfma_f32_16x16x32_bf16 a[100:103], a[248:251], v[236:239], a[100:103]
  v_xor_b32 v0, 32, v0
  v_mfma_f32_16x16x32_bf16 a[100:103], a[252:255], v[20:23], a[100:103]
  ds_read_b64_tr_b16 a[244:245], v0 offset:36864
  v_mfma_f32_16x16x32_bf16 a[104:107], a[248:251], v[240:243], a[104:107]
  ds_read_b64_tr_b16 a[246:247], v0 offset:38912
  v_accvgpr_read_b32 v208, a48
  v_accvgpr_read_b32 v209, a49
  v_accvgpr_read_b32 v210, a50
  v_mfma_f32_16x16x32_bf16 a[104:107], a[252:255], v[24:27], a[104:107]
  v_accvgpr_read_b32 v211, a51
  v_mul_f32 v208, v10, v208
  v_mul_f32 v209, v10, v209
  v_mul_f32 v210, v10, v210
  v_mfma_f32_16x16x32_bf16 a[108:111], a[248:251], v[244:247], a[108:111]
  v_mul_f32 v211, v10, v211
  v_cvt_pk_bf16_f32 v208, v208, v209
  v_cvt_pk_bf16_f32 v209, v210, v211
  v_accvgpr_read_b32 v210, a52
  v_mfma_f32_16x16x32_bf16 a[108:111], a[252:255], v[28:31], a[108:111]
  v_accvgpr_read_b32 v211, a53
  v_accvgpr_read_b32 v212, a54
  v_accvgpr_read_b32 v213, a55
  v_mul_f32 v210, v11, v210
  v_mfma_f32_16x16x32_bf16 a[112:115], a[248:251], v[248:251], a[112:115]
  s_add_u32 s47, s34, 30848
  buffer_store_dwordx4 v[104:107], v9, s[24:27], s47 offen sc1
  v_mfma_f32_16x16x32_bf16 a[112:115], a[252:255], v[32:35], a[112:115]
  v_mul_f32 v211, v11, v211
  v_mul_f32 v212, v11, v212
  v_mul_f32 v213, v11, v213
  v_cvt_pk_bf16_f32 v210, v210, v211
  v_mfma_f32_16x16x32_bf16 a[116:119], a[248:251], v[252:255], a[116:119]
  v_cvt_pk_bf16_f32 v211, v212, v213
  v_accvgpr_read_b32 v212, a72
  v_accvgpr_read_b32 v213, a73
  v_accvgpr_read_b32 v214, a74
  v_mfma_f32_16x16x32_bf16 a[116:119], a[252:255], v[36:39], a[116:119]
  s_waitcnt lgkmcnt(0)
  v_accvgpr_read_b32 v215, a75
  v_mul_f32 v212, v10, v212
  v_mul_f32 v213, v10, v213
  v_mul_f32 v214, v10, v214
  v_mfma_f32_16x16x32_bf16 a[96:99], a[240:243], v[64:67], a[96:99]
  ds_read_b64_tr_b16 a[248:249], v0 offset:40960
  v_mul_f32 v215, v10, v215
  v_cvt_pk_bf16_f32 v212, v212, v213
  v_cvt_pk_bf16_f32 v213, v214, v215
  v_mfma_f32_16x16x32_bf16 a[120:123], a[244:247], v[232:235], a[120:123]
  ds_read_b64_tr_b16 a[250:251], v0 offset:43008
  v_accvgpr_read_b32 v214, a76
  v_accvgpr_read_b32 v215, a77
  v_accvgpr_read_b32 v156, a79
  v_mfma_f32_16x16x32_bf16 a[100:103], a[240:243], v[68:71], a[100:103]
  ds_read_b64_tr_b16 a[252:253], v0 offset:45056
  v_mul_f32 v214, v11, v214
  v_mul_f32 v215, v11, v215
  v_mul_f32 v156, v11, v156
  v_mfma_f32_16x16x32_bf16 a[124:127], a[244:247], v[236:239], a[124:127]
  ds_read_b64_tr_b16 a[254:255], v0 offset:47104
  v_cvt_pk_bf16_f32 v214, v214, v215
  v_accvgpr_read_b32 v215, a78
  v_mul_f32 v215, v11, v215
  v_mfma_f32_16x16x32_bf16 a[104:107], a[240:243], v[72:75], a[104:107]
  v_xor_b32 v0, 96, v0
  v_cvt_pk_bf16_f32 v215, v215, v156
  v_accvgpr_read_b32 v216, a56
  v_mfma_f32_16x16x32_bf16 a[128:131], a[244:247], v[240:243], a[128:131]
  v_accvgpr_read_b32 v217, a57
  v_accvgpr_read_b32 v218, a58
  v_accvgpr_read_b32 v219, a59
  v_mul_f32 v216, v12, v216
  v_mfma_f32_16x16x32_bf16 a[108:111], a[240:243], v[76:79], a[108:111]
  v_mbcnt_lo_u32_b32 v146, -1, 0
  v_mbcnt_hi_u32_b32 v146, -1, v146
  v_mul_f32 v217, v12, v217
  v_mul_f32 v218, v12, v218
  v_mfma_f32_16x16x32_bf16 a[132:135], a[244:247], v[244:247], a[132:135]
  v_bfe_u32 v147, v146, 1, 3
  v_lshrrev_b32 v1, 4, v146
  v_mul_f32 v219, v12, v219
  v_cvt_pk_bf16_f32 v216, v216, v217
  v_mfma_f32_16x16x32_bf16 a[112:115], a[240:243], v[80:83], a[112:115]
  v_xor_b32 v147, v147, v1
  v_and_b32 v146, 15, v146
  v_cvt_pk_bf16_f32 v217, v218, v219
  v_accvgpr_read_b32 v218, a60
  v_mfma_f32_16x16x32_bf16 a[136:139], a[244:247], v[248:251], a[136:139]
  v_mul_u32_u24 v146, 384, v146
  v_lshl_add_u32 v0, v147, 4, v146
  v_accvgpr_read_b32 v219, a61
  v_accvgpr_read_b32 v220, a62
  v_mfma_f32_16x16x32_bf16 a[116:119], a[240:243], v[84:87], a[116:119]
  v_add_u32 v0, 98304, v0
  v_xor_b32 v1, 64, v0
  s_mov_b64 exec, 0
  s_cmp_eq_u32 s3, 0
  s_cbranch_scc1 L_pad_11
  s_cmp_eq_u32 s3, 1
  s_cbranch_scc1 L_pad_12
  s_cmp_eq_u32 s3, 2
  s_cbranch_scc1 L_pad_13
  s_branch L_pad_14
L_padret2:
  s_mov_b64 exec, -1
  v_accvgpr_read_b32 v221, a63
  v_mfma_f32_16x16x32_bf16 a[140:143], a[244:247], v[252:255], a[140:143]
  s_waitcnt vmcnt(29) lgkmcnt(0)
  s_barrier
  ds_read_b128 v[88:91], v0 offset:0
  v_mfma_f32_16x16x32_bf16 a[120:123], a[248:251], v[16:19], a[120:123]
  ds_read_b128 v[92:95], v1 offset:0
  v_mul_f32 v218, v13, v218
  v_mul_f32 v219, v13, v219
  v_mul_f32 v220, v13, v220
  v_mfma_f32_16x16x32_bf16 a[120:123], a[252:255], v[64:67], a[120:123]
  v_mul_f32 v221, v13, v221
  v_cvt_pk_bf16_f32 v218, v218, v219
  v_cvt_pk_bf16_f32 v219, v220, v221
  v_accvgpr_read_b32 v220, a80
  v_mfma_f32_16x16x32_bf16 a[124:127], a[248:251], v[20:23], a[124:127]
  buffer_store_dwordx4 v[108:111], v9, s[24:27], s47 offen offset:3072 sc1
  v_accvgpr_read_b32 v221, a81
  v_mfma_f32_16x16x32_bf16 a[124:127], a[252:255], v[68:71], a[124:127]
  v_accvgpr_read_b32 v222, a82
  v_accvgpr_read_b32 v223, a83
  v_mul_f32 v220, v12, v220
  v_mul_f32 v221, v12, v221
  v_mfma_f32_16x16x32_bf16 a[128:131], a[248:251], v[24:27], a[128:131]
  v_mul_f32 v222, v12, v222
  v_mul_f32 v223, v12, v223
  v_cvt_pk_bf16_f32 v220, v220, v221
  v_mfma_f32_16x16x32_bf16 a[128:131], a[252:255], v[72:75], a[128:131]
  v_cvt_pk_bf16_f32 v221, v222, v223
  v_accvgpr_read_b32 v222, a84
  v_accvgpr_read_b32 v223, a85
  v_accvgpr_read_b32 v156, a87
  v_mfma_f32_16x16x32_bf16 a[132:135], a[248:251], v[28:31], a[132:135]
  v_mul_f32 v222, v13, v222
  v_mul_f32 v223, v13, v223
  v_mul_f32 v156, v13, v156
  v_cvt_pk_bf16_f32 v222, v222, v223
  v_mfma_f32_16x16x32_bf16 a[132:135], a[252:255], v[76:79], a[132:135]
  v_accvgpr_read_b32 v223, a86
  v_mul_f32 v223, v13, v223
  v_cvt_pk_bf16_f32 v223, v223, v156
  v_accvgpr_read_b32 v224, a64
  v_mfma_f32_16x16x32_bf16 a[136:139], a[248:251], v[32:35], a[136:139]
  v_accvgpr_read_b32 v225, a65
  v_accvgpr_read_b32 v226, a66
  v_accvgpr_read_b32 v227, a67
  v_mul_f32 v224, v14, v224
  v_mfma_f32_16x16x32_bf16 a[136:139], a[252:255], v[80:83], a[136:139]
  v_mul_f32 v225, v14, v225
  v_mul_f32 v226, v14, v226
  v_mul_f32 v227, v14, v227
  v_cvt_pk_bf16_f32 v224, v224, v225
  v_mfma_f32_16x16x32_bf16 a[140:143], a[248:251], v[36:39], a[140:143]
  v_cvt_pk_bf16_f32 v225, v226, v227
  v_accvgpr_read_b32 v226, a68
  v_accvgpr_read_b32 v227, a69
  v_accvgpr_read_b32 v228, a70
  v_mfma_f32_16x16x32_bf16 a[140:143], a[252:255], v[84:87], a[140:143]
  s_waitcnt lgkmcnt(0)
  v_accvgpr_read_b32 v229, a71
  v_mul_f32 v226, v15, v226
  v_mul_f32 v227, v15, v227
  v_mul_f32 v228, v15, v228
  v_mfma_f32_16x16x32_bf16 v[16:19], v[88:91], a[144:147], 0
  ds_read_b128 v[96:99], v0 offset:128
  v_mul_f32 v229, v15, v229
  v_cvt_pk_bf16_f32 v226, v226, v227
  v_cvt_pk_bf16_f32 v227, v228, v229
  v_mfma_f32_16x16x32_bf16 v[16:19], v[92:95], a[148:151], v[16:19]
  v_accvgpr_read_b32 v228, a88
  v_accvgpr_read_b32 v229, a89
  v_accvgpr_read_b32 v230, a90
  v_mfma_f32_16x16x32_bf16 v[24:27], v[88:91], a[168:171], 0
  ds_read_b128 v[100:103], v1 offset:128
  v_accvgpr_read_b32 v231, a91
  v_mul_f32 v228, v14, v228
  v_mul_f32 v229, v14, v229
  v_mfma_f32_16x16x32_bf16 v[24:27], v[92:95], a[172:175], v[24:27]
  v_mul_f32 v230, v14, v230
  v_mul_f32 v231, v14, v231
  v_cvt_pk_bf16_f32 v228, v228, v229
  v_cvt_pk_bf16_f32 v229, v230, v231
  v_mfma_f32_16x16x32_bf16 v[32:35], v[88:91], a[192:195], 0
  ds_read_b128 v[104:107], v0 offset:256
  v_accvgpr_read_b32 v230, a92
  v_accvgpr_read_b32 v231, a93
  v_accvgpr_read_b32 v156, a95
  v_mfma_f32_16x16x32_bf16 v[32:35], v[92:95], a[196:199], v[32:35]
  v_mul_f32 v230, v15, v230
  v_mul_f32 v231, v15, v231
  v_mul_f32 v156, v15, v156
  v_cvt_pk_bf16_f32 v230, v230, v231
  v_mfma_f32_16x16x32_bf16 v[40:43], v[88:91], a[216:219], 0
  ds_read_b128 v[108:111], v1 offset:256
  v_accvgpr_read_b32 v231, a94
  v_mul_f32 v231, v15, v231
  v_cvt_pk_bf16_f32 v231, v231, v156
  v_mfma_f32_16x16x32_bf16 v[40:43], v[92:95], a[220:223], v[40:43]
  s_waitcnt lgkmcnt(3)
  v_accvgpr_read_b32 v232, a96
  v_accvgpr_read_b32 v233, a97
  v_mfma_f32_16x16x32_bf16 v[16:19], v[96:99], a[152:155], v[16:19]
  s_waitcnt lgkmcnt(2)
  ds_read_b128 v[64:67], v0 offset:6144
  s_add_u32 m0, s32, 135168
  v_accvgpr_read_b32 v234, a98
  v_mfma_f32_16x16x32_bf16 v[16:19], v[100:103], a[156:159], v[16:19]
  s_add_u32 s40, s37, 36864
  v_accvgpr_read_b32 v235, a99
  v_mul_f32 v232, v10, v232
  v_mfma_f32_16x16x32_bf16 v[24:27], v[96:99], a[176:179], v[24:27]
  ds_read_b128 v[68:71], v1 offset:6144
  buffer_load_dwordx4 v4, s[16:19], s40 offen nt lds
  v_mfma_f32_16x16x32_bf16 v[24:27], v[100:103], a[180:183], v[24:27]
  buffer_load_dwordx4 v5, s[16:19], s40 offen offset:1024 nt lds
  v_mul_f32 v233, v10, v233
  v_mfma_f32_16x16x32_bf16 v[32:35], v[96:99], a[200:203], v[32:35]
  ds_read_b128 v[72:75], v0 offset:6272
  buffer_load_dwordx4 v6, s[16:19], s40 offen offset:2048 nt lds
  v_mfma_f32_16x16x32_bf16 v[32:35], v[100:103], a[204:207], v[32:35]
  v_mul_f32 v234, v10, v234
  v_mul_f32 v235, v10, v235
  v_mfma_f32_16x16x32_bf16 v[40:43], v[96:99], a[224:227], v[40:43]
  ds_read_b128 v[76:79], v1 offset:6272
  v_cvt_pk_bf16_f32 v232, v232, v233
  v_mfma_f32_16x16x32_bf16 v[40:43], v[100:103], a[228:231], v[40:43]
  s_waitcnt lgkmcnt(4)
  v_cvt_pk_bf16_f32 v233, v234, v235
  v_accvgpr_read_b32 v234, a100
  v_accvgpr_read_b32 v235, a101
  v_mfma_f32_16x16x32_bf16 v[16:19], v[104:107], a[160:163], v[16:19]
  ds_read_b128 v[80:83], v0 offset:6400
  v_accvgpr_read_b32 v236, a102
  v_mfma_f32_16x16x32_bf16 v[16:19], v[108:111], a[164:167], v[16:19]
  v_accvgpr_read_b32 v237, a103
  v_mul_f32 v234, v11, v234
  v_mul_f32 v235, v11, v235
  v_mfma_f32_16x16x32_bf16 v[24:27], v[104:107], a[184:187], v[24:27]
  ds_read_b128 v[84:87], v1 offset:6400
  v_mul_f32 v236, v11, v236
  v_mfma_f32_16x16x32_bf16 v[24:27], v[108:111], a[188:191], v[24:27]
  v_mul_f32 v237, v11, v237
  v_cvt_pk_bf16_f32 v234, v234, v235
  v_mfma_f32_16x16x32_bf16 v[32:35], v[104:107], a[208:211], v[32:35]
  s_waitcnt vmcnt(16)
  v_cvt_pk_bf16_f32 v235, v236, v237
  v_accvgpr_read_b32 v236, a120
  v_mfma_f32_16x16x32_bf16 v[32:35], v[108:111], a[212:215], v[32:35]
  ds_read_b128 a[0:3], v144 offset:0
  v_accvgpr_read_b32 v237, a121
  v_mfma_f32_16x16x32_bf16 v[40:43], v[104:107], a[232:235], v[40:43]
  ds_read_b128 a[24:27], v144 offset:24576
  v_accvgpr_read_b32 v238, a122
  v_mfma_f32_16x16x32_bf16 v[40:43], v[108:111], a[236:239], v[40:43]
L_pad_9:
  s_cbranch_execz L_padret
  s_waitcnt lgkmcnt(6)
  ds_read_b128 a[8:11], v144 offset:128
  v_accvgpr_read_b32 v239, a123
  v_mul_f32 v236, v10, v236
  v_mfma_f32_16x16x32_bf16 v[20:23], v[64:67], a[144:147], 0
  ds_read_b128 a[32:35], v144 offset:24704
  v_mul_f32 v237, v10, v237
  v_mfma_f32_16x16x32_bf16 v[20:23], v[68:71], a[148:151], v[20:23]
  ds_read_b128 a[16:19], v144 offset:256
  v_mul_f32 v238, v10, v238
  v_mul_f32 v239, v10, v239
  v_mfma_f32_16x16x32_bf16 v[28:31], v[64:67], a[168:171], 0
  ds_read_b128 a[40:43], v144 offset:24832
  v_cvt_pk_bf16_f32 v236, v236, v237
  v_mfma_f32_16x16x32_bf16 v[28:31], v[68:71], a[172:175], v[28:31]
  v_xor_b32 v145, 64, v144
  v_cvt_pk_bf16_f32 v237, v238, v239
  v_mfma_f32_16x16x32_bf16 v[36:39], v[64:67], a[192:195], 0
  ds_read_b128 a[4:7], v145 offset:0
  v_accvgpr_read_b32 v238, a124
  v_accvgpr_read_b32 v239, a125
  v_mfma_f32_16x16x32_bf16 v[36:39], v[68:71], a[196:199], v[36:39]
  ds_read_b128 a[28:31], v145 offset:24576
  v_accvgpr_read_b32 v156, a127
  v_mfma_f32_16x16x32_bf16 v[44:47], v[64:67], a[216:219], 0
  ds_read_b128 a[12:15], v145 offset:128
  v_mul_f32 v238, v11, v238
  v_mul_f32 v239, v11, v239
  v_mfma_f32_16x16x32_bf16 v[44:47], v[68:71], a[220:223], v[44:47]
  s_waitcnt lgkmcnt(11)
  ds_read_b128 a[36:39], v145 offset:24704
  v_mul_f32 v156, v11, v156
  v_mfma_f32_16x16x32_bf16 v[20:23], v[72:75], a[152:155], v[20:23]
  ds_read_b128 a[20:23], v145 offset:256
  v_cvt_pk_bf16_f32 v238, v238, v239
  v_mfma_f32_16x16x32_bf16 v[20:23], v[76:79], a[156:159], v[20:23]
  ds_read_b128 a[44:47], v145 offset:24832
  v_accvgpr_read_b32 v239, a126
  v_mul_f32 v239, v11, v239
  v_mfma_f32_16x16x32_bf16 v[28:31], v[72:75], a[176:179], v[28:31]
  v_cvt_pk_bf16_f32 v239, v239, v156
  v_accvgpr_read_b32 v240, a104
  v_mfma_f32_16x16x32_bf16 v[28:31], v[76:79], a[180:183], v[28:31]
  v_accvgpr_read_b32 v241, a105
  v_accvgpr_read_b32 v242, a106
  v_accvgpr_read_b32 v243, a107
  v_mfma_f32_16x16x32_bf16 v[36:39], v[72:75], a[200:203], v[36:39]
  v_mul_f32 v240, v12, v240
  v_mul_f32 v241, v12, v241
  v_mfma_f32_16x16x32_bf16 v[36:39], v[76:79], a[204:207], v[36:39]
  v_mul_f32 v242, v12, v242
  v_mul_f32 v243, v12, v243
  v_mfma_f32_16x16x32_bf16 v[44:47], v[72:75], a[224:227], v[44:47]
  v_cvt_pk_bf16_f32 v240, v240, v241
  v_cvt_pk_bf16_f32 v241, v242, v243
  v_accvgpr_read_b32 v242, a108
  v_mfma_f32_16x16x32_bf16 v[44:47], v[76:79], a[228:231], v[44:47]
  s_waitcnt lgkmcnt(12)
  v_accvgpr_read_b32 v243, a109
  v_accvgpr_read_b32 v244, a110
  v_mfma_f32_16x16x32_bf16 v[20:23], v[80:83], a[160:163], v[20:23]
  v_accvgpr_read_b32 v245, a111
  v_mul_f32 v242, v13, v242
  v_mfma_f32_16x16x32_bf16 v[20:23], v[84:87], a[164:167], v[20:23]
  v_mul_f32 v243, v13, v243
  v_mul_f32 v244, v13, v244
  v_mul_f32 v245, v13, v245
  v_mfma_f32_16x16x32_bf16 v[28:31], v[80:83], a[184:187], v[28:31]
  v_cvt_pk_bf16_f32 v242, v242, v243
  v_cvt_pk_bf16_f32 v243, v244, v245
  v_mfma_f32_16x16x32_bf16 v[28:31], v[84:87], a[188:191], v[28:31]
  v_accvgpr_read_b32 v244, a128
  v_accvgpr_read_b32 v245, a129
  v_mfma_f32_16x16x32_bf16 v[36:39], v[80:83], a[208:211], v[36:39]
  v_accvgpr_read_b32 v246, a130
  v_accvgpr_read_b32 v247, a131
  v_mul_f32 v244, v12, v244
  v_mfma_f32_16x16x32_bf16 v[36:39], v[84:87], a[212:215], v[36:39]
  v_mul_f32 v245, v12, v245
  v_mul_f32 v246, v12, v246
  v_mfma_f32_16x16x32_bf16 v[44:47], v[80:83], a[232:235], v[44:47]
  v_mul_f32 v247, v12, v247
  v_cvt_pk_bf16_f32 v244, v244, v245
  v_cvt_pk_bf16_f32 v245, v246, v247
  v_mfma_f32_16x16x32_bf16 v[44:47], v[84:87], a[236:239], v[44:47]
  s_waitcnt lgkmcnt(2)
  v_accvgpr_read_b32 v246, a132
  v_accvgpr_read_b32 v247, a133
  v_mfma_f32_16x16x32_bf16 v[48:51], v[88:91], a[0:3], 0
  v_accvgpr_read_b32 v156, a135
  v_mul_f32 v246, v13, v246
  v_mfma_f32_16x16x32_bf16 v[48:51], v[92:95], a[4:7], v[48:51]
  v_mul_f32 v247, v13, v247
  v_mul_f32 v156, v13, v156
  v_cvt_pk_bf16_f32 v246, v246, v247
  v_mfma_f32_16x16x32_bf16 v[56:59], v[88:91], a[24:27], 0
  v_accvgpr_read_b32 v247, a134
  v_mul_f32 v247, v13, v247
  v_mfma_f32_16x16x32_bf16 v[56:59], v[92:95], a[28:31], v[56:59]
  v_cvt_pk_bf16_f32 v247, v247, v156
  v_accvgpr_read_b32 v248, a112
  v_mfma_f32_16x16x32_bf16 v[48:51], v[96:99], a[8:11], v[48:51]
  v_accvgpr_read_b32 v249, a113
  v_accvgpr_read_b32 v250, a114
  v_accvgpr_read_b32 v251, a115
  v_mfma_f32_16x16x32_bf16 v[48:51], v[100:103], a[12:15], v[48:51]
  v_mul_f32 v248, v14, v248
  v_mul_f32 v249, v14, v249
  v_mfma_f32_16x16x32_bf16 v[56:59], v[96:99], a[32:35], v[56:59]
  v_mul_f32 v250, v14, v250
  v_mul_f32 v251, v14, v251
  v_mfma_f32_16x16x32_bf16 v[56:59], v[100:103], a[36:39], v[56:59]
  v_cvt_pk_bf16_f32 v248, v248, v249
  v_cvt_pk_bf16_f32 v249, v250, v251
  v_accvgpr_read_b32 v250, a116
  v_mfma_f32_16x16x32_bf16 v[48:51], v[104:107], a[16:19], v[48:51]
  s_waitcnt lgkmcnt(0)
  v_accvgpr_read_b32 v251, a117
  v_accvgpr_read_b32 v252, a118
  v_mfma_f32_16x16x32_bf16 v[48:51], v[108:111], a[20:23], v[48:51]
  v_accvgpr_read_b32 v253, a119
  v_mul_f32 v250, v15, v250
  v_mfma_f32_16x16x32_bf16 v[56:59], v[104:107], a[40:43], v[56:59]
  v_mul_f32 v251, v15, v251
  v_mul_f32 v252, v15, v252
  v_mul_f32 v253, v15, v253
  v_mfma_f32_16x16x32_bf16 v[56:59], v[108:111], a[44:47], v[56:59]
  s_waitcnt vmcnt(6)
  s_barrier
  ds_read_b128 a[240:243], v0 offset:12288
  v_mfma_f32_16x16x32_bf16 v[52:55], v[64:67], a[0:3], 0
  ds_read_b128 a[244:247], v1 offset:12288
  v_cvt_pk_bf16_f32 v250, v250, v251
  v_mfma_f32_16x16x32_bf16 v[52:55], v[68:71], a[4:7], v[52:55]
  v_cvt_pk_bf16_f32 v251, v252, v253
  v_accvgpr_read_b32 v252, a136
  v_accvgpr_read_b32 v253, a137
  v_mfma_f32_16x16x32_bf16 v[60:63], v[64:67], a[24:27], 0
  v_accvgpr_read_b32 v254, a138
  v_accvgpr_read_b32 v255, a139
  v_mfma_f32_16x16x32_bf16 v[60:63], v[68:71], a[28:31], v[60:63]
  v_mul_f32 v252, v14, v252
  v_mul_f32 v253, v14, v253
  v_mfma_f32_16x16x32_bf16 v[52:55], v[72:75], a[8:11], v[52:55]
  s_add_u32 m0, s32, 0
  v_mul_f32 v254, v14, v254
  v_mul_f32 v255, v14, v255
  v_mfma_f32_16x16x32_bf16 v[52:55], v[76:79], a[12:15], v[52:55]
  s_add_u32 s40, s37, 49152
  v_cvt_pk_bf16_f32 v252, v252, v253
  v_cvt_pk_bf16_f32 v253, v254, v255
  v_mfma_f32_16x16x32_bf16 v[60:63], v[72:75], a[32:35], v[60:63]
  buffer_load_dwordx4 v4, s[16:19], s40 offen nt lds
  v_accvgpr_read_b32 v254, a140
  v_mfma_f32_16x16x32_bf16 v[60:63], v[76:79], a[36:39], v[60:63]
  buffer_load_dwordx4 v5, s[16:19], s40 offen offset:1024 nt lds
  v_mfma_f32_16x16x32_bf16 v[52:55], v[80:83], a[16:19], v[52:55]
  buffer_load_dwordx4 v6, s[16:19], s40 offen offset:2048 nt lds
  v_mfma_f32_16x16x32_bf16 v[52:55], v[84:87], a[20:23], v[52:55]
  v_accvgpr_read_b32 v255, a141
  v_accvgpr_read_b32 v156, a143
  v_mul_f32 v254, v15, v254
  v_mfma_f32_16x16x32_bf16 v[60:63], v[80:83], a[40:43], v[60:63]
  v_mul_f32 v255, v15, v255
  v_mul_f32 v156, v15, v156
  v_mfma_f32_16x16x32_bf16 v[60:63], v[84:87], a[44:47], v[60:63]
  s_waitcnt lgkmcnt(0)
  v_cvt_pk_bf16_f32 v254, v254, v255
  v_accvgpr_read_b32 v255, a142
  v_mfma_f32_16x16x32_bf16 v[64:67], a[240:243], a[144:147], 0
  ds_read_b128 a[248:251], v0 offset:12416
  v_mul_f32 v255, v15, v255
  v_cvt_pk_bf16_f32 v255, v255, v156
  v_mfma_f32_16x16x32_bf16 v[64:67], a[244:247], a[148:151], v[64:67]
  ds_read_b128 a[252:255], v1 offset:12416
  v_mov_b32 v12, v4
  v_mfma_f32_16x16x32_bf16 v[72:75], a[240:243], a[168:171], 0
  v_mov_b32 v13, v5
  v_mov_b32 v14, v6
  v_mov_b32 v15, v9
  v_mfma_f32_16x16x32_bf16 v[72:75], a[244:247], a[172:175], v[72:75]
  v_mov_b32 v10, v7
  v_mov_b32 v11, v8
  v_mfma_f32_16x16x32_bf16 v[80:83], a[240:243], a[192:195], 0
  v_max3_f32 v4, v16, v17, v18
  v_max3_f32 v4, v4, v19, v20
  v_max3_f32 v4, v4, v21, v22
  v_max_f32 v4, v4, v23
  v_mfma_f32_16x16x32_bf16 v[80:83], a[244:247], a[196:199], v[80:83]
  v_max3_f32 v5, v24, v25, v26
  v_max3_f32 v5, v5, v27, v28
  v_max3_f32 v5, v5, v29, v30
  v_max_f32 v5, v5, v31
  v_mfma_f32_16x16x32_bf16 v[88:91], a[240:243], a[216:219], 0
  v_max3_f32 v6, v32, v33, v34
  v_max3_f32 v6, v6, v35, v36
  v_max3_f32 v6, v6, v37, v38
  v_max_f32 v6, v6, v39
  v_max3_f32 v7, v40, v41, v42
  v_mfma_f32_16x16x32_bf16 v[88:91], a[244:247], a[220:223], v[88:91]
  v_max3_f32 v7, v7, v43, v44
  v_max3_f32 v7, v7, v45, v46
  v_max_f32 v7, v7, v47
  v_max3_f32 v8, v48, v49, v50
  v_mfma_f32_16x16x32_bf16 v[96:99], a[240:243], a[0:3], 0
  v_max3_f32 v8, v8, v51, v52
  v_max3_f32 v8, v8, v53, v54
  v_max_f32 v8, v8, v55
  v_max3_f32 v9, v56, v57, v58
  v_mfma_f32_16x16x32_bf16 v[96:99], a[244:247], a[4:7], v[96:99]
  v_max3_f32 v9, v9, v59, v60
  v_max3_f32 v9, v9, v61, v62
  v_max_f32 v9, v9, v63
  v_mov_b32 v148, v4
  v_mfma_f32_16x16x32_bf16 v[104:107], a[240:243], a[24:27], 0
  v_mov_b32 v149, v5
  v_mov_b32 v150, v6
  v_mov_b32 v151, v7
  v_mov_b32 v152, v8
  v_mfma_f32_16x16x32_bf16 v[104:107], a[244:247], a[28:31], v[104:107]
  s_waitcnt lgkmcnt(0)
  v_mov_b32 v153, v9
  v_permlane32_swap_b32 v4, v148
  v_permlane32_swap_b32 v5, v149
  v_permlane32_swap_b32 v6, v150
  v_mfma_f32_16x16x32_bf16 v[64:67], a[248:251], a[152:155], v[64:67]
  ds_read_b128 a[240:243], v0 offset:12544
  v_permlane32_swap_b32 v7, v151
  v_permlane32_swap_b32 v8, v152
  v_permlane32_swap_b32 v9, v153
  v_max_f32 v4, v4, v148
  v_mfma_f32_16x16x32_bf16 v[64:67], a[252:255], a[156:159], v[64:67]
  ds_read_b128 a[244:247], v1 offset:12544
  v_max_f32 v5, v5, v149
  v_max_f32 v6, v6, v150
  v_max_f32 v7, v7, v151
  v_mfma_f32_16x16x32_bf16 v[72:75], a[248:251], a[176:179], v[72:75]
  v_max_f32 v8, v8, v152
  v_max_f32 v9, v9, v153
  v_mov_b32 v148, v4
  v_mov_b32 v149, v5
  v_mfma_f32_16x16x32_bf16 v[72:75], a[252:255], a[180:183], v[72:75]
  v_mov_b32 v150, v6
  v_mov_b32 v151, v7
  v_mov_b32 v152, v8
  v_mov_b32 v153, v9
  v_mfma_f32_16x16x32_bf16 v[80:83], a[248:251], a[200:203], v[80:83]
  v_permlane16_swap_b32 v4, v148
  v_permlane16_swap_b32 v5, v149
  v_permlane16_swap_b32 v6, v150
  v_permlane16_swap_b32 v7, v151
  v_mfma_f32_16x16x32_bf16 v[80:83], a[252:255], a[204:207], v[80:83]
  v_permlane16_swap_b32 v8, v152
  v_permlane16_swap_b32 v9, v153
  v_max_f32 v4, v4, v148
  v_max_f32 v5, v5, v149
  v_mfma_f32_16x16x32_bf16 v[88:91], a[248:251], a[224:227], v[88:91]
  v_max_f32 v6, v6, v150
  v_max_f32 v7, v7, v151
  v_max_f32 v8, v8, v152
  v_max_f32 v9, v9, v153
  v_mul_f32 v4, s30, v4
  v_mfma_f32_16x16x32_bf16 v[88:91], a[252:255], a[228:231], v[88:91]
  v_mul_f32 v5, s30, v5
  v_mul_f32 v6, s30, v6
  v_mul_f32 v7, s30, v7
  v_mul_f32 v8, s30, v8
  v_mfma_f32_16x16x32_bf16 v[96:99], a[248:251], a[8:11], v[96:99]
  v_mul_f32 v9, s30, v9
  v_ceil_f32 v4, v4
  v_ceil_f32 v5, v5
  v_ceil_f32 v6, v6
  v_mfma_f32_16x16x32_bf16 v[96:99], a[252:255], a[12:15], v[96:99]
  v_ceil_f32 v7, v7
  v_ceil_f32 v8, v8
  v_ceil_f32 v9, v9
  v_fma_f32 v16, v16, s30, -v4
  v_mfma_f32_16x16x32_bf16 v[104:107], a[248:251], a[32:35], v[104:107]
  v_fma_f32 v17, v17, s30, -v4
  v_fma_f32 v18, v18, s30, -v4
  v_fma_f32 v19, v19, s30, -v4
  v_fma_f32 v20, v20, s30, -v4
  v_mfma_f32_16x16x32_bf16 v[104:107], a[252:255], a[36:39], v[104:107]
  s_waitcnt lgkmcnt(0)
  v_fma_f32 v21, v21, s30, -v4
  v_fma_f32 v22, v22, s30, -v4
  v_fma_f32 v23, v23, s30, -v4
  v_fma_f32 v24, v24, s30, -v5
  v_mfma_f32_16x16x32_bf16 v[64:67], a[240:243], a[160:163], v[64:67]
  ds_read_b128 a[248:251], v0 offset:18432
  v_fma_f32 v25, v25, s30, -v5
  v_fma_f32 v26, v26, s30, -v5
  v_fma_f32 v27, v27, s30, -v5
  v_fma_f32 v28, v28, s30, -v5
  v_mfma_f32_16x16x32_bf16 v[64:67], a[244:247], a[164:167], v[64:67]
  ds_read_b128 a[252:255], v1 offset:18432
  v_fma_f32 v29, v29, s30, -v5
  v_fma_f32 v30, v30, s30, -v5
  v_fma_f32 v31, v31, s30, -v5
  v_mfma_f32_16x16x32_bf16 v[72:75], a[240:243], a[184:187], v[72:75]
  v_fma_f32 v32, v32, s30, -v6
  v_fma_f32 v33, v33, s30, -v6
  v_fma_f32 v34, v34, s30, -v6
  v_fma_f32 v35, v35, s30, -v6
  v_mfma_f32_16x16x32_bf16 v[72:75], a[244:247], a[188:191], v[72:75]
  v_fma_f32 v36, v36, s30, -v6
  v_fma_f32 v37, v37, s30, -v6
  v_fma_f32 v38, v38, s30, -v6
  v_fma_f32 v39, v39, s30, -v6
  v_mfma_f32_16x16x32_bf16 v[80:83], a[240:243], a[208:211], v[80:83]
  v_fma_f32 v40, v40, s30, -v7
  v_fma_f32 v41, v41, s30, -v7
  v_fma_f32 v42, v42, s30, -v7
  v_fma_f32 v43, v43, s30, -v7
  v_mfma_f32_16x16x32_bf16 v[80:83], a[244:247], a[212:215], v[80:83]
  v_fma_f32 v44, v44, s30, -v7
  v_fma_f32 v45, v45, s30, -v7
  v_fma_f32 v46, v46, s30, -v7
  v_fma_f32 v47, v47, s30, -v7
  v_fma_f32 v48, v48, s30, -v8
  v_mfma_f32_16x16x32_bf16 v[88:91], a[240:243], a[232:235], v[88:91]
  v_fma_f32 v49, v49, s30, -v8
  v_fma_f32 v50, v50, s30, -v8
  v_fma_f32 v51, v51, s30, -v8
  v_fma_f32 v52, v52, s30, -v8
  v_mfma_f32_16x16x32_bf16 v[88:91], a[244:247], a[236:239], v[88:91]
  v_fma_f32 v53, v53, s30, -v8
  v_fma_f32 v54, v54, s30, -v8
  v_fma_f32 v55, v55, s30, -v8
  v_fma_f32 v56, v56, s30, -v9
  v_mfma_f32_16x16x32_bf16 v[96:99], a[240:243], a[16:19], v[96:99]
  v_fma_f32 v57, v57, s30, -v9
  v_fma_f32 v58, v58, s30, -v9
  v_fma_f32 v59, v59, s30, -v9
  v_fma_f32 v60, v60, s30, -v9
  v_mfma_f32_16x16x32_bf16 v[96:99], a[244:247], a[20:23], v[96:99]
  v_fma_f32 v61, v61, s30, -v9
  v_fma_f32 v62, v62, s30, -v9
  v_fma_f32 v63, v63, s30, -v9
  v_exp_f32 v16, v16
  v_mfma_f32_16x16x32_bf16 v[104:107], a[240:243], a[40:43], v[104:107]
  v_exp_f32 v17, v17
  v_exp_f32 v18, v18
  v_mfma_f32_16x16x32_bf16 v[104:107], a[244:247], a[44:47], v[104:107]
  s_waitcnt lgkmcnt(0)
  v_exp_f32 v19, v19
  v_exp_f32 v20, v20
  v_mfma_f32_16x16x32_bf16 v[68:71], a[248:251], a[144:147], 0
  ds_read_b128 a[240:243], v0 offset:18560
  v_cvt_pk_bf16_f32 v16, v16, v17
  v_exp_f32 v21, v21
  v_mfma_f32_16x16x32_bf16 v[68:71], a[252:255], a[148:151], v[68:71]
  ds_read_b128 a[244:247], v1 offset:18560
  v_accvgpr_write_b32 a48, v16
  v_exp_f32 v22, v22
  v_mfma_f32_16x16x32_bf16 v[76:79], a[248:251], a[168:171], 0
  ds_write_b64 v10, v[208:209] offset:0
  v_cvt_pk_bf16_f32 v18, v18, v19
  v_exp_f32 v23, v23
  v_mfma_f32_16x16x32_bf16 v[76:79], a[252:255], a[172:175], v[76:79]
  v_accvgpr_write_b32 a49, v18
  v_exp_f32 v24, v24
  v_cvt_pk_bf16_f32 v20, v20, v21
  v_mfma_f32_16x16x32_bf16 v[84:87], a[248:251], a[192:195], 0
  ds_write_b64 v10, v[210:211] offset:2048
  v_exp_f32 v25, v25
  v_accvgpr_write_b32 a50, v20
  v_mfma_f32_16x16x32_bf16 v[84:87], a[252:255], a[196:199], v[84:87]
  v_exp_f32 v26, v26
  v_cvt_pk_bf16_f32 v22, v22, v23
  v_exp_f32 v27, v27
  v_mfma_f32_16x16x32_bf16 v[92:95], a[248:251], a[216:219], 0
  v_xor_b32 v10, 32, v10
  v_accvgpr_write_b32 a51, v22
  v_exp_f32 v28, v28
  v_mfma_f32_16x16x32_bf16 v[92:95], a[252:255], a[220:223], v[92:95]
  v_cvt_pk_bf16_f32 v24, v24, v25
  v_exp_f32 v29, v29
  v_accvgpr_write_b32 a52, v24
  v_mfma_f32_16x16x32_bf16 v[100:103], a[248:251], a[0:3], 0
  ds_write_b64 v10, v[212:213] offset:0
  v_exp_f32 v30, v30
  v_mfma_f32_16x16x32_bf16 v[100:103], a[252:255], a[4:7], v[100:103]
  v_cvt_pk_bf16_f32 v26, v26, v27
  v_exp_f32 v31, v31
  v_accvgpr_write_b32 a53, v26
  v_mfma_f32_16x16x32_bf16 v[108:111], a[248:251], a[24:27], 0
  ds_write_b64 v10, v[214:215] offset:2048
  v_exp_f32 v32, v32
  v_cvt_pk_bf16_f32 v28, v28, v29
  v_mfma_f32_16x16x32_bf16 v[108:111], a[252:255], a[28:31], v[108:111]
  s_waitcnt lgkmcnt(4)
  v_exp_f32 v33, v33
  v_accvgpr_write_b32 a54, v28
  v_exp_f32 v34, v34
  v_mfma_f32_16x16x32_bf16 v[68:71], a[240:243], a[152:155], v[68:71]
  ds_read_b128 a[248:251], v0 offset:18688
  v_xor_b32 v10, 96, v10
  v_cvt_pk_bf16_f32 v30, v30, v31
  v_mfma_f32_16x16x32_bf16 v[68:71], a[244:247], a[156:159], v[68:71]
  ds_read_b128 a[252:255], v1 offset:18688
  v_exp_f32 v35, v35
  v_accvgpr_write_b32 a55, v30
  v_mfma_f32_16x16x32_bf16 v[76:79], a[240:243], a[176:179], v[76:79]
  ds_write_b64 v10, v[232:233] offset:0
  v_exp_f32 v36, v36
  v_cvt_pk_bf16_f32 v32, v32, v33
  v_mfma_f32_16x16x32_bf16 v[76:79], a[244:247], a[180:183], v[76:79]
  v_exp_f32 v37, v37
  v_accvgpr_write_b32 a56, v32
  v_exp_f32 v38, v38
  v_mfma_f32_16x16x32_bf16 v[84:87], a[240:243], a[200:203], v[84:87]
  ds_write_b64 v10, v[234:235] offset:2048
  v_cvt_pk_bf16_f32 v34, v34, v35
  v_exp_f32 v39, v39
  v_mfma_f32_16x16x32_bf16 v[84:87], a[244:247], a[204:207], v[84:87]
  v_accvgpr_write_b32 a57, v34
  v_exp_f32 v40, v40
  v_cvt_pk_bf16_f32 v36, v36, v37
  v_mfma_f32_16x16x32_bf16 v[92:95], a[240:243], a[224:227], v[92:95]
  v_xor_b32 v10, 32, v10
  v_exp_f32 v41, v41
  v_accvgpr_write_b32 a58, v36
  v_mfma_f32_16x16x32_bf16 v[92:95], a[244:247], a[228:231], v[92:95]
  v_exp_f32 v42, v42
  v_cvt_pk_bf16_f32 v38, v38, v39
  v_exp_f32 v43, v43
  v_mfma_f32_16x16x32_bf16 v[100:103], a[240:243], a[8:11], v[100:103]
  ds_write_b64 v10, v[236:237] offset:0
  v_accvgpr_write_b32 a59, v38
  v_exp_f32 v44, v44
  v_mfma_f32_16x16x32_bf16 v[100:103], a[244:247], a[12:15], v[100:103]
  v_cvt_pk_bf16_f32 v40, v40, v41
  v_exp_f32 v45, v45
  v_mfma_f32_16x16x32_bf16 v[108:111], a[240:243], a[32:35], v[108:111]
  ds_write_b64 v10, v[238:239] offset:2048
  v_accvgpr_write_b32 a60, v40
  v_exp_f32 v46, v46
  v_mfma_f32_16x16x32_bf16 v[108:111], a[244:247], a[36:39], v[108:111]
  s_waitcnt lgkmcnt(4)
  ds_read_b128 a[240:243], v0 offset:24576
  v_cvt_pk_bf16_f32 v42, v42, v43
  v_exp_f32 v47, v47
  v_mfma_f32_16x16x32_bf16 v[68:71], a[248:251], a[160:163], v[68:71]
  ds_read_b128 a[244:247], v1 offset:24576
  v_xor_b32 v10, 96, v10
  v_accvgpr_write_b32 a61, v42
  v_exp_f32 v48, v48
  v_mfma_f32_16x16x32_bf16 v[68:71], a[252:255], a[164:167], v[68:71]
  v_cvt_pk_bf16_f32 v44, v44, v45
  v_exp_f32 v49, v49
  v_accvgpr_write_b32 a62, v44
  v_mfma_f32_16x16x32_bf16 v[76:79], a[248:251], a[184:187], v[76:79]
  ds_read_b128 v[208:211], v11 offset:0
  v_exp_f32 v50, v50
  v_cvt_pk_bf16_f32 v46, v46, v47
  v_mfma_f32_16x16x32_bf16 v[76:79], a[252:255], a[188:191], v[76:79]
  v_exp_f32 v51, v51
  v_accvgpr_write_b32 a63, v46
  v_exp_f32 v52, v52
  v_mfma_f32_16x16x32_bf16 v[84:87], a[248:251], a[208:211], v[84:87]
  s_add_u32 m0, s32, 12288
  ds_read_b128 v[212:215], v11 offset:1024
  v_cvt_pk_bf16_f32 v48, v48, v49
  v_mfma_f32_16x16x32_bf16 v[84:87], a[252:255], a[212:215], v[84:87]
  s_add_u32 s40, s37, 61440
  v_exp_f32 v53, v53
  v_accvgpr_write_b32 a64, v48
  v_exp_f32 v54, v54
  v_mfma_f32_16x16x32_bf16 v[92:95], a[248:251], a[232:235], v[92:95]
  buffer_load_dwordx4 v12, s[16:19], s40 offen nt lds
  ds_read_b128 v[232:235], v11 offset:2048
  v_cvt_pk_bf16_f32 v50, v50, v51
  v_mfma_f32_16x16x32_bf16 v[92:95], a[252:255], a[236:239], v[92:95]
  buffer_load_dwordx4 v13, s[16:19], s40 offen offset:1024 nt lds
  v_exp_f32 v55, v55
  v_mfma_f32_16x16x32_bf16 v[100:103], a[248:251], a[16:19], v[100:103]
  buffer_load_dwordx4 v14, s[16:19], s40 offen offset:2048 nt lds
  ds_read_b128 v[236:239], v11 offset:3072
  v_accvgpr_write_b32 a65, v50
  v_mfma_f32_16x16x32_bf16 v[100:103], a[252:255], a[20:23], v[100:103]
  v_exp_f32 v56, v56
  v_cvt_pk_bf16_f32 v52, v52, v53
  v_exp_f32 v57, v57
  v_mfma_f32_16x16x32_bf16 v[108:111], a[248:251], a[40:43], v[108:111]
  v_accvgpr_write_b32 a66, v52
  v_exp_f32 v58, v58
  v_cvt_pk_bf16_f32 v54, v54, v55
  v_mfma_f32_16x16x32_bf16 v[108:111], a[252:255], a[44:47], v[108:111]
  s_waitcnt lgkmcnt(4)
  v_exp_f32 v59, v59
  v_accvgpr_write_b32 a67, v54
  v_exp_f32 v60, v60
  v_mfma_f32_16x16x32_bf16 v[16:19], a[240:243], a[144:147], 0
  ds_read_b128 a[248:251], v0 offset:24704
  v_cvt_pk_bf16_f32 v56, v56, v57
  v_exp_f32 v61, v61
  v_mfma_f32_16x16x32_bf16 v[16:19], a[244:247], a[148:151], v[16:19]
  ds_read_b128 a[252:255], v1 offset:24704
  v_accvgpr_write_b32 a68, v56
  v_exp_f32 v62, v62
  v_mfma_f32_16x16x32_bf16 v[24:27], a[240:243], a[168:171], 0
  v_cvt_pk_bf16_f32 v58, v58, v59
  v_exp_f32 v63, v63
  v_accvgpr_write_b32 a69, v58
  v_mfma_f32_16x16x32_bf16 v[24:27], a[244:247], a[172:175], v[24:27]
  v_cvt_pk_bf16_f32 v60, v60, v61
  v_accvgpr_write_b32 a70, v60
  v_cvt_pk_bf16_f32 v62, v62, v63
  v_accvgpr_write_b32 a71, v62
  v_mfma_f32_16x16x32_bf16 v[32:35], a[240:243], a[192:195], 0
  v_fma_f32 v64, v64, s30, -v4
  v_fma_f32 v65, v65, s30, -v4
  v_fma_f32 v66, v66, s30, -v4
  v_mfma_f32_16x16x32_bf16 v[32:35], a[244:247], a[196:199], v[32:35]
  v_max_f32 v3, v64, v65
  v_fma_f32 v67, v67, s30, -v4
  v_fma_f32 v68, v68, s30, -v4
  v_max3_f32 v3, v3, v66, v67
  v_mfma_f32_16x16x32_bf16 v[40:43], a[240:243], a[216:219], 0
  s_add_u32 s46, s34, 256
  s_waitcnt lgkmcnt(5)
  buffer_store_dwordx4 v[208:211], v15, s[24:27], s46 offen sc1
  v_mfma_f32_16x16x32_bf16 v[40:43], a[244:247], a[220:223], v[40:43]
  v_fma_f32 v69, v69, s30, -v4
  v_fma_f32 v70, v70, s30, -v4
  v_max3_f32 v3, v3, v68, v69
  v_mfma_f32_16x16x32_bf16 v[48:51], a[240:243], a[0:3], 0
  v_fma_f32 v71, v71, s30, -v4
  v_fma_f32 v72, v72, s30, -v5
  v_max3_f32 v3, v3, v70, v71
  v_fma_f32 v73, v73, s30, -v5
  v_mfma_f32_16x16x32_bf16 v[48:51], a[244:247], a[4:7], v[48:51]
  v_fma_f32 v74, v74, s30, -v5
  v_max3_f32 v3, v3, v72, v73
  v_fma_f32 v75, v75, s30, -v5
  v_mfma_f32_16x16x32_bf16 v[56:59], a[240:243], a[24:27], 0
  v_fma_f32 v76, v76, s30, -v5
  v_max3_f32 v3, v3, v74, v75
  v_fma_f32 v77, v77, s30, -v5
  v_mfma_f32_16x16x32_bf16 v[56:59], a[244:247], a[28:31], v[56:59]
  s_waitcnt lgkmcnt(0)
  v_fma_f32 v78, v78, s30, -v5
  v_max3_f32 v3, v3, v76, v77
  v_fma_f32 v79, v79, s30, -v5
  v_fma_f32 v80, v80, s30, -v6
  v_mfma_f32_16x16x32_bf16 v[16:19], a[248:251], a[152:155], v[16:19]
  ds_read_b128 a[240:243], v0 offset:24832
  v_max3_f32 v3, v3, v78, v79
  v_fma_f32 v81, v81, s30, -v6
  v_mfma_f32_16x16x32_bf16 v[16:19], a[252:255], a[156:159], v[16:19]
  ds_read_b128 a[244:247], v1 offset:24832
  v_fma_f32 v82, v82, s30, -v6
  v_max3_f32 v3, v3, v80, v81
  v_fma_f32 v83, v83, s30, -v6
  v_mfma_f32_16x16x32_bf16 v[24:27], a[248:251], a[176:179], v[24:27]
  v_fma_f32 v84, v84, s30, -v6
  v_max3_f32 v3, v3, v82, v83
  v_fma_f32 v85, v85, s30, -v6
  v_mfma_f32_16x16x32_bf16 v[24:27], a[252:255], a[180:183], v[24:27]
  v_fma_f32 v86, v86, s30, -v6
  v_max3_f32 v3, v3, v84, v85
  v_fma_f32 v87, v87, s30, -v6
  v_fma_f32 v88, v88, s30, -v7
  v_mfma_f32_16x16x32_bf16 v[32:35], a[248:251], a[200:203], v[32:35]
  v_max3_f32 v3, v3, v86, v87
  v_fma_f32 v89, v89, s30, -v7
  v_fma_f32 v90, v90, s30, -v7
  v_mfma_f32_16x16x32_bf16 v[32:35], a[252:255], a[204:207], v[32:35]
  v_max3_f32 v3, v3, v88, v89
  v_fma_f32 v91, v91, s30, -v7
  v_fma_f32 v92, v92, s30, -v7
  v_mfma_f32_16x16x32_bf16 v[40:43], a[248:251], a[224:227], v[40:43]
  v_max3_f32 v3, v3, v90, v91
  v_fma_f32 v93, v93, s30, -v7
  v_fma_f32 v94, v94, s30, -v7
  v_max3_f32 v3, v3, v92, v93
  v_mfma_f32_16x16x32_bf16 v[40:43], a[252:255], a[228:231], v[40:43]
  v_fma_f32 v95, v95, s30, -v7
  v_fma_f32 v96, v96, s30, -v8
  v_max3_f32 v3, v3, v94, v95
  v_mfma_f32_16x16x32_bf16 v[48:51], a[248:251], a[8:11], v[48:51]
  v_fma_f32 v97, v97, s30, -v8
  v_fma_f32 v98, v98, s30, -v8
  v_max3_f32 v3, v3, v96, v97
  v_fma_f32 v99, v99, s30, -v8
  v_mfma_f32_16x16x32_bf16 v[48:51], a[252:255], a[12:15], v[48:51]
  v_fma_f32 v100, v100, s30, -v8
  v_max3_f32 v3, v3, v98, v99
  v_fma_f32 v101, v101, s30, -v8
  v_mfma_f32_16x16x32_bf16 v[56:59], a[248:251], a[32:35], v[56:59]
  v_fma_f32 v102, v102, s30, -v8
  v_max3_f32 v3, v3, v100, v101
  v_fma_f32 v103, v103, s30, -v8
  v_mfma_f32_16x16x32_bf16 v[56:59], a[252:255], a[36:39], v[56:59]
  s_waitcnt lgkmcnt(0)
  v_fma_f32 v104, v104, s30, -v9
  v_max3_f32 v3, v3, v102, v103
  v_fma_f32 v105, v105, s30, -v9
  v_fma_f32 v106, v106, s30, -v9
  v_mfma_f32_16x16x32_bf16 v[16:19], a[240:243], a[160:163], v[16:19]
L_pad_10:
  s_cbranch_execz L_padret
  ds_read_b128 a[248:251], v0 offset:30720
  v_max3_f32 v3, v3, v104, v105
  v_fma_f32 v107, v107, s30, -v9
  v_mfma_f32_16x16x32_bf16 v[16:19], a[244:247], a[164:167], v[16:19]
  ds_read_b128 a[252:255], v1 offset:30720
  v_fma_f32 v108, v108, s30, -v9
  v_max3_f32 v3, v3, v106, v107
  v_fma_f32 v109, v109, s30, -v9
  v_mfma_f32_16x16x32_bf16 v[24:27], a[240:243], a[184:187], v[24:27]
  v_fma_f32 v110, v110, s30, -v9
  v_max3_f32 v3, v3, v108, v109
  v_fma_f32 v111, v111, s30, -v9
  v_mfma_f32_16x16x32_bf16 v[24:27], a[244:247], a[188:191], v[24:27]
  v_max3_f32 v3, v3, v110, v111
  v_cmp_lt_f32 vcc, s31, v3
  v_mfma_f32_16x16x32_bf16 v[32:35], a[240:243], a[208:211], v[32:35]
  s_cbranch_vccnz L_slow_1_1
L_back_1_1:
  v_exp_f32 v64, v64
  v_exp_f32 v65, v65
  v_mfma_f32_16x16x32_bf16 v[32:35], a[244:247], a[212:215], v[32:35]
  v_exp_f32 v66, v66
  v_exp_f32 v67, v67
  v_mfma_f32_16x16x32_bf16 v[40:43], a[240:243], a[232:235], v[40:43]
  v_exp_f32 v68, v68
  v_cvt_pk_bf16_f32 v64, v64, v65
  v_mfma_f32_16x16x32_bf16 v[40:43], a[244:247], a[236:239], v[40:43]
  v_exp_f32 v69, v69
  v_accvgpr_write_b32 a72, v64
  v_mfma_f32_16x16x32_bf16 v[48:51], a[240:243], a[16:19], v[48:51]
  v_exp_f32 v70, v70
  v_cvt_pk_bf16_f32 v66, v66, v67
  v_mfma_f32_16x16x32_bf16 v[48:51], a[244:247], a[20:23], v[48:51]
  v_exp_f32 v71, v71
  v_accvgpr_write_b32 a73, v66
  v_exp_f32 v72, v72
  v_mfma_f32_16x16x32_bf16 v[56:59], a[240:243], a[40:43], v[56:59]
  v_cvt_pk_bf16_f32 v68, v68, v69
  v_exp_f32 v73, v73
  v_mfma_f32_16x16x32_bf16 v[56:59], a[244:247], a[44:47], v[56:59]
  s_waitcnt lgkmcnt(0)
  v_accvgpr_write_b32 a74, v68
  v_exp_f32 v74, v74
  v_mfma_f32_16x16x32_bf16 v[20:23], a[248:251], a[144:147], 0
  ds_read_b128 a[240:243], v0 offset:30848
  buffer_store_dwordx4 v[212:215], v15, s[24:27], s46 offen offset:3072 sc1
  v_mfma_f32_16x16x32_bf16 v[20:23], a[252:255], a[148:151], v[20:23]
  ds_read_b128 a[244:247], v1 offset:30848
  v_cvt_pk_bf16_f32 v70, v70, v71
  v_exp_f32 v75, v75
  v_mfma_f32_16x16x32_bf16 v[28:31], a[248:251], a[168:171], 0
  v_accvgpr_write_b32 a75, v70
  v_exp_f32 v76, v76
  v_mfma_f32_16x16x32_bf16 v[28:31], a[252:255], a[172:175], v[28:31]
  v_cvt_pk_bf16_f32 v72, v72, v73
  v_exp_f32 v77, v77
  v_mfma_f32_16x16x32_bf16 v[36:39], a[248:251], a[192:195], 0
  v_accvgpr_write_b32 a76, v72
  v_exp_f32 v78, v78
  v_cvt_pk_bf16_f32 v74, v74, v75
  v_mfma_f32_16x16x32_bf16 v[36:39], a[252:255], a[196:199], v[36:39]
  v_exp_f32 v79, v79
  v_accvgpr_write_b32 a77, v74
  v_mfma_f32_16x16x32_bf16 v[44:47], a[248:251], a[216:219], 0
  v_exp_f32 v80, v80
  v_cvt_pk_bf16_f32 v76, v76, v77
  v_mfma_f32_16x16x32_bf16 v[44:47], a[252:255], a[220:223], v[44:47]
  v_exp_f32 v81, v81
  v_accvgpr_write_b32 a78, v76
  v_mfma_f32_16x16x32_bf16 v[52:55], a[248:251], a[0:3], 0
  v_exp_f32 v82, v82
  v_cvt_pk_bf16_f32 v78, v78, v79
  v_exp_f32 v83, v83
  v_mfma_f32_16x16x32_bf16 v[52:55], a[252:255], a[4:7], v[52:55]
  v_accvgpr_write_b32 a79, v78
  v_exp_f32 v84, v84
  v_mfma_f32_16x16x32_bf16 v[60:63], a[248:251], a[24:27], 0
  v_cvt_pk_bf16_f32 v80, v80, v81
  v_exp_f32 v85, v85
  v_mfma_f32_16x16x32_bf16 v[60:63], a[252:255], a[28:31], v[60:63]
  s_waitcnt lgkmcnt(0)
  v_accvgpr_write_b32 a80, v80
  v_exp_f32 v86, v86
  v_cvt_pk_bf16_f32 v82, v82, v83
  v_mfma_f32_16x16x32_bf16 v[20:23], a[240:243], a[152:155], v[20:23]
  ds_read_b128 a[248:251], v0 offset:30976
  v_exp_f32 v87, v87
  v_mfma_f32_16x16x32_bf16 v[20:23], a[244:247], a[156:159], v[20:23]
  ds_read_b128 a[252:255], v1 offset:30976
  v_accvgpr_write_b32 a81, v82
  v_exp_f32 v88, v88
  v_mfma_f32_16x16x32_bf16 v[28:31], a[240:243], a[176:179], v[28:31]
  v_cvt_pk_bf16_f32 v84, v84, v85
  v_exp_f32 v89, v89
  v_mfma_f32_16x16x32_bf16 v[28:31], a[244:247], a[180:183], v[28:31]
  v_accvgpr_write_b32 a82, v84
  v_exp_f32 v90, v90
  v_mfma_f32_16x16x32_bf16 v[36:39], a[240:243], a[200:203], v[36:39]
  v_cvt_pk_bf16_f32 v86, v86, v87
  v_exp_f32 v91, v91
  v_accvgpr_write_b32 a83, v86
  v_mfma_f32_16x16x32_bf16 v[36:39], a[244:247], a[204:207], v[36:39]
  v_exp_f32 v92, v92
  v_cvt_pk_bf16_f32 v88, v88, v89
  v_mfma_f32_16x16x32_bf16 v[44:47], a[240:243], a[224:227], v[44:47]
  v_exp_f32 v93, v93
  v_accvgpr_write_b32 a84, v88
  v_mfma_f32_16x16x32_bf16 v[44:47], a[244:247], a[228:231], v[44:47]
  v_exp_f32 v94, v94
  v_cvt_pk_bf16_f32 v90, v90, v91
  v_exp_f32 v95, v95
  v_mfma_f32_16x16x32_bf16 v[52:55], a[240:243], a[8:11], v[52:55]
  v_accvgpr_write_b32 a85, v90
  v_exp_f32 v96, v96
  v_mfma_f32_16x16x32_bf16 v[52:55], a[244:247], a[12:15], v[52:55]
  v_cvt_pk_bf16_f32 v92, v92, v93
  v_exp_f32 v97, v97
  v_mfma_f32_16x16x32_bf16 v[60:63], a[240:243], a[32:35], v[60:63]
  v_accvgpr_write_b32 a86, v92
  v_exp_f32 v98, v98
  v_mfma_f32_16x16x32_bf16 v[60:63], a[244:247], a[36:39], v[60:63]
  s_waitcnt vmcnt(5) lgkmcnt(0)
  s_barrier
  ds_read_b128 a[240:243], v0 offset:36864
  v_mfma_f32_16x16x32_bf16 v[20:23], a[248:251], a[160:163], v[20:23]
  ds_read_b128 a[244:247], v1 offset:36864
  v_cvt_pk_bf16_f32 v94, v94, v95
  v_exp_f32 v99, v99
  v_mfma_f32_16x16x32_bf16 v[20:23], a[252:255], a[164:167], v[20:23]
  v_accvgpr_write_b32 a87, v94
  v_exp_f32 v100, v100
  v_mfma_f32_16x16x32_bf16 v[28:31], a[248:251], a[184:187], v[28:31]
  v_cvt_pk_bf16_f32 v96, v96, v97
  v_exp_f32 v101, v101
  v_accvgpr_write_b32 a88, v96
  v_mfma_f32_16x16x32_bf16 v[28:31], a[252:255], a[188:191], v[28:31]
  v_exp_f32 v102, v102
  v_cvt_pk_bf16_f32 v98, v98, v99
  v_mfma_f32_16x16x32_bf16 v[36:39], a[248:251], a[208:211], v[36:39]
  s_add_u32 m0, s32, 24576
  v_exp_f32 v103, v103
  v_accvgpr_write_b32 a89, v98
  v_mfma_f32_16x16x32_bf16 v[36:39], a[252:255], a[212:215], v[36:39]
  s_add_u32 s40, s37, 73728
  v_exp_f32 v104, v104
  v_cvt_pk_bf16_f32 v100, v100, v101
  v_mfma_f32_16x16x32_bf16 v[44:47], a[248:251], a[232:235], v[44:47]
  buffer_load_dwordx4 v12, s[16:19], s40 offen nt lds
  s_add_u32 s46, s34, 6400
  buffer_store_dwordx4 v[232:235], v15, s[24:27], s46 offen sc1
  v_mfma_f32_16x16x32_bf16 v[44:47], a[252:255], a[236:239], v[44:47]
  buffer_load_dwordx4 v13, s[16:19], s40 offen offset:1024 nt lds
  v_exp_f32 v105, v105
  v_mfma_f32_16x16x32_bf16 v[52:55], a[248:251], a[16:19], v[52:55]
  buffer_load_dwordx4 v14, s[16:19], s40 offen offset:2048 nt lds
  v_accvgpr_write_b32 a90, v100
  v_mfma_f32_16x16x32_bf16 v[52:55], a[252:255], a[20:23], v[52:55]
  v_exp_f32 v106, v106
  v_cvt_pk_bf16_f32 v102, v102, v103
  v_mfma_f32_16x16x32_bf16 v[60:63], a[248:251], a[40:43], v[60:63]
  v_exp_f32 v107, v107
  v_accvgpr_write_b32 a91, v102
  v_mfma_f32_16x16x32_bf16 v[60:63], a[252:255], a[44:47], v[60:63]
  s_waitcnt lgkmcnt(0)
  v_exp_f32 v108, v108
  v_cvt_pk_bf16_f32 v104, v104, v105
  v_exp_f32 v109, v109
  v_mfma_f32_16x16x32_bf16 v[64:67], a[240:243], a[144:147], 0
  ds_read_b128 a[248:251], v0 offset:36992
  v_accvgpr_write_b32 a92, v104
  v_mfma_f32_16x16x32_bf16 v[64:67], a[244:247], a[148:151], v[64:67]
  ds_read_b128 a[252:255], v1 offset:36992
  v_exp_f32 v110, v110
  v_cvt_pk_bf16_f32 v106, v106, v107
  v_mfma_f32_16x16x32_bf16 v[72:75], a[240:243], a[168:171], 0
  v_exp_f32 v111, v111
  v_accvgpr_write_b32 a93, v106
  v_cvt_pk_bf16_f32 v108, v108, v109
  v_mfma_f32_16x16x32_bf16 v[72:75], a[244:247], a[172:175], v[72:75]
  v_accvgpr_write_b32 a94, v108
  v_cvt_pk_bf16_f32 v110, v110, v111
  v_accvgpr_write_b32 a95, v110
  v_mfma_f32_16x16x32_bf16 v[80:83], a[240:243], a[192:195], 0
  v_fma_f32 v16, v16, s30, -v4
  v_fma_f32 v17, v17, s30, -v4
  v_fma_f32 v18, v18, s30, -v4
  v_max_f32 v3, v16, v17
  v_mfma_f32_16x16x32_bf16 v[80:83], a[244:247], a[196:199], v[80:83]
  v_fma_f32 v19, v19, s30, -v4
  v_fma_f32 v20, v20, s30, -v4
  v_max3_f32 v3, v3, v18, v19
  v_mfma_f32_16x16x32_bf16 v[88:91], a[240:243], a[216:219], 0
  v_fma_f32 v21, v21, s30, -v4
  v_fma_f32 v22, v22, s30, -v4
  v_max3_f32 v3, v3, v20, v21
  v_fma_f32 v23, v23, s30, -v4
  v_mfma_f32_16x16x32_bf16 v[88:91], a[244:247], a[220:223], v[88:91]
  v_fma_f32 v24, v24, s30, -v5
  v_max3_f32 v3, v3, v22, v23
  v_fma_f32 v25, v25, s30, -v5
  v_fma_f32 v26, v26, s30, -v5
  v_mfma_f32_16x16x32_bf16 v[96:99], a[240:243], a[0:3], 0
  v_max3_f32 v3, v3, v24, v25
  v_fma_f32 v27, v27, s30, -v5
  v_fma_f32 v28, v28, s30, -v5
  v_mfma_f32_16x16x32_bf16 v[96:99], a[244:247], a[4:7], v[96:99]
  v_max3_f32 v3, v3, v26, v27
  v_fma_f32 v29, v29, s30, -v5
  v_fma_f32 v30, v30, s30, -v5
  v_max3_f32 v3, v3, v28, v29
  v_mfma_f32_16x16x32_bf16 v[104:107], a[240:243], a[24:27], 0
  v_fma_f32 v31, v31, s30, -v5
  v_fma_f32 v32, v32, s30, -v6
  v_max3_f32 v3, v3, v30, v31
  v_mfma_f32_16x16x32_bf16 v[104:107], a[244:247], a[28:31], v[104:107]
  s_waitcnt lgkmcnt(0)
  v_fma_f32 v33, v33, s30, -v6
  v_fma_f32 v34, v34, s30, -v6
  v_max3_f32 v3, v3, v32, v33
  v_fma_f32 v35, v35, s30, -v6
  v_mfma_f32_16x16x32_bf16 v[64:67], a[248:251], a[152:155], v[64:67]
  ds_read_b128 a[240:243], v0 offset:37120
  v_fma_f32 v36, v36, s30, -v6
  v_max3_f32 v3, v3, v34, v35
  v_fma_f32 v37, v37, s30, -v6
  v_mfma_f32_16x16x32_bf16 v[64:67], a[252:255], a[156:159], v[64:67]
  ds_read_b128 a[244:247], v1 offset:37120
  v_fma_f32 v38, v38, s30, -v6
  v_max3_f32 v3, v3, v36, v37
  v_mfma_f32_16x16x32_bf16 v[72:75], a[248:251], a[176:179], v[72:75]
  ds_write_b64 v10, v[216:217] offset:0
  v_fma_f32 v39, v39, s30, -v6
  v_fma_f32 v40, v40, s30, -v7
  v_max3_f32 v3, v3, v38, v39
  v_mfma_f32_16x16x32_bf16 v[72:75], a[252:255], a[180:183], v[72:75]
  v_fma_f32 v41, v41, s30, -v7
  v_fma_f32 v42, v42, s30, -v7
  v_max3_f32 v3, v3, v40, v41
  v_mfma_f32_16x16x32_bf16 v[80:83], a[248:251], a[200:203], v[80:83]
  ds_write_b64 v10, v[218:219] offset:2048
  v_fma_f32 v43, v43, s30, -v7
  v_fma_f32 v44, v44, s30, -v7
  v_mfma_f32_16x16x32_bf16 v[80:83], a[252:255], a[204:207], v[80:83]
  v_max3_f32 v3, v3, v42, v43
  v_fma_f32 v45, v45, s30, -v7
  v_fma_f32 v46, v46, s30, -v7
  v_max3_f32 v3, v3, v44, v45
  v_mfma_f32_16x16x32_bf16 v[88:91], a[248:251], a[224:227], v[88:91]
  v_xor_b32 v10, 32, v10
  v_fma_f32 v47, v47, s30, -v7
  v_fma_f32 v48, v48, s30, -v8
  v_max3_f32 v3, v3, v46, v47
  v_mfma_f32_16x16x32_bf16 v[88:91], a[252:255], a[228:231], v[88:91]
  v_fma_f32 v49, v49, s30, -v8
  v_fma_f32 v50, v50, s30, -v8
  v_max3_f32 v3, v3, v48, v49
  v_mfma_f32_16x16x32_bf16 v[96:99], a[248:251], a[8:11], v[96:99]
  ds_write_b64 v10, v[220:221] offset:0
  v_fma_f32 v51, v51, s30, -v8
  v_fma_f32 v52, v52, s30, -v8
  v_mfma_f32_16x16x32_bf16 v[96:99], a[252:255], a[12:15], v[96:99]
  v_max3_f32 v3, v3, v50, v51
  v_fma_f32 v53, v53, s30, -v8
  v_fma_f32 v54, v54, s30, -v8
  v_max3_f32 v3, v3, v52, v53
  v_mfma_f32_16x16x32_bf16 v[104:107], a[248:251], a[32:35], v[104:107]
  ds_write_b64 v10, v[222:223] offset:2048
  v_fma_f32 v55, v55, s30, -v8
  v_fma_f32 v56, v56, s30, -v9
  v_mfma_f32_16x16x32_bf16 v[104:107], a[252:255], a[36:39], v[104:107]
  s_waitcnt lgkmcnt(4)
  v_max3_f32 v3, v3, v54, v55
  v_fma_f32 v57, v57, s30, -v9
  v_fma_f32 v58, v58, s30, -v9
  v_max3_f32 v3, v3, v56, v57
  v_mfma_f32_16x16x32_bf16 v[64:67], a[240:243], a[160:163], v[64:67]
  ds_read_b128 a[248:251], v0 offset:43008
  v_xor_b32 v10, 96, v10
  buffer_store_dwordx4 v[236:239], v15, s[24:27], s46 offen offset:3072 sc1
  v_mfma_f32_16x16x32_bf16 v[64:67], a[244:247], a[164:167], v[64:67]
  ds_read_b128 a[252:255], v1 offset:43008
  v_fma_f32 v59, v59, s30, -v9
  v_fma_f32 v60, v60, s30, -v9
  v_max3_f32 v3, v3, v58, v59
  v_mfma_f32_16x16x32_bf16 v[72:75], a[240:243], a[184:187], v[72:75]
  ds_write_b64 v10, v[240:241] offset:0
  v_fma_f32 v61, v61, s30, -v9
  v_fma_f32 v62, v62, s30, -v9
  v_mfma_f32_16x16x32_bf16 v[72:75], a[244:247], a[188:191], v[72:75]
  v_max3_f32 v3, v3, v60, v61
  v_fma_f32 v63, v63, s30, -v9
  v_max3_f32 v3, v3, v62, v63
  v_mfma_f32_16x16x32_bf16 v[80:83], a[240:243], a[208:211], v[80:83]
  ds_write_b64 v10, v[242:243] offset:2048
  v_cmp_lt_f32 vcc, s31, v3
  v_mfma_f32_16x16x32_bf16 v[80:83], a[244:247], a[212:215], v[80:83]
  s_cbranch_vccnz L_slow_1_2
L_back_1_2:
  v_exp_f32 v16, v16
  v_exp_f32 v17, v17
  v_mfma_f32_16x16x32_bf16 v[88:91], a[240:243], a[232:235], v[88:91]
  v_xor_b32 v10, 32, v10
  v_exp_f32 v18, v18
  v_exp_f32 v19, v19
  v_mfma_f32_16x16x32_bf16 v[88:91], a[244:247], a[236:239], v[88:91]
  v_exp_f32 v20, v20
  v_cvt_pk_bf16_f32 v16, v16, v17
  v_mfma_f32_16x16x32_bf16 v[96:99], a[240:243], a[16:19], v[96:99]
  ds_write_b64 v10, v[244:245] offset:0
  v_exp_f32 v21, v21
  v_mfma_f32_16x16x32_bf16 v[96:99], a[244:247], a[20:23], v[96:99]
  v_accvgpr_write_b32 a96, v16
  v_exp_f32 v22, v22
  v_cvt_pk_bf16_f32 v18, v18, v19
  v_mfma_f32_16x16x32_bf16 v[104:107], a[240:243], a[40:43], v[104:107]
  ds_write_b64 v10, v[246:247] offset:2048
  v_exp_f32 v23, v23
  v_mfma_f32_16x16x32_bf16 v[104:107], a[244:247], a[44:47], v[104:107]
  s_waitcnt lgkmcnt(4)
  v_accvgpr_write_b32 a97, v18
  v_exp_f32 v24, v24
  v_mfma_f32_16x16x32_bf16 v[68:71], a[248:251], a[144:147], 0
  ds_read_b128 a[240:243], v0 offset:43136
  v_xor_b32 v10, 96, v10
  v_cvt_pk_bf16_f32 v20, v20, v21
  v_exp_f32 v25, v25
  v_mfma_f32_16x16x32_bf16 v[68:71], a[252:255], a[148:151], v[68:71]
  ds_read_b128 a[244:247], v1 offset:43136
  v_accvgpr_write_b32 a98, v20
  v_mfma_f32_16x16x32_bf16 v[76:79], a[248:251], a[168:171], 0
  ds_read_b128 v[216:219], v11 offset:0
  v_exp_f32 v26, v26
  v_cvt_pk_bf16_f32 v22, v22, v23
  v_mfma_f32_16x16x32_bf16 v[76:79], a[252:255], a[172:175], v[76:79]
  v_exp_f32 v27, v27
  v_accvgpr_write_b32 a99, v22
  v_exp_f32 v28, v28
  v_mfma_f32_16x16x32_bf16 v[84:87], a[248:251], a[192:195], 0
  ds_read_b128 v[220:223], v11 offset:1024
  v_cvt_pk_bf16_f32 v24, v24, v25
  v_mfma_f32_16x16x32_bf16 v[84:87], a[252:255], a[196:199], v[84:87]
  v_exp_f32 v29, v29
  v_accvgpr_write_b32 a100, v24
  v_exp_f32 v30, v30
  v_mfma_f32_16x16x32_bf16 v[92:95], a[248:251], a[216:219], 0
  ds_read_b128 v[240:243], v11 offset:2048
  v_cvt_pk_bf16_f32 v26, v26, v27
  v_exp_f32 v31, v31
  v_mfma_f32_16x16x32_bf16 v[92:95], a[252:255], a[220:223], v[92:95]
  v_accvgpr_write_b32 a101, v26
  v_exp_f32 v32, v32
  v_mfma_f32_16x16x32_bf16 v[100:103], a[248:251], a[0:3], 0
  ds_read_b128 v[244:247], v11 offset:3072
  v_cvt_pk_bf16_f32 v28, v28, v29
  v_exp_f32 v33, v33
  v_mfma_f32_16x16x32_bf16 v[100:103], a[252:255], a[4:7], v[100:103]
  v_accvgpr_write_b32 a102, v28
  v_exp_f32 v34, v34
  v_mfma_f32_16x16x32_bf16 v[108:111], a[248:251], a[24:27], 0
  v_cvt_pk_bf16_f32 v30, v30, v31
  v_exp_f32 v35, v35
  v_accvgpr_write_b32 a103, v30
  v_mfma_f32_16x16x32_bf16 v[108:111], a[252:255], a[28:31], v[108:111]
  s_waitcnt lgkmcnt(4)
  v_exp_f32 v36, v36
  v_cvt_pk_bf16_f32 v32, v32, v33
  v_mfma_f32_16x16x32_bf16 v[68:71], a[240:243], a[152:155], v[68:71]
  ds_read_b128 a[248:251], v0 offset:43264
  v_exp_f32 v37, v37
  v_accvgpr_write_b32 a104, v32
  v_mfma_f32_16x16x32_bf16 v[68:71], a[244:247], a[156:159], v[68:71]
  ds_read_b128 a[252:255], v1 offset:43264
  v_exp_f32 v38, v38
  v_cvt_pk_bf16_f32 v34, v34, v35
  v_mfma_f32_16x16x32_bf16 v[76:79], a[240:243], a[176:179], v[76:79]
  v_exp_f32 v39, v39
  v_accvgpr_write_b32 a105, v34
  v_mfma_f32_16x16x32_bf16 v[76:79], a[244:247], a[180:183], v[76:79]
  v_exp_f32 v40, v40
  v_cvt_pk_bf16_f32 v36, v36, v37
  v_exp_f32 v41, v41
  v_mfma_f32_16x16x32_bf16 v[84:87], a[240:243], a[200:203], v[84:87]
  v_accvgpr_write_b32 a106, v36
  v_exp_f32 v42, v42
  v_mfma_f32_16x16x32_bf16 v[84:87], a[244:247], a[204:207], v[84:87]
  v_cvt_pk_bf16_f32 v38, v38, v39
  v_exp_f32 v43, v43
  v_accvgpr_write_b32 a107, v38
  v_mfma_f32_16x16x32_bf16 v[92:95], a[240:243], a[224:227], v[92:95]
  s_add_u32 s46, s34, 12544
  s_waitcnt lgkmcnt(5)
  buffer_store_dwordx4 v[216:219], v15, s[24:27], s46 offen sc1
  v_mfma_f32_16x16x32_bf16 v[92:95], a[244:247], a[228:231], v[92:95]
  v_exp_f32 v44, v44
  v_cvt_pk_bf16_f32 v40, v40, v41
  v_mfma_f32_16x16x32_bf16 v[100:103], a[240:243], a[8:11], v[100:103]
  v_subrev_u32 v0, 98304, v0
  v_exp_f32 v45, v45
  v_accvgpr_write_b32 a108, v40
  v_mfma_f32_16x16x32_bf16 v[100:103], a[244:247], a[12:15], v[100:103]
  v_exp_f32 v46, v46
  v_cvt_pk_bf16_f32 v42, v42, v43
  v_mfma_f32_16x16x32_bf16 v[108:111], a[240:243], a[32:35], v[108:111]
  v_subrev_u32 v1, 98304, v1
  v_exp_f32 v47, v47
  v_accvgpr_write_b32 a109, v42
  v_mfma_f32_16x16x32_bf16 v[108:111], a[244:247], a[36:39], v[108:111]
  s_waitcnt lgkmcnt(0)
  ds_read_b128 a[240:243], v0 offset:0
  v_exp_f32 v48, v48
  v_cvt_pk_bf16_f32 v44, v44, v45
  v_mfma_f32_16x16x32_bf16 v[68:71], a[248:251], a[160:163], v[68:71]
  ds_read_b128 a[244:247], v1 offset:0
  v_exp_f32 v49, v49
  v_accvgpr_write_b32 a110, v44
  v_mfma_f32_16x16x32_bf16 v[68:71], a[252:255], a[164:167], v[68:71]
  v_exp_f32 v50, v50
  v_cvt_pk_bf16_f32 v46, v46, v47
  v_mfma_f32_16x16x32_bf16 v[76:79], a[248:251], a[184:187], v[76:79]
  v_exp_f32 v51, v51
  v_accvgpr_write_b32 a111, v46
  v_exp_f32 v52, v52
  v_mfma_f32_16x16x32_bf16 v[76:79], a[252:255], a[188:191], v[76:79]
  v_cvt_pk_bf16_f32 v48, v48, v49
  v_exp_f32 v53, v53
  v_mfma_f32_16x16x32_bf16 v[84:87], a[248:251], a[208:211], v[84:87]
  s_add_u32 m0, s32, 36864
  v_accvgpr_write_b32 a112, v48
  v_exp_f32 v54, v54
  v_mfma_f32_16x16x32_bf16 v[84:87], a[252:255], a[212:215], v[84:87]
  s_add_u32 s40, s37, 86016
  v_cvt_pk_bf16_f32 v50, v50, v51
  v_exp_f32 v55, v55
  v_mfma_f32_16x16x32_bf16 v[92:95], a[248:251], a[232:235], v[92:95]
  buffer_load_dwordx4 v12, s[16:19], s40 offen nt lds
  v_accvgpr_write_b32 a113, v50
  v_mfma_f32_16x16x32_bf16 v[92:95], a[252:255], a[236:239], v[92:95]
  buffer_load_dwordx4 v13, s[16:19], s40 offen offset:1024 nt lds
  v_exp_f32 v56, v56
  v_cvt_pk_bf16_f32 v52, v52, v53
  v_mfma_f32_16x16x32_bf16 v[100:103], a[248:251], a[16:19], v[100:103]
  buffer_load_dwordx4 v14, s[16:19], s40 offen offset:2048 nt lds
  v_exp_f32 v57, v57
  v_mfma_f32_16x16x32_bf16 v[100:103], a[252:255], a[20:23], v[100:103]
  v_accvgpr_write_b32 a114, v52
  v_exp_f32 v58, v58
  v_mfma_f32_16x16x32_bf16 v[108:111], a[248:251], a[40:43], v[108:111]
  v_cvt_pk_bf16_f32 v54, v54, v55
  v_exp_f32 v59, v59
  v_accvgpr_write_b32 a115, v54
  v_mfma_f32_16x16x32_bf16 v[108:111], a[252:255], a[44:47], v[108:111]
  s_waitcnt lgkmcnt(0)
  v_exp_f32 v60, v60
  v_cvt_pk_bf16_f32 v56, v56, v57
  v_mfma_f32_16x16x32_bf16 v[16:19], a[240:243], a[144:147], 0
  ds_read_b128 a[248:251], v0 offset:128
  v_exp_f32 v61, v61
  v_accvgpr_write_b32 a116, v56
  v_mfma_f32_16x16x32_bf16 v[16:19], a[244:247], a[148:151], v[16:19]
  ds_read_b128 a[252:255], v1 offset:128
  v_exp_f32 v62, v62
  v_cvt_pk_bf16_f32 v58, v58, v59
  v_mfma_f32_16x16x32_bf16 v[24:27], a[240:243], a[168:171], 0
  v_exp_f32 v63, v63
  v_accvgpr_write_b32 a117, v58
  v_mfma_f32_16x16x32_bf16 v[24:27], a[244:247], a[172:175], v[24:27]
  v_cvt_pk_bf16_f32 v60, v60, v61
  v_accvgpr_write_b32 a118, v60
  v_cvt_pk_bf16_f32 v62, v62, v63
  v_accvgpr_write_b32 a119, v62
  v_mfma_f32_16x16x32_bf16 v[32:35], a[240:243], a[192:195], 0
  v_fma_f32 v64, v64, s30, -v4
  v_fma_f32 v65, v65, s30, -v4
  v_fma_f32 v66, v66, s30, -v4
  v_max_f32 v3, v64, v65
  v_mfma_f32_16x16x32_bf16 v[32:35], a[244:247], a[196:199], v[32:35]
  v_fma_f32 v67, v67, s30, -v4
  v_fma_f32 v68, v68, s30, -v4
  v_max3_f32 v3, v3, v66, v67
  v_mfma_f32_16x16x32_bf16 v[40:43], a[240:243], a[216:219], 0
  v_fma_f32 v69, v69, s30, -v4
  v_fma_f32 v70, v70, s30, -v4
  v_max3_f32 v3, v3, v68, v69
  v_fma_f32 v71, v71, s30, -v4
  v_mfma_f32_16x16x32_bf16 v[40:43], a[244:247], a[220:223], v[40:43]
  v_fma_f32 v72, v72, s30, -v5
  v_max3_f32 v3, v3, v70, v71
  v_fma_f32 v73, v73, s30, -v5
  v_mfma_f32_16x16x32_bf16 v[48:51], a[240:243], a[0:3], 0
  v_fma_f32 v74, v74, s30, -v5
  v_max3_f32 v3, v3, v72, v73
  v_fma_f32 v75, v75, s30, -v5
  v_fma_f32 v76, v76, s30, -v5
  v_mfma_f32_16x16x32_bf16 v[48:51], a[244:247], a[4:7], v[48:51]
  v_max3_f32 v3, v3, v74, v75
  v_fma_f32 v77, v77, s30, -v5
  v_fma_f32 v78, v78, s30, -v5
  v_mfma_f32_16x16x32_bf16 v[56:59], a[240:243], a[24:27], 0
  v_max3_f32 v3, v3, v76, v77
  v_fma_f32 v79, v79, s30, -v5
  v_fma_f32 v80, v80, s30, -v6
  v_max3_f32 v3, v3, v78, v79
  v_mfma_f32_16x16x32_bf16 v[56:59], a[244:247], a[28:31], v[56:59]
  s_waitcnt lgkmcnt(0)
  v_fma_f32 v81, v81, s30, -v6
  v_fma_f32 v82, v82, s30, -v6
  v_max3_f32 v3, v3, v80, v81
  v_mfma_f32_16x16x32_bf16 v[16:19], a[248:251], a[152:155], v[16:19]
  ds_read_b128 a[240:243], v0 offset:256
  buffer_store_dwordx4 v[220:223], v15, s[24:27], s46 offen offset:3072 sc1
  v_mfma_f32_16x16x32_bf16 v[16:19], a[252:255], a[156:159], v[16:19]
  ds_read_b128 a[244:247], v1 offset:256
  v_fma_f32 v83, v83, s30, -v6
  v_fma_f32 v84, v84, s30, -v6
  v_max3_f32 v3, v3, v82, v83
  v_mfma_f32_16x16x32_bf16 v[24:27], a[248:251], a[176:179], v[24:27]
  v_fma_f32 v85, v85, s30, -v6
  v_fma_f32 v86, v86, s30, -v6
  v_max3_f32 v3, v3, v84, v85
  v_mfma_f32_16x16x32_bf16 v[24:27], a[252:255], a[180:183], v[24:27]
  v_fma_f32 v87, v87, s30, -v6
  v_fma_f32 v88, v88, s30, -v7
  v_max3_f32 v3, v3, v86, v87
  v_fma_f32 v89, v89, s30, -v7
  v_mfma_f32_16x16x32_bf16 v[32:35], a[248:251], a[200:203], v[32:35]
  v_fma_f32 v90, v90, s30, -v7
  v_max3_f32 v3, v3, v88, v89
  v_fma_f32 v91, v91, s30, -v7
  v_mfma_f32_16x16x32_bf16 v[32:35], a[252:255], a[204:207], v[32:35]
  v_fma_f32 v92, v92, s30, -v7
  v_max3_f32 v3, v3, v90, v91
  v_fma_f32 v93, v93, s30, -v7
  v_fma_f32 v94, v94, s30, -v7
  v_mfma_f32_16x16x32_bf16 v[40:43], a[248:251], a[224:227], v[40:43]
  v_max3_f32 v3, v3, v92, v93
  v_fma_f32 v95, v95, s30, -v7
  v_fma_f32 v96, v96, s30, -v8
  v_mfma_f32_16x16x32_bf16 v[40:43], a[252:255], a[228:231], v[40:43]
  v_max3_f32 v3, v3, v94, v95
  v_fma_f32 v97, v97, s30, -v8
  v_fma_f32 v98, v98, s30, -v8
  v_max3_f32 v3, v3, v96, v97
  v_mfma_f32_16x16x32_bf16 v[48:51], a[248:251], a[8:11], v[48:51]
  v_fma_f32 v99, v99, s30, -v8
  v_fma_f32 v100, v100, s30, -v8
  v_max3_f32 v3, v3, v98, v99
  v_fma_f32 v101, v101, s30, -v8
  v_mfma_f32_16x16x32_bf16 v[48:51], a[252:255], a[12:15], v[48:51]
  v_fma_f32 v102, v102, s30, -v8
  v_max3_f32 v3, v3, v100, v101
  v_fma_f32 v103, v103, s30, -v8
  v_mfma_f32_16x16x32_bf16 v[56:59], a[248:251], a[32:35], v[56:59]
  v_fma_f32 v104, v104, s30, -v9
  v_max3_f32 v3, v3, v102, v103
  v_fma_f32 v105, v105, s30, -v9
  v_fma_f32 v106, v106, s30, -v9
  v_mfma_f32_16x16x32_bf16 v[56:59], a[252:255], a[36:39], v[56:59]
  s_waitcnt lgkmcnt(0)
  v_max3_f32 v3, v3, v104, v105
  v_fma_f32 v107, v107, s30, -v9
  v_fma_f32 v108, v108, s30, -v9
  v_mfma_f32_16x16x32_bf16 v[16:19], a[240:243], a[160:163], v[16:19]
  ds_read_b128 a[248:251], v0 offset:6144
  v_max3_f32 v3, v3, v106, v107
  v_fma_f32 v109, v109, s30, -v9
  v_fma_f32 v110, v110, s30, -v9
  v_mfma_f32_16x16x32_bf16 v[16:19], a[244:247], a[164:167], v[16:19]
  ds_read_b128 a[252:255], v1 offset:6144
  v_max3_f32 v3, v3, v108, v109
  v_fma_f32 v111, v111, s30, -v9
  v_mfma_f32_16x16x32_bf16 v[24:27], a[240:243], a[184:187], v[24:27]
L_pad_11:
  s_cbranch_execz L_pad_15
  v_max3_f32 v3, v3, v110, v111
  v_cmp_lt_f32 vcc, s31, v3
  v_mfma_f32_16x16x32_bf16 v[24:27], a[244:247], a[188:191], v[24:27]
  s_cbranch_vccnz L_slow_1_3
L_back_1_3:
  v_exp_f32 v64, v64
  v_exp_f32 v65, v65
  v_mfma_f32_16x16x32_bf16 v[32:35], a[240:243], a[208:211], v[32:35]
  v_exp_f32 v66, v66
  v_exp_f32 v67, v67
  v_mfma_f32_16x16x32_bf16 v[32:35], a[244:247], a[212:215], v[32:35]
  v_exp_f32 v68, v68
  v_cvt_pk_bf16_f32 v64, v64, v65
  v_mfma_f32_16x16x32_bf16 v[40:43], a[240:243], a[232:235], v[40:43]
  v_exp_f32 v69, v69
  v_accvgpr_write_b32 a120, v64
  v_exp_f32 v70, v70
  v_mfma_f32_16x16x32_bf16 v[40:43], a[244:247], a[236:239], v[40:43]
  v_cvt_pk_bf16_f32 v66, v66, v67
  v_exp_f32 v71, v71
  v_mfma_f32_16x16x32_bf16 v[48:51], a[240:243], a[16:19], v[48:51]
  v_accvgpr_write_b32 a121, v66
  v_exp_f32 v72, v72
  v_mfma_f32_16x16x32_bf16 v[48:51], a[244:247], a[20:23], v[48:51]
  v_cvt_pk_bf16_f32 v68, v68, v69
  v_exp_f32 v73, v73
  v_accvgpr_write_b32 a122, v68
  v_mfma_f32_16x16x32_bf16 v[56:59], a[240:243], a[40:43], v[56:59]
  v_exp_f32 v74, v74
  v_cvt_pk_bf16_f32 v70, v70, v71
  v_mfma_f32_16x16x32_bf16 v[56:59], a[244:247], a[44:47], v[56:59]
  s_waitcnt lgkmcnt(0)
  v_exp_f32 v75, v75
  v_accvgpr_write_b32 a123, v70
  v_mfma_f32_16x16x32_bf16 v[20:23], a[248:251], a[144:147], 0
  ds_read_b128 a[240:243], v0 offset:6272
  v_exp_f32 v76, v76
  v_cvt_pk_bf16_f32 v72, v72, v73
  v_mfma_f32_16x16x32_bf16 v[20:23], a[252:255], a[148:151], v[20:23]
  ds_read_b128 a[244:247], v1 offset:6272
  v_exp_f32 v77, v77
  v_accvgpr_write_b32 a124, v72
  v_mfma_f32_16x16x32_bf16 v[28:31], a[248:251], a[168:171], 0
  v_exp_f32 v78, v78
  v_cvt_pk_bf16_f32 v74, v74, v75
  v_mfma_f32_16x16x32_bf16 v[28:31], a[252:255], a[172:175], v[28:31]
  v_exp_f32 v79, v79
  v_accvgpr_write_b32 a125, v74
  v_exp_f32 v80, v80
  v_mfma_f32_16x16x32_bf16 v[36:39], a[248:251], a[192:195], 0
  v_cvt_pk_bf16_f32 v76, v76, v77
  v_exp_f32 v81, v81
  v_mfma_f32_16x16x32_bf16 v[36:39], a[252:255], a[196:199], v[36:39]
  v_accvgpr_write_b32 a126, v76
  v_exp_f32 v82, v82
  v_mfma_f32_16x16x32_bf16 v[44:47], a[248:251], a[216:219], 0
  s_add_u32 s46, s34, 18688
  buffer_store_dwordx4 v[240:243], v15, s[24:27], s46 offen sc1
  v_cvt_pk_bf16_f32 v78, v78, v79
  v_mfma_f32_16x16x32_bf16 v[44:47], a[252:255], a[220:223], v[44:47]
  v_exp_f32 v83, v83
  v_accvgpr_write_b32 a127, v78
  v_mfma_f32_16x16x32_bf16 v[52:55], a[248:251], a[0:3], 0
  v_exp_f32 v84, v84
  v_cvt_pk_bf16_f32 v80, v80, v81
  v_mfma_f32_16x16x32_bf16 v[52:55], a[252:255], a[4:7], v[52:55]
  v_exp_f32 v85, v85
  v_accvgpr_write_b32 a128, v80
  v_exp_f32 v86, v86
  v_mfma_f32_16x16x32_bf16 v[60:63], a[248:251], a[24:27], 0
  v_cvt_pk_bf16_f32 v82, v82, v83
  v_exp_f32 v87, v87
  v_mfma_f32_16x16x32_bf16 v[60:63], a[252:255], a[28:31], v[60:63]
  s_waitcnt lgkmcnt(0)
  v_accvgpr_write_b32 a129, v82
  v_exp_f32 v88, v88
  v_mfma_f32_16x16x32_bf16 v[20:23], a[240:243], a[152:155], v[20:23]
  ds_read_b128 a[248:251], v0 offset:6400
  v_cvt_pk_bf16_f32 v84, v84, v85
  v_exp_f32 v89, v89
  v_mfma_f32_16x16x32_bf16 v[20:23], a[244:247], a[156:159], v[20:23]
  ds_read_b128 a[252:255], v1 offset:6400
  v_accvgpr_write_b32 a130, v84
  v_exp_f32 v90, v90
  v_mfma_f32_16x16x32_bf16 v[28:31], a[240:243], a[176:179], v[28:31]
  v_cvt_pk_bf16_f32 v86, v86, v87
  v_exp_f32 v91, v91
  v_mfma_f32_16x16x32_bf16 v[28:31], a[244:247], a[180:183], v[28:31]
  v_accvgpr_write_b32 a131, v86
  v_exp_f32 v92, v92
  v_cvt_pk_bf16_f32 v88, v88, v89
  v_mfma_f32_16x16x32_bf16 v[36:39], a[240:243], a[200:203], v[36:39]
  v_exp_f32 v93, v93
  v_accvgpr_write_b32 a132, v88
  v_mfma_f32_16x16x32_bf16 v[36:39], a[244:247], a[204:207], v[36:39]
  v_exp_f32 v94, v94
  v_cvt_pk_bf16_f32 v90, v90, v91
  v_mfma_f32_16x16x32_bf16 v[44:47], a[240:243], a[224:227], v[44:47]
  v_exp_f32 v95, v95
  v_accvgpr_write_b32 a133, v90
  v_exp_f32 v96, v96
  v_mfma_f32_16x16x32_bf16 v[44:47], a[244:247], a[228:231], v[44:47]
  v_cvt_pk_bf16_f32 v92, v92, v93
  v_exp_f32 v97, v97
  v_mfma_f32_16x16x32_bf16 v[52:55], a[240:243], a[8:11], v[52:55]
  v_accvgpr_write_b32 a134, v92
  v_exp_f32 v98, v98
  v_mfma_f32_16x16x32_bf16 v[52:55], a[244:247], a[12:15], v[52:55]
  v_cvt_pk_bf16_f32 v94, v94, v95
  v_exp_f32 v99, v99
  v_accvgpr_write_b32 a135, v94
  v_mfma_f32_16x16x32_bf16 v[60:63], a[240:243], a[32:35], v[60:63]
  v_exp_f32 v100, v100
  v_cvt_pk_bf16_f32 v96, v96, v97
  v_mfma_f32_16x16x32_bf16 v[60:63], a[244:247], a[36:39], v[60:63]
  s_waitcnt vmcnt(7) lgkmcnt(0)
  s_barrier
  ds_read_b128 a[240:243], v0 offset:12288
  v_mfma_f32_16x16x32_bf16 v[20:23], a[248:251], a[160:163], v[20:23]
  ds_read_b128 a[244:247], v1 offset:12288
  v_exp_f32 v101, v101
  v_accvgpr_write_b32 a136, v96
  v_mfma_f32_16x16x32_bf16 v[20:23], a[252:255], a[164:167], v[20:23]
  v_exp_f32 v102, v102
  v_cvt_pk_bf16_f32 v98, v98, v99
  v_mfma_f32_16x16x32_bf16 v[28:31], a[248:251], a[184:187], v[28:31]
  ds_write_b64 v10, v[224:225] offset:0
  v_exp_f32 v103, v103
  v_accvgpr_write_b32 a137, v98
  v_mfma_f32_16x16x32_bf16 v[28:31], a[252:255], a[188:191], v[28:31]
  v_exp_f32 v104, v104
  v_cvt_pk_bf16_f32 v100, v100, v101
  v_mfma_f32_16x16x32_bf16 v[36:39], a[248:251], a[208:211], v[36:39]
  s_add_u32 m0, s32, 49152
  ds_write_b64 v10, v[226:227] offset:2048
  v_exp_f32 v105, v105
  v_mfma_f32_16x16x32_bf16 v[36:39], a[252:255], a[212:215], v[36:39]
  s_add_u32 s40, s37, 98304
  v_accvgpr_write_b32 a138, v100
  v_exp_f32 v106, v106
  v_mfma_f32_16x16x32_bf16 v[44:47], a[248:251], a[232:235], v[44:47]
  buffer_load_dwordx4 v12, s[16:19], s40 offen nt lds
  v_xor_b32 v10, 32, v10
  v_cvt_pk_bf16_f32 v102, v102, v103
  v_mfma_f32_16x16x32_bf16 v[44:47], a[252:255], a[236:239], v[44:47]
  buffer_load_dwordx4 v13, s[16:19], s40 offen offset:1024 nt lds
  v_exp_f32 v107, v107
  v_mfma_f32_16x16x32_bf16 v[52:55], a[248:251], a[16:19], v[52:55]
  buffer_load_dwordx4 v14, s[16:19], s40 offen offset:2048 nt lds
  ds_write_b64 v10, v[228:229] offset:0
  v_mfma_f32_16x16x32_bf16 v[52:55], a[252:255], a[20:23], v[52:55]
  v_accvgpr_write_b32 a139, v102
  v_exp_f32 v108, v108
  v_mfma_f32_16x16x32_bf16 v[60:63], a[248:251], a[40:43], v[60:63]
  ds_write_b64 v10, v[230:231] offset:2048
  v_cvt_pk_bf16_f32 v104, v104, v105
  v_exp_f32 v109, v109
  v_mfma_f32_16x16x32_bf16 v[60:63], a[252:255], a[44:47], v[60:63]
  s_waitcnt lgkmcnt(4)
  v_accvgpr_write_b32 a140, v104
  v_exp_f32 v110, v110
  v_mfma_f32_16x16x32_bf16 v[64:67], a[240:243], a[144:147], 0
  ds_read_b128 a[248:251], v0 offset:12416
  v_xor_b32 v10, 96, v10
  buffer_store_dwordx4 v[244:247], v15, s[24:27], s46 offen offset:3072 sc1
  v_mfma_f32_16x16x32_bf16 v[64:67], a[244:247], a[148:151], v[64:67]
  ds_read_b128 a[252:255], v1 offset:12416
  v_cvt_pk_bf16_f32 v106, v106, v107
  v_exp_f32 v111, v111
  v_mfma_f32_16x16x32_bf16 v[72:75], a[240:243], a[168:171], 0
  ds_write_b64 v10, v[248:249] offset:0
  v_accvgpr_write_b32 a141, v106
  v_mfma_f32_16x16x32_bf16 v[72:75], a[244:247], a[172:175], v[72:75]
  v_cvt_pk_bf16_f32 v108, v108, v109
  v_accvgpr_write_b32 a142, v108
  v_cvt_pk_bf16_f32 v110, v110, v111
  v_accvgpr_write_b32 a143, v110
  v_mfma_f32_16x16x32_bf16 v[80:83], a[240:243], a[192:195], 0
  ds_write_b64 v10, v[250:251] offset:2048
  v_fma_f32 v16, v16, s30, -v4
  v_fma_f32 v17, v17, s30, -v4
  v_mfma_f32_16x16x32_bf16 v[80:83], a[244:247], a[196:199], v[80:83]
  v_fma_f32 v18, v18, s30, -v4
  v_max_f32 v3, v16, v17
  v_fma_f32 v19, v19, s30, -v4
  v_mfma_f32_16x16x32_bf16 v[88:91], a[240:243], a[216:219], 0
  v_xor_b32 v10, 32, v10
  v_fma_f32 v20, v20, s30, -v4
  v_max3_f32 v3, v3, v18, v19
  v_mfma_f32_16x16x32_bf16 v[88:91], a[244:247], a[220:223], v[88:91]
  v_fma_f32 v21, v21, s30, -v4
  v_fma_f32 v22, v22, s30, -v4
  v_max3_f32 v3, v3, v20, v21
  v_mfma_f32_16x16x32_bf16 v[96:99], a[240:243], a[0:3], 0
  ds_write_b64 v10, v[252:253] offset:0
  v_fma_f32 v23, v23, s30, -v4
  v_fma_f32 v24, v24, s30, -v5
  v_mfma_f32_16x16x32_bf16 v[96:99], a[244:247], a[4:7], v[96:99]
  v_max3_f32 v3, v3, v22, v23
  v_fma_f32 v25, v25, s30, -v5
  v_fma_f32 v26, v26, s30, -v5
  v_mfma_f32_16x16x32_bf16 v[104:107], a[240:243], a[24:27], 0
  ds_write_b64 v10, v[254:255] offset:2048
  v_max3_f32 v3, v3, v24, v25
  v_fma_f32 v27, v27, s30, -v5
  v_mfma_f32_16x16x32_bf16 v[104:107], a[244:247], a[28:31], v[104:107]
  s_waitcnt lgkmcnt(4)
  v_fma_f32 v28, v28, s30, -v5
  v_max3_f32 v3, v3, v26, v27
  v_fma_f32 v29, v29, s30, -v5
  v_mfma_f32_16x16x32_bf16 v[64:67], a[248:251], a[152:155], v[64:67]
  ds_read_b128 a[240:243], v0 offset:12544
  v_xor_b32 v10, 96, v10
  v_fma_f32 v30, v30, s30, -v5
  v_mfma_f32_16x16x32_bf16 v[64:67], a[252:255], a[156:159], v[64:67]
  ds_read_b128 a[244:247], v1 offset:12544
  v_max3_f32 v3, v3, v28, v29
  v_fma_f32 v31, v31, s30, -v5
  v_mfma_f32_16x16x32_bf16 v[72:75], a[248:251], a[176:179], v[72:75]
  ds_read_b128 v[224:227], v11 offset:0
  v_fma_f32 v32, v32, s30, -v6
  v_max3_f32 v3, v3, v30, v31
  v_mfma_f32_16x16x32_bf16 v[72:75], a[252:255], a[180:183], v[72:75]
  v_fma_f32 v33, v33, s30, -v6
  v_fma_f32 v34, v34, s30, -v6
  v_max3_f32 v3, v3, v32, v33
  v_fma_f32 v35, v35, s30, -v6
  v_mfma_f32_16x16x32_bf16 v[80:83], a[248:251], a[200:203], v[80:83]
  ds_read_b128 v[228:231], v11 offset:1024
  v_fma_f32 v36, v36, s30, -v6
  v_max3_f32 v3, v3, v34, v35
  v_mfma_f32_16x16x32_bf16 v[80:83], a[252:255], a[204:207], v[80:83]
  v_fma_f32 v37, v37, s30, -v6
  v_fma_f32 v38, v38, s30, -v6
  v_max3_f32 v3, v3, v36, v37
  v_mfma_f32_16x16x32_bf16 v[88:91], a[248:251], a[224:227], v[88:91]
  ds_read_b128 v[248:251], v11 offset:2048
  v_fma_f32 v39, v39, s30, -v6
  v_fma_f32 v40, v40, s30, -v7
  v_mfma_f32_16x16x32_bf16 v[88:91], a[252:255], a[228:231], v[88:91]
  v_max3_f32 v3, v3, v38, v39
  v_fma_f32 v41, v41, s30, -v7
  v_fma_f32 v42, v42, s30, -v7
  v_mfma_f32_16x16x32_bf16 v[96:99], a[248:251], a[8:11], v[96:99]
  ds_read_b128 v[252:255], v11 offset:3072
  v_max3_f32 v3, v3, v40, v41
  v_fma_f32 v43, v43, s30, -v7
  v_mfma_f32_16x16x32_bf16 v[96:99], a[252:255], a[12:15], v[96:99]
  v_fma_f32 v44, v44, s30, -v7
  v_max3_f32 v3, v3, v42, v43
  v_fma_f32 v45, v45, s30, -v7
  v_fma_f32 v46, v46, s30, -v7
  v_mfma_f32_16x16x32_bf16 v[104:107], a[248:251], a[32:35], v[104:107]
  v_max3_f32 v3, v3, v44, v45
  v_fma_f32 v47, v47, s30, -v7
  v_fma_f32 v48, v48, s30, -v8
  v_mfma_f32_16x16x32_bf16 v[104:107], a[252:255], a[36:39], v[104:107]
  s_waitcnt lgkmcnt(4)
  v_max3_f32 v3, v3, v46, v47
  v_fma_f32 v49, v49, s30, -v8
  v_fma_f32 v50, v50, s30, -v8
  v_mfma_f32_16x16x32_bf16 v[64:67], a[240:243], a[160:163], v[64:67]
  ds_read_b128 a[248:251], v0 offset:18432
  v_max3_f32 v3, v3, v48, v49
  v_fma_f32 v51, v51, s30, -v8
  v_mfma_f32_16x16x32_bf16 v[64:67], a[244:247], a[164:167], v[64:67]
  ds_read_b128 a[252:255], v1 offset:18432
  v_fma_f32 v52, v52, s30, -v8
  v_max3_f32 v3, v3, v50, v51
  v_mfma_f32_16x16x32_bf16 v[72:75], a[240:243], a[184:187], v[72:75]
  v_fma_f32 v53, v53, s30, -v8
  v_fma_f32 v54, v54, s30, -v8
  v_max3_f32 v3, v3, v52, v53
  v_mfma_f32_16x16x32_bf16 v[72:75], a[244:247], a[188:191], v[72:75]
  v_fma_f32 v55, v55, s30, -v8
  v_fma_f32 v56, v56, s30, -v9
  v_max3_f32 v3, v3, v54, v55
  v_fma_f32 v57, v57, s30, -v9
  v_mfma_f32_16x16x32_bf16 v[80:83], a[240:243], a[208:211], v[80:83]
  v_fma_f32 v58, v58, s30, -v9
  v_max3_f32 v3, v3, v56, v57
  v_fma_f32 v59, v59, s30, -v9
  v_mfma_f32_16x16x32_bf16 v[80:83], a[244:247], a[212:215], v[80:83]
  v_fma_f32 v60, v60, s30, -v9
  v_max3_f32 v3, v3, v58, v59
  v_fma_f32 v61, v61, s30, -v9
  v_mfma_f32_16x16x32_bf16 v[88:91], a[240:243], a[232:235], v[88:91]
  s_add_u32 s46, s34, 24832
  s_waitcnt lgkmcnt(5)
  buffer_store_dwordx4 v[224:227], v15, s[24:27], s46 offen sc1
  v_mfma_f32_16x16x32_bf16 v[88:91], a[244:247], a[236:239], v[88:91]
  v_fma_f32 v62, v62, s30, -v9
  v_max3_f32 v3, v3, v60, v61
  v_fma_f32 v63, v63, s30, -v9
  v_mfma_f32_16x16x32_bf16 v[96:99], a[240:243], a[16:19], v[96:99]
  v_max3_f32 v3, v3, v62, v63
  v_cmp_lt_f32 vcc, s31, v3
  v_mfma_f32_16x16x32_bf16 v[96:99], a[244:247], a[20:23], v[96:99]
  s_cbranch_vccnz L_slow_1_4
L_back_1_4:
  v_exp_f32 v16, v16
  v_exp_f32 v17, v17
  v_mfma_f32_16x16x32_bf16 v[104:107], a[240:243], a[40:43], v[104:107]
  v_exp_f32 v18, v18
  v_mfma_f32_16x16x32_bf16 v[104:107], a[244:247], a[44:47], v[104:107]
  s_waitcnt lgkmcnt(0)
  v_exp_f32 v19, v19
  v_exp_f32 v20, v20
  v_mfma_f32_16x16x32_bf16 v[68:71], a[248:251], a[144:147], 0
  ds_read_b128 a[240:243], v0 offset:18560
  v_cvt_pk_bf16_f32 v112, v16, v17
  v_mfma_f32_16x16x32_bf16 v[68:71], a[252:255], a[148:151], v[68:71]
  ds_read_b128 a[244:247], v1 offset:18560
  v_exp_f32 v21, v21
  v_exp_f32 v22, v22
  v_mfma_f32_16x16x32_bf16 v[76:79], a[248:251], a[168:171], 0
  v_cvt_pk_bf16_f32 v113, v18, v19
  v_exp_f32 v23, v23
  v_mfma_f32_16x16x32_bf16 v[76:79], a[252:255], a[172:175], v[76:79]
  v_exp_f32 v24, v24
  v_cvt_pk_bf16_f32 v114, v20, v21
  v_mfma_f32_16x16x32_bf16 v[84:87], a[248:251], a[192:195], 0
  v_exp_f32 v25, v25
  v_mfma_f32_16x16x32_bf16 v[84:87], a[252:255], a[196:199], v[84:87]
  v_exp_f32 v26, v26
  v_cvt_pk_bf16_f32 v115, v22, v23
  v_mfma_f32_16x16x32_bf16 v[92:95], a[248:251], a[216:219], 0
  v_exp_f32 v27, v27
  v_exp_f32 v28, v28
  v_mfma_f32_16x16x32_bf16 v[92:95], a[252:255], a[220:223], v[92:95]
  v_cvt_pk_bf16_f32 v116, v24, v25
  v_exp_f32 v29, v29
  v_mfma_f32_16x16x32_bf16 v[100:103], a[248:251], a[0:3], 0
  v_exp_f32 v30, v30
  v_cvt_pk_bf16_f32 v117, v26, v27
  v_mfma_f32_16x16x32_bf16 v[100:103], a[252:255], a[4:7], v[100:103]
  v_exp_f32 v31, v31
  v_exp_f32 v32, v32
  v_mfma_f32_16x16x32_bf16 v[108:111], a[248:251], a[24:27], 0
  v_cvt_pk_bf16_f32 v118, v28, v29
  v_exp_f32 v33, v33
  v_mfma_f32_16x16x32_bf16 v[108:111], a[252:255], a[28:31], v[108:111]
  s_waitcnt lgkmcnt(0)
  v_exp_f32 v34, v34
  v_cvt_pk_bf16_f32 v119, v30, v31
  v_mfma_f32_16x16x32_bf16 v[68:71], a[240:243], a[152:155], v[68:71]
  ds_read_b128 a[248:251], v0 offset:18688
  v_exp_f32 v35, v35
  v_mfma_f32_16x16x32_bf16 v[68:71], a[244:247], a[156:159], v[68:71]
  ds_read_b128 a[252:255], v1 offset:18688
  v_exp_f32 v36, v36
  v_mfma_f32_16x16x32_bf16 v[76:79], a[240:243], a[176:179], v[76:79]
  v_cvt_pk_bf16_f32 v120, v32, v33
  v_exp_f32 v37, v37
  v_mfma_f32_16x16x32_bf16 v[76:79], a[244:247], a[180:183], v[76:79]
  v_exp_f32 v38, v38
  v_cvt_pk_bf16_f32 v121, v34, v35
  v_mfma_f32_16x16x32_bf16 v[84:87], a[240:243], a[200:203], v[84:87]
  v_exp_f32 v39, v39
  v_exp_f32 v40, v40
  v_mfma_f32_16x16x32_bf16 v[84:87], a[244:247], a[204:207], v[84:87]
  v_cvt_pk_bf16_f32 v122, v36, v37
  v_exp_f32 v41, v41
  v_mfma_f32_16x16x32_bf16 v[92:95], a[240:243], a[224:227], v[92:95]
  v_exp_f32 v42, v42
  v_cvt_pk_bf16_f32 v123, v38, v39
  v_mfma_f32_16x16x32_bf16 v[92:95], a[244:247], a[228:231], v[92:95]
  v_exp_f32 v43, v43
  v_exp_f32 v44, v44
  v_mfma_f32_16x16x32_bf16 v[100:103], a[240:243], a[8:11], v[100:103]
  v_cvt_pk_bf16_f32 v124, v40, v41
  v_exp_f32 v45, v45
  v_mfma_f32_16x16x32_bf16 v[100:103], a[244:247], a[12:15], v[100:103]
  v_exp_f32 v46, v46
  v_cvt_pk_bf16_f32 v125, v42, v43
  v_mfma_f32_16x16x32_bf16 v[108:111], a[240:243], a[32:35], v[108:111]
  v_exp_f32 v47, v47
  v_mfma_f32_16x16x32_bf16 v[108:111], a[244:247], a[36:39], v[108:111]
  s_waitcnt lgkmcnt(0)
  ds_read_b128 a[240:243], v0 offset:24576
  v_exp_f32 v48, v48
  v_cvt_pk_bf16_f32 v126, v44, v45
  v_mfma_f32_16x16x32_bf16 v[68:71], a[248:251], a[160:163], v[68:71]
  ds_read_b128 a[244:247], v1 offset:24576
  buffer_store_dwordx4 v[228:231], v15, s[24:27], s46 offen offset:3072 sc1
  v_mfma_f32_16x16x32_bf16 v[68:71], a[252:255], a[164:167], v[68:71]
  v_exp_f32 v49, v49
  v_exp_f32 v50, v50
  v_mfma_f32_16x16x32_bf16 v[76:79], a[248:251], a[184:187], v[76:79]
  v_cvt_pk_bf16_f32 v127, v46, v47
  v_exp_f32 v51, v51
  v_mfma_f32_16x16x32_bf16 v[76:79], a[252:255], a[188:191], v[76:79]
  v_exp_f32 v52, v52
  v_cvt_pk_bf16_f32 v128, v48, v49
  v_mfma_f32_16x16x32_bf16 v[84:87], a[248:251], a[208:211], v[84:87]
  s_add_u32 m0, s32, 61440
  v_exp_f32 v53, v53
  v_mfma_f32_16x16x32_bf16 v[84:87], a[252:255], a[212:215], v[84:87]
  s_add_u32 s40, s37, 110592
  v_exp_f32 v54, v54
  v_cvt_pk_bf16_f32 v129, v50, v51
  v_mfma_f32_16x16x32_bf16 v[92:95], a[248:251], a[232:235], v[92:95]
  buffer_load_dwordx4 v12, s[16:19], s40 offen nt lds
  v_exp_f32 v55, v55
  v_mfma_f32_16x16x32_bf16 v[92:95], a[252:255], a[236:239], v[92:95]
  buffer_load_dwordx4 v13, s[16:19], s40 offen offset:1024 nt lds
  v_mfma_f32_16x16x32_bf16 v[100:103], a[248:251], a[16:19], v[100:103]
  buffer_load_dwordx4 v14, s[16:19], s40 offen offset:2048 nt lds
  v_exp_f32 v56, v56
  v_mfma_f32_16x16x32_bf16 v[100:103], a[252:255], a[20:23], v[100:103]
  v_cvt_pk_bf16_f32 v130, v52, v53
  v_exp_f32 v57, v57
  v_mfma_f32_16x16x32_bf16 v[108:111], a[248:251], a[40:43], v[108:111]
  v_exp_f32 v58, v58
  v_cvt_pk_bf16_f32 v131, v54, v55
  v_mfma_f32_16x16x32_bf16 v[108:111], a[252:255], a[44:47], v[108:111]
  s_waitcnt lgkmcnt(0)
  v_exp_f32 v59, v59
  v_exp_f32 v60, v60
  v_mfma_f32_16x16x32_bf16 v[16:19], a[240:243], a[144:147], 0
  ds_read_b128 a[248:251], v0 offset:24704
  v_cvt_pk_bf16_f32 v132, v56, v57
  v_mfma_f32_16x16x32_bf16 v[16:19], a[244:247], a[148:151], v[16:19]
  ds_read_b128 a[252:255], v1 offset:24704
  v_exp_f32 v61, v61
  v_mfma_f32_16x16x32_bf16 v[24:27], a[240:243], a[168:171], 0
  v_exp_f32 v62, v62
  v_cvt_pk_bf16_f32 v133, v58, v59
  v_mfma_f32_16x16x32_bf16 v[24:27], a[244:247], a[172:175], v[24:27]
  v_exp_f32 v63, v63
  v_cvt_pk_bf16_f32 v134, v60, v61
  v_cvt_pk_bf16_f32 v135, v62, v63
  v_mfma_f32_16x16x32_bf16 v[32:35], a[240:243], a[192:195], 0
  v_fma_f32 v64, v64, s30, -v4
  v_fma_f32 v65, v65, s30, -v4
  v_fma_f32 v66, v66, s30, -v4
  v_mfma_f32_16x16x32_bf16 v[32:35], a[244:247], a[196:199], v[32:35]
  v_max_f32 v3, v64, v65
  v_fma_f32 v67, v67, s30, -v4
  v_fma_f32 v68, v68, s30, -v4
  v_mfma_f32_16x16x32_bf16 v[40:43], a[240:243], a[216:219], 0
  v_max3_f32 v3, v3, v66, v67
  v_fma_f32 v69, v69, s30, -v4
  v_fma_f32 v70, v70, s30, -v4
  v_mfma_f32_16x16x32_bf16 v[40:43], a[244:247], a[220:223], v[40:43]
  v_max3_f32 v3, v3, v68, v69
  v_fma_f32 v71, v71, s30, -v4
  v_fma_f32 v72, v72, s30, -v5
  v_mfma_f32_16x16x32_bf16 v[48:51], a[240:243], a[0:3], 0
  v_max3_f32 v3, v3, v70, v71
  v_fma_f32 v73, v73, s30, -v5
  v_fma_f32 v74, v74, s30, -v5
  v_mfma_f32_16x16x32_bf16 v[48:51], a[244:247], a[4:7], v[48:51]
  v_max3_f32 v3, v3, v72, v73
  v_fma_f32 v75, v75, s30, -v5
  v_fma_f32 v76, v76, s30, -v5
  v_mfma_f32_16x16x32_bf16 v[56:59], a[240:243], a[24:27], 0
  v_max3_f32 v3, v3, v74, v75
  v_fma_f32 v77, v77, s30, -v5
  v_fma_f32 v78, v78, s30, -v5
  v_mfma_f32_16x16x32_bf16 v[56:59], a[244:247], a[28:31], v[56:59]
  s_waitcnt lgkmcnt(0)
  v_max3_f32 v3, v3, v76, v77
  v_fma_f32 v79, v79, s30, -v5
  v_fma_f32 v80, v80, s30, -v6
  v_mfma_f32_16x16x32_bf16 v[16:19], a[248:251], a[152:155], v[16:19]
  ds_read_b128 a[240:243], v0 offset:24832
  v_max3_f32 v3, v3, v78, v79
  v_fma_f32 v81, v81, s30, -v6
  v_mfma_f32_16x16x32_bf16 v[16:19], a[252:255], a[156:159], v[16:19]
  ds_read_b128 a[244:247], v1 offset:24832
  v_fma_f32 v82, v82, s30, -v6
  v_max3_f32 v3, v3, v80, v81
  v_mfma_f32_16x16x32_bf16 v[24:27], a[248:251], a[176:179], v[24:27]
  v_fma_f32 v83, v83, s30, -v6
  v_fma_f32 v84, v84, s30, -v6
  v_max3_f32 v3, v3, v82, v83
  v_mfma_f32_16x16x32_bf16 v[24:27], a[252:255], a[180:183], v[24:27]
  v_fma_f32 v85, v85, s30, -v6
  v_fma_f32 v86, v86, s30, -v6
  v_max3_f32 v3, v3, v84, v85
  v_mfma_f32_16x16x32_bf16 v[32:35], a[248:251], a[200:203], v[32:35]
  v_fma_f32 v87, v87, s30, -v6
  v_fma_f32 v88, v88, s30, -v7
  v_max3_f32 v3, v3, v86, v87
  v_mfma_f32_16x16x32_bf16 v[32:35], a[252:255], a[204:207], v[32:35]
  v_fma_f32 v89, v89, s30, -v7
  v_fma_f32 v90, v90, s30, -v7
  v_max3_f32 v3, v3, v88, v89
  v_mfma_f32_16x16x32_bf16 v[40:43], a[248:251], a[224:227], v[40:43]
  s_add_u32 s46, s34, 30976
  buffer_store_dwordx4 v[248:251], v15, s[24:27], s46 offen sc1
  v_mfma_f32_16x16x32_bf16 v[40:43], a[252:255], a[228:231], v[40:43]
  v_fma_f32 v91, v91, s30, -v7
  v_fma_f32 v92, v92, s30, -v7
  v_max3_f32 v3, v3, v90, v91
  v_fma_f32 v93, v93, s30, -v7
  v_mfma_f32_16x16x32_bf16 v[48:51], a[248:251], a[8:11], v[48:51]
  v_fma_f32 v94, v94, s30, -v7
  v_max3_f32 v3, v3, v92, v93
  v_fma_f32 v95, v95, s30, -v7
  v_mfma_f32_16x16x32_bf16 v[48:51], a[252:255], a[12:15], v[48:51]
  v_fma_f32 v96, v96, s30, -v8
  v_max3_f32 v3, v3, v94, v95
  v_fma_f32 v97, v97, s30, -v8
  v_mfma_f32_16x16x32_bf16 v[56:59], a[248:251], a[32:35], v[56:59]
  v_fma_f32 v98, v98, s30, -v8
  v_max3_f32 v3, v3, v96, v97
  v_fma_f32 v99, v99, s30, -v8
  v_mfma_f32_16x16x32_bf16 v[56:59], a[252:255], a[36:39], v[56:59]
  s_waitcnt lgkmcnt(0)
  v_fma_f32 v100, v100, s30, -v8
  v_max3_f32 v3, v3, v98, v99
  v_fma_f32 v101, v101, s30, -v8
  v_mfma_f32_16x16x32_bf16 v[16:19], a[240:243], a[160:163], v[16:19]
  ds_read_b128 a[248:251], v0 offset:30720
  v_fma_f32 v102, v102, s30, -v8
  v_max3_f32 v3, v3, v100, v101
  v_mfma_f32_16x16x32_bf16 v[16:19], a[244:247], a[164:167], v[16:19]
  ds_read_b128 a[252:255], v1 offset:30720
  v_fma_f32 v103, v103, s30, -v8
  v_fma_f32 v104, v104, s30, -v9
  v_mfma_f32_16x16x32_bf16 v[24:27], a[240:243], a[184:187], v[24:27]
  v_max3_f32 v3, v3, v102, v103
  v_fma_f32 v105, v105, s30, -v9
  v_fma_f32 v106, v106, s30, -v9
  v_mfma_f32_16x16x32_bf16 v[24:27], a[244:247], a[188:191], v[24:27]
  v_max3_f32 v3, v3, v104, v105
  v_fma_f32 v107, v107, s30, -v9
  v_fma_f32 v108, v108, s30, -v9
  v_mfma_f32_16x16x32_bf16 v[32:35], a[240:243], a[208:211], v[32:35]
  v_max3_f32 v3, v3, v106, v107
  v_fma_f32 v109, v109, s30, -v9
  v_fma_f32 v110, v110, s30, -v9
  v_mfma_f32_16x16x32_bf16 v[32:35], a[244:247], a[212:215], v[32:35]
  v_max3_f32 v3, v3, v108, v109
  v_fma_f32 v111, v111, s30, -v9
  v_max3_f32 v3, v3, v110, v111
  v_mfma_f32_16x16x32_bf16 v[40:43], a[240:243], a[232:235], v[40:43]
  v_cmp_lt_f32 vcc, s31, v3
  v_mfma_f32_16x16x32_bf16 v[40:43], a[244:247], a[236:239], v[40:43]
  s_cbranch_vccnz L_slow_1_5
L_back_1_5:
  v_exp_f32 v64, v64
  v_exp_f32 v65, v65
  v_mfma_f32_16x16x32_bf16 v[48:51], a[240:243], a[16:19], v[48:51]
  v_exp_f32 v66, v66
  v_exp_f32 v67, v67
  v_mfma_f32_16x16x32_bf16 v[48:51], a[244:247], a[20:23], v[48:51]
  v_exp_f32 v68, v68
  v_mfma_f32_16x16x32_bf16 v[56:59], a[240:243], a[40:43], v[56:59]
  v_cvt_pk_bf16_f32 v136, v64, v65
  v_exp_f32 v69, v69
  v_mfma_f32_16x16x32_bf16 v[56:59], a[244:247], a[44:47], v[56:59]
  s_waitcnt lgkmcnt(0)
  v_exp_f32 v70, v70
  v_cvt_pk_bf16_f32 v137, v66, v67
  v_mfma_f32_16x16x32_bf16 v[20:23], a[248:251], a[144:147], 0
  ds_read_b128 a[240:243], v0 offset:30848
  v_exp_f32 v71, v71
  v_mfma_f32_16x16x32_bf16 v[20:23], a[252:255], a[148:151], v[20:23]
  ds_read_b128 a[244:247], v1 offset:30848
  v_exp_f32 v72, v72
  v_cvt_pk_bf16_f32 v138, v68, v69
  v_mfma_f32_16x16x32_bf16 v[28:31], a[248:251], a[168:171], 0
  v_exp_f32 v73, v73
  v_mfma_f32_16x16x32_bf16 v[28:31], a[252:255], a[172:175], v[28:31]
  v_exp_f32 v74, v74
  v_cvt_pk_bf16_f32 v139, v70, v71
  v_mfma_f32_16x16x32_bf16 v[36:39], a[248:251], a[192:195], 0
  v_exp_f32 v75, v75
  v_exp_f32 v76, v76
  v_mfma_f32_16x16x32_bf16 v[36:39], a[252:255], a[196:199], v[36:39]
  v_cvt_pk_bf16_f32 v140, v72, v73
  v_exp_f32 v77, v77
  v_mfma_f32_16x16x32_bf16 v[44:47], a[248:251], a[216:219], 0
  v_exp_f32 v78, v78
  v_cvt_pk_bf16_f32 v141, v74, v75
  v_mfma_f32_16x16x32_bf16 v[44:47], a[252:255], a[220:223], v[44:47]
L_pad_12:
  s_cbranch_execz L_pad_16
  v_exp_f32 v79, v79
  v_mfma_f32_16x16x32_bf16 v[52:55], a[248:251], a[0:3], 0
  v_exp_f32 v80, v80
  v_cvt_pk_bf16_f32 v142, v76, v77
  v_mfma_f32_16x16x32_bf16 v[52:55], a[252:255], a[4:7], v[52:55]
  v_exp_f32 v81, v81
  v_exp_f32 v82, v82
  v_mfma_f32_16x16x32_bf16 v[60:63], a[248:251], a[24:27], 0
  v_cvt_pk_bf16_f32 v143, v78, v79
  v_exp_f32 v83, v83
  v_mfma_f32_16x16x32_bf16 v[60:63], a[252:255], a[28:31], v[60:63]
  s_waitcnt lgkmcnt(0)
  v_exp_f32 v84, v84
  v_cvt_pk_bf16_f32 v144, v80, v81
  v_mfma_f32_16x16x32_bf16 v[20:23], a[240:243], a[152:155], v[20:23]
  ds_read_b128 a[248:251], v0 offset:30976
  buffer_store_dwordx4 v[252:255], v15, s[24:27], s46 offen offset:3072 sc1
  v_mfma_f32_16x16x32_bf16 v[20:23], a[244:247], a[156:159], v[20:23]
  ds_read_b128 a[252:255], v1 offset:30976
  v_exp_f32 v85, v85
  v_mfma_f32_16x16x32_bf16 v[28:31], a[240:243], a[176:179], v[28:31]
  v_exp_f32 v86, v86
  v_cvt_pk_bf16_f32 v145, v82, v83
  v_mfma_f32_16x16x32_bf16 v[28:31], a[244:247], a[180:183], v[28:31]
  v_exp_f32 v87, v87
  v_exp_f32 v88, v88
  v_mfma_f32_16x16x32_bf16 v[36:39], a[240:243], a[200:203], v[36:39]
  v_cvt_pk_bf16_f32 v146, v84, v85
  v_exp_f32 v89, v89
  v_mfma_f32_16x16x32_bf16 v[36:39], a[244:247], a[204:207], v[36:39]
  v_exp_f32 v90, v90
  v_mfma_f32_16x16x32_bf16 v[44:47], a[240:243], a[224:227], v[44:47]
  v_cvt_pk_bf16_f32 v147, v86, v87
  v_exp_f32 v91, v91
  v_mfma_f32_16x16x32_bf16 v[44:47], a[244:247], a[228:231], v[44:47]
  v_exp_f32 v92, v92
  v_cvt_pk_bf16_f32 v148, v88, v89
  v_mfma_f32_16x16x32_bf16 v[52:55], a[240:243], a[8:11], v[52:55]
  v_exp_f32 v93, v93
  v_exp_f32 v94, v94
  v_mfma_f32_16x16x32_bf16 v[52:55], a[244:247], a[12:15], v[52:55]
  v_cvt_pk_bf16_f32 v149, v90, v91
  v_exp_f32 v95, v95
  v_mfma_f32_16x16x32_bf16 v[60:63], a[240:243], a[32:35], v[60:63]
  v_exp_f32 v96, v96
  v_cvt_pk_bf16_f32 v150, v92, v93
  v_mfma_f32_16x16x32_bf16 v[60:63], a[244:247], a[36:39], v[60:63]
  s_waitcnt vmcnt(8) lgkmcnt(0)
  s_barrier
  ds_read_b128 a[240:243], v0 offset:36864
  v_mfma_f32_16x16x32_bf16 v[20:23], a[248:251], a[160:163], v[20:23]
  ds_read_b128 a[244:247], v1 offset:36864
  v_exp_f32 v97, v97
  v_mfma_f32_16x16x32_bf16 v[20:23], a[252:255], a[164:167], v[20:23]
  v_exp_f32 v98, v98
  v_cvt_pk_bf16_f32 v151, v94, v95
  v_mfma_f32_16x16x32_bf16 v[28:31], a[248:251], a[184:187], v[28:31]
  v_exp_f32 v99, v99
  v_mfma_f32_16x16x32_bf16 v[28:31], a[252:255], a[188:191], v[28:31]
  v_exp_f32 v100, v100
  v_cvt_pk_bf16_f32 v152, v96, v97
  v_mfma_f32_16x16x32_bf16 v[36:39], a[248:251], a[208:211], v[36:39]
  s_add_u32 m0, s32, 73728
  v_exp_f32 v101, v101
  v_exp_f32 v102, v102
  v_mfma_f32_16x16x32_bf16 v[36:39], a[252:255], a[212:215], v[36:39]
  s_add_u32 s40, s37, 122880
  v_cvt_pk_bf16_f32 v153, v98, v99
  v_exp_f32 v103, v103
  v_mfma_f32_16x16x32_bf16 v[44:47], a[248:251], a[232:235], v[44:47]
  buffer_load_dwordx4 v12, s[16:19], s40 offen nt lds
  v_mfma_f32_16x16x32_bf16 v[44:47], a[252:255], a[236:239], v[44:47]
  buffer_load_dwordx4 v13, s[16:19], s40 offen offset:1024 nt lds
  v_exp_f32 v104, v104
  v_mfma_f32_16x16x32_bf16 v[52:55], a[248:251], a[16:19], v[52:55]
  buffer_load_dwordx4 v14, s[16:19], s40 offen offset:2048 nt lds
  v_cvt_pk_bf16_f32 v154, v100, v101
  v_mfma_f32_16x16x32_bf16 v[52:55], a[252:255], a[20:23], v[52:55]
  v_exp_f32 v105, v105
  v_mfma_f32_16x16x32_bf16 v[60:63], a[248:251], a[40:43], v[60:63]
  v_exp_f32 v106, v106
  v_cvt_pk_bf16_f32 v155, v102, v103
  v_mfma_f32_16x16x32_bf16 v[60:63], a[252:255], a[44:47], v[60:63]
  s_waitcnt lgkmcnt(0)
  v_exp_f32 v107, v107
  v_exp_f32 v108, v108
  v_mfma_f32_16x16x32_bf16 v[64:67], a[240:243], a[144:147], 0
  ds_read_b128 a[248:251], v0 offset:36992
  v_cvt_pk_bf16_f32 v156, v104, v105
  v_mfma_f32_16x16x32_bf16 v[64:67], a[244:247], a[148:151], v[64:67]
  ds_read_b128 a[252:255], v1 offset:36992
  v_exp_f32 v109, v109
  v_mfma_f32_16x16x32_bf16 v[72:75], a[240:243], a[168:171], 0
  v_exp_f32 v110, v110
  v_cvt_pk_bf16_f32 v157, v106, v107
  v_mfma_f32_16x16x32_bf16 v[72:75], a[244:247], a[172:175], v[72:75]
  v_exp_f32 v111, v111
  v_cvt_pk_bf16_f32 v158, v108, v109
  v_cvt_pk_bf16_f32 v159, v110, v111
  v_mfma_f32_16x16x32_bf16 v[80:83], a[240:243], a[192:195], 0
  v_fma_f32 v16, v16, s30, -v4
  v_fma_f32 v17, v17, s30, -v4
  v_fma_f32 v18, v18, s30, -v4
  v_mfma_f32_16x16x32_bf16 v[80:83], a[244:247], a[196:199], v[80:83]
  v_max_f32 v3, v16, v17
  v_fma_f32 v19, v19, s30, -v4
  v_fma_f32 v20, v20, s30, -v4
  v_mfma_f32_16x16x32_bf16 v[88:91], a[240:243], a[216:219], 0
  v_max3_f32 v3, v3, v18, v19
  v_fma_f32 v21, v21, s30, -v4
  v_fma_f32 v22, v22, s30, -v4
  v_mfma_f32_16x16x32_bf16 v[88:91], a[244:247], a[220:223], v[88:91]
  v_max3_f32 v3, v3, v20, v21
  v_fma_f32 v23, v23, s30, -v4
  v_fma_f32 v24, v24, s30, -v5
  v_mfma_f32_16x16x32_bf16 v[96:99], a[240:243], a[0:3], 0
  v_max3_f32 v3, v3, v22, v23
  v_fma_f32 v25, v25, s30, -v5
  v_fma_f32 v26, v26, s30, -v5
  v_mfma_f32_16x16x32_bf16 v[96:99], a[244:247], a[4:7], v[96:99]
  v_max3_f32 v3, v3, v24, v25
  v_fma_f32 v27, v27, s30, -v5
  v_fma_f32 v28, v28, s30, -v5
  v_mfma_f32_16x16x32_bf16 v[104:107], a[240:243], a[24:27], 0
  v_max3_f32 v3, v3, v26, v27
  v_fma_f32 v29, v29, s30, -v5
  v_fma_f32 v30, v30, s30, -v5
  v_mfma_f32_16x16x32_bf16 v[104:107], a[244:247], a[28:31], v[104:107]
  s_waitcnt lgkmcnt(0)
  v_max3_f32 v3, v3, v28, v29
  v_fma_f32 v31, v31, s30, -v5
  v_fma_f32 v32, v32, s30, -v6
  v_mfma_f32_16x16x32_bf16 v[64:67], a[248:251], a[152:155], v[64:67]
  ds_read_b128 a[240:243], v0 offset:37120
  v_max3_f32 v3, v3, v30, v31
  v_fma_f32 v33, v33, s30, -v6
  v_fma_f32 v34, v34, s30, -v6
  v_mfma_f32_16x16x32_bf16 v[64:67], a[252:255], a[156:159], v[64:67]
  ds_read_b128 a[244:247], v1 offset:37120
  v_max3_f32 v3, v3, v32, v33
  v_fma_f32 v35, v35, s30, -v6
  v_mfma_f32_16x16x32_bf16 v[72:75], a[248:251], a[176:179], v[72:75]
  v_fma_f32 v36, v36, s30, -v6
  v_max3_f32 v3, v3, v34, v35
  v_fma_f32 v37, v37, s30, -v6
  v_mfma_f32_16x16x32_bf16 v[72:75], a[252:255], a[180:183], v[72:75]
  v_fma_f32 v38, v38, s30, -v6
  v_max3_f32 v3, v3, v36, v37
  v_fma_f32 v39, v39, s30, -v6
  v_mfma_f32_16x16x32_bf16 v[80:83], a[248:251], a[200:203], v[80:83]
  v_fma_f32 v40, v40, s30, -v7
  v_max3_f32 v3, v3, v38, v39
  v_fma_f32 v41, v41, s30, -v7
  v_mfma_f32_16x16x32_bf16 v[80:83], a[252:255], a[204:207], v[80:83]
  v_fma_f32 v42, v42, s30, -v7
  v_max3_f32 v3, v3, v40, v41
  v_fma_f32 v43, v43, s30, -v7
  v_mfma_f32_16x16x32_bf16 v[88:91], a[248:251], a[224:227], v[88:91]
  v_fma_f32 v44, v44, s30, -v7
  v_max3_f32 v3, v3, v42, v43
  v_fma_f32 v45, v45, s30, -v7
  v_mfma_f32_16x16x32_bf16 v[88:91], a[252:255], a[228:231], v[88:91]
  v_fma_f32 v46, v46, s30, -v7
  v_max3_f32 v3, v3, v44, v45
  v_fma_f32 v47, v47, s30, -v7
  v_mfma_f32_16x16x32_bf16 v[96:99], a[248:251], a[8:11], v[96:99]
  v_fma_f32 v48, v48, s30, -v8
  v_max3_f32 v3, v3, v46, v47
  v_fma_f32 v49, v49, s30, -v8
  v_mfma_f32_16x16x32_bf16 v[96:99], a[252:255], a[12:15], v[96:99]
  v_fma_f32 v50, v50, s30, -v8
  v_max3_f32 v3, v3, v48, v49
  v_fma_f32 v51, v51, s30, -v8
  v_mfma_f32_16x16x32_bf16 v[104:107], a[248:251], a[32:35], v[104:107]
  v_fma_f32 v52, v52, s30, -v8
  v_max3_f32 v3, v3, v50, v51
  v_fma_f32 v53, v53, s30, -v8
  v_mfma_f32_16x16x32_bf16 v[104:107], a[252:255], a[36:39], v[104:107]
  s_waitcnt lgkmcnt(0)
  v_fma_f32 v54, v54, s30, -v8
  v_max3_f32 v3, v3, v52, v53
  v_fma_f32 v55, v55, s30, -v8
  v_mfma_f32_16x16x32_bf16 v[64:67], a[240:243], a[160:163], v[64:67]
  ds_read_b128 a[248:251], v0 offset:43008
  v_fma_f32 v56, v56, s30, -v9
  v_max3_f32 v3, v3, v54, v55
  v_mfma_f32_16x16x32_bf16 v[64:67], a[244:247], a[164:167], v[64:67]
  ds_read_b128 a[252:255], v1 offset:43008
  v_fma_f32 v57, v57, s30, -v9
  v_fma_f32 v58, v58, s30, -v9
  v_max3_f32 v3, v3, v56, v57
  v_mfma_f32_16x16x32_bf16 v[72:75], a[240:243], a[184:187], v[72:75]
  s_add_u32 m0, s32, 98304
  v_fma_f32 v59, v59, s30, -v9
  v_fma_f32 v60, v60, s30, -v9
  v_mfma_f32_16x16x32_bf16 v[72:75], a[244:247], a[188:191], v[72:75]
  s_add_u32 s40, s39, 0
  v_max3_f32 v3, v3, v58, v59
  v_fma_f32 v61, v61, s30, -v9
  v_fma_f32 v62, v62, s30, -v9
  v_mfma_f32_16x16x32_bf16 v[80:83], a[240:243], a[208:211], v[80:83]
  buffer_load_dwordx4 v2, s[20:23], s40 offen nt lds
  v_max3_f32 v3, v3, v60, v61
  v_mfma_f32_16x16x32_bf16 v[80:83], a[244:247], a[212:215], v[80:83]
  s_add_u32 s40, s39, 2048
  v_fma_f32 v63, v63, s30, -v9
  v_max3_f32 v3, v3, v62, v63
  v_mfma_f32_16x16x32_bf16 v[88:91], a[240:243], a[232:235], v[88:91]
  buffer_load_dwordx4 v2, s[20:23], s40 offen offset:1024 nt lds
  v_cmp_lt_f32 vcc, s31, v3
  v_mfma_f32_16x16x32_bf16 v[88:91], a[244:247], a[236:239], v[88:91]
  s_add_u32 s40, s39, 4096
  s_cbranch_vccnz L_slow_1_6
L_back_1_6:
  v_exp_f32 v16, v16
  v_mfma_f32_16x16x32_bf16 v[96:99], a[240:243], a[16:19], v[96:99]
  buffer_load_dwordx4 v2, s[20:23], s40 offen offset:2048 nt lds
  v_exp_f32 v17, v17
  v_mfma_f32_16x16x32_bf16 v[96:99], a[244:247], a[20:23], v[96:99]
  v_exp_f32 v18, v18
  v_mfma_f32_16x16x32_bf16 v[104:107], a[240:243], a[40:43], v[104:107]
  v_exp_f32 v19, v19
  v_exp_f32 v20, v20
  v_mfma_f32_16x16x32_bf16 v[104:107], a[244:247], a[44:47], v[104:107]
  s_waitcnt lgkmcnt(0)
  v_cvt_pk_bf16_f32 v160, v16, v17
  v_exp_f32 v21, v21
  v_mfma_f32_16x16x32_bf16 v[68:71], a[248:251], a[144:147], 0
  ds_read_b128 a[240:243], v0 offset:43136
  v_exp_f32 v22, v22
  v_mfma_f32_16x16x32_bf16 v[68:71], a[252:255], a[148:151], v[68:71]
  ds_read_b128 a[244:247], v1 offset:43136
  v_cvt_pk_bf16_f32 v161, v18, v19
  v_exp_f32 v23, v23
  v_mfma_f32_16x16x32_bf16 v[76:79], a[248:251], a[168:171], 0
  v_exp_f32 v24, v24
  v_mfma_f32_16x16x32_bf16 v[76:79], a[252:255], a[172:175], v[76:79]
  v_cvt_pk_bf16_f32 v162, v20, v21
  v_exp_f32 v25, v25
  v_mfma_f32_16x16x32_bf16 v[84:87], a[248:251], a[192:195], 0
  v_exp_f32 v26, v26
  v_cvt_pk_bf16_f32 v163, v22, v23
  v_mfma_f32_16x16x32_bf16 v[84:87], a[252:255], a[196:199], v[84:87]
  v_exp_f32 v27, v27
  v_exp_f32 v28, v28
  v_mfma_f32_16x16x32_bf16 v[92:95], a[248:251], a[216:219], 0
  v_cvt_pk_bf16_f32 v164, v24, v25
  v_exp_f32 v29, v29
  v_mfma_f32_16x16x32_bf16 v[92:95], a[252:255], a[220:223], v[92:95]
  v_exp_f32 v30, v30
  v_cvt_pk_bf16_f32 v165, v26, v27
  v_mfma_f32_16x16x32_bf16 v[100:103], a[248:251], a[0:3], 0
  v_exp_f32 v31, v31
  v_mfma_f32_16x16x32_bf16 v[100:103], a[252:255], a[4:7], v[100:103]
  v_exp_f32 v32, v32
  v_cvt_pk_bf16_f32 v166, v28, v29
  v_mfma_f32_16x16x32_bf16 v[108:111], a[248:251], a[24:27], 0
  v_exp_f32 v33, v33
  v_exp_f32 v34, v34
  v_mfma_f32_16x16x32_bf16 v[108:111], a[252:255], a[28:31], v[108:111]
  s_waitcnt lgkmcnt(0)
  v_cvt_pk_bf16_f32 v167, v30, v31
  v_exp_f32 v35, v35
  v_mfma_f32_16x16x32_bf16 v[68:71], a[240:243], a[152:155], v[68:71]
  ds_read_b128 a[248:251], v0 offset:43264
  v_exp_f32 v36, v36
  v_mfma_f32_16x16x32_bf16 v[68:71], a[244:247], a[156:159], v[68:71]
  ds_read_b128 a[252:255], v1 offset:43264
  v_cvt_pk_bf16_f32 v168, v32, v33
  v_exp_f32 v37, v37
  v_mfma_f32_16x16x32_bf16 v[76:79], a[240:243], a[176:179], v[76:79]
  v_exp_f32 v38, v38
  v_mfma_f32_16x16x32_bf16 v[76:79], a[244:247], a[180:183], v[76:79]
  v_cvt_pk_bf16_f32 v169, v34, v35
  v_exp_f32 v39, v39
  v_mfma_f32_16x16x32_bf16 v[84:87], a[240:243], a[200:203], v[84:87]
  v_exp_f32 v40, v40
  v_cvt_pk_bf16_f32 v170, v36, v37
  v_mfma_f32_16x16x32_bf16 v[84:87], a[244:247], a[204:207], v[84:87]
  v_exp_f32 v41, v41
  v_exp_f32 v42, v42
  v_mfma_f32_16x16x32_bf16 v[92:95], a[240:243], a[224:227], v[92:95]
  v_cvt_pk_bf16_f32 v171, v38, v39
  v_exp_f32 v43, v43
  v_mfma_f32_16x16x32_bf16 v[92:95], a[244:247], a[228:231], v[92:95]
  v_exp_f32 v44, v44
  v_cvt_pk_bf16_f32 v172, v40, v41
  v_mfma_f32_16x16x32_bf16 v[100:103], a[240:243], a[8:11], v[100:103]
  v_add_u32 v0, 49152, v0
  v_exp_f32 v45, v45
  v_mfma_f32_16x16x32_bf16 v[100:103], a[244:247], a[12:15], v[100:103]
  v_exp_f32 v46, v46
  v_cvt_pk_bf16_f32 v173, v42, v43
  v_mfma_f32_16x16x32_bf16 v[108:111], a[240:243], a[32:35], v[108:111]
  v_add_u32 v1, 49152, v1
  v_exp_f32 v47, v47
  v_mfma_f32_16x16x32_bf16 v[108:111], a[244:247], a[36:39], v[108:111]
  s_waitcnt lgkmcnt(0)
  ds_read_b128 a[240:243], v0 offset:0
  v_exp_f32 v48, v48
  v_mfma_f32_16x16x32_bf16 v[68:71], a[248:251], a[160:163], v[68:71]
  ds_read_b128 a[244:247], v1 offset:0
  v_cvt_pk_bf16_f32 v174, v44, v45
  v_exp_f32 v49, v49
  v_mfma_f32_16x16x32_bf16 v[68:71], a[252:255], a[164:167], v[68:71]
  v_exp_f32 v50, v50
  v_mfma_f32_16x16x32_bf16 v[76:79], a[248:251], a[184:187], v[76:79]
  v_cvt_pk_bf16_f32 v175, v46, v47
  v_exp_f32 v51, v51
  v_mfma_f32_16x16x32_bf16 v[76:79], a[252:255], a[188:191], v[76:79]
  v_exp_f32 v52, v52
  v_cvt_pk_bf16_f32 v176, v48, v49
  v_mfma_f32_16x16x32_bf16 v[84:87], a[248:251], a[208:211], v[84:87]
  s_add_u32 m0, s32, 86016
  v_exp_f32 v53, v53
  v_exp_f32 v54, v54
  v_mfma_f32_16x16x32_bf16 v[84:87], a[252:255], a[212:215], v[84:87]
  s_add_u32 s40, s37, 135168
  v_cvt_pk_bf16_f32 v177, v50, v51
  v_mfma_f32_16x16x32_bf16 v[92:95], a[248:251], a[232:235], v[92:95]
  buffer_load_dwordx4 v12, s[16:19], s40 offen nt lds
  v_exp_f32 v55, v55
  v_mfma_f32_16x16x32_bf16 v[92:95], a[252:255], a[236:239], v[92:95]
  buffer_load_dwordx4 v13, s[16:19], s40 offen offset:1024 nt lds
  v_exp_f32 v56, v56
  v_mfma_f32_16x16x32_bf16 v[100:103], a[248:251], a[16:19], v[100:103]
  buffer_load_dwordx4 v14, s[16:19], s40 offen offset:2048 nt lds
  v_mfma_f32_16x16x32_bf16 v[100:103], a[252:255], a[20:23], v[100:103]
  v_cvt_pk_bf16_f32 v178, v52, v53
  v_exp_f32 v57, v57
  v_mfma_f32_16x16x32_bf16 v[108:111], a[248:251], a[40:43], v[108:111]
  v_exp_f32 v58, v58
  v_cvt_pk_bf16_f32 v179, v54, v55
  v_mfma_f32_16x16x32_bf16 v[108:111], a[252:255], a[44:47], v[108:111]
  s_waitcnt lgkmcnt(0)
  v_exp_f32 v59, v59
  v_exp_f32 v60, v60
  v_mfma_f32_16x16x32_bf16 v[16:19], a[240:243], a[144:147], 0
  ds_read_b128 a[248:251], v0 offset:128
  v_cvt_pk_bf16_f32 v180, v56, v57
  v_mfma_f32_16x16x32_bf16 v[16:19], a[244:247], a[148:151], v[16:19]
  ds_read_b128 a[252:255], v1 offset:128
  v_exp_f32 v61, v61
  v_mfma_f32_16x16x32_bf16 v[24:27], a[240:243], a[168:171], 0
  v_exp_f32 v62, v62
  v_cvt_pk_bf16_f32 v181, v58, v59
  v_mfma_f32_16x16x32_bf16 v[24:27], a[244:247], a[172:175], v[24:27]
  v_exp_f32 v63, v63
  v_cvt_pk_bf16_f32 v182, v60, v61
  v_cvt_pk_bf16_f32 v183, v62, v63
  v_mfma_f32_16x16x32_bf16 v[32:35], a[240:243], a[192:195], 0
  v_fma_f32 v64, v64, s30, -v4
  v_fma_f32 v65, v65, s30, -v4
  v_fma_f32 v66, v66, s30, -v4
  v_mfma_f32_16x16x32_bf16 v[32:35], a[244:247], a[196:199], v[32:35]
  v_max_f32 v3, v64, v65
  v_fma_f32 v67, v67, s30, -v4
  v_fma_f32 v68, v68, s30, -v4
  v_mfma_f32_16x16x32_bf16 v[40:43], a[240:243], a[216:219], 0
  v_max3_f32 v3, v3, v66, v67
  v_fma_f32 v69, v69, s30, -v4
  v_fma_f32 v70, v70, s30, -v4
  v_mfma_f32_16x16x32_bf16 v[40:43], a[244:247], a[220:223], v[40:43]
  v_max3_f32 v3, v3, v68, v69
  v_fma_f32 v71, v71, s30, -v4
  v_fma_f32 v72, v72, s30, -v5
  v_mfma_f32_16x16x32_bf16 v[48:51], a[240:243], a[0:3], 0
  v_max3_f32 v3, v3, v70, v71
  v_fma_f32 v73, v73, s30, -v5
  v_fma_f32 v74, v74, s30, -v5
  v_mfma_f32_16x16x32_bf16 v[48:51], a[244:247], a[4:7], v[48:51]
  v_max3_f32 v3, v3, v72, v73
  v_fma_f32 v75, v75, s30, -v5
  v_fma_f32 v76, v76, s30, -v5
  v_mfma_f32_16x16x32_bf16 v[56:59], a[240:243], a[24:27], 0
  v_max3_f32 v3, v3, v74, v75
  v_fma_f32 v77, v77, s30, -v5
  v_fma_f32 v78, v78, s30, -v5
  v_mfma_f32_16x16x32_bf16 v[56:59], a[244:247], a[28:31], v[56:59]
  s_waitcnt lgkmcnt(0)
  v_max3_f32 v3, v3, v76, v77
  v_fma_f32 v79, v79, s30, -v5
  v_fma_f32 v80, v80, s30, -v6
  v_mfma_f32_16x16x32_bf16 v[16:19], a[248:251], a[152:155], v[16:19]
  ds_read_b128 a[240:243], v0 offset:256
  v_max3_f32 v3, v3, v78, v79
  v_fma_f32 v81, v81, s30, -v6
  v_mfma_f32_16x16x32_bf16 v[16:19], a[252:255], a[156:159], v[16:19]
  ds_read_b128 a[244:247], v1 offset:256
  v_fma_f32 v82, v82, s30, -v6
  v_max3_f32 v3, v3, v80, v81
  v_mfma_f32_16x16x32_bf16 v[24:27], a[248:251], a[176:179], v[24:27]
  v_fma_f32 v83, v83, s30, -v6
  v_fma_f32 v84, v84, s30, -v6
  v_max3_f32 v3, v3, v82, v83
  v_mfma_f32_16x16x32_bf16 v[24:27], a[252:255], a[180:183], v[24:27]
  v_fma_f32 v85, v85, s30, -v6
  v_fma_f32 v86, v86, s30, -v6
  v_max3_f32 v3, v3, v84, v85
  v_mfma_f32_16x16x32_bf16 v[32:35], a[248:251], a[200:203], v[32:35]
  v_fma_f32 v87, v87, s30, -v6
  v_fma_f32 v88, v88, s30, -v7
  v_max3_f32 v3, v3, v86, v87
  v_mfma_f32_16x16x32_bf16 v[32:35], a[252:255], a[204:207], v[32:35]
  v_fma_f32 v89, v89, s30, -v7
  v_fma_f32 v90, v90, s30, -v7
  v_max3_f32 v3, v3, v88, v89
  v_mfma_f32_16x16x32_bf16 v[40:43], a[248:251], a[224:227], v[40:43]
  v_fma_f32 v91, v91, s30, -v7
  v_fma_f32 v92, v92, s30, -v7
  v_max3_f32 v3, v3, v90, v91
  v_mfma_f32_16x16x32_bf16 v[40:43], a[252:255], a[228:231], v[40:43]
  v_fma_f32 v93, v93, s30, -v7
  v_fma_f32 v94, v94, s30, -v7
  v_max3_f32 v3, v3, v92, v93
  v_mfma_f32_16x16x32_bf16 v[48:51], a[248:251], a[8:11], v[48:51]
  v_fma_f32 v95, v95, s30, -v7
  v_fma_f32 v96, v96, s30, -v8
  v_max3_f32 v3, v3, v94, v95
  v_mfma_f32_16x16x32_bf16 v[48:51], a[252:255], a[12:15], v[48:51]
  v_fma_f32 v97, v97, s30, -v8
  v_fma_f32 v98, v98, s30, -v8
  v_max3_f32 v3, v3, v96, v97
  v_mfma_f32_16x16x32_bf16 v[56:59], a[248:251], a[32:35], v[56:59]
  v_fma_f32 v99, v99, s30, -v8
  v_fma_f32 v100, v100, s30, -v8
  v_max3_f32 v3, v3, v98, v99
  v_mfma_f32_16x16x32_bf16 v[56:59], a[252:255], a[36:39], v[56:59]
  s_waitcnt lgkmcnt(0)
  v_fma_f32 v101, v101, s30, -v8
  v_fma_f32 v102, v102, s30, -v8
  v_mfma_f32_16x16x32_bf16 v[16:19], a[240:243], a[160:163], v[16:19]
  ds_read_b128 a[248:251], v0 offset:6144
  v_max3_f32 v3, v3, v100, v101
  v_fma_f32 v103, v103, s30, -v8
  v_fma_f32 v104, v104, s30, -v9
  v_mfma_f32_16x16x32_bf16 v[16:19], a[244:247], a[164:167], v[16:19]
  ds_read_b128 a[252:255], v1 offset:6144
  v_max3_f32 v3, v3, v102, v103
  v_fma_f32 v105, v105, s30, -v9
  v_mfma_f32_16x16x32_bf16 v[24:27], a[240:243], a[184:187], v[24:27]
  s_add_u32 m0, s32, 110592
  v_fma_f32 v106, v106, s30, -v9
  v_max3_f32 v3, v3, v104, v105
  v_mfma_f32_16x16x32_bf16 v[24:27], a[244:247], a[188:191], v[24:27]
  s_add_u32 s40, s39, 36864
  v_fma_f32 v107, v107, s30, -v9
  v_fma_f32 v108, v108, s30, -v9
  v_max3_f32 v3, v3, v106, v107
  v_mfma_f32_16x16x32_bf16 v[32:35], a[240:243], a[208:211], v[32:35]
  buffer_load_dwordx4 v2, s[20:23], s40 offen nt lds
  v_fma_f32 v109, v109, s30, -v9
  v_mfma_f32_16x16x32_bf16 v[32:35], a[244:247], a[212:215], v[32:35]
  s_add_u32 s40, s39, 38912
  v_fma_f32 v110, v110, s30, -v9
  v_max3_f32 v3, v3, v108, v109
  v_mfma_f32_16x16x32_bf16 v[40:43], a[240:243], a[232:235], v[40:43]
  buffer_load_dwordx4 v2, s[20:23], s40 offen offset:1024 nt lds
  v_fma_f32 v111, v111, s30, -v9
  v_mfma_f32_16x16x32_bf16 v[40:43], a[244:247], a[236:239], v[40:43]
  s_add_u32 s40, s39, 40960
  v_max3_f32 v3, v3, v110, v111
  v_cmp_lt_f32 vcc, s31, v3
  v_mfma_f32_16x16x32_bf16 v[48:51], a[240:243], a[16:19], v[48:51]
  buffer_load_dwordx4 v2, s[20:23], s40 offen offset:2048 nt lds
  s_cbranch_vccnz L_slow_1_7
L_back_1_7:
  v_mfma_f32_16x16x32_bf16 v[48:51], a[244:247], a[20:23], v[48:51]
  v_exp_f32 v64, v64
  v_exp_f32 v65, v65
  v_mfma_f32_16x16x32_bf16 v[56:59], a[240:243], a[40:43], v[56:59]
  v_exp_f32 v66, v66
  v_mfma_f32_16x16x32_bf16 v[56:59], a[244:247], a[44:47], v[56:59]
  s_waitcnt lgkmcnt(0)
  v_exp_f32 v67, v67
  v_exp_f32 v68, v68
  v_mfma_f32_16x16x32_bf16 v[20:23], a[248:251], a[144:147], 0
  ds_read_b128 a[240:243], v0 offset:6272
  v_cvt_pk_bf16_f32 v184, v64, v65
  v_mfma_f32_16x16x32_bf16 v[20:23], a[252:255], a[148:151], v[20:23]
  ds_read_b128 a[244:247], v1 offset:6272
  v_exp_f32 v69, v69
  v_mfma_f32_16x16x32_bf16 v[28:31], a[248:251], a[168:171], 0
  v_exp_f32 v70, v70
  v_cvt_pk_bf16_f32 v185, v66, v67
  v_mfma_f32_16x16x32_bf16 v[28:31], a[252:255], a[172:175], v[28:31]
  v_exp_f32 v71, v71
  v_exp_f32 v72, v72
  v_mfma_f32_16x16x32_bf16 v[36:39], a[248:251], a[192:195], 0
  v_cvt_pk_bf16_f32 v186, v68, v69
  v_exp_f32 v73, v73
  v_mfma_f32_16x16x32_bf16 v[36:39], a[252:255], a[196:199], v[36:39]
  v_exp_f32 v74, v74
  v_cvt_pk_bf16_f32 v187, v70, v71
  v_mfma_f32_16x16x32_bf16 v[44:47], a[248:251], a[216:219], 0
  v_exp_f32 v75, v75
  v_mfma_f32_16x16x32_bf16 v[44:47], a[252:255], a[220:223], v[44:47]
  v_exp_f32 v76, v76
  v_cvt_pk_bf16_f32 v188, v72, v73
  v_mfma_f32_16x16x32_bf16 v[52:55], a[248:251], a[0:3], 0
  v_exp_f32 v77, v77
  v_exp_f32 v78, v78
  v_mfma_f32_16x16x32_bf16 v[52:55], a[252:255], a[4:7], v[52:55]
  v_cvt_pk_bf16_f32 v189, v74, v75
  v_exp_f32 v79, v79
  v_mfma_f32_16x16x32_bf16 v[60:63], a[248:251], a[24:27], 0
  v_exp_f32 v80, v80
  v_cvt_pk_bf16_f32 v190, v76, v77
  v_mfma_f32_16x16x32_bf16 v[60:63], a[252:255], a[28:31], v[60:63]
  s_waitcnt lgkmcnt(0)
  v_exp_f32 v81, v81
  v_mfma_f32_16x16x32_bf16 v[20:23], a[240:243], a[152:155], v[20:23]
  ds_read_b128 a[248:251], v0 offset:6400
  v_exp_f32 v82, v82
  v_cvt_pk_bf16_f32 v191, v78, v79
  v_mfma_f32_16x16x32_bf16 v[20:23], a[244:247], a[156:159], v[20:23]
  ds_read_b128 a[252:255], v1 offset:6400
  v_exp_f32 v83, v83
  v_mfma_f32_16x16x32_bf16 v[28:31], a[240:243], a[176:179], v[28:31]
  v_exp_f32 v84, v84
  v_cvt_pk_bf16_f32 v192, v80, v81
  v_mfma_f32_16x16x32_bf16 v[28:31], a[244:247], a[180:183], v[28:31]
  v_exp_f32 v85, v85
  v_mfma_f32_16x16x32_bf16 v[36:39], a[240:243], a[200:203], v[36:39]
  v_exp_f32 v86, v86
  v_cvt_pk_bf16_f32 v193, v82, v83
  v_mfma_f32_16x16x32_bf16 v[36:39], a[244:247], a[204:207], v[36:39]
  v_exp_f32 v87, v87
  v_exp_f32 v88, v88
  v_mfma_f32_16x16x32_bf16 v[44:47], a[240:243], a[224:227], v[44:47]
  v_cvt_pk_bf16_f32 v194, v84, v85
  v_exp_f32 v89, v89
  v_mfma_f32_16x16x32_bf16 v[44:47], a[244:247], a[228:231], v[44:47]
  v_exp_f32 v90, v90
  v_cvt_pk_bf16_f32 v195, v86, v87
  v_mfma_f32_16x16x32_bf16 v[52:55], a[240:243], a[8:11], v[52:55]
  v_exp_f32 v91, v91
  v_mfma_f32_16x16x32_bf16 v[52:55], a[244:247], a[12:15], v[52:55]
  v_exp_f32 v92, v92
  v_cvt_pk_bf16_f32 v196, v88, v89
  v_mfma_f32_16x16x32_bf16 v[60:63], a[240:243], a[32:35], v[60:63]
  v_exp_f32 v93, v93
  v_exp_f32 v94, v94
  v_mfma_f32_16x16x32_bf16 v[60:63], a[244:247], a[36:39], v[60:63]
  s_waitcnt vmcnt(9) lgkmcnt(0)
  s_barrier
  ds_read_b128 a[240:243], v0 offset:12288
  v_mfma_f32_16x16x32_bf16 v[20:23], a[248:251], a[160:163], v[20:23]
  ds_read_b128 a[244:247], v1 offset:12288
  v_cvt_pk_bf16_f32 v197, v90, v91
  v_mfma_f32_16x16x32_bf16 v[20:23], a[252:255], a[164:167], v[20:23]
  v_exp_f32 v95, v95
  v_exp_f32 v96, v96
  v_mfma_f32_16x16x32_bf16 v[28:31], a[248:251], a[184:187], v[28:31]
  v_cvt_pk_bf16_f32 v198, v92, v93
  v_exp_f32 v97, v97
  v_mfma_f32_16x16x32_bf16 v[28:31], a[252:255], a[188:191], v[28:31]
  v_exp_f32 v98, v98
  v_cvt_pk_bf16_f32 v199, v94, v95
  v_mfma_f32_16x16x32_bf16 v[36:39], a[248:251], a[208:211], v[36:39]
  v_exp_f32 v99, v99
  v_mfma_f32_16x16x32_bf16 v[36:39], a[252:255], a[212:215], v[36:39]
  v_exp_f32 v100, v100
  v_cvt_pk_bf16_f32 v200, v96, v97
  v_mfma_f32_16x16x32_bf16 v[44:47], a[248:251], a[232:235], v[44:47]
  v_exp_f32 v101, v101
  v_exp_f32 v102, v102
  v_mfma_f32_16x16x32_bf16 v[44:47], a[252:255], a[236:239], v[44:47]
  v_cvt_pk_bf16_f32 v201, v98, v99
  v_exp_f32 v103, v103
  v_mfma_f32_16x16x32_bf16 v[52:55], a[248:251], a[16:19], v[52:55]
  v_exp_f32 v104, v104
  v_cvt_pk_bf16_f32 v202, v100, v101
  v_mfma_f32_16x16x32_bf16 v[52:55], a[252:255], a[20:23], v[52:55]
  v_exp_f32 v105, v105
  v_mfma_f32_16x16x32_bf16 v[60:63], a[248:251], a[40:43], v[60:63]
  v_exp_f32 v106, v106
  v_cvt_pk_bf16_f32 v203, v102, v103
  v_mfma_f32_16x16x32_bf16 v[60:63], a[252:255], a[44:47], v[60:63]
  s_waitcnt lgkmcnt(0)
  v_exp_f32 v107, v107
  v_exp_f32 v108, v108
  v_mfma_f32_16x16x32_bf16 v[64:67], a[240:243], a[144:147], 0
  ds_read_b128 a[248:251], v0 offset:12416
  v_cvt_pk_bf16_f32 v204, v104, v105
  v_mfma_f32_16x16x32_bf16 v[64:67], a[244:247], a[148:151], v[64:67]
  ds_read_b128 a[252:255], v1 offset:12416
  v_exp_f32 v109, v109
  v_exp_f32 v110, v110
  v_mfma_f32_16x16x32_bf16 v[72:75], a[240:243], a[168:171], 0
L_pad_13:
  s_cbranch_execz L_pad_17
  v_cvt_pk_bf16_f32 v205, v106, v107
  v_exp_f32 v111, v111
  v_mfma_f32_16x16x32_bf16 v[72:75], a[244:247], a[172:175], v[72:75]
  v_cvt_pk_bf16_f32 v206, v108, v109
  v_cvt_pk_bf16_f32 v207, v110, v111
  v_mfma_f32_16x16x32_bf16 v[80:83], a[240:243], a[192:195], 0
  v_fma_f32 v16, v16, s30, -v4
  v_fma_f32 v17, v17, s30, -v4
  v_fma_f32 v18, v18, s30, -v4
  v_mfma_f32_16x16x32_bf16 v[80:83], a[244:247], a[196:199], v[80:83]
  v_max_f32 v3, v16, v17
  v_fma_f32 v19, v19, s30, -v4
  v_fma_f32 v20, v20, s30, -v4
  v_mfma_f32_16x16x32_bf16 v[88:91], a[240:243], a[216:219], 0
  v_max3_f32 v3, v3, v18, v19
  v_fma_f32 v21, v21, s30, -v4
  v_fma_f32 v22, v22, s30, -v4
  v_mfma_f32_16x16x32_bf16 v[88:91], a[244:247], a[220:223], v[88:91]
  v_max3_f32 v3, v3, v20, v21
  v_fma_f32 v23, v23, s30, -v4
  v_fma_f32 v24, v24, s30, -v5
  v_mfma_f32_16x16x32_bf16 v[96:99], a[240:243], a[0:3], 0
  s_add_u32 m0, s32, 122880
  v_max3_f32 v3, v3, v22, v23
  v_fma_f32 v25, v25, s30, -v5
  v_fma_f32 v26, v26, s30, -v5
  v_mfma_f32_16x16x32_bf16 v[96:99], a[244:247], a[4:7], v[96:99]
  s_add_u32 s40, s39, 73728
  v_max3_f32 v3, v3, v24, v25
  v_fma_f32 v27, v27, s30, -v5
  v_mfma_f32_16x16x32_bf16 v[104:107], a[240:243], a[24:27], 0
  buffer_load_dwordx4 v2, s[20:23], s40 offen nt lds
  v_fma_f32 v28, v28, s30, -v5
  v_mfma_f32_16x16x32_bf16 v[104:107], a[244:247], a[28:31], v[104:107]
  s_waitcnt lgkmcnt(0)
  s_add_u32 s40, s39, 75776
  v_max3_f32 v3, v3, v26, v27
  v_fma_f32 v29, v29, s30, -v5
  v_fma_f32 v30, v30, s30, -v5
  v_mfma_f32_16x16x32_bf16 v[64:67], a[248:251], a[152:155], v[64:67]
  ds_read_b128 a[240:243], v0 offset:12544
  buffer_load_dwordx4 v2, s[20:23], s40 offen offset:1024 nt lds
  v_mfma_f32_16x16x32_bf16 v[64:67], a[252:255], a[156:159], v[64:67]
  ds_read_b128 a[244:247], v1 offset:12544
  s_add_u32 s40, s39, 77824
  v_max3_f32 v3, v3, v28, v29
  v_fma_f32 v31, v31, s30, -v5
  v_mfma_f32_16x16x32_bf16 v[72:75], a[248:251], a[176:179], v[72:75]
  buffer_load_dwordx4 v2, s[20:23], s40 offen offset:2048 nt lds
  v_fma_f32 v32, v32, s30, -v6
  v_mfma_f32_16x16x32_bf16 v[72:75], a[252:255], a[180:183], v[72:75]
  v_max3_f32 v3, v3, v30, v31
  v_fma_f32 v33, v33, s30, -v6
  v_fma_f32 v34, v34, s30, -v6
  v_mfma_f32_16x16x32_bf16 v[80:83], a[248:251], a[200:203], v[80:83]
  v_max3_f32 v3, v3, v32, v33
  v_fma_f32 v35, v35, s30, -v6
  v_fma_f32 v36, v36, s30, -v6
  v_mfma_f32_16x16x32_bf16 v[80:83], a[252:255], a[204:207], v[80:83]
  v_max3_f32 v3, v3, v34, v35
  v_fma_f32 v37, v37, s30, -v6
  v_fma_f32 v38, v38, s30, -v6
  v_mfma_f32_16x16x32_bf16 v[88:91], a[248:251], a[224:227], v[88:91]
  v_max3_f32 v3, v3, v36, v37
  v_fma_f32 v39, v39, s30, -v6
  v_fma_f32 v40, v40, s30, -v7
  v_mfma_f32_16x16x32_bf16 v[88:91], a[252:255], a[228:231], v[88:91]
  v_max3_f32 v3, v3, v38, v39
  v_fma_f32 v41, v41, s30, -v7
  v_fma_f32 v42, v42, s30, -v7
  v_mfma_f32_16x16x32_bf16 v[96:99], a[248:251], a[8:11], v[96:99]
  v_max3_f32 v3, v3, v40, v41
  v_fma_f32 v43, v43, s30, -v7
  v_fma_f32 v44, v44, s30, -v7
  v_mfma_f32_16x16x32_bf16 v[96:99], a[252:255], a[12:15], v[96:99]
  v_max3_f32 v3, v3, v42, v43
  v_fma_f32 v45, v45, s30, -v7
  v_fma_f32 v46, v46, s30, -v7
  v_mfma_f32_16x16x32_bf16 v[104:107], a[248:251], a[32:35], v[104:107]
  v_max3_f32 v3, v3, v44, v45
  v_fma_f32 v47, v47, s30, -v7
  v_fma_f32 v48, v48, s30, -v8
  v_mfma_f32_16x16x32_bf16 v[104:107], a[252:255], a[36:39], v[104:107]
  s_waitcnt lgkmcnt(0)
  v_max3_f32 v3, v3, v46, v47
  v_fma_f32 v49, v49, s30, -v8
  v_fma_f32 v50, v50, s30, -v8
  v_mfma_f32_16x16x32_bf16 v[64:67], a[240:243], a[160:163], v[64:67]
  ds_read_b128 a[248:251], v0 offset:18432
  v_max3_f32 v3, v3, v48, v49
  v_fma_f32 v51, v51, s30, -v8
  v_fma_f32 v52, v52, s30, -v8
  v_mfma_f32_16x16x32_bf16 v[64:67], a[244:247], a[164:167], v[64:67]
  ds_read_b128 a[252:255], v1 offset:18432
  v_max3_f32 v3, v3, v50, v51
  v_fma_f32 v53, v53, s30, -v8
  v_mfma_f32_16x16x32_bf16 v[72:75], a[240:243], a[184:187], v[72:75]
  v_fma_f32 v54, v54, s30, -v8
  v_max3_f32 v3, v3, v52, v53
  v_fma_f32 v55, v55, s30, -v8
  v_mfma_f32_16x16x32_bf16 v[72:75], a[244:247], a[188:191], v[72:75]
  v_fma_f32 v56, v56, s30, -v9
  v_max3_f32 v3, v3, v54, v55
  v_fma_f32 v57, v57, s30, -v9
  v_mfma_f32_16x16x32_bf16 v[80:83], a[240:243], a[208:211], v[80:83]
  v_fma_f32 v58, v58, s30, -v9
  v_max3_f32 v3, v3, v56, v57
  v_fma_f32 v59, v59, s30, -v9
  v_mfma_f32_16x16x32_bf16 v[80:83], a[244:247], a[212:215], v[80:83]
  v_fma_f32 v60, v60, s30, -v9
  v_max3_f32 v3, v3, v58, v59
  v_fma_f32 v61, v61, s30, -v9
  v_mfma_f32_16x16x32_bf16 v[88:91], a[240:243], a[232:235], v[88:91]
  v_fma_f32 v62, v62, s30, -v9
  v_max3_f32 v3, v3, v60, v61
  v_fma_f32 v63, v63, s30, -v9
  v_mfma_f32_16x16x32_bf16 v[88:91], a[244:247], a[236:239], v[88:91]
  v_max3_f32 v3, v3, v62, v63
  v_cmp_lt_f32 vcc, s31, v3
  v_mfma_f32_16x16x32_bf16 v[96:99], a[240:243], a[16:19], v[96:99]
  s_cbranch_vccnz L_slow_1_8
L_back_1_8:
  v_exp_f32 v16, v16
  v_exp_f32 v17, v17
  v_mfma_f32_16x16x32_bf16 v[96:99], a[244:247], a[20:23], v[96:99]
  v_exp_f32 v18, v18
  v_mfma_f32_16x16x32_bf16 v[104:107], a[240:243], a[40:43], v[104:107]
  v_exp_f32 v19, v19
  v_exp_f32 v20, v20
  v_mfma_f32_16x16x32_bf16 v[104:107], a[244:247], a[44:47], v[104:107]
  s_waitcnt lgkmcnt(0)
  v_cvt_pk_bf16_f32 v208, v16, v17
  v_exp_f32 v21, v21
  v_mfma_f32_16x16x32_bf16 v[68:71], a[248:251], a[144:147], 0
  ds_read_b128 a[240:243], v0 offset:18560
  v_exp_f32 v22, v22
  v_mfma_f32_16x16x32_bf16 v[68:71], a[252:255], a[148:151], v[68:71]
  ds_read_b128 a[244:247], v1 offset:18560
  v_cvt_pk_bf16_f32 v209, v18, v19
  v_mfma_f32_16x16x32_bf16 v[76:79], a[248:251], a[168:171], 0
  v_exp_f32 v23, v23
  v_exp_f32 v24, v24
  v_mfma_f32_16x16x32_bf16 v[76:79], a[252:255], a[172:175], v[76:79]
  v_cvt_pk_bf16_f32 v210, v20, v21
  v_exp_f32 v25, v25
  v_mfma_f32_16x16x32_bf16 v[84:87], a[248:251], a[192:195], 0
  v_exp_f32 v26, v26
  v_cvt_pk_bf16_f32 v211, v22, v23
  v_mfma_f32_16x16x32_bf16 v[84:87], a[252:255], a[196:199], v[84:87]
  v_exp_f32 v27, v27
  v_mfma_f32_16x16x32_bf16 v[92:95], a[248:251], a[216:219], 0
  v_exp_f32 v28, v28
  v_cvt_pk_bf16_f32 v212, v24, v25
  v_mfma_f32_16x16x32_bf16 v[92:95], a[252:255], a[220:223], v[92:95]
  v_exp_f32 v29, v29
  v_exp_f32 v30, v30
  v_mfma_f32_16x16x32_bf16 v[100:103], a[248:251], a[0:3], 0
  s_add_u32 m0, s32, 135168
  v_cvt_pk_bf16_f32 v213, v26, v27
  v_exp_f32 v31, v31
  v_mfma_f32_16x16x32_bf16 v[100:103], a[252:255], a[4:7], v[100:103]
  s_add_u32 s40, s39, 110592
  v_exp_f32 v32, v32
  v_mfma_f32_16x16x32_bf16 v[108:111], a[248:251], a[24:27], 0
  buffer_load_dwordx4 v2, s[20:23], s40 offen nt lds
  v_cvt_pk_bf16_f32 v214, v28, v29
  v_mfma_f32_16x16x32_bf16 v[108:111], a[252:255], a[28:31], v[108:111]
  s_waitcnt lgkmcnt(0)
  s_add_u32 s40, s39, 112640
  v_exp_f32 v33, v33
  v_mfma_f32_16x16x32_bf16 v[68:71], a[240:243], a[152:155], v[68:71]
  ds_read_b128 a[248:251], v0 offset:18688
  buffer_load_dwordx4 v2, s[20:23], s40 offen offset:1024 nt lds
  v_exp_f32 v34, v34
  v_mfma_f32_16x16x32_bf16 v[68:71], a[244:247], a[156:159], v[68:71]
  ds_read_b128 a[252:255], v1 offset:18688
  s_add_u32 s40, s39, 114688
  v_cvt_pk_bf16_f32 v215, v30, v31
  v_mfma_f32_16x16x32_bf16 v[76:79], a[240:243], a[176:179], v[76:79]
  buffer_load_dwordx4 v2, s[20:23], s40 offen offset:2048 nt lds
  v_mfma_f32_16x16x32_bf16 v[76:79], a[244:247], a[180:183], v[76:79]
  v_exp_f32 v35, v35
  v_exp_f32 v36, v36
  v_mfma_f32_16x16x32_bf16 v[84:87], a[240:243], a[200:203], v[84:87]
  v_cvt_pk_bf16_f32 v216, v32, v33
  v_exp_f32 v37, v37
  v_mfma_f32_16x16x32_bf16 v[84:87], a[244:247], a[204:207], v[84:87]
  v_exp_f32 v38, v38
  v_cvt_pk_bf16_f32 v217, v34, v35
  v_mfma_f32_16x16x32_bf16 v[92:95], a[240:243], a[224:227], v[92:95]
  v_exp_f32 v39, v39
  v_exp_f32 v40, v40
  v_mfma_f32_16x16x32_bf16 v[92:95], a[244:247], a[228:231], v[92:95]
  v_cvt_pk_bf16_f32 v218, v36, v37
  v_exp_f32 v41, v41
  v_mfma_f32_16x16x32_bf16 v[100:103], a[240:243], a[8:11], v[100:103]
  v_exp_f32 v42, v42
  v_mfma_f32_16x16x32_bf16 v[100:103], a[244:247], a[12:15], v[100:103]
  v_cvt_pk_bf16_f32 v219, v38, v39
  v_exp_f32 v43, v43
  v_mfma_f32_16x16x32_bf16 v[108:111], a[240:243], a[32:35], v[108:111]
  v_exp_f32 v44, v44
  v_cvt_pk_bf16_f32 v220, v40, v41
  v_mfma_f32_16x16x32_bf16 v[108:111], a[244:247], a[36:39], v[108:111]
  s_waitcnt lgkmcnt(0)
  ds_read_b128 a[240:243], v0 offset:24576
  v_exp_f32 v45, v45
  v_mfma_f32_16x16x32_bf16 v[68:71], a[248:251], a[160:163], v[68:71]
  ds_read_b128 a[244:247], v1 offset:24576
  v_exp_f32 v46, v46
  v_cvt_pk_bf16_f32 v221, v42, v43
  v_mfma_f32_16x16x32_bf16 v[68:71], a[252:255], a[164:167], v[68:71]
  v_exp_f32 v47, v47
  v_mfma_f32_16x16x32_bf16 v[76:79], a[248:251], a[184:187], v[76:79]
  v_exp_f32 v48, v48
  v_cvt_pk_bf16_f32 v222, v44, v45
  v_mfma_f32_16x16x32_bf16 v[76:79], a[252:255], a[188:191], v[76:79]
  v_exp_f32 v49, v49
  v_exp_f32 v50, v50
  v_mfma_f32_16x16x32_bf16 v[84:87], a[248:251], a[208:211], v[84:87]
  v_cvt_pk_bf16_f32 v223, v46, v47
  v_exp_f32 v51, v51
  v_mfma_f32_16x16x32_bf16 v[84:87], a[252:255], a[212:215], v[84:87]
  v_exp_f32 v52, v52
  v_cvt_pk_bf16_f32 v224, v48, v49
  v_mfma_f32_16x16x32_bf16 v[92:95], a[248:251], a[232:235], v[92:95]
  v_exp_f32 v53, v53
  v_exp_f32 v54, v54
  v_mfma_f32_16x16x32_bf16 v[92:95], a[252:255], a[236:239], v[92:95]
  v_cvt_pk_bf16_f32 v225, v50, v51
  v_exp_f32 v55, v55
  v_mfma_f32_16x16x32_bf16 v[100:103], a[248:251], a[16:19], v[100:103]
  v_exp_f32 v56, v56
  v_mfma_f32_16x16x32_bf16 v[100:103], a[252:255], a[20:23], v[100:103]
  v_cvt_pk_bf16_f32 v226, v52, v53
  v_exp_f32 v57, v57
  v_mfma_f32_16x16x32_bf16 v[108:111], a[248:251], a[40:43], v[108:111]
  v_exp_f32 v58, v58
  v_cvt_pk_bf16_f32 v227, v54, v55
  v_mfma_f32_16x16x32_bf16 v[108:111], a[252:255], a[44:47], v[108:111]
  s_waitcnt lgkmcnt(0)
  v_exp_f32 v59, v59
  v_exp_f32 v60, v60
  v_mfma_f32_16x16x32_bf16 v[16:19], a[240:243], a[144:147], 0
  ds_read_b128 a[248:251], v0 offset:24704
  v_cvt_pk_bf16_f32 v228, v56, v57
  v_mfma_f32_16x16x32_bf16 v[16:19], a[244:247], a[148:151], v[16:19]
  ds_read_b128 a[252:255], v1 offset:24704
  v_exp_f32 v61, v61
  v_mfma_f32_16x16x32_bf16 v[24:27], a[240:243], a[168:171], 0
  v_exp_f32 v62, v62
  v_cvt_pk_bf16_f32 v229, v58, v59
  v_mfma_f32_16x16x32_bf16 v[24:27], a[244:247], a[172:175], v[24:27]
  v_exp_f32 v63, v63
  v_cvt_pk_bf16_f32 v230, v60, v61
  v_cvt_pk_bf16_f32 v231, v62, v63
  v_mfma_f32_16x16x32_bf16 v[32:35], a[240:243], a[192:195], 0
  v_fma_f32 v64, v64, s30, -v4
  v_fma_f32 v65, v65, s30, -v4
  v_fma_f32 v66, v66, s30, -v4
  v_mfma_f32_16x16x32_bf16 v[32:35], a[244:247], a[196:199], v[32:35]
  v_max_f32 v3, v64, v65
  v_fma_f32 v67, v67, s30, -v4
  v_fma_f32 v68, v68, s30, -v4
  v_mfma_f32_16x16x32_bf16 v[40:43], a[240:243], a[216:219], 0
  v_max3_f32 v3, v3, v66, v67
  v_fma_f32 v69, v69, s30, -v4
  v_fma_f32 v70, v70, s30, -v4
  v_mfma_f32_16x16x32_bf16 v[40:43], a[244:247], a[220:223], v[40:43]
  v_max3_f32 v3, v3, v68, v69
  v_fma_f32 v71, v71, s30, -v4
  v_fma_f32 v72, v72, s30, -v5
  v_mfma_f32_16x16x32_bf16 v[48:51], a[240:243], a[0:3], 0
  v_max3_f32 v3, v3, v70, v71
  v_fma_f32 v73, v73, s30, -v5
  v_fma_f32 v74, v74, s30, -v5
  v_mfma_f32_16x16x32_bf16 v[48:51], a[244:247], a[4:7], v[48:51]
  v_max3_f32 v3, v3, v72, v73
  v_fma_f32 v75, v75, s30, -v5
  v_fma_f32 v76, v76, s30, -v5
  v_mfma_f32_16x16x32_bf16 v[56:59], a[240:243], a[24:27], 0
  v_max3_f32 v3, v3, v74, v75
  v_fma_f32 v77, v77, s30, -v5
  v_fma_f32 v78, v78, s30, -v5
  v_mfma_f32_16x16x32_bf16 v[56:59], a[244:247], a[28:31], v[56:59]
  s_waitcnt lgkmcnt(0)
  v_max3_f32 v3, v3, v76, v77
  v_fma_f32 v79, v79, s30, -v5
  v_fma_f32 v80, v80, s30, -v6
  v_mfma_f32_16x16x32_bf16 v[16:19], a[248:251], a[152:155], v[16:19]
  ds_read_b128 a[240:243], v0 offset:24832
  v_max3_f32 v3, v3, v78, v79
  v_fma_f32 v81, v81, s30, -v6
  v_mfma_f32_16x16x32_bf16 v[16:19], a[252:255], a[156:159], v[16:19]
  ds_read_b128 a[244:247], v1 offset:24832
  v_fma_f32 v82, v82, s30, -v6
  v_max3_f32 v3, v3, v80, v81
  v_mfma_f32_16x16x32_bf16 v[24:27], a[248:251], a[176:179], v[24:27]
  v_fma_f32 v83, v83, s30, -v6
  v_fma_f32 v84, v84, s30, -v6
  v_max3_f32 v3, v3, v82, v83
  v_mfma_f32_16x16x32_bf16 v[24:27], a[252:255], a[180:183], v[24:27]
  v_fma_f32 v85, v85, s30, -v6
  v_fma_f32 v86, v86, s30, -v6
  v_max3_f32 v3, v3, v84, v85
  v_mfma_f32_16x16x32_bf16 v[32:35], a[248:251], a[200:203], v[32:35]
  v_fma_f32 v87, v87, s30, -v6
  v_fma_f32 v88, v88, s30, -v7
  v_max3_f32 v3, v3, v86, v87
  v_mfma_f32_16x16x32_bf16 v[32:35], a[252:255], a[204:207], v[32:35]
  v_fma_f32 v89, v89, s30, -v7
  v_fma_f32 v90, v90, s30, -v7
  v_max3_f32 v3, v3, v88, v89
  v_mfma_f32_16x16x32_bf16 v[40:43], a[248:251], a[224:227], v[40:43]
  v_fma_f32 v91, v91, s30, -v7
  v_fma_f32 v92, v92, s30, -v7
  v_max3_f32 v3, v3, v90, v91
  v_mfma_f32_16x16x32_bf16 v[40:43], a[252:255], a[228:231], v[40:43]
  v_fma_f32 v93, v93, s30, -v7
  v_fma_f32 v94, v94, s30, -v7
  v_max3_f32 v3, v3, v92, v93
  v_mfma_f32_16x16x32_bf16 v[48:51], a[248:251], a[8:11], v[48:51]
  v_fma_f32 v95, v95, s30, -v7
  v_fma_f32 v96, v96, s30, -v8
  v_max3_f32 v3, v3, v94, v95
  v_mfma_f32_16x16x32_bf16 v[48:51], a[252:255], a[12:15], v[48:51]
  v_fma_f32 v97, v97, s30, -v8
  v_fma_f32 v98, v98, s30, -v8
  v_max3_f32 v3, v3, v96, v97
  v_mfma_f32_16x16x32_bf16 v[56:59], a[248:251], a[32:35], v[56:59]
  v_fma_f32 v99, v99, s30, -v8
  v_fma_f32 v100, v100, s30, -v8
  v_max3_f32 v3, v3, v98, v99
  v_mfma_f32_16x16x32_bf16 v[56:59], a[252:255], a[36:39], v[56:59]
  s_waitcnt lgkmcnt(0)
  v_fma_f32 v101, v101, s30, -v8
  v_fma_f32 v102, v102, s30, -v8
  v_mfma_f32_16x16x32_bf16 v[16:19], a[240:243], a[160:163], v[16:19]
  ds_read_b128 a[248:251], v0 offset:30720
  v_max3_f32 v3, v3, v100, v101
  v_fma_f32 v103, v103, s30, -v8
  v_fma_f32 v104, v104, s30, -v9
  v_mfma_f32_16x16x32_bf16 v[16:19], a[244:247], a[164:167], v[16:19]
  ds_read_b128 a[252:255], v1 offset:30720
  v_max3_f32 v3, v3, v102, v103
  v_fma_f32 v105, v105, s30, -v9
  v_mfma_f32_16x16x32_bf16 v[24:27], a[240:243], a[184:187], v[24:27]
  s_add_u32 m0, s32, 0
  v_fma_f32 v106, v106, s30, -v9
  v_max3_f32 v3, v3, v104, v105
  v_mfma_f32_16x16x32_bf16 v[24:27], a[244:247], a[188:191], v[24:27]
  s_add_u32 s40, s39, 128
  v_fma_f32 v107, v107, s30, -v9
  v_fma_f32 v108, v108, s30, -v9
  v_max3_f32 v3, v3, v106, v107
  v_mfma_f32_16x16x32_bf16 v[32:35], a[240:243], a[208:211], v[32:35]
  buffer_load_dwordx4 v2, s[20:23], s40 offen nt lds
  v_fma_f32 v109, v109, s30, -v9
  v_mfma_f32_16x16x32_bf16 v[32:35], a[244:247], a[212:215], v[32:35]
  s_add_u32 s40, s39, 2176
  v_fma_f32 v110, v110, s30, -v9
  v_max3_f32 v3, v3, v108, v109
  v_mfma_f32_16x16x32_bf16 v[40:43], a[240:243], a[232:235], v[40:43]
  buffer_load_dwordx4 v2, s[20:23], s40 offen offset:1024 nt lds
  v_fma_f32 v111, v111, s30, -v9
  v_mfma_f32_16x16x32_bf16 v[40:43], a[244:247], a[236:239], v[40:43]
  s_add_u32 s40, s39, 4224
  v_max3_f32 v3, v3, v110, v111
  v_cmp_lt_f32 vcc, s31, v3
  v_mfma_f32_16x16x32_bf16 v[48:51], a[240:243], a[16:19], v[48:51]
  buffer_load_dwordx4 v2, s[20:23], s40 offen offset:2048 nt lds
  s_cbranch_vccnz L_slow_1_9
L_back_1_9:
  v_mfma_f32_16x16x32_bf16 v[48:51], a[244:247], a[20:23], v[48:51]
  v_exp_f32 v64, v64
  v_exp_f32 v65, v65
  v_mfma_f32_16x16x32_bf16 v[56:59], a[240:243], a[40:43], v[56:59]
  v_exp_f32 v66, v66
  v_mfma_f32_16x16x32_bf16 v[56:59], a[244:247], a[44:47], v[56:59]
  s_waitcnt lgkmcnt(0)
  v_exp_f32 v67, v67
  v_exp_f32 v68, v68
  v_mfma_f32_16x16x32_bf16 v[20:23], a[248:251], a[144:147], 0
  ds_read_b128 a[240:243], v0 offset:30848
  v_cvt_pk_bf16_f32 v232, v64, v65
  v_mfma_f32_16x16x32_bf16 v[20:23], a[252:255], a[148:151], v[20:23]
  ds_read_b128 a[244:247], v1 offset:30848
  v_exp_f32 v69, v69
  v_mfma_f32_16x16x32_bf16 v[28:31], a[248:251], a[168:171], 0
  v_exp_f32 v70, v70
  v_cvt_pk_bf16_f32 v233, v66, v67
  v_mfma_f32_16x16x32_bf16 v[28:31], a[252:255], a[172:175], v[28:31]
  v_exp_f32 v71, v71
  v_exp_f32 v72, v72
  v_mfma_f32_16x16x32_bf16 v[36:39], a[248:251], a[192:195], 0
  v_cvt_pk_bf16_f32 v234, v68, v69
  v_exp_f32 v73, v73
  v_mfma_f32_16x16x32_bf16 v[36:39], a[252:255], a[196:199], v[36:39]
  v_exp_f32 v74, v74
  v_cvt_pk_bf16_f32 v235, v70, v71
  v_mfma_f32_16x16x32_bf16 v[44:47], a[248:251], a[216:219], 0
  v_exp_f32 v75, v75
  v_mfma_f32_16x16x32_bf16 v[44:47], a[252:255], a[220:223], v[44:47]
  v_exp_f32 v76, v76
  v_cvt_pk_bf16_f32 v236, v72, v73
  v_mfma_f32_16x16x32_bf16 v[52:55], a[248:251], a[0:3], 0
  v_exp_f32 v77, v77
  v_exp_f32 v78, v78
  v_mfma_f32_16x16x32_bf16 v[52:55], a[252:255], a[4:7], v[52:55]
  v_cvt_pk_bf16_f32 v237, v74, v75
  v_exp_f32 v79, v79
  v_mfma_f32_16x16x32_bf16 v[60:63], a[248:251], a[24:27], 0
  v_exp_f32 v80, v80
  v_cvt_pk_bf16_f32 v238, v76, v77
  v_mfma_f32_16x16x32_bf16 v[60:63], a[252:255], a[28:31], v[60:63]
  s_waitcnt lgkmcnt(0)
  v_exp_f32 v81, v81
  v_mfma_f32_16x16x32_bf16 v[20:23], a[240:243], a[152:155], v[20:23]
  ds_read_b128 a[248:251], v0 offset:30976
  v_exp_f32 v82, v82
  v_cvt_pk_bf16_f32 v239, v78, v79
  v_mfma_f32_16x16x32_bf16 v[20:23], a[244:247], a[156:159], v[20:23]
  ds_read_b128 a[252:255], v1 offset:30976
  v_exp_f32 v83, v83
  v_mfma_f32_16x16x32_bf16 v[28:31], a[240:243], a[176:179], v[28:31]
  v_exp_f32 v84, v84
  v_cvt_pk_bf16_f32 v240, v80, v81
  v_mfma_f32_16x16x32_bf16 v[28:31], a[244:247], a[180:183], v[28:31]
  v_exp_f32 v85, v85
  v_mfma_f32_16x16x32_bf16 v[36:39], a[240:243], a[200:203], v[36:39]
  v_exp_f32 v86, v86
  v_cvt_pk_bf16_f32 v241, v82, v83
  v_mfma_f32_16x16x32_bf16 v[36:39], a[244:247], a[204:207], v[36:39]
  v_exp_f32 v87, v87
  v_exp_f32 v88, v88
  v_mfma_f32_16x16x32_bf16 v[44:47], a[240:243], a[224:227], v[44:47]
  v_cvt_pk_bf16_f32 v242, v84, v85
  v_exp_f32 v89, v89
  v_mfma_f32_16x16x32_bf16 v[44:47], a[244:247], a[228:231], v[44:47]
  v_exp_f32 v90, v90
  v_cvt_pk_bf16_f32 v243, v86, v87
  v_mfma_f32_16x16x32_bf16 v[52:55], a[240:243], a[8:11], v[52:55]
  v_exp_f32 v91, v91
  v_mfma_f32_16x16x32_bf16 v[52:55], a[244:247], a[12:15], v[52:55]
  v_exp_f32 v92, v92
  v_cvt_pk_bf16_f32 v244, v88, v89
  v_mfma_f32_16x16x32_bf16 v[60:63], a[240:243], a[32:35], v[60:63]
  v_exp_f32 v93, v93
  v_exp_f32 v94, v94
  v_mfma_f32_16x16x32_bf16 v[60:63], a[244:247], a[36:39], v[60:63]
  s_waitcnt vmcnt(12) lgkmcnt(0)
  s_barrier
  ds_read_b128 a[240:243], v0 offset:36864
  v_mfma_f32_16x16x32_bf16 v[20:23], a[248:251], a[160:163], v[20:23]
  ds_read_b128 a[244:247], v1 offset:36864
  v_cvt_pk_bf16_f32 v245, v90, v91
  v_mfma_f32_16x16x32_bf16 v[20:23], a[252:255], a[164:167], v[20:23]
  v_exp_f32 v95, v95
  v_exp_f32 v96, v96
  v_mfma_f32_16x16x32_bf16 v[28:31], a[248:251], a[184:187], v[28:31]
  v_cvt_pk_bf16_f32 v246, v92, v93
  v_exp_f32 v97, v97
  v_mfma_f32_16x16x32_bf16 v[28:31], a[252:255], a[188:191], v[28:31]
  v_exp_f32 v98, v98
  v_cvt_pk_bf16_f32 v247, v94, v95
  v_mfma_f32_16x16x32_bf16 v[36:39], a[248:251], a[208:211], v[36:39]
  v_exp_f32 v99, v99
  v_mfma_f32_16x16x32_bf16 v[36:39], a[252:255], a[212:215], v[36:39]
  v_exp_f32 v100, v100
  v_cvt_pk_bf16_f32 v248, v96, v97
  v_mfma_f32_16x16x32_bf16 v[44:47], a[248:251], a[232:235], v[44:47]
  v_exp_f32 v101, v101
  v_exp_f32 v102, v102
  v_mfma_f32_16x16x32_bf16 v[44:47], a[252:255], a[236:239], v[44:47]
  v_cvt_pk_bf16_f32 v249, v98, v99
  v_exp_f32 v103, v103
  v_mfma_f32_16x16x32_bf16 v[52:55], a[248:251], a[16:19], v[52:55]
  v_exp_f32 v104, v104
  v_cvt_pk_bf16_f32 v250, v100, v101
  v_mfma_f32_16x16x32_bf16 v[52:55], a[252:255], a[20:23], v[52:55]
  v_exp_f32 v105, v105
  v_mfma_f32_16x16x32_bf16 v[60:63], a[248:251], a[40:43], v[60:63]
  v_exp_f32 v106, v106
  v_cvt_pk_bf16_f32 v251, v102, v103
  v_mfma_f32_16x16x32_bf16 v[60:63], a[252:255], a[44:47], v[60:63]
  s_waitcnt lgkmcnt(0)
  v_exp_f32 v107, v107
  v_exp_f32 v108, v108
  v_mfma_f32_16x16x32_bf16 v[64:67], a[240:243], a[144:147], 0
  ds_read_b128 a[248:251], v0 offset:36992
  v_cvt_pk_bf16_f32 v252, v104, v105
  v_mfma_f32_16x16x32_bf16 v[64:67], a[244:247], a[148:151], v[64:67]
  ds_read_b128 a[252:255], v1 offset:36992
  v_exp_f32 v109, v109
  v_exp_f32 v110, v110
  v_mfma_f32_16x16x32_bf16 v[72:75], a[240:243], a[168:171], 0
  v_cvt_pk_bf16_f32 v253, v106, v107
  v_exp_f32 v111, v111
  v_mfma_f32_16x16x32_bf16 v[72:75], a[244:247], a[172:175], v[72:75]
  v_cvt_pk_bf16_f32 v254, v108, v109
  v_cvt_pk_bf16_f32 v255, v110, v111
  v_mfma_f32_16x16x32_bf16 v[80:83], a[240:243], a[192:195], 0
  v_fma_f32 v16, v16, s30, -v4
  v_fma_f32 v17, v17, s30, -v4
  v_mfma_f32_16x16x32_bf16 v[80:83], a[244:247], a[196:199], v[80:83]
  v_fma_f32 v18, v18, s30, -v4
  v_max_f32 v3, v16, v17
  v_mfma_f32_16x16x32_bf16 v[88:91], a[240:243], a[216:219], 0
  v_fma_f32 v19, v19, s30, -v4
  v_fma_f32 v20, v20, s30, -v4
  v_mfma_f32_16x16x32_bf16 v[88:91], a[244:247], a[220:223], v[88:91]
  v_max3_f32 v3, v3, v18, v19
  v_fma_f32 v21, v21, s30, -v4
  v_mfma_f32_16x16x32_bf16 v[96:99], a[240:243], a[0:3], 0
  s_add_u32 m0, s32, 12288
  v_fma_f32 v22, v22, s30, -v4
  v_max3_f32 v3, v3, v20, v21
  v_mfma_f32_16x16x32_bf16 v[96:99], a[244:247], a[4:7], v[96:99]
  s_add_u32 s40, s39, 36992
  v_fma_f32 v23, v23, s30, -v4
  v_mfma_f32_16x16x32_bf16 v[104:107], a[240:243], a[24:27], 0
  buffer_load_dwordx4 v2, s[20:23], s40 offen nt lds
  v_mfma_f32_16x16x32_bf16 v[104:107], a[244:247], a[28:31], v[104:107]
  s_waitcnt lgkmcnt(0)
  s_add_u32 s40, s39, 39040
  v_fma_f32 v24, v24, s30, -v5
  v_max3_f32 v3, v3, v22, v23
  v_mfma_f32_16x16x32_bf16 v[64:67], a[248:251], a[152:155], v[64:67]
  ds_read_b128 a[240:243], v0 offset:37120
  buffer_load_dwordx4 v2, s[20:23], s40 offen offset:1024 nt lds
  v_mfma_f32_16x16x32_bf16 v[64:67], a[252:255], a[156:159], v[64:67]
  ds_read_b128 a[244:247], v1 offset:37120
  s_add_u32 s40, s39, 41088
  v_mfma_f32_16x16x32_bf16 v[72:75], a[248:251], a[176:179], v[72:75]
  buffer_load_dwordx4 v2, s[20:23], s40 offen offset:2048 nt lds
  v_fma_f32 v25, v25, s30, -v5
  v_mfma_f32_16x16x32_bf16 v[72:75], a[252:255], a[180:183], v[72:75]
  v_fma_f32 v26, v26, s30, -v5
  v_max3_f32 v3, v3, v24, v25
  v_mfma_f32_16x16x32_bf16 v[80:83], a[248:251], a[200:203], v[80:83]
  v_fma_f32 v27, v27, s30, -v5
  v_fma_f32 v28, v28, s30, -v5
  v_mfma_f32_16x16x32_bf16 v[80:83], a[252:255], a[204:207], v[80:83]
  v_max3_f32 v3, v3, v26, v27
  v_fma_f32 v29, v29, s30, -v5
  v_mfma_f32_16x16x32_bf16 v[88:91], a[248:251], a[224:227], v[88:91]
  v_fma_f32 v30, v30, s30, -v5
  v_max3_f32 v3, v3, v28, v29
  v_mfma_f32_16x16x32_bf16 v[88:91], a[252:255], a[228:231], v[88:91]
  v_fma_f32 v31, v31, s30, -v5
  v_fma_f32 v32, v32, s30, -v6
  v_mfma_f32_16x16x32_bf16 v[96:99], a[248:251], a[8:11], v[96:99]
  v_max3_f32 v3, v3, v30, v31
  v_fma_f32 v33, v33, s30, -v6
  v_mfma_f32_16x16x32_bf16 v[96:99], a[252:255], a[12:15], v[96:99]
  v_fma_f32 v34, v34, s30, -v6
  v_max3_f32 v3, v3, v32, v33
  v_mfma_f32_16x16x32_bf16 v[104:107], a[248:251], a[32:35], v[104:107]
  v_fma_f32 v35, v35, s30, -v6
  v_fma_f32 v36, v36, s30, -v6
  v_mfma_f32_16x16x32_bf16 v[104:107], a[252:255], a[36:39], v[104:107]
  s_waitcnt lgkmcnt(0)
  v_max3_f32 v3, v3, v34, v35
  v_fma_f32 v37, v37, s30, -v6
  v_mfma_f32_16x16x32_bf16 v[64:67], a[240:243], a[160:163], v[64:67]
  ds_read_b128 a[248:251], v0 offset:43008
  v_fma_f32 v38, v38, s30, -v6
  v_mfma_f32_16x16x32_bf16 v[64:67], a[244:247], a[164:167], v[64:67]
  ds_read_b128 a[252:255], v1 offset:43008
  v_max3_f32 v3, v3, v36, v37
  v_mfma_f32_16x16x32_bf16 v[72:75], a[240:243], a[184:187], v[72:75]
  v_fma_f32 v39, v39, s30, -v6
  v_fma_f32 v40, v40, s30, -v7
  v_mfma_f32_16x16x32_bf16 v[72:75], a[244:247], a[188:191], v[72:75]
L_pad_14:
  s_cbranch_execz L_pad_18
  v_max3_f32 v3, v3, v38, v39
  v_fma_f32 v41, v41, s30, -v7
  v_mfma_f32_16x16x32_bf16 v[80:83], a[240:243], a[208:211], v[80:83]
  v_fma_f32 v42, v42, s30, -v7
  v_max3_f32 v3, v3, v40, v41
  v_mfma_f32_16x16x32_bf16 v[80:83], a[244:247], a[212:215], v[80:83]
  v_fma_f32 v43, v43, s30, -v7
  v_fma_f32 v44, v44, s30, -v7
  v_mfma_f32_16x16x32_bf16 v[88:91], a[240:243], a[232:235], v[88:91]
  v_max3_f32 v3, v3, v42, v43
  v_fma_f32 v45, v45, s30, -v7
  v_mfma_f32_16x16x32_bf16 v[88:91], a[244:247], a[236:239], v[88:91]
  v_fma_f32 v46, v46, s30, -v7
  v_max3_f32 v3, v3, v44, v45
  v_mfma_f32_16x16x32_bf16 v[96:99], a[240:243], a[16:19], v[96:99]
  v_fma_f32 v47, v47, s30, -v7
  v_fma_f32 v48, v48, s30, -v8
  v_mfma_f32_16x16x32_bf16 v[96:99], a[244:247], a[20:23], v[96:99]
  v_max3_f32 v3, v3, v46, v47
  v_fma_f32 v49, v49, s30, -v8
  v_mfma_f32_16x16x32_bf16 v[104:107], a[240:243], a[40:43], v[104:107]
  v_fma_f32 v50, v50, s30, -v8
  v_max3_f32 v3, v3, v48, v49
  v_mfma_f32_16x16x32_bf16 v[104:107], a[244:247], a[44:47], v[104:107]
  s_waitcnt lgkmcnt(0)
  v_fma_f32 v51, v51, s30, -v8
  v_fma_f32 v52, v52, s30, -v8
  v_mfma_f32_16x16x32_bf16 v[68:71], a[248:251], a[144:147], 0
  ds_read_b128 a[240:243], v0 offset:43136
  v_max3_f32 v3, v3, v50, v51
  v_mfma_f32_16x16x32_bf16 v[68:71], a[252:255], a[148:151], v[68:71]
  ds_read_b128 a[244:247], v1 offset:43136
  v_fma_f32 v53, v53, s30, -v8
  v_mfma_f32_16x16x32_bf16 v[76:79], a[248:251], a[168:171], 0
  v_fma_f32 v54, v54, s30, -v8
  v_max3_f32 v3, v3, v52, v53
  v_mfma_f32_16x16x32_bf16 v[76:79], a[252:255], a[172:175], v[76:79]
  v_fma_f32 v55, v55, s30, -v8
  v_fma_f32 v56, v56, s30, -v9
  v_mfma_f32_16x16x32_bf16 v[84:87], a[248:251], a[192:195], 0
  v_max3_f32 v3, v3, v54, v55
  v_fma_f32 v57, v57, s30, -v9
  v_mfma_f32_16x16x32_bf16 v[84:87], a[252:255], a[196:199], v[84:87]
  v_fma_f32 v58, v58, s30, -v9
  v_max3_f32 v3, v3, v56, v57
  v_mfma_f32_16x16x32_bf16 v[92:95], a[248:251], a[216:219], 0
  v_fma_f32 v59, v59, s30, -v9
  v_fma_f32 v60, v60, s30, -v9
  v_mfma_f32_16x16x32_bf16 v[92:95], a[252:255], a[220:223], v[92:95]
  v_max3_f32 v3, v3, v58, v59
  v_fma_f32 v61, v61, s30, -v9
  v_mfma_f32_16x16x32_bf16 v[100:103], a[248:251], a[0:3], 0
  s_add_u32 m0, s32, 24576
  v_fma_f32 v62, v62, s30, -v9
  v_max3_f32 v3, v3, v60, v61
  v_mfma_f32_16x16x32_bf16 v[100:103], a[252:255], a[4:7], v[100:103]
  s_add_u32 s40, s39, 73856
  v_fma_f32 v63, v63, s30, -v9
  v_max3_f32 v3, v3, v62, v63
  v_mfma_f32_16x16x32_bf16 v[108:111], a[248:251], a[24:27], 0
  buffer_load_dwordx4 v2, s[20:23], s40 offen nt lds
  v_mfma_f32_16x16x32_bf16 v[108:111], a[252:255], a[28:31], v[108:111]
  s_waitcnt lgkmcnt(0)
  s_add_u32 s40, s39, 75904
  v_cmp_lt_f32 vcc, s31, v3
  v_mfma_f32_16x16x32_bf16 v[68:71], a[240:243], a[152:155], v[68:71]
  ds_read_b128 a[248:251], v0 offset:43264
  buffer_load_dwordx4 v2, s[20:23], s40 offen offset:1024 nt lds
  v_mfma_f32_16x16x32_bf16 v[68:71], a[244:247], a[156:159], v[68:71]
  ds_read_b128 a[252:255], v1 offset:43264
  s_add_u32 s40, s39, 77952
  s_cbranch_vccnz L_slow_1_10
L_back_1_10:
  v_mfma_f32_16x16x32_bf16 v[76:79], a[240:243], a[176:179], v[76:79]
  buffer_load_dwordx4 v2, s[20:23], s40 offen offset:2048 nt lds
  v_mfma_f32_16x16x32_bf16 v[76:79], a[244:247], a[180:183], v[76:79]
  v_exp_f32 v16, v16
  v_mfma_f32_16x16x32_bf16 v[84:87], a[240:243], a[200:203], v[84:87]
  v_exp_f32 v17, v17
  v_mfma_f32_16x16x32_bf16 v[84:87], a[244:247], a[204:207], v[84:87]
  v_exp_f32 v18, v18
  v_exp_f32 v19, v19
  v_mfma_f32_16x16x32_bf16 v[92:95], a[240:243], a[224:227], v[92:95]
  v_mbcnt_lo_u32_b32 v1, -1, 0
  v_mfma_f32_16x16x32_bf16 v[92:95], a[244:247], a[228:231], v[92:95]
  v_mbcnt_hi_u32_b32 v1, -1, v1
  v_lshrrev_b32 v3, 2, v1
  v_mfma_f32_16x16x32_bf16 v[100:103], a[240:243], a[8:11], v[100:103]
  v_lshlrev_b32 v0, 7, v3
  v_bfe_u32 v3, v1, 3, 2
  v_mfma_f32_16x16x32_bf16 v[100:103], a[244:247], a[12:15], v[100:103]
  v_lshl_add_u32 v0, v3, 5, v0
  v_and_b32 v3, 3, v1
  v_exp_f32 v20, v20
  v_mfma_f32_16x16x32_bf16 v[108:111], a[240:243], a[32:35], v[108:111]
  v_lshl_add_u32 v0, v3, 3, v0
  v_add_u32 v0, 98304, v0
  v_mfma_f32_16x16x32_bf16 v[108:111], a[244:247], a[36:39], v[108:111]
  s_waitcnt vmcnt(9) lgkmcnt(0)
  s_barrier
  ds_read_b64_tr_b16 a[240:241], v0 offset:0
  v_mfma_f32_16x16x32_bf16 v[68:71], a[248:251], a[160:163], v[68:71]
  ds_read_b64_tr_b16 a[242:243], v0 offset:2048
  v_cvt_pk_bf16_f32 v16, v16, v17
  v_mfma_f32_16x16x32_bf16 v[68:71], a[252:255], a[164:167], v[68:71]
  ds_read_b64_tr_b16 a[244:245], v0 offset:4096
  v_exp_f32 v21, v21
  v_mfma_f32_16x16x32_bf16 v[76:79], a[248:251], a[184:187], v[76:79]
  ds_read_b64_tr_b16 a[246:247], v0 offset:6144
  v_mfma_f32_16x16x32_bf16 v[76:79], a[252:255], a[188:191], v[76:79]
  v_exp_f32 v22, v22
  v_cvt_pk_bf16_f32 v17, v18, v19
  v_mfma_f32_16x16x32_bf16 v[84:87], a[248:251], a[208:211], v[84:87]
  v_exp_f32 v23, v23
  v_mfma_f32_16x16x32_bf16 v[84:87], a[252:255], a[212:215], v[84:87]
  v_exp_f32 v24, v24
  v_cvt_pk_bf16_f32 v18, v20, v21
  v_mfma_f32_16x16x32_bf16 v[92:95], a[248:251], a[232:235], v[92:95]
  v_exp_f32 v25, v25
  v_mfma_f32_16x16x32_bf16 v[92:95], a[252:255], a[236:239], v[92:95]
  v_exp_f32 v26, v26
  v_mfma_f32_16x16x32_bf16 v[100:103], a[248:251], a[16:19], v[100:103]
  v_cvt_pk_bf16_f32 v19, v22, v23
  v_exp_f32 v27, v27
  v_mfma_f32_16x16x32_bf16 v[100:103], a[252:255], a[20:23], v[100:103]
  v_exp_f32 v28, v28
  v_mfma_f32_16x16x32_bf16 v[108:111], a[248:251], a[40:43], v[108:111]
  v_cvt_pk_bf16_f32 v20, v24, v25
  v_exp_f32 v29, v29
  v_mfma_f32_16x16x32_bf16 v[108:111], a[252:255], a[44:47], v[108:111]
  s_waitcnt lgkmcnt(0)
  v_exp_f32 v30, v30
  v_mfma_f32_16x16x32_bf16 a[144:147], a[240:243], a[48:51], 0
  ds_read_b64_tr_b16 a[248:249], v0 offset:8192
  v_cvt_pk_bf16_f32 v21, v26, v27
  v_mfma_f32_16x16x32_bf16 a[144:147], a[244:247], a[72:75], a[144:147]
  ds_read_b64_tr_b16 a[250:251], v0 offset:10240
  v_exp_f32 v31, v31
  v_mfma_f32_16x16x32_bf16 a[148:151], a[240:243], a[52:55], 0
  v_xor_b32 v0, 32, v0
  v_cvt_pk_bf16_f32 v22, v28, v29
  v_mfma_f32_16x16x32_bf16 a[148:151], a[244:247], a[76:79], a[148:151]
  ds_read_b64_tr_b16 a[252:253], v0 offset:0
  v_cvt_pk_bf16_f32 v23, v30, v31
  v_mfma_f32_16x16x32_bf16 a[152:155], a[240:243], a[56:59], 0
  ds_read_b64_tr_b16 a[254:255], v0 offset:2048
  v_fma_f32 v64, v64, s30, -v4
  v_fma_f32 v65, v65, s30, -v4
  v_mfma_f32_16x16x32_bf16 a[152:155], a[244:247], a[80:83], a[152:155]
  v_fma_f32 v66, v66, s30, -v4
  v_max_f32 v3, v64, v65
  v_fma_f32 v67, v67, s30, -v4
  v_mfma_f32_16x16x32_bf16 a[156:159], a[240:243], a[60:63], 0
  v_fma_f32 v68, v68, s30, -v4
  v_max3_f32 v3, v3, v66, v67
  v_fma_f32 v69, v69, s30, -v4
  v_mfma_f32_16x16x32_bf16 a[156:159], a[244:247], a[84:87], a[156:159]
  v_fma_f32 v70, v70, s30, -v4
  v_max3_f32 v3, v3, v68, v69
  v_fma_f32 v71, v71, s30, -v4
  v_mfma_f32_16x16x32_bf16 a[160:163], a[240:243], a[64:67], 0
  v_fma_f32 v72, v72, s30, -v5
  v_max3_f32 v3, v3, v70, v71
  v_fma_f32 v73, v73, s30, -v5
  v_mfma_f32_16x16x32_bf16 a[160:163], a[244:247], a[88:91], a[160:163]
  v_fma_f32 v74, v74, s30, -v5
  v_max3_f32 v3, v3, v72, v73
  v_fma_f32 v75, v75, s30, -v5
  v_mfma_f32_16x16x32_bf16 a[164:167], a[240:243], a[68:71], 0
  v_fma_f32 v76, v76, s30, -v5
  v_max3_f32 v3, v3, v74, v75
  v_fma_f32 v77, v77, s30, -v5
  v_mfma_f32_16x16x32_bf16 a[164:167], a[244:247], a[92:95], a[164:167]
  s_waitcnt lgkmcnt(0)
  v_fma_f32 v78, v78, s30, -v5
  v_max3_f32 v3, v3, v76, v77
  v_fma_f32 v79, v79, s30, -v5
  v_accvgpr_write_b32 a24, s33
  v_mfma_f32_16x16x32_bf16 a[144:147], a[248:251], a[96:99], a[144:147]
  ds_read_b64_tr_b16 a[240:241], v0 offset:4096
  v_fma_f32 v80, v80, s30, -v6
  v_max3_f32 v3, v3, v78, v79
  v_mfma_f32_16x16x32_bf16 a[168:171], a[252:255], a[48:51], 0
  ds_read_b64_tr_b16 a[242:243], v0 offset:6144
  v_fma_f32 v81, v81, s30, -v6
  v_fma_f32 v82, v82, s30, -v6
  v_mfma_f32_16x16x32_bf16 a[148:151], a[248:251], a[100:103], a[148:151]
  ds_read_b64_tr_b16 a[244:245], v0 offset:8192
  v_max3_f32 v3, v3, v80, v81
  v_fma_f32 v83, v83, s30, -v6
  v_mfma_f32_16x16x32_bf16 a[172:175], a[252:255], a[52:55], 0
  ds_read_b64_tr_b16 a[246:247], v0 offset:10240
  v_fma_f32 v84, v84, s30, -v6
  v_max3_f32 v3, v3, v82, v83
  v_mfma_f32_16x16x32_bf16 a[152:155], a[248:251], a[104:107], a[152:155]
  v_xor_b32 v0, 96, v0
  v_fma_f32 v85, v85, s30, -v6
  v_accvgpr_write_b32 a25, s33
  v_mfma_f32_16x16x32_bf16 a[176:179], a[252:255], a[56:59], 0
  v_fma_f32 v86, v86, s30, -v6
  v_max3_f32 v3, v3, v84, v85
  v_fma_f32 v87, v87, s30, -v6
  v_mfma_f32_16x16x32_bf16 a[156:159], a[248:251], a[108:111], a[156:159]
  v_fma_f32 v88, v88, s30, -v7
  v_max3_f32 v3, v3, v86, v87
  v_fma_f32 v89, v89, s30, -v7
  v_mfma_f32_16x16x32_bf16 a[180:183], a[252:255], a[60:63], 0
  v_fma_f32 v90, v90, s30, -v7
  v_max3_f32 v3, v3, v88, v89
  v_fma_f32 v91, v91, s30, -v7
  v_mfma_f32_16x16x32_bf16 a[160:163], a[248:251], a[112:115], a[160:163]
  v_fma_f32 v92, v92, s30, -v7
  v_max3_f32 v3, v3, v90, v91
  v_fma_f32 v93, v93, s30, -v7
  v_mfma_f32_16x16x32_bf16 a[184:187], a[252:255], a[64:67], 0
  v_fma_f32 v94, v94, s30, -v7
  v_max3_f32 v3, v3, v92, v93
  v_fma_f32 v95, v95, s30, -v7
  v_mfma_f32_16x16x32_bf16 a[164:167], a[248:251], a[116:119], a[164:167]
  v_fma_f32 v96, v96, s30, -v8
  v_max3_f32 v3, v3, v94, v95
  v_fma_f32 v97, v97, s30, -v8
  v_mfma_f32_16x16x32_bf16 a[188:191], a[252:255], a[68:71], 0
  s_waitcnt lgkmcnt(0)
  v_fma_f32 v98, v98, s30, -v8
  v_max3_f32 v3, v3, v96, v97
  v_fma_f32 v99, v99, s30, -v8
  v_mfma_f32_16x16x32_bf16 a[168:171], a[240:243], a[72:75], a[168:171]
  ds_read_b64_tr_b16 a[248:249], v0 offset:0
  v_fma_f32 v100, v100, s30, -v8
  v_max3_f32 v3, v3, v98, v99
  v_accvgpr_write_b32 a26, s33
  v_mfma_f32_16x16x32_bf16 a[168:171], a[244:247], a[96:99], a[168:171]
  ds_read_b64_tr_b16 a[250:251], v0 offset:2048
  v_fma_f32 v101, v101, s30, -v8
  v_fma_f32 v102, v102, s30, -v8
  v_mfma_f32_16x16x32_bf16 a[172:175], a[240:243], a[76:79], a[172:175]
  ds_read_b64_tr_b16 a[252:253], v0 offset:4096
  s_add_u32 m0, s32, 36864
  v_max3_f32 v3, v3, v100, v101
  v_mfma_f32_16x16x32_bf16 a[172:175], a[244:247], a[100:103], a[172:175]
  ds_read_b64_tr_b16 a[254:255], v0 offset:6144
  s_add_u32 s40, s39, 110720
  v_fma_f32 v103, v103, s30, -v8
  v_fma_f32 v104, v104, s30, -v9
  v_mfma_f32_16x16x32_bf16 a[176:179], a[240:243], a[80:83], a[176:179]
  buffer_load_dwordx4 v2, s[20:23], s40 offen nt lds
  v_max3_f32 v3, v3, v102, v103
  v_mfma_f32_16x16x32_bf16 a[176:179], a[244:247], a[104:107], a[176:179]
  s_add_u32 s40, s39, 112768
  v_fma_f32 v105, v105, s30, -v9
  v_fma_f32 v106, v106, s30, -v9
  v_accvgpr_write_b32 a27, s33
  v_mfma_f32_16x16x32_bf16 a[180:183], a[240:243], a[84:87], a[180:183]
  buffer_load_dwordx4 v2, s[20:23], s40 offen offset:1024 nt lds
  v_max3_f32 v3, v3, v104, v105
  v_fma_f32 v107, v107, s30, -v9
  v_mfma_f32_16x16x32_bf16 a[180:183], a[244:247], a[108:111], a[180:183]
  s_add_u32 s40, s39, 114816
  v_fma_f32 v108, v108, s30, -v9
  v_max3_f32 v3, v3, v106, v107
  v_mfma_f32_16x16x32_bf16 a[184:187], a[240:243], a[88:91], a[184:187]
  buffer_load_dwordx4 v2, s[20:23], s40 offen offset:2048 nt lds
  v_fma_f32 v109, v109, s30, -v9
  v_mfma_f32_16x16x32_bf16 a[184:187], a[244:247], a[112:115], a[184:187]
  v_fma_f32 v110, v110, s30, -v9
  v_max3_f32 v3, v3, v108, v109
  v_fma_f32 v111, v111, s30, -v9
  v_mfma_f32_16x16x32_bf16 a[188:191], a[240:243], a[92:95], a[188:191]
  v_max3_f32 v3, v3, v110, v111
  v_cmp_lt_f32 vcc, s31, v3
  s_nop 0
  s_cbranch_vccnz L_slow_1_11
L_back_1_11:
  v_mfma_f32_16x16x32_bf16 a[188:191], a[244:247], a[116:119], a[188:191]
  s_waitcnt lgkmcnt(0)
  v_exp_f32 v32, v32
  v_mfma_f32_16x16x32_bf16 a[192:195], a[248:251], a[48:51], 0
  ds_read_b64_tr_b16 a[240:241], v0 offset:8192
  v_mfma_f32_16x16x32_bf16 a[192:195], a[252:255], a[72:75], a[192:195]
  ds_read_b64_tr_b16 a[242:243], v0 offset:10240
  v_mfma_f32_16x16x32_bf16 a[0:3], a[24:27], a[48:51], 0
  v_xor_b32 v0, 32, v0
  v_mfma_f32_16x16x32_bf16 a[0:3], a[24:27], a[72:75], a[0:3]
  ds_read_b64_tr_b16 a[244:245], v0 offset:0
  v_mfma_f32_16x16x32_bf16 a[196:199], a[248:251], a[52:55], 0
  ds_read_b64_tr_b16 a[246:247], v0 offset:2048
  v_mfma_f32_16x16x32_bf16 a[196:199], a[252:255], a[76:79], a[196:199]
  v_exp_f32 v33, v33
  v_mfma_f32_16x16x32_bf16 a[200:203], a[248:251], a[56:59], 0
  v_mfma_f32_16x16x32_bf16 a[200:203], a[252:255], a[80:83], a[200:203]
  v_exp_f32 v34, v34
  v_mfma_f32_16x16x32_bf16 a[4:7], a[24:27], a[52:55], 0
  v_mfma_f32_16x16x32_bf16 a[4:7], a[24:27], a[76:79], a[4:7]
  v_exp_f32 v35, v35
  v_mfma_f32_16x16x32_bf16 a[204:207], a[248:251], a[60:63], 0
  v_mfma_f32_16x16x32_bf16 a[204:207], a[252:255], a[84:87], a[204:207]
  v_exp_f32 v36, v36
  v_mfma_f32_16x16x32_bf16 a[208:211], a[248:251], a[64:67], 0
  v_cvt_pk_bf16_f32 v24, v32, v33
  v_mfma_f32_16x16x32_bf16 a[208:211], a[252:255], a[88:91], a[208:211]
  v_exp_f32 v37, v37
  v_mfma_f32_16x16x32_bf16 a[212:215], a[248:251], a[68:71], 0
  v_mfma_f32_16x16x32_bf16 a[212:215], a[252:255], a[92:95], a[212:215]
  v_exp_f32 v38, v38
  v_mfma_f32_16x16x32_bf16 a[8:11], a[24:27], a[56:59], 0
  v_cvt_pk_bf16_f32 v25, v34, v35
  v_mfma_f32_16x16x32_bf16 a[8:11], a[24:27], a[80:83], a[8:11]
  s_waitcnt lgkmcnt(0)
  v_mfma_f32_16x16x32_bf16 a[192:195], a[240:243], a[96:99], a[192:195]
  ds_read_b64_tr_b16 a[248:249], v0 offset:4096
  v_exp_f32 v39, v39
  v_mfma_f32_16x16x32_bf16 a[216:219], a[244:247], a[48:51], 0
  ds_read_b64_tr_b16 a[250:251], v0 offset:6144
  v_mfma_f32_16x16x32_bf16 a[196:199], a[240:243], a[100:103], a[196:199]
  ds_read_b64_tr_b16 a[252:253], v0 offset:8192
  v_mfma_f32_16x16x32_bf16 a[220:223], a[244:247], a[52:55], 0
  ds_read_b64_tr_b16 a[254:255], v0 offset:10240
  v_mfma_f32_16x16x32_bf16 a[200:203], a[240:243], a[104:107], a[200:203]
  v_xor_b32 v0, 96, v0
  v_mfma_f32_16x16x32_bf16 a[224:227], a[244:247], a[56:59], 0
  v_mfma_f32_16x16x32_bf16 a[12:15], a[24:27], a[60:63], 0
  v_exp_f32 v40, v40
  v_mfma_f32_16x16x32_bf16 a[12:15], a[24:27], a[84:87], a[12:15]
  v_cvt_pk_bf16_f32 v26, v36, v37
  v_mfma_f32_16x16x32_bf16 a[204:207], a[240:243], a[108:111], a[204:207]
  v_exp_f32 v41, v41
  v_mfma_f32_16x16x32_bf16 a[228:231], a[244:247], a[60:63], 0
  v_mfma_f32_16x16x32_bf16 a[208:211], a[240:243], a[112:115], a[208:211]
  v_exp_f32 v42, v42
  v_mfma_f32_16x16x32_bf16 a[232:235], a[244:247], a[64:67], 0
  v_cvt_pk_bf16_f32 v27, v38, v39
  v_mfma_f32_16x16x32_bf16 a[212:215], a[240:243], a[116:119], a[212:215]
  v_exp_f32 v43, v43
  v_mfma_f32_16x16x32_bf16 a[236:239], a[244:247], a[68:71], 0
  ds_read_b64_tr_b16 a[240:241], v0 offset:12288
  v_mfma_f32_16x16x32_bf16 a[16:19], a[24:27], a[64:67], 0
  ds_read_b64_tr_b16 a[242:243], v0 offset:14336
  v_mfma_f32_16x16x32_bf16 a[16:19], a[24:27], a[88:91], a[16:19]
  s_waitcnt lgkmcnt(2)
  ds_read_b64_tr_b16 a[244:245], v0 offset:16384
  v_mfma_f32_16x16x32_bf16 a[216:219], a[248:251], a[72:75], a[216:219]
  ds_read_b64_tr_b16 a[246:247], v0 offset:18432
  v_mfma_f32_16x16x32_bf16 a[216:219], a[252:255], a[96:99], a[216:219]
  v_mfma_f32_16x16x32_bf16 a[220:223], a[248:251], a[76:79], a[220:223]
  v_exp_f32 v44, v44
  v_mfma_f32_16x16x32_bf16 a[220:223], a[252:255], a[100:103], a[220:223]
  v_cvt_pk_bf16_f32 v28, v40, v41
  v_mfma_f32_16x16x32_bf16 a[224:227], a[248:251], a[80:83], a[224:227]
  v_exp_f32 v45, v45
  v_mfma_f32_16x16x32_bf16 a[224:227], a[252:255], a[104:107], a[224:227]
  v_mfma_f32_16x16x32_bf16 a[20:23], a[24:27], a[68:71], 0
  v_exp_f32 v46, v46
  v_mfma_f32_16x16x32_bf16 a[20:23], a[24:27], a[92:95], a[20:23]
  v_cvt_pk_bf16_f32 v29, v42, v43
  v_mfma_f32_16x16x32_bf16 a[228:231], a[248:251], a[84:87], a[228:231]
  v_mfma_f32_16x16x32_bf16 a[228:231], a[252:255], a[108:111], a[228:231]
  v_exp_f32 v47, v47
  v_mfma_f32_16x16x32_bf16 a[232:235], a[248:251], a[88:91], a[232:235]
  v_exp_f32 v48, v48
  v_mfma_f32_16x16x32_bf16 a[232:235], a[252:255], a[112:115], a[232:235]
  v_mfma_f32_16x16x32_bf16 a[236:239], a[248:251], a[92:95], a[236:239]
  v_cvt_pk_bf16_f32 v30, v44, v45
  v_mfma_f32_16x16x32_bf16 a[236:239], a[252:255], a[116:119], a[236:239]
  v_exp_f32 v49, v49
  v_mfma_f32_16x16x32_bf16 a[0:3], a[24:27], a[96:99], a[0:3]
  v_mfma_f32_16x16x32_bf16 a[0:3], a[24:27], a[120:123], a[0:3]
  s_waitcnt lgkmcnt(0)
  v_exp_f32 v50, v50
  v_mfma_f32_16x16x32_bf16 a[144:147], a[240:243], a[120:123], a[144:147]
  ds_read_b64_tr_b16 a[248:249], v0 offset:20480
  v_mfma_f32_16x16x32_bf16 a[144:147], a[244:247], v[112:115], a[144:147]
  ds_read_b64_tr_b16 a[250:251], v0 offset:22528
  v_mfma_f32_16x16x32_bf16 a[148:151], a[240:243], a[124:127], a[148:151]
  v_xor_b32 v0, 32, v0
  v_mfma_f32_16x16x32_bf16 a[148:151], a[244:247], v[116:119], a[148:151]
  ds_read_b64_tr_b16 a[252:253], v0 offset:12288
  v_cvt_pk_bf16_f32 v31, v46, v47
  v_mfma_f32_16x16x32_bf16 a[152:155], a[240:243], a[128:131], a[152:155]
  ds_read_b64_tr_b16 a[254:255], v0 offset:14336
  v_mfma_f32_16x16x32_bf16 a[152:155], a[244:247], v[120:123], a[152:155]
  v_mfma_f32_16x16x32_bf16 a[4:7], a[24:27], a[100:103], a[4:7]
  v_exp_f32 v51, v51
  v_mfma_f32_16x16x32_bf16 a[4:7], a[24:27], a[124:127], a[4:7]
  v_exp_f32 v52, v52
  v_mfma_f32_16x16x32_bf16 a[156:159], a[240:243], a[132:135], a[156:159]
  v_mfma_f32_16x16x32_bf16 a[156:159], a[244:247], v[124:127], a[156:159]
  v_cvt_pk_bf16_f32 v32, v48, v49
  v_mfma_f32_16x16x32_bf16 a[160:163], a[240:243], a[136:139], a[160:163]
  v_exp_f32 v53, v53
  v_mfma_f32_16x16x32_bf16 a[160:163], a[244:247], v[128:131], a[160:163]
  v_mfma_f32_16x16x32_bf16 a[164:167], a[240:243], a[140:143], a[164:167]
  v_exp_f32 v54, v54
  v_mfma_f32_16x16x32_bf16 a[164:167], a[244:247], v[132:135], a[164:167]
  v_cvt_pk_bf16_f32 v33, v50, v51
  v_mfma_f32_16x16x32_bf16 a[8:11], a[24:27], a[104:107], a[8:11]
  v_exp_f32 v55, v55
  v_mfma_f32_16x16x32_bf16 a[8:11], a[24:27], a[128:131], a[8:11]
  s_waitcnt lgkmcnt(0)
  v_mfma_f32_16x16x32_bf16 a[144:147], a[248:251], v[136:139], a[144:147]
  ds_read_b64_tr_b16 a[240:241], v0 offset:16384
  v_mfma_f32_16x16x32_bf16 a[168:171], a[252:255], a[120:123], a[168:171]
  ds_read_b64_tr_b16 a[242:243], v0 offset:18432
  v_mfma_f32_16x16x32_bf16 a[148:151], a[248:251], v[140:143], a[148:151]
  ds_read_b64_tr_b16 a[244:245], v0 offset:20480
  v_exp_f32 v56, v56
  v_mfma_f32_16x16x32_bf16 a[172:175], a[252:255], a[124:127], a[172:175]
  ds_read_b64_tr_b16 a[246:247], v0 offset:22528
  v_mfma_f32_16x16x32_bf16 a[152:155], a[248:251], v[144:147], a[152:155]
  v_xor_b32 v0, 96, v0
  v_mfma_f32_16x16x32_bf16 a[176:179], a[252:255], a[128:131], a[176:179]
  v_mfma_f32_16x16x32_bf16 a[12:15], a[24:27], a[108:111], a[12:15]
  v_cvt_pk_bf16_f32 v34, v52, v53
  v_mfma_f32_16x16x32_bf16 a[12:15], a[24:27], a[132:135], a[12:15]
  v_exp_f32 v57, v57
  v_mfma_f32_16x16x32_bf16 a[156:159], a[248:251], v[148:151], a[156:159]
  v_mfma_f32_16x16x32_bf16 a[180:183], a[252:255], a[132:135], a[180:183]
  v_exp_f32 v58, v58
  v_mfma_f32_16x16x32_bf16 a[160:163], a[248:251], v[152:155], a[160:163]
  v_cvt_pk_bf16_f32 v35, v54, v55
  v_mfma_f32_16x16x32_bf16 a[184:187], a[252:255], a[136:139], a[184:187]
  v_exp_f32 v59, v59
  v_mfma_f32_16x16x32_bf16 a[164:167], a[248:251], v[156:159], a[164:167]
  v_mfma_f32_16x16x32_bf16 a[188:191], a[252:255], a[140:143], a[188:191]
  v_exp_f32 v60, v60
  v_mfma_f32_16x16x32_bf16 a[16:19], a[24:27], a[112:115], a[16:19]
  v_cvt_pk_bf16_f32 v36, v56, v57
  v_mfma_f32_16x16x32_bf16 a[16:19], a[24:27], a[136:139], a[16:19]
  s_waitcnt lgkmcnt(0)
  v_mfma_f32_16x16x32_bf16 a[168:171], a[240:243], v[112:115], a[168:171]
  ds_read_b64_tr_b16 a[248:249], v0 offset:12288
  v_exp_f32 v61, v61
  v_mfma_f32_16x16x32_bf16 a[168:171], a[244:247], v[136:139], a[168:171]
  ds_read_b64_tr_b16 a[250:251], v0 offset:14336
  v_mfma_f32_16x16x32_bf16 a[172:175], a[240:243], v[116:119], a[172:175]
  ds_read_b64_tr_b16 a[252:253], v0 offset:16384
  s_add_u32 m0, s32, 49152
  v_mfma_f32_16x16x32_bf16 a[172:175], a[244:247], v[140:143], a[172:175]
  ds_read_b64_tr_b16 a[254:255], v0 offset:18432
  s_add_u32 s40, s39, 256
  v_mfma_f32_16x16x32_bf16 a[176:179], a[240:243], v[120:123], a[176:179]
  buffer_load_dwordx4 v2, s[20:23], s40 offen nt lds
  v_mfma_f32_16x16x32_bf16 a[176:179], a[244:247], v[144:147], a[176:179]
  s_add_u32 s40, s39, 2304
  v_mfma_f32_16x16x32_bf16 a[20:23], a[24:27], a[116:119], a[20:23]
  buffer_load_dwordx4 v2, s[20:23], s40 offen offset:1024 nt lds
  v_mfma_f32_16x16x32_bf16 a[20:23], a[24:27], a[140:143], a[20:23]
  s_add_u32 s40, s39, 4352
  v_mfma_f32_16x16x32_bf16 a[180:183], a[240:243], v[124:127], a[180:183]
  buffer_load_dwordx4 v2, s[20:23], s40 offen offset:2048 nt lds
  v_mfma_f32_16x16x32_bf16 a[180:183], a[244:247], v[148:151], a[180:183]
  v_exp_f32 v62, v62
  v_mfma_f32_16x16x32_bf16 a[184:187], a[240:243], v[128:131], a[184:187]
  v_cvt_pk_bf16_f32 v37, v58, v59
  v_mfma_f32_16x16x32_bf16 a[184:187], a[244:247], v[152:155], a[184:187]
  v_exp_f32 v63, v63
  v_mfma_f32_16x16x32_bf16 a[188:191], a[240:243], v[132:135], a[188:191]
  v_mfma_f32_16x16x32_bf16 a[188:191], a[244:247], v[156:159], a[188:191]
  v_cvt_pk_bf16_f32 v38, v60, v61
  v_mfma_f32_16x16x32_bf16 a[0:3], a[24:27], v[112:115], a[0:3]
  v_cvt_pk_bf16_f32 v39, v62, v63
  v_mfma_f32_16x16x32_bf16 a[0:3], a[24:27], v[136:139], a[0:3]
  s_waitcnt lgkmcnt(0)
  v_exp_f32 v64, v64
  v_mfma_f32_16x16x32_bf16 a[192:195], a[248:251], a[120:123], a[192:195]
  ds_read_b64_tr_b16 a[240:241], v0 offset:20480
  v_mfma_f32_16x16x32_bf16 a[192:195], a[252:255], v[112:115], a[192:195]
  ds_read_b64_tr_b16 a[242:243], v0 offset:22528
  v_mfma_f32_16x16x32_bf16 a[196:199], a[248:251], a[124:127], a[196:199]
  v_xor_b32 v0, 32, v0
  v_mfma_f32_16x16x32_bf16 a[196:199], a[252:255], v[116:119], a[196:199]
  ds_read_b64_tr_b16 a[244:245], v0 offset:12288
  v_mfma_f32_16x16x32_bf16 a[200:203], a[248:251], a[128:131], a[200:203]
  ds_read_b64_tr_b16 a[246:247], v0 offset:14336
  v_mfma_f32_16x16x32_bf16 a[200:203], a[252:255], v[120:123], a[200:203]
  v_exp_f32 v65, v65
  v_mfma_f32_16x16x32_bf16 a[4:7], a[24:27], v[116:119], a[4:7]
  v_mfma_f32_16x16x32_bf16 a[4:7], a[24:27], v[140:143], a[4:7]
  v_exp_f32 v66, v66
  v_mfma_f32_16x16x32_bf16 a[204:207], a[248:251], a[132:135], a[204:207]
  v_exp_f32 v67, v67
  v_mfma_f32_16x16x32_bf16 a[204:207], a[252:255], v[124:127], a[204:207]
  v_mfma_f32_16x16x32_bf16 a[208:211], a[248:251], a[136:139], a[208:211]
  v_exp_f32 v68, v68
  v_mfma_f32_16x16x32_bf16 a[208:211], a[252:255], v[128:131], a[208:211]
  v_cvt_pk_bf16_f32 v64, v64, v65
  v_mfma_f32_16x16x32_bf16 a[212:215], a[248:251], a[140:143], a[212:215]
  v_mfma_f32_16x16x32_bf16 a[212:215], a[252:255], v[132:135], a[212:215]
  v_exp_f32 v69, v69
  v_mfma_f32_16x16x32_bf16 a[8:11], a[24:27], v[120:123], a[8:11]
  v_exp_f32 v70, v70
  v_mfma_f32_16x16x32_bf16 a[8:11], a[24:27], v[144:147], a[8:11]
  s_waitcnt lgkmcnt(0)
  v_mfma_f32_16x16x32_bf16 a[192:195], a[240:243], v[136:139], a[192:195]
  ds_read_b64_tr_b16 a[248:249], v0 offset:16384
  v_mfma_f32_16x16x32_bf16 a[216:219], a[244:247], a[120:123], a[216:219]
  ds_read_b64_tr_b16 a[250:251], v0 offset:18432
  v_cvt_pk_bf16_f32 v65, v66, v67
  v_mfma_f32_16x16x32_bf16 a[196:199], a[240:243], v[140:143], a[196:199]
  ds_read_b64_tr_b16 a[252:253], v0 offset:20480
  v_mfma_f32_16x16x32_bf16 a[220:223], a[244:247], a[124:127], a[220:223]
  ds_read_b64_tr_b16 a[254:255], v0 offset:22528
  v_mfma_f32_16x16x32_bf16 a[200:203], a[240:243], v[144:147], a[200:203]
  v_xor_b32 v0, 96, v0
  v_mfma_f32_16x16x32_bf16 a[224:227], a[244:247], a[128:131], a[224:227]
  v_exp_f32 v71, v71
  v_mfma_f32_16x16x32_bf16 a[12:15], a[24:27], v[124:127], a[12:15]
  v_mfma_f32_16x16x32_bf16 a[12:15], a[24:27], v[148:151], a[12:15]
  v_exp_f32 v72, v72
  v_mfma_f32_16x16x32_bf16 a[204:207], a[240:243], v[148:151], a[204:207]
  v_cvt_pk_bf16_f32 v66, v68, v69
  v_mfma_f32_16x16x32_bf16 a[228:231], a[244:247], a[132:135], a[228:231]
  v_mfma_f32_16x16x32_bf16 a[208:211], a[240:243], v[152:155], a[208:211]
  v_exp_f32 v73, v73
  v_mfma_f32_16x16x32_bf16 a[232:235], a[244:247], a[136:139], a[232:235]
  v_exp_f32 v74, v74
  v_mfma_f32_16x16x32_bf16 a[212:215], a[240:243], v[156:159], a[212:215]
  v_mfma_f32_16x16x32_bf16 a[236:239], a[244:247], a[140:143], a[236:239]
  ds_read_b64_tr_b16 a[240:241], v0 offset:24576
  v_mfma_f32_16x16x32_bf16 a[16:19], a[24:27], v[128:131], a[16:19]
  ds_read_b64_tr_b16 a[242:243], v0 offset:26624
  v_cvt_pk_bf16_f32 v67, v70, v71
  v_mfma_f32_16x16x32_bf16 a[16:19], a[24:27], v[152:155], a[16:19]
  s_waitcnt lgkmcnt(2)
  ds_read_b64_tr_b16 a[244:245], v0 offset:28672
  v_mfma_f32_16x16x32_bf16 a[216:219], a[248:251], v[112:115], a[216:219]
  ds_read_b64_tr_b16 a[246:247], v0 offset:30720
  v_mfma_f32_16x16x32_bf16 a[216:219], a[252:255], v[136:139], a[216:219]
  v_exp_f32 v75, v75
  v_mfma_f32_16x16x32_bf16 a[220:223], a[248:251], v[116:119], a[220:223]
  v_mfma_f32_16x16x32_bf16 a[220:223], a[252:255], v[140:143], a[220:223]
  v_exp_f32 v76, v76
  v_mfma_f32_16x16x32_bf16 a[224:227], a[248:251], v[120:123], a[224:227]
  v_cvt_pk_bf16_f32 v68, v72, v73
  v_mfma_f32_16x16x32_bf16 a[224:227], a[252:255], v[144:147], a[224:227]
  v_mfma_f32_16x16x32_bf16 a[20:23], a[24:27], v[132:135], a[20:23]
  v_exp_f32 v77, v77
  v_mfma_f32_16x16x32_bf16 a[20:23], a[24:27], v[156:159], a[20:23]
  v_exp_f32 v78, v78
  v_mfma_f32_16x16x32_bf16 a[228:231], a[248:251], v[124:127], a[228:231]
  v_mfma_f32_16x16x32_bf16 a[228:231], a[252:255], v[148:151], a[228:231]
  v_cvt_pk_bf16_f32 v69, v74, v75
  v_mfma_f32_16x16x32_bf16 a[232:235], a[248:251], v[128:131], a[232:235]
  v_exp_f32 v79, v79
  v_mfma_f32_16x16x32_bf16 a[232:235], a[252:255], v[152:155], a[232:235]
  v_mfma_f32_16x16x32_bf16 a[236:239], a[248:251], v[132:135], a[236:239]
  v_exp_f32 v80, v80
  v_mfma_f32_16x16x32_bf16 a[236:239], a[252:255], v[156:159], a[236:239]
  v_cvt_pk_bf16_f32 v70, v76, v77
  v_mfma_f32_16x16x32_bf16 a[0:3], a[24:27], v[160:163], a[0:3]
  v_exp_f32 v81, v81
  v_mfma_f32_16x16x32_bf16 a[0:3], a[24:27], v[184:187], a[0:3]
  s_waitcnt lgkmcnt(0)
  v_mfma_f32_16x16x32_bf16 a[144:147], a[240:243], v[160:163], a[144:147]
  ds_read_b64_tr_b16 a[248:249], v0 offset:32768
  v_mfma_f32_16x16x32_bf16 a[144:147], a[244:247], v[184:187], a[144:147]
  ds_read_b64_tr_b16 a[250:251], v0 offset:34816
  v_mfma_f32_16x16x32_bf16 a[148:151], a[240:243], v[164:167], a[148:151]
  v_xor_b32 v0, 32, v0
  v_mfma_f32_16x16x32_bf16 a[148:151], a[244:247], v[188:191], a[148:151]
  ds_read_b64_tr_b16 a[252:253], v0 offset:24576
  v_mfma_f32_16x16x32_bf16 a[152:155], a[240:243], v[168:171], a[152:155]
L_pad_15:
  s_cbranch_execz L_padret2
  ds_read_b64_tr_b16 a[254:255], v0 offset:26624
  v_exp_f32 v82, v82
  v_mfma_f32_16x16x32_bf16 a[152:155], a[244:247], v[192:195], a[152:155]
  v_mfma_f32_16x16x32_bf16 a[4:7], a[24:27], v[164:167], a[4:7]
  v_cvt_pk_bf16_f32 v71, v78, v79
  v_mfma_f32_16x16x32_bf16 a[4:7], a[24:27], v[188:191], a[4:7]
  v_exp_f32 v83, v83
  v_mfma_f32_16x16x32_bf16 a[156:159], a[240:243], v[172:175], a[156:159]
  v_mfma_f32_16x16x32_bf16 a[156:159], a[244:247], v[196:199], a[156:159]
  v_exp_f32 v84, v84
  v_mfma_f32_16x16x32_bf16 a[160:163], a[240:243], v[176:179], a[160:163]
  v_cvt_pk_bf16_f32 v72, v80, v81
  v_mfma_f32_16x16x32_bf16 a[160:163], a[244:247], v[200:203], a[160:163]
  v_exp_f32 v85, v85
  v_mfma_f32_16x16x32_bf16 a[164:167], a[240:243], v[180:183], a[164:167]
  v_mfma_f32_16x16x32_bf16 a[164:167], a[244:247], v[204:207], a[164:167]
  v_exp_f32 v86, v86
  v_mfma_f32_16x16x32_bf16 a[8:11], a[24:27], v[168:171], a[8:11]
  v_cvt_pk_bf16_f32 v73, v82, v83
  v_mfma_f32_16x16x32_bf16 a[8:11], a[24:27], v[192:195], a[8:11]
  s_waitcnt lgkmcnt(0)
  v_mfma_f32_16x16x32_bf16 a[144:147], a[248:251], v[208:211], a[144:147]
  ds_read_b64_tr_b16 a[240:241], v0 offset:28672
  v_mfma_f32_16x16x32_bf16 a[168:171], a[252:255], v[160:163], a[168:171]
  ds_read_b64_tr_b16 a[242:243], v0 offset:30720
  v_exp_f32 v87, v87
  v_mfma_f32_16x16x32_bf16 a[148:151], a[248:251], v[212:215], a[148:151]
  ds_read_b64_tr_b16 a[244:245], v0 offset:32768
  v_mfma_f32_16x16x32_bf16 a[172:175], a[252:255], v[164:167], a[172:175]
  ds_read_b64_tr_b16 a[246:247], v0 offset:34816
  v_mfma_f32_16x16x32_bf16 a[152:155], a[248:251], v[216:219], a[152:155]
  v_xor_b32 v0, 96, v0
  v_mfma_f32_16x16x32_bf16 a[176:179], a[252:255], v[168:171], a[176:179]
  v_mfma_f32_16x16x32_bf16 a[12:15], a[24:27], v[172:175], a[12:15]
  v_exp_f32 v88, v88
  v_mfma_f32_16x16x32_bf16 a[12:15], a[24:27], v[196:199], a[12:15]
  v_cvt_pk_bf16_f32 v74, v84, v85
  v_mfma_f32_16x16x32_bf16 a[156:159], a[248:251], v[220:223], a[156:159]
  v_exp_f32 v89, v89
  v_mfma_f32_16x16x32_bf16 a[180:183], a[252:255], v[172:175], a[180:183]
  v_mfma_f32_16x16x32_bf16 a[160:163], a[248:251], v[224:227], a[160:163]
  v_exp_f32 v90, v90
  v_mfma_f32_16x16x32_bf16 a[184:187], a[252:255], v[176:179], a[184:187]
  v_cvt_pk_bf16_f32 v75, v86, v87
  v_mfma_f32_16x16x32_bf16 a[164:167], a[248:251], v[228:231], a[164:167]
  v_mfma_f32_16x16x32_bf16 a[188:191], a[252:255], v[180:183], a[188:191]
  v_exp_f32 v91, v91
  v_mfma_f32_16x16x32_bf16 a[16:19], a[24:27], v[176:179], a[16:19]
  v_exp_f32 v92, v92
  v_mfma_f32_16x16x32_bf16 a[16:19], a[24:27], v[200:203], a[16:19]
  s_waitcnt lgkmcnt(0)
  v_mfma_f32_16x16x32_bf16 a[168:171], a[240:243], v[184:187], a[168:171]
  ds_read_b64_tr_b16 a[248:249], v0 offset:24576
  v_mfma_f32_16x16x32_bf16 a[168:171], a[244:247], v[208:211], a[168:171]
  ds_read_b64_tr_b16 a[250:251], v0 offset:26624
  v_cvt_pk_bf16_f32 v76, v88, v89
  v_mfma_f32_16x16x32_bf16 a[172:175], a[240:243], v[188:191], a[172:175]
  ds_read_b64_tr_b16 a[252:253], v0 offset:28672
  s_add_u32 m0, s32, 61440
  v_mfma_f32_16x16x32_bf16 a[172:175], a[244:247], v[212:215], a[172:175]
  ds_read_b64_tr_b16 a[254:255], v0 offset:30720
  s_add_u32 s40, s39, 37120
  v_mfma_f32_16x16x32_bf16 a[176:179], a[240:243], v[192:195], a[176:179]
  buffer_load_dwordx4 v2, s[20:23], s40 offen nt lds
  v_mfma_f32_16x16x32_bf16 a[176:179], a[244:247], v[216:219], a[176:179]
  s_add_u32 s40, s39, 39168
  v_mfma_f32_16x16x32_bf16 a[20:23], a[24:27], v[180:183], a[20:23]
  buffer_load_dwordx4 v2, s[20:23], s40 offen offset:1024 nt lds
  v_mfma_f32_16x16x32_bf16 a[20:23], a[24:27], v[204:207], a[20:23]
  s_add_u32 s40, s39, 41216
  v_mfma_f32_16x16x32_bf16 a[180:183], a[240:243], v[196:199], a[180:183]
  buffer_load_dwordx4 v2, s[20:23], s40 offen offset:2048 nt lds
  v_mfma_f32_16x16x32_bf16 a[180:183], a[244:247], v[220:223], a[180:183]
  v_exp_f32 v93, v93
  v_mfma_f32_16x16x32_bf16 a[184:187], a[240:243], v[200:203], a[184:187]
  v_exp_f32 v94, v94
  v_mfma_f32_16x16x32_bf16 a[184:187], a[244:247], v[224:227], a[184:187]
  v_mfma_f32_16x16x32_bf16 a[188:191], a[240:243], v[204:207], a[188:191]
  v_cvt_pk_bf16_f32 v77, v90, v91
  v_mfma_f32_16x16x32_bf16 a[188:191], a[244:247], v[228:231], a[188:191]
  v_exp_f32 v95, v95
  v_mfma_f32_16x16x32_bf16 a[0:3], a[24:27], v[208:211], a[0:3]
  v_mfma_f32_16x16x32_bf16 a[0:3], a[24:27], v[232:235], a[0:3]
  s_waitcnt lgkmcnt(0)
  v_exp_f32 v96, v96
  v_mfma_f32_16x16x32_bf16 a[192:195], a[248:251], v[160:163], a[192:195]
  ds_read_b64_tr_b16 a[240:241], v0 offset:32768
  v_mfma_f32_16x16x32_bf16 a[192:195], a[252:255], v[184:187], a[192:195]
  ds_read_b64_tr_b16 a[242:243], v0 offset:34816
  v_mfma_f32_16x16x32_bf16 a[196:199], a[248:251], v[164:167], a[196:199]
  v_xor_b32 v0, 32, v0
  v_mfma_f32_16x16x32_bf16 a[196:199], a[252:255], v[188:191], a[196:199]
  ds_read_b64_tr_b16 a[244:245], v0 offset:24576
  v_cvt_pk_bf16_f32 v78, v92, v93
  v_mfma_f32_16x16x32_bf16 a[200:203], a[248:251], v[168:171], a[200:203]
  ds_read_b64_tr_b16 a[246:247], v0 offset:26624
  v_mfma_f32_16x16x32_bf16 a[200:203], a[252:255], v[192:195], a[200:203]
  v_mfma_f32_16x16x32_bf16 a[4:7], a[24:27], v[212:215], a[4:7]
  v_exp_f32 v97, v97
  v_mfma_f32_16x16x32_bf16 a[4:7], a[24:27], v[236:239], a[4:7]
  v_exp_f32 v98, v98
  v_mfma_f32_16x16x32_bf16 a[204:207], a[248:251], v[172:175], a[204:207]
  v_mfma_f32_16x16x32_bf16 a[204:207], a[252:255], v[196:199], a[204:207]
  v_cvt_pk_bf16_f32 v79, v94, v95
  v_mfma_f32_16x16x32_bf16 a[208:211], a[248:251], v[176:179], a[208:211]
  v_exp_f32 v99, v99
  v_mfma_f32_16x16x32_bf16 a[208:211], a[252:255], v[200:203], a[208:211]
  v_mfma_f32_16x16x32_bf16 a[212:215], a[248:251], v[180:183], a[212:215]
  v_exp_f32 v100, v100
  v_mfma_f32_16x16x32_bf16 a[212:215], a[252:255], v[204:207], a[212:215]
  v_cvt_pk_bf16_f32 v80, v96, v97
  v_mfma_f32_16x16x32_bf16 a[8:11], a[24:27], v[216:219], a[8:11]
  v_exp_f32 v101, v101
  v_mfma_f32_16x16x32_bf16 a[8:11], a[24:27], v[240:243], a[8:11]
  s_waitcnt lgkmcnt(0)
  v_mfma_f32_16x16x32_bf16 a[192:195], a[240:243], v[208:211], a[192:195]
  ds_read_b64_tr_b16 a[248:249], v0 offset:28672
  v_mfma_f32_16x16x32_bf16 a[216:219], a[244:247], v[160:163], a[216:219]
  ds_read_b64_tr_b16 a[250:251], v0 offset:30720
  v_mfma_f32_16x16x32_bf16 a[196:199], a[240:243], v[212:215], a[196:199]
  ds_read_b64_tr_b16 a[252:253], v0 offset:32768
  v_mfma_f32_16x16x32_bf16 a[220:223], a[244:247], v[164:167], a[220:223]
  ds_read_b64_tr_b16 a[254:255], v0 offset:34816
  v_exp_f32 v102, v102
  v_mfma_f32_16x16x32_bf16 a[200:203], a[240:243], v[216:219], a[200:203]
  v_xor_b32 v0, 96, v0
  v_mfma_f32_16x16x32_bf16 a[224:227], a[244:247], v[168:171], a[224:227]
  v_mfma_f32_16x16x32_bf16 a[12:15], a[24:27], v[220:223], a[12:15]
  v_cvt_pk_bf16_f32 v81, v98, v99
  v_mfma_f32_16x16x32_bf16 a[12:15], a[24:27], v[244:247], a[12:15]
  v_exp_f32 v103, v103
  v_mfma_f32_16x16x32_bf16 a[204:207], a[240:243], v[220:223], a[204:207]
  v_mfma_f32_16x16x32_bf16 a[228:231], a[244:247], v[172:175], a[228:231]
  v_exp_f32 v104, v104
  v_mfma_f32_16x16x32_bf16 a[208:211], a[240:243], v[224:227], a[208:211]
  v_cvt_pk_bf16_f32 v82, v100, v101
  v_mfma_f32_16x16x32_bf16 a[232:235], a[244:247], v[176:179], a[232:235]
  v_exp_f32 v105, v105
  v_mfma_f32_16x16x32_bf16 a[212:215], a[240:243], v[228:231], a[212:215]
  v_mfma_f32_16x16x32_bf16 a[236:239], a[244:247], v[180:183], a[236:239]
  ds_read_b64_tr_b16 a[240:241], v0 offset:36864
  v_mfma_f32_16x16x32_bf16 a[16:19], a[24:27], v[224:227], a[16:19]
  ds_read_b64_tr_b16 a[242:243], v0 offset:38912
  v_mfma_f32_16x16x32_bf16 a[16:19], a[24:27], v[248:251], a[16:19]
  s_waitcnt lgkmcnt(2)
  ds_read_b64_tr_b16 a[244:245], v0 offset:40960
  v_exp_f32 v106, v106
  v_mfma_f32_16x16x32_bf16 a[216:219], a[248:251], v[184:187], a[216:219]
  ds_read_b64_tr_b16 a[246:247], v0 offset:43008
  v_mfma_f32_16x16x32_bf16 a[216:219], a[252:255], v[208:211], a[216:219]
  v_mfma_f32_16x16x32_bf16 a[220:223], a[248:251], v[188:191], a[220:223]
  v_cvt_pk_bf16_f32 v83, v102, v103
  v_mfma_f32_16x16x32_bf16 a[220:223], a[252:255], v[212:215], a[220:223]
  v_exp_f32 v107, v107
  v_mfma_f32_16x16x32_bf16 a[224:227], a[248:251], v[192:195], a[224:227]
  v_mfma_f32_16x16x32_bf16 a[224:227], a[252:255], v[216:219], a[224:227]
  v_exp_f32 v108, v108
  v_mfma_f32_16x16x32_bf16 a[20:23], a[24:27], v[228:231], a[20:23]
  v_cvt_pk_bf16_f32 v84, v104, v105
  v_mfma_f32_16x16x32_bf16 a[20:23], a[24:27], v[252:255], a[20:23]
  v_exp_f32 v109, v109
  v_mfma_f32_16x16x32_bf16 a[228:231], a[248:251], v[196:199], a[228:231]
  v_mfma_f32_16x16x32_bf16 a[228:231], a[252:255], v[220:223], a[228:231]
  v_exp_f32 v110, v110
  v_mfma_f32_16x16x32_bf16 a[232:235], a[248:251], v[200:203], a[232:235]
  v_cvt_pk_bf16_f32 v85, v106, v107
  v_mfma_f32_16x16x32_bf16 a[232:235], a[252:255], v[224:227], a[232:235]
  v_mfma_f32_16x16x32_bf16 a[236:239], a[248:251], v[204:207], a[236:239]
  v_exp_f32 v111, v111
  v_mfma_f32_16x16x32_bf16 a[236:239], a[252:255], v[228:231], a[236:239]
  s_waitcnt lgkmcnt(0)
  v_cvt_pk_bf16_f32 v86, v108, v109
  v_mfma_f32_16x16x32_bf16 a[144:147], a[240:243], v[232:235], a[144:147]
  ds_read_b64_tr_b16 a[248:249], v0 offset:45056
  v_mfma_f32_16x16x32_bf16 a[144:147], a[244:247], v[16:19], a[144:147]
  ds_read_b64_tr_b16 a[250:251], v0 offset:47104
  v_mfma_f32_16x16x32_bf16 a[148:151], a[240:243], v[236:239], a[148:151]
  v_xor_b32 v0, 32, v0
  v_cvt_pk_bf16_f32 v87, v110, v111
  v_mfma_f32_16x16x32_bf16 a[148:151], a[244:247], v[20:23], a[148:151]
  ds_read_b64_tr_b16 a[252:253], v0 offset:36864
  v_mfma_f32_16x16x32_bf16 a[152:155], a[240:243], v[240:243], a[152:155]
  ds_read_b64_tr_b16 a[254:255], v0 offset:38912
  v_mfma_f32_16x16x32_bf16 a[152:155], a[244:247], v[24:27], a[152:155]
  v_mbcnt_lo_u32_b32 v90, -1, 0
  v_mfma_f32_16x16x32_bf16 a[156:159], a[240:243], v[244:247], a[156:159]
  v_mfma_f32_16x16x32_bf16 a[156:159], a[244:247], v[28:31], a[156:159]
  v_mbcnt_hi_u32_b32 v90, -1, v90
  v_mfma_f32_16x16x32_bf16 a[0:3], a[24:27], v[16:19], a[0:3]
  v_and_b32 v91, 15, v90
  v_mfma_f32_16x16x32_bf16 a[0:3], a[24:27], v[64:67], a[0:3]
  v_mfma_f32_16x16x32_bf16 a[160:163], a[240:243], v[248:251], a[160:163]
  v_lshl_add_u32 v7, v91, 7, s28
  v_mfma_f32_16x16x32_bf16 a[160:163], a[244:247], v[32:35], a[160:163]
  v_mfma_f32_16x16x32_bf16 a[164:167], a[240:243], v[252:255], a[164:167]
  v_bfe_u32 v91, v90, 4, 1
  v_mfma_f32_16x16x32_bf16 a[164:167], a[244:247], v[36:39], a[164:167]
  v_lshl_add_u32 v7, v91, 3, v7
  v_mfma_f32_16x16x32_bf16 a[4:7], a[24:27], v[20:23], a[4:7]
  v_mfma_f32_16x16x32_bf16 a[4:7], a[24:27], v[68:71], a[4:7]
  s_waitcnt lgkmcnt(0)
  v_and_b32 v91, 7, v90
  v_mfma_f32_16x16x32_bf16 a[144:147], a[248:251], v[64:67], a[144:147]
  ds_read_b64_tr_b16 a[240:241], v0 offset:40960
  v_mfma_f32_16x16x32_bf16 a[168:171], a[252:255], v[232:235], a[168:171]
  ds_read_b64_tr_b16 a[242:243], v0 offset:43008
  v_mfma_f32_16x16x32_bf16 a[148:151], a[248:251], v[68:71], a[148:151]
  ds_read_b64_tr_b16 a[244:245], v0 offset:45056
  v_mfma_f32_16x16x32_bf16 a[172:175], a[252:255], v[236:239], a[172:175]
  ds_read_b64_tr_b16 a[246:247], v0 offset:47104
  v_mfma_f32_16x16x32_bf16 a[8:11], a[24:27], v[24:27], a[8:11]
  v_xor_b32 v0, 96, v0
  v_mfma_f32_16x16x32_bf16 a[8:11], a[24:27], v[72:75], a[8:11]
  v_lshlrev_b32 v9, 4, v91
  v_mfma_f32_16x16x32_bf16 a[152:155], a[248:251], v[72:75], a[152:155]
  v_mfma_f32_16x16x32_bf16 a[176:179], a[252:255], v[240:243], a[176:179]
  v_lshrrev_b32 v8, 5, v90
  v_mfma_f32_16x16x32_bf16 a[156:159], a[248:251], v[76:79], a[156:159]
  v_xor_b32 v8, v8, v91
  v_mfma_f32_16x16x32_bf16 a[180:183], a[252:255], v[244:247], a[180:183]
  v_mfma_f32_16x16x32_bf16 a[12:15], a[24:27], v[28:31], a[12:15]
  v_lshl_add_u32 v7, v8, 4, v7
  v_mfma_f32_16x16x32_bf16 a[12:15], a[24:27], v[76:79], a[12:15]
  v_lshrrev_b32 v90, 3, v90
  v_mfma_f32_16x16x32_bf16 a[160:163], a[248:251], v[80:83], a[160:163]
  v_mfma_f32_16x16x32_bf16 a[184:187], a[252:255], v[248:251], a[184:187]
  v_xor_b32 v91, v91, v90
  v_mfma_f32_16x16x32_bf16 a[164:167], a[248:251], v[84:87], a[164:167]
  v_mfma_f32_16x16x32_bf16 a[188:191], a[252:255], v[252:255], a[188:191]
  v_lshl_add_u32 v8, v90, 7, s28
  v_mfma_f32_16x16x32_bf16 a[16:19], a[24:27], v[32:35], a[16:19]
  v_lshl_add_u32 v8, v91, 4, v8
  v_mfma_f32_16x16x32_bf16 a[16:19], a[24:27], v[80:83], a[16:19]
  s_waitcnt lgkmcnt(0)
  v_mfma_f32_16x16x32_bf16 a[168:171], a[240:243], v[16:19], a[168:171]
  ds_read_b64_tr_b16 a[248:249], v0 offset:36864
  v_mfma_f32_16x16x32_bf16 a[168:171], a[244:247], v[64:67], a[168:171]
  ds_read_b64_tr_b16 a[250:251], v0 offset:38912
  v_mfma_f32_16x16x32_bf16 a[172:175], a[240:243], v[20:23], a[172:175]
  ds_read_b64_tr_b16 a[252:253], v0 offset:40960
  s_add_u32 m0, s32, 73728
  v_mfma_f32_16x16x32_bf16 a[172:175], a[244:247], v[68:71], a[172:175]
  ds_read_b64_tr_b16 a[254:255], v0 offset:43008
  s_add_u32 s40, s39, 73984
  v_mfma_f32_16x16x32_bf16 a[20:23], a[24:27], v[36:39], a[20:23]
  buffer_load_dwordx4 v2, s[20:23], s40 offen nt lds
  v_mfma_f32_16x16x32_bf16 a[20:23], a[24:27], v[84:87], a[20:23]
  s_add_u32 s40, s39, 76032
  v_mul_u32_u24 v90, 384, v90
  v_mfma_f32_16x16x32_bf16 a[176:179], a[240:243], v[24:27], a[176:179]
  buffer_load_dwordx4 v2, s[20:23], s40 offen offset:1024 nt lds
  v_mfma_f32_16x16x32_bf16 a[176:179], a[244:247], v[72:75], a[176:179]
  s_add_u32 s40, s39, 78080
  v_mfma_f32_16x16x32_bf16 a[180:183], a[240:243], v[28:31], a[180:183]
  buffer_load_dwordx4 v2, s[20:23], s40 offen offset:2048 nt lds
  v_mfma_f32_16x16x32_bf16 a[180:183], a[244:247], v[76:79], a[180:183]
  v_mfma_f32_16x16x32_bf16 a[184:187], a[240:243], v[32:35], a[184:187]
  v_add_u32 v9, v9, v90
  v_mfma_f32_16x16x32_bf16 a[184:187], a[244:247], v[80:83], a[184:187]
  v_accvgpr_read_b32 v10, a0
  v_accvgpr_read_b32 v11, a4
  v_accvgpr_read_b32 v12, a8
  v_mfma_f32_16x16x32_bf16 a[188:191], a[240:243], v[36:39], a[188:191]
  v_accvgpr_read_b32 v13, a12
  v_accvgpr_read_b32 v14, a16
  v_accvgpr_read_b32 v15, a20
  v_mfma_f32_16x16x32_bf16 a[188:191], a[244:247], v[84:87], a[188:191]
  s_waitcnt lgkmcnt(0)
  v_rcp_f32 v10, v10
  v_rcp_f32 v11, v11
  v_mfma_f32_16x16x32_bf16 a[192:195], a[248:251], v[232:235], a[192:195]
  ds_read_b64_tr_b16 a[240:241], v0 offset:45056
  v_rcp_f32 v12, v12
  v_mfma_f32_16x16x32_bf16 a[192:195], a[252:255], v[16:19], a[192:195]
  ds_read_b64_tr_b16 a[242:243], v0 offset:47104
  v_rcp_f32 v13, v13
  v_mfma_f32_16x16x32_bf16 a[196:199], a[248:251], v[236:239], a[196:199]
  v_xor_b32 v0, 32, v0
  v_rcp_f32 v14, v14
  v_mfma_f32_16x16x32_bf16 a[196:199], a[252:255], v[20:23], a[196:199]
  ds_read_b64_tr_b16 a[244:245], v0 offset:36864
  v_rcp_f32 v15, v15
  v_mfma_f32_16x16x32_bf16 a[200:203], a[248:251], v[240:243], a[200:203]
  ds_read_b64_tr_b16 a[246:247], v0 offset:38912
  v_accvgpr_read_b32 v40, a144
  v_mfma_f32_16x16x32_bf16 a[200:203], a[252:255], v[24:27], a[200:203]
  v_accvgpr_read_b32 v41, a145
  v_accvgpr_read_b32 v42, a146
  v_accvgpr_read_b32 v43, a147
  v_mfma_f32_16x16x32_bf16 a[204:207], a[248:251], v[244:247], a[204:207]
  v_mul_f32 v40, v10, v40
  v_mul_f32 v41, v10, v41
  v_mfma_f32_16x16x32_bf16 a[204:207], a[252:255], v[28:31], a[204:207]
  v_mul_f32 v42, v10, v42
  v_mul_f32 v43, v10, v43
  v_mfma_f32_16x16x32_bf16 a[208:211], a[248:251], v[248:251], a[208:211]
  v_cvt_pk_bf16_f32 v40, v40, v41
  v_cvt_pk_bf16_f32 v41, v42, v43
  v_mfma_f32_16x16x32_bf16 a[208:211], a[252:255], v[32:35], a[208:211]
  v_accvgpr_read_b32 v42, a148
  v_accvgpr_read_b32 v43, a149
  v_accvgpr_read_b32 v44, a150
  v_mfma_f32_16x16x32_bf16 a[212:215], a[248:251], v[252:255], a[212:215]
  v_accvgpr_read_b32 v45, a151
  v_mul_f32 v42, v11, v42
  v_mfma_f32_16x16x32_bf16 a[212:215], a[252:255], v[36:39], a[212:215]
  s_waitcnt lgkmcnt(0)
  v_mul_f32 v43, v11, v43
  v_mul_f32 v44, v11, v44
  v_mfma_f32_16x16x32_bf16 a[192:195], a[240:243], v[64:67], a[192:195]
  ds_read_b64_tr_b16 a[248:249], v0 offset:40960
  v_mul_f32 v45, v11, v45
  v_mfma_f32_16x16x32_bf16 a[216:219], a[244:247], v[232:235], a[216:219]
  ds_read_b64_tr_b16 a[250:251], v0 offset:43008
  v_cvt_pk_bf16_f32 v42, v42, v43
  v_cvt_pk_bf16_f32 v43, v44, v45
  v_mfma_f32_16x16x32_bf16 a[196:199], a[240:243], v[68:71], a[196:199]
  ds_read_b64_tr_b16 a[252:253], v0 offset:45056
  v_accvgpr_read_b32 v44, a168
  v_mfma_f32_16x16x32_bf16 a[220:223], a[244:247], v[236:239], a[220:223]
  ds_read_b64_tr_b16 a[254:255], v0 offset:47104
  v_accvgpr_read_b32 v45, a169
  v_mfma_f32_16x16x32_bf16 a[200:203], a[240:243], v[72:75], a[200:203]
  v_xor_b32 v0, 96, v0
  v_accvgpr_read_b32 v46, a170
  v_mfma_f32_16x16x32_bf16 a[224:227], a[244:247], v[240:243], a[224:227]
  v_accvgpr_read_b32 v47, a171
  v_mul_f32 v44, v10, v44
  v_mul_f32 v45, v10, v45
  v_mfma_f32_16x16x32_bf16 a[204:207], a[240:243], v[76:79], a[204:207]
  v_mul_f32 v46, v10, v46
  v_mul_f32 v47, v10, v47
  v_mfma_f32_16x16x32_bf16 a[228:231], a[244:247], v[244:247], a[228:231]
  v_cvt_pk_bf16_f32 v44, v44, v45
  v_cvt_pk_bf16_f32 v45, v46, v47
  v_mfma_f32_16x16x32_bf16 a[208:211], a[240:243], v[80:83], a[208:211]
  v_accvgpr_read_b32 v46, a172
  v_accvgpr_read_b32 v47, a173
  v_mfma_f32_16x16x32_bf16 a[232:235], a[244:247], v[248:251], a[232:235]
  v_accvgpr_read_b32 v3, a175
  v_mul_f32 v46, v11, v46
  v_mul_f32 v47, v11, v47
  v_mfma_f32_16x16x32_bf16 a[212:215], a[240:243], v[84:87], a[212:215]
  v_subrev_u32 v0, 98304, v0
  v_mul_f32 v3, v11, v3
  v_mfma_f32_16x16x32_bf16 a[236:239], a[244:247], v[252:255], a[236:239]
  s_waitcnt vmcnt(9) lgkmcnt(0)
  s_barrier
  ds_read_b64_tr_b16 a[240:241], v0 offset:0
  v_mfma_f32_16x16x32_bf16 a[216:219], a[248:251], v[16:19], a[216:219]
  ds_read_b64_tr_b16 a[242:243], v0 offset:2048
  v_cvt_pk_bf16_f32 v46, v46, v47
  v_mfma_f32_16x16x32_bf16 a[216:219], a[252:255], v[64:67], a[216:219]
  ds_read_b64_tr_b16 a[244:245], v0 offset:4096
  v_accvgpr_read_b32 v47, a174
  v_mul_f32 v47, v11, v47
  v_mfma_f32_16x16x32_bf16 a[220:223], a[248:251], v[20:23], a[220:223]
  ds_read_b64_tr_b16 a[246:247], v0 offset:6144
  v_cvt_pk_bf16_f32 v47, v47, v3
  v_mfma_f32_16x16x32_bf16 a[220:223], a[252:255], v[68:71], a[220:223]
  v_accvgpr_read_b32 v48, a152
  v_accvgpr_read_b32 v49, a153
  v_mfma_f32_16x16x32_bf16 a[224:227], a[248:251], v[24:27], a[224:227]
  s_add_u32 m0, s32, 86016
  v_accvgpr_read_b32 v50, a154
  v_accvgpr_read_b32 v51, a155
  v_mfma_f32_16x16x32_bf16 a[224:227], a[252:255], v[72:75], a[224:227]
  s_add_u32 s40, s39, 110848
  v_mul_f32 v48, v12, v48
  v_mul_f32 v49, v12, v49
  v_mfma_f32_16x16x32_bf16 a[228:231], a[248:251], v[28:31], a[228:231]
  buffer_load_dwordx4 v2, s[20:23], s40 offen nt lds
  v_mfma_f32_16x16x32_bf16 a[228:231], a[252:255], v[76:79], a[228:231]
  s_add_u32 s40, s39, 112896
  v_mul_f32 v50, v12, v50
  v_mul_f32 v51, v12, v51
  v_mfma_f32_16x16x32_bf16 a[232:235], a[248:251], v[32:35], a[232:235]
  buffer_load_dwordx4 v2, s[20:23], s40 offen offset:1024 nt lds
  v_mfma_f32_16x16x32_bf16 a[232:235], a[252:255], v[80:83], a[232:235]
  s_add_u32 s40, s39, 114944
  v_cvt_pk_bf16_f32 v48, v48, v49
  v_cvt_pk_bf16_f32 v49, v50, v51
  v_mfma_f32_16x16x32_bf16 a[236:239], a[248:251], v[36:39], a[236:239]
  buffer_load_dwordx4 v2, s[20:23], s40 offen offset:2048 nt lds
  v_mfma_f32_16x16x32_bf16 a[236:239], a[252:255], v[84:87], a[236:239]
  s_waitcnt lgkmcnt(0)
  v_accvgpr_read_b32 v50, a156
  v_accvgpr_read_b32 v51, a157
  v_mfma_f32_16x16x32_bf16 a[0:3], a[240:243], a[48:51], 0
  ds_read_b64_tr_b16 a[248:249], v0 offset:8192
  v_accvgpr_read_b32 v52, a158
  v_accvgpr_read_b32 v53, a159
  v_mfma_f32_16x16x32_bf16 a[0:3], a[244:247], a[72:75], a[0:3]
  ds_read_b64_tr_b16 a[250:251], v0 offset:10240
  v_mul_f32 v50, v13, v50
  v_mfma_f32_16x16x32_bf16 a[4:7], a[240:243], a[52:55], 0
  v_xor_b32 v0, 32, v0
  v_mul_f32 v51, v13, v51
  v_mfma_f32_16x16x32_bf16 a[4:7], a[244:247], a[76:79], a[4:7]
  ds_read_b64_tr_b16 a[252:253], v0 offset:0
  v_mul_f32 v52, v13, v52
  v_mul_f32 v53, v13, v53
  v_mfma_f32_16x16x32_bf16 a[8:11], a[240:243], a[56:59], 0
  ds_read_b64_tr_b16 a[254:255], v0 offset:2048
  v_cvt_pk_bf16_f32 v50, v50, v51
  v_mfma_f32_16x16x32_bf16 a[8:11], a[244:247], a[80:83], a[8:11]
  v_cvt_pk_bf16_f32 v51, v52, v53
  v_accvgpr_read_b32 v52, a176
  v_mfma_f32_16x16x32_bf16 a[12:15], a[240:243], a[60:63], 0
  v_accvgpr_read_b32 v53, a177
  v_accvgpr_read_b32 v54, a178
  v_mfma_f32_16x16x32_bf16 a[12:15], a[244:247], a[84:87], a[12:15]
  v_accvgpr_read_b32 v55, a179
  v_mul_f32 v52, v12, v52
  v_mul_f32 v53, v12, v53
  v_mfma_f32_16x16x32_bf16 a[16:19], a[240:243], a[64:67], 0
  v_mul_f32 v54, v12, v54
  v_mul_f32 v55, v12, v55
  v_mfma_f32_16x16x32_bf16 a[16:19], a[244:247], a[88:91], a[16:19]
  v_cvt_pk_bf16_f32 v52, v52, v53
  v_cvt_pk_bf16_f32 v53, v54, v55
  v_mfma_f32_16x16x32_bf16 a[20:23], a[240:243], a[68:71], 0
  v_accvgpr_read_b32 v54, a180
  v_accvgpr_read_b32 v55, a181
  v_mfma_f32_16x16x32_bf16 a[20:23], a[244:247], a[92:95], a[20:23]
  s_waitcnt lgkmcnt(0)
  v_accvgpr_read_b32 v3, a183
  v_mul_f32 v54, v13, v54
  v_mul_f32 v55, v13, v55
  v_mfma_f32_16x16x32_bf16 a[0:3], a[248:251], a[96:99], a[0:3]
  ds_read_b64_tr_b16 a[240:241], v0 offset:4096
  v_mul_f32 v3, v13, v3
  v_mfma_f32_16x16x32_bf16 a[24:27], a[252:255], a[48:51], 0
  ds_read_b64_tr_b16 a[242:243], v0 offset:6144
  v_cvt_pk_bf16_f32 v54, v54, v55
  v_mfma_f32_16x16x32_bf16 a[4:7], a[248:251], a[100:103], a[4:7]
  ds_read_b64_tr_b16 a[244:245], v0 offset:8192
  v_accvgpr_read_b32 v55, a182
  v_mul_f32 v55, v13, v55
  v_mfma_f32_16x16x32_bf16 a[28:31], a[252:255], a[52:55], 0
  ds_read_b64_tr_b16 a[246:247], v0 offset:10240
  v_cvt_pk_bf16_f32 v55, v55, v3
  v_mfma_f32_16x16x32_bf16 a[8:11], a[248:251], a[104:107], a[8:11]
  v_xor_b32 v0, 96, v0
  v_accvgpr_read_b32 v56, a160
  v_mfma_f32_16x16x32_bf16 a[32:35], a[252:255], a[56:59], 0
  v_accvgpr_read_b32 v57, a161
  v_accvgpr_read_b32 v58, a162
  v_mfma_f32_16x16x32_bf16 a[12:15], a[248:251], a[108:111], a[12:15]
  v_accvgpr_read_b32 v59, a163
  v_mul_f32 v56, v14, v56
  v_mul_f32 v57, v14, v57
  v_mfma_f32_16x16x32_bf16 a[36:39], a[252:255], a[60:63], 0
  v_mul_f32 v58, v14, v58
  v_mul_f32 v59, v14, v59
  v_mfma_f32_16x16x32_bf16 a[16:19], a[248:251], a[112:115], a[16:19]
  v_cvt_pk_bf16_f32 v56, v56, v57
  v_cvt_pk_bf16_f32 v57, v58, v59
  v_mfma_f32_16x16x32_bf16 a[40:43], a[252:255], a[64:67], 0
  v_accvgpr_read_b32 v58, a164
  v_accvgpr_read_b32 v59, a165
  v_mfma_f32_16x16x32_bf16 a[20:23], a[248:251], a[116:119], a[20:23]
  v_accvgpr_read_b32 v60, a166
  v_accvgpr_read_b32 v61, a167
  v_mul_f32 v58, v15, v58
  v_mfma_f32_16x16x32_bf16 a[44:47], a[252:255], a[68:71], 0
  s_waitcnt lgkmcnt(0)
  v_mul_f32 v59, v15, v59
  v_mul_f32 v60, v15, v60
  v_mfma_f32_16x16x32_bf16 a[24:27], a[240:243], a[72:75], a[24:27]
  ds_read_b64_tr_b16 a[248:249], v0 offset:0
  v_mul_f32 v61, v15, v61
  v_mfma_f32_16x16x32_bf16 a[24:27], a[244:247], a[96:99], a[24:27]
  ds_read_b64_tr_b16 a[250:251], v0 offset:2048
  v_cvt_pk_bf16_f32 v58, v58, v59
  v_mfma_f32_16x16x32_bf16 a[28:31], a[240:243], a[76:79], a[28:31]
  ds_read_b64_tr_b16 a[252:253], v0 offset:4096
  v_cvt_pk_bf16_f32 v59, v60, v61
  v_accvgpr_read_b32 v60, a184
  v_mfma_f32_16x16x32_bf16 a[28:31], a[244:247], a[100:103], a[28:31]
  ds_read_b64_tr_b16 a[254:255], v0 offset:6144
  v_accvgpr_read_b32 v61, a185
  v_mfma_f32_16x16x32_bf16 a[32:35], a[240:243], a[80:83], a[32:35]
  v_accvgpr_read_b32 v62, a186
  v_accvgpr_read_b32 v63, a187
  v_mfma_f32_16x16x32_bf16 a[32:35], a[244:247], a[104:107], a[32:35]
  v_mul_f32 v60, v14, v60
  v_mul_f32 v61, v14, v61
  v_mul_f32 v62, v14, v62
  v_mfma_f32_16x16x32_bf16 a[36:39], a[240:243], a[84:87], a[36:39]
  v_mul_f32 v63, v14, v63
  v_cvt_pk_bf16_f32 v60, v60, v61
  v_mfma_f32_16x16x32_bf16 a[36:39], a[244:247], a[108:111], a[36:39]
  v_cvt_pk_bf16_f32 v61, v62, v63
  v_accvgpr_read_b32 v62, a188
  v_mfma_f32_16x16x32_bf16 a[40:43], a[240:243], a[88:91], a[40:43]
  v_accvgpr_read_b32 v63, a189
  v_accvgpr_read_b32 v3, a191
  v_mfma_f32_16x16x32_bf16 a[40:43], a[244:247], a[112:115], a[40:43]
  v_mul_f32 v62, v15, v62
  v_mul_f32 v63, v15, v63
  v_mul_f32 v3, v15, v3
  v_mfma_f32_16x16x32_bf16 a[44:47], a[240:243], a[92:95], a[44:47]
  v_cvt_pk_bf16_f32 v62, v62, v63
  v_accvgpr_read_b32 v63, a190
  v_mfma_f32_16x16x32_bf16 a[44:47], a[244:247], a[116:119], a[44:47]
  s_waitcnt lgkmcnt(0)
  v_mul_f32 v63, v15, v63
  v_cvt_pk_bf16_f32 v63, v63, v3
  v_mfma_f32_16x16x32_bf16 a[144:147], a[248:251], a[48:51], 0
  ds_read_b64_tr_b16 a[240:241], v0 offset:8192
  v_accvgpr_read_b32 v88, a192
  v_mfma_f32_16x16x32_bf16 a[144:147], a[252:255], a[72:75], a[144:147]
  ds_read_b64_tr_b16 a[242:243], v0 offset:10240
  v_accvgpr_read_b32 v89, a193
  v_mfma_f32_16x16x32_bf16 a[148:151], a[248:251], a[52:55], 0
  v_xor_b32 v0, 32, v0
  v_accvgpr_read_b32 v90, a194
  v_mfma_f32_16x16x32_bf16 a[148:151], a[252:255], a[76:79], a[148:151]
  ds_read_b64_tr_b16 a[244:245], v0 offset:0
  v_accvgpr_read_b32 v91, a195
  v_mfma_f32_16x16x32_bf16 a[152:155], a[248:251], a[56:59], 0
  ds_read_b64_tr_b16 a[246:247], v0 offset:2048
  v_mul_f32 v88, v10, v88
  v_mfma_f32_16x16x32_bf16 a[152:155], a[252:255], a[80:83], a[152:155]
  v_mul_f32 v89, v10, v89
  v_mul_f32 v90, v10, v90
  v_mfma_f32_16x16x32_bf16 a[156:159], a[248:251], a[60:63], 0
  v_mul_f32 v91, v10, v91
  v_cvt_pk_bf16_f32 v88, v88, v89
  v_mfma_f32_16x16x32_bf16 a[156:159], a[252:255], a[84:87], a[156:159]
  v_cvt_pk_bf16_f32 v89, v90, v91
  v_mfma_f32_16x16x32_bf16 a[160:163], a[248:251], a[64:67], 0
  v_accvgpr_read_b32 v90, a196
  v_accvgpr_read_b32 v91, a197
  v_mfma_f32_16x16x32_bf16 a[160:163], a[252:255], a[88:91], a[160:163]
  v_accvgpr_read_b32 v92, a198
  v_accvgpr_read_b32 v93, a199
  v_mfma_f32_16x16x32_bf16 a[164:167], a[248:251], a[68:71], 0
  v_mul_f32 v90, v11, v90
  v_mul_f32 v91, v11, v91
  v_mfma_f32_16x16x32_bf16 a[164:167], a[252:255], a[92:95], a[164:167]
  s_waitcnt lgkmcnt(0)
  v_mul_f32 v92, v11, v92
  v_mul_f32 v93, v11, v93
  v_mfma_f32_16x16x32_bf16 a[144:147], a[240:243], a[96:99], a[144:147]
  ds_read_b64_tr_b16 a[248:249], v0 offset:4096
  v_cvt_pk_bf16_f32 v90, v90, v91
  v_mfma_f32_16x16x32_bf16 a[168:171], a[244:247], a[48:51], 0
  ds_read_b64_tr_b16 a[250:251], v0 offset:6144
  v_cvt_pk_bf16_f32 v91, v92, v93
  v_mfma_f32_16x16x32_bf16 a[148:151], a[240:243], a[100:103], a[148:151]
  ds_read_b64_tr_b16 a[252:253], v0 offset:8192
  v_accvgpr_read_b32 v92, a216
  v_mfma_f32_16x16x32_bf16 a[172:175], a[244:247], a[52:55], 0
  ds_read_b64_tr_b16 a[254:255], v0 offset:10240
  v_accvgpr_read_b32 v93, a217
  v_mfma_f32_16x16x32_bf16 a[152:155], a[240:243], a[104:107], a[152:155]
  v_xor_b32 v0, 96, v0
  v_accvgpr_read_b32 v94, a218
  v_mfma_f32_16x16x32_bf16 a[176:179], a[244:247], a[56:59], 0
  v_accvgpr_read_b32 v95, a219
  v_mul_f32 v92, v10, v92
  v_mfma_f32_16x16x32_bf16 a[156:159], a[240:243], a[108:111], a[156:159]
  v_mul_f32 v93, v10, v93
  v_mul_f32 v94, v10, v94
  v_mfma_f32_16x16x32_bf16 a[180:183], a[244:247], a[60:63], 0
  v_mul_f32 v95, v10, v95
  v_cvt_pk_bf16_f32 v92, v92, v93
  v_mfma_f32_16x16x32_bf16 a[160:163], a[240:243], a[112:115], a[160:163]
  v_cvt_pk_bf16_f32 v93, v94, v95
  v_accvgpr_read_b32 v94, a220
  v_mfma_f32_16x16x32_bf16 a[184:187], a[244:247], a[64:67], 0
  v_accvgpr_read_b32 v95, a221
  v_mfma_f32_16x16x32_bf16 a[164:167], a[240:243], a[116:119], a[164:167]
L_pad_16:
  s_cbranch_execz L_padret2
  v_accvgpr_read_b32 v3, a223
  v_mul_f32 v94, v11, v94
  v_mfma_f32_16x16x32_bf16 a[188:191], a[244:247], a[68:71], 0
  s_waitcnt lgkmcnt(0)
  ds_read_b64_tr_b16 a[240:241], v0 offset:12288
  v_mul_f32 v95, v11, v95
  v_mfma_f32_16x16x32_bf16 a[168:171], a[248:251], a[72:75], a[168:171]
  ds_read_b64_tr_b16 a[242:243], v0 offset:14336
  v_mul_f32 v3, v11, v3
  v_mfma_f32_16x16x32_bf16 a[168:171], a[252:255], a[96:99], a[168:171]
  ds_read_b64_tr_b16 a[244:245], v0 offset:16384
  v_cvt_pk_bf16_f32 v94, v94, v95
  v_mfma_f32_16x16x32_bf16 a[172:175], a[248:251], a[76:79], a[172:175]
  ds_read_b64_tr_b16 a[246:247], v0 offset:18432
  v_accvgpr_read_b32 v95, a222
  v_mfma_f32_16x16x32_bf16 a[172:175], a[252:255], a[100:103], a[172:175]
  v_mul_f32 v95, v11, v95
  v_cvt_pk_bf16_f32 v95, v95, v3
  v_mfma_f32_16x16x32_bf16 a[176:179], a[248:251], a[80:83], a[176:179]
  ds_write_b64 v7, v[40:41] offset:0
  v_mfma_f32_16x16x32_bf16 a[176:179], a[252:255], a[104:107], a[176:179]
  ds_write_b64 v7, v[42:43] offset:2048
  v_xor_b32 v7, 32, v7
  v_mfma_f32_16x16x32_bf16 a[180:183], a[248:251], a[84:87], a[180:183]
  ds_write_b64 v7, v[44:45] offset:0
  v_mfma_f32_16x16x32_bf16 a[180:183], a[252:255], a[108:111], a[180:183]
  ds_write_b64 v7, v[46:47] offset:2048
  v_xor_b32 v7, 96, v7
  v_mfma_f32_16x16x32_bf16 a[184:187], a[248:251], a[88:91], a[184:187]
  ds_write_b64 v7, v[88:89] offset:0
  v_mfma_f32_16x16x32_bf16 a[184:187], a[252:255], a[112:115], a[184:187]
  ds_write_b64 v7, v[90:91] offset:2048
  v_xor_b32 v7, 32, v7
  v_mfma_f32_16x16x32_bf16 a[188:191], a[248:251], a[92:95], a[188:191]
  ds_write_b64 v7, v[92:93] offset:0
  v_mfma_f32_16x16x32_bf16 a[188:191], a[252:255], a[116:119], a[188:191]
  s_waitcnt lgkmcnt(7)
  ds_write_b64 v7, v[94:95] offset:2048
  v_xor_b32 v7, 96, v7
  v_mfma_f32_16x16x32_bf16 a[0:3], a[240:243], a[120:123], a[0:3]
  ds_read_b64_tr_b16 a[248:249], v0 offset:20480
  ds_read_b128 v[40:43], v8 offset:0
  v_mfma_f32_16x16x32_bf16 a[0:3], a[244:247], v[112:115], a[0:3]
  ds_read_b64_tr_b16 a[250:251], v0 offset:22528
  ds_read_b128 v[44:47], v8 offset:1024
  v_mfma_f32_16x16x32_bf16 a[4:7], a[240:243], a[124:127], a[4:7]
  v_xor_b32 v0, 32, v0
  v_mfma_f32_16x16x32_bf16 a[4:7], a[244:247], v[116:119], a[4:7]
  ds_read_b64_tr_b16 a[252:253], v0 offset:12288
  ds_read_b128 v[88:91], v8 offset:2048
  ds_read_b128 v[92:95], v8 offset:3072
  v_mfma_f32_16x16x32_bf16 a[8:11], a[240:243], a[128:131], a[8:11]
  ds_read_b64_tr_b16 a[254:255], v0 offset:14336
  v_accvgpr_read_b32 v96, a200
  v_mfma_f32_16x16x32_bf16 a[8:11], a[244:247], v[120:123], a[8:11]
  v_accvgpr_read_b32 v97, a201
  v_accvgpr_read_b32 v98, a202
  v_mfma_f32_16x16x32_bf16 a[12:15], a[240:243], a[132:135], a[12:15]
  v_accvgpr_read_b32 v99, a203
  v_mul_f32 v96, v12, v96
  v_mfma_f32_16x16x32_bf16 a[12:15], a[244:247], v[124:127], a[12:15]
  v_mul_f32 v97, v12, v97
  v_mul_f32 v98, v12, v98
  v_mfma_f32_16x16x32_bf16 a[16:19], a[240:243], a[136:139], a[16:19]
  s_add_u32 s46, s35, 0
  s_waitcnt lgkmcnt(6)
  buffer_store_dwordx4 v[40:43], v9, s[24:27], s46 offen sc1
  v_mfma_f32_16x16x32_bf16 a[16:19], a[244:247], v[128:131], a[16:19]
  v_mul_f32 v99, v12, v99
  v_cvt_pk_bf16_f32 v96, v96, v97
  v_mfma_f32_16x16x32_bf16 a[20:23], a[240:243], a[140:143], a[20:23]
  v_cvt_pk_bf16_f32 v97, v98, v99
  v_accvgpr_read_b32 v98, a204
  v_mfma_f32_16x16x32_bf16 a[20:23], a[244:247], v[132:135], a[20:23]
  s_waitcnt lgkmcnt(0)
  v_accvgpr_read_b32 v99, a205
  v_accvgpr_read_b32 v100, a206
  v_mfma_f32_16x16x32_bf16 a[0:3], a[248:251], v[136:139], a[0:3]
  ds_read_b64_tr_b16 a[240:241], v0 offset:16384
  v_accvgpr_read_b32 v101, a207
  v_mfma_f32_16x16x32_bf16 a[24:27], a[252:255], a[120:123], a[24:27]
  ds_read_b64_tr_b16 a[242:243], v0 offset:18432
  v_mul_f32 v98, v13, v98
  v_mul_f32 v99, v13, v99
  v_mfma_f32_16x16x32_bf16 a[4:7], a[248:251], v[140:143], a[4:7]
  ds_read_b64_tr_b16 a[244:245], v0 offset:20480
  v_mul_f32 v100, v13, v100
  v_mfma_f32_16x16x32_bf16 a[28:31], a[252:255], a[124:127], a[28:31]
  ds_read_b64_tr_b16 a[246:247], v0 offset:22528
  v_mul_f32 v101, v13, v101
  v_mfma_f32_16x16x32_bf16 a[8:11], a[248:251], v[144:147], a[8:11]
  v_xor_b32 v0, 96, v0
  v_cvt_pk_bf16_f32 v98, v98, v99
  v_mfma_f32_16x16x32_bf16 a[32:35], a[252:255], a[128:131], a[32:35]
  v_cvt_pk_bf16_f32 v99, v100, v101
  v_accvgpr_read_b32 v100, a224
  v_mfma_f32_16x16x32_bf16 a[12:15], a[248:251], v[148:151], a[12:15]
  v_accvgpr_read_b32 v101, a225
  v_accvgpr_read_b32 v102, a226
  v_mfma_f32_16x16x32_bf16 a[36:39], a[252:255], a[132:135], a[36:39]
  buffer_store_dwordx4 v[44:47], v9, s[24:27], s46 offen offset:3072 sc1
  v_mfma_f32_16x16x32_bf16 a[16:19], a[248:251], v[152:155], a[16:19]
  v_accvgpr_read_b32 v103, a227
  v_mul_f32 v100, v12, v100
  v_mfma_f32_16x16x32_bf16 a[40:43], a[252:255], a[136:139], a[40:43]
  v_mul_f32 v101, v12, v101
  v_mul_f32 v102, v12, v102
  v_mfma_f32_16x16x32_bf16 a[20:23], a[248:251], v[156:159], a[20:23]
  v_mul_f32 v103, v12, v103
  v_cvt_pk_bf16_f32 v100, v100, v101
  v_mfma_f32_16x16x32_bf16 a[44:47], a[252:255], a[140:143], a[44:47]
  s_waitcnt lgkmcnt(0)
  v_cvt_pk_bf16_f32 v101, v102, v103
  v_accvgpr_read_b32 v102, a228
  v_mfma_f32_16x16x32_bf16 a[24:27], a[240:243], v[112:115], a[24:27]
  ds_read_b64_tr_b16 a[248:249], v0 offset:12288
  v_accvgpr_read_b32 v103, a229
  v_mfma_f32_16x16x32_bf16 a[24:27], a[244:247], v[136:139], a[24:27]
  ds_read_b64_tr_b16 a[250:251], v0 offset:14336
  v_accvgpr_read_b32 v3, a231
  v_mfma_f32_16x16x32_bf16 a[28:31], a[240:243], v[116:119], a[28:31]
  ds_read_b64_tr_b16 a[252:253], v0 offset:16384
  v_mul_f32 v102, v13, v102
  v_mfma_f32_16x16x32_bf16 a[28:31], a[244:247], v[140:143], a[28:31]
  ds_read_b64_tr_b16 a[254:255], v0 offset:18432
  v_mul_f32 v103, v13, v103
  v_mfma_f32_16x16x32_bf16 a[32:35], a[240:243], v[120:123], a[32:35]
  v_mul_f32 v3, v13, v3
  v_cvt_pk_bf16_f32 v102, v102, v103
  v_mfma_f32_16x16x32_bf16 a[32:35], a[244:247], v[144:147], a[32:35]
  v_accvgpr_read_b32 v103, a230
  v_mul_f32 v103, v13, v103
  v_cvt_pk_bf16_f32 v103, v103, v3
  v_mfma_f32_16x16x32_bf16 a[36:39], a[240:243], v[124:127], a[36:39]
  s_add_u32 s46, s35, 6144
  buffer_store_dwordx4 v[88:91], v9, s[24:27], s46 offen sc1
  v_mfma_f32_16x16x32_bf16 a[36:39], a[244:247], v[148:151], a[36:39]
  ds_write_b64 v7, v[48:49] offset:0
  v_mfma_f32_16x16x32_bf16 a[40:43], a[240:243], v[128:131], a[40:43]
  ds_write_b64 v7, v[50:51] offset:2048
  v_xor_b32 v7, 32, v7
  v_mfma_f32_16x16x32_bf16 a[40:43], a[244:247], v[152:155], a[40:43]
  ds_write_b64 v7, v[52:53] offset:0
  v_mfma_f32_16x16x32_bf16 a[44:47], a[240:243], v[132:135], a[44:47]
  ds_write_b64 v7, v[54:55] offset:2048
  v_xor_b32 v7, 96, v7
  v_mfma_f32_16x16x32_bf16 a[44:47], a[244:247], v[156:159], a[44:47]
  s_waitcnt lgkmcnt(4)
  ds_write_b64 v7, v[96:97] offset:0
  v_mfma_f32_16x16x32_bf16 a[144:147], a[248:251], a[120:123], a[144:147]
  ds_read_b64_tr_b16 a[240:241], v0 offset:20480
  ds_write_b64 v7, v[98:99] offset:2048
  v_mfma_f32_16x16x32_bf16 a[144:147], a[252:255], v[112:115], a[144:147]
  ds_read_b64_tr_b16 a[242:243], v0 offset:22528
  v_xor_b32 v7, 32, v7
  v_mfma_f32_16x16x32_bf16 a[148:151], a[248:251], a[124:127], a[148:151]
  v_xor_b32 v0, 32, v0
  v_mfma_f32_16x16x32_bf16 a[148:151], a[252:255], v[116:119], a[148:151]
  ds_read_b64_tr_b16 a[244:245], v0 offset:12288
  ds_write_b64 v7, v[100:101] offset:0
  ds_write_b64 v7, v[102:103] offset:2048
  v_mfma_f32_16x16x32_bf16 a[152:155], a[248:251], a[128:131], a[152:155]
  ds_read_b64_tr_b16 a[246:247], v0 offset:14336
  v_xor_b32 v7, 96, v7
  v_mfma_f32_16x16x32_bf16 a[152:155], a[252:255], v[120:123], a[152:155]
  buffer_store_dwordx4 v[92:95], v9, s[24:27], s46 offen offset:3072 sc1
  v_mfma_f32_16x16x32_bf16 a[156:159], a[248:251], a[132:135], a[156:159]
  ds_read_b128 v[48:51], v8 offset:0
  ds_read_b128 v[52:55], v8 offset:1024
  v_mfma_f32_16x16x32_bf16 a[156:159], a[252:255], v[124:127], a[156:159]
  ds_read_b128 v[96:99], v8 offset:2048
  ds_read_b128 v[100:103], v8 offset:3072
  v_mfma_f32_16x16x32_bf16 a[160:163], a[248:251], a[136:139], a[160:163]
  v_accvgpr_read_b32 v104, a208
  v_accvgpr_read_b32 v105, a209
  v_mfma_f32_16x16x32_bf16 a[160:163], a[252:255], v[128:131], a[160:163]
  v_accvgpr_read_b32 v106, a210
  v_accvgpr_read_b32 v107, a211
  v_mfma_f32_16x16x32_bf16 a[164:167], a[248:251], a[140:143], a[164:167]
  v_mul_f32 v104, v14, v104
  v_mul_f32 v105, v14, v105
  v_mfma_f32_16x16x32_bf16 a[164:167], a[252:255], v[132:135], a[164:167]
  s_waitcnt lgkmcnt(4)
  v_mul_f32 v106, v14, v106
  v_mul_f32 v107, v14, v107
  v_mfma_f32_16x16x32_bf16 a[144:147], a[240:243], v[136:139], a[144:147]
  ds_read_b64_tr_b16 a[248:249], v0 offset:16384
  v_cvt_pk_bf16_f32 v104, v104, v105
  v_mfma_f32_16x16x32_bf16 a[168:171], a[244:247], a[120:123], a[168:171]
  ds_read_b64_tr_b16 a[250:251], v0 offset:18432
  v_cvt_pk_bf16_f32 v105, v106, v107
  v_mfma_f32_16x16x32_bf16 a[148:151], a[240:243], v[140:143], a[148:151]
  ds_read_b64_tr_b16 a[252:253], v0 offset:20480
  v_accvgpr_read_b32 v106, a212
  v_mfma_f32_16x16x32_bf16 a[172:175], a[244:247], a[124:127], a[172:175]
  ds_read_b64_tr_b16 a[254:255], v0 offset:22528
  v_mfma_f32_16x16x32_bf16 a[152:155], a[240:243], v[144:147], a[152:155]
  v_xor_b32 v0, 96, v0
  s_add_u32 s46, s35, 12288
  s_waitcnt lgkmcnt(7)
  buffer_store_dwordx4 v[48:51], v9, s[24:27], s46 offen sc1
  v_mfma_f32_16x16x32_bf16 a[176:179], a[244:247], a[128:131], a[176:179]
  v_accvgpr_read_b32 v107, a213
  v_accvgpr_read_b32 v108, a214
  v_mfma_f32_16x16x32_bf16 a[156:159], a[240:243], v[148:151], a[156:159]
  v_accvgpr_read_b32 v109, a215
  v_mul_f32 v106, v15, v106
  v_mfma_f32_16x16x32_bf16 a[180:183], a[244:247], a[132:135], a[180:183]
  v_mul_f32 v107, v15, v107
  v_mul_f32 v108, v15, v108
  v_mfma_f32_16x16x32_bf16 a[160:163], a[240:243], v[152:155], a[160:163]
  v_mul_f32 v109, v15, v109
  v_cvt_pk_bf16_f32 v106, v106, v107
  v_mfma_f32_16x16x32_bf16 a[184:187], a[244:247], a[136:139], a[184:187]
  v_cvt_pk_bf16_f32 v107, v108, v109
  v_accvgpr_read_b32 v108, a232
  v_mfma_f32_16x16x32_bf16 a[164:167], a[240:243], v[156:159], a[164:167]
  v_accvgpr_read_b32 v109, a233
  v_accvgpr_read_b32 v110, a234
  v_mfma_f32_16x16x32_bf16 a[188:191], a[244:247], a[140:143], a[188:191]
  s_waitcnt lgkmcnt(0)
  ds_read_b64_tr_b16 a[240:241], v0 offset:24576
  v_accvgpr_read_b32 v111, a235
  v_mfma_f32_16x16x32_bf16 a[168:171], a[248:251], v[112:115], a[168:171]
  ds_read_b64_tr_b16 a[242:243], v0 offset:26624
  v_mul_f32 v108, v14, v108
  v_mfma_f32_16x16x32_bf16 a[168:171], a[252:255], v[136:139], a[168:171]
  ds_read_b64_tr_b16 a[244:245], v0 offset:28672
  v_mul_f32 v109, v14, v109
  v_mfma_f32_16x16x32_bf16 a[172:175], a[248:251], v[116:119], a[172:175]
  ds_read_b64_tr_b16 a[246:247], v0 offset:30720
  v_mul_f32 v110, v14, v110
  v_mfma_f32_16x16x32_bf16 a[172:175], a[252:255], v[140:143], a[172:175]
  buffer_store_dwordx4 v[52:55], v9, s[24:27], s46 offen offset:3072 sc1
  v_mfma_f32_16x16x32_bf16 a[176:179], a[248:251], v[120:123], a[176:179]
  v_mul_f32 v111, v14, v111
  v_cvt_pk_bf16_f32 v108, v108, v109
  v_mfma_f32_16x16x32_bf16 a[176:179], a[252:255], v[144:147], a[176:179]
  v_cvt_pk_bf16_f32 v109, v110, v111
  v_accvgpr_read_b32 v110, a236
  v_mfma_f32_16x16x32_bf16 a[180:183], a[248:251], v[124:127], a[180:183]
  v_accvgpr_read_b32 v111, a237
  v_mfma_f32_16x16x32_bf16 a[180:183], a[252:255], v[148:151], a[180:183]
  v_accvgpr_read_b32 v3, a239
  v_mul_f32 v110, v15, v110
  v_mfma_f32_16x16x32_bf16 a[184:187], a[248:251], v[128:131], a[184:187]
  v_mul_f32 v111, v15, v111
  v_mul_f32 v3, v15, v3
  v_mfma_f32_16x16x32_bf16 a[184:187], a[252:255], v[152:155], a[184:187]
  v_cvt_pk_bf16_f32 v110, v110, v111
  v_accvgpr_read_b32 v111, a238
  v_mfma_f32_16x16x32_bf16 a[188:191], a[248:251], v[132:135], a[188:191]
  v_mul_f32 v111, v15, v111
  v_cvt_pk_bf16_f32 v111, v111, v3
  v_mfma_f32_16x16x32_bf16 a[188:191], a[252:255], v[156:159], a[188:191]
  s_waitcnt lgkmcnt(0)
  ds_write_b64 v7, v[56:57] offset:0
  v_mfma_f32_16x16x32_bf16 a[0:3], a[240:243], v[160:163], a[0:3]
  ds_read_b64_tr_b16 a[248:249], v0 offset:32768
  ds_write_b64 v7, v[58:59] offset:2048
  v_mfma_f32_16x16x32_bf16 a[0:3], a[244:247], v[184:187], a[0:3]
  ds_read_b64_tr_b16 a[250:251], v0 offset:34816
  v_xor_b32 v7, 32, v7
  v_mfma_f32_16x16x32_bf16 a[4:7], a[240:243], v[164:167], a[4:7]
  v_xor_b32 v0, 32, v0
  s_add_u32 s46, s35, 18432
  buffer_store_dwordx4 v[96:99], v9, s[24:27], s46 offen sc1
  v_mfma_f32_16x16x32_bf16 a[4:7], a[244:247], v[188:191], a[4:7]
  ds_read_b64_tr_b16 a[252:253], v0 offset:24576
  ds_write_b64 v7, v[60:61] offset:0
  v_mfma_f32_16x16x32_bf16 a[8:11], a[240:243], v[168:171], a[8:11]
  ds_read_b64_tr_b16 a[254:255], v0 offset:26624
  v_mfma_f32_16x16x32_bf16 a[8:11], a[244:247], v[192:195], a[8:11]
  ds_write_b64 v7, v[62:63] offset:2048
  v_xor_b32 v7, 96, v7
  v_mfma_f32_16x16x32_bf16 a[12:15], a[240:243], v[172:175], a[12:15]
  ds_write_b64 v7, v[104:105] offset:0
  v_mfma_f32_16x16x32_bf16 a[12:15], a[244:247], v[196:199], a[12:15]
  ds_write_b64 v7, v[106:107] offset:2048
  v_xor_b32 v7, 32, v7
  v_mfma_f32_16x16x32_bf16 a[16:19], a[240:243], v[176:179], a[16:19]
  ds_write_b64 v7, v[108:109] offset:0
  v_mfma_f32_16x16x32_bf16 a[16:19], a[244:247], v[200:203], a[16:19]
  ds_write_b64 v7, v[110:111] offset:2048
  v_xor_b32 v7, 96, v7
  v_mfma_f32_16x16x32_bf16 a[20:23], a[240:243], v[180:183], a[20:23]
  ds_read_b128 v[56:59], v8 offset:0
  ds_read_b128 v[60:63], v8 offset:1024
  v_mfma_f32_16x16x32_bf16 a[20:23], a[244:247], v[204:207], a[20:23]
  s_waitcnt lgkmcnt(7)
  ds_read_b128 v[104:107], v8 offset:2048
  ds_read_b128 v[108:111], v8 offset:3072
  v_mfma_f32_16x16x32_bf16 a[0:3], a[248:251], v[208:211], a[0:3]
  ds_read_b64_tr_b16 a[240:241], v0 offset:28672
  v_mfma_f32_16x16x32_bf16 a[24:27], a[252:255], v[160:163], a[24:27]
  ds_read_b64_tr_b16 a[242:243], v0 offset:30720
  buffer_store_dwordx4 v[100:103], v9, s[24:27], s46 offen offset:3072 sc1
  v_mfma_f32_16x16x32_bf16 a[4:7], a[248:251], v[212:215], a[4:7]
  ds_read_b64_tr_b16 a[244:245], v0 offset:32768
  v_mfma_f32_16x16x32_bf16 a[28:31], a[252:255], v[164:167], a[28:31]
  ds_read_b64_tr_b16 a[246:247], v0 offset:34816
  v_mfma_f32_16x16x32_bf16 a[8:11], a[248:251], v[216:219], a[8:11]
  v_xor_b32 v0, 96, v0
  v_mfma_f32_16x16x32_bf16 a[32:35], a[252:255], v[168:171], a[32:35]
  v_mfma_f32_16x16x32_bf16 a[12:15], a[248:251], v[220:223], a[12:15]
  v_mfma_f32_16x16x32_bf16 a[36:39], a[252:255], v[172:175], a[36:39]
  v_mfma_f32_16x16x32_bf16 a[16:19], a[248:251], v[224:227], a[16:19]
  v_mfma_f32_16x16x32_bf16 a[40:43], a[252:255], v[176:179], a[40:43]
  v_mfma_f32_16x16x32_bf16 a[20:23], a[248:251], v[228:231], a[20:23]
  v_mfma_f32_16x16x32_bf16 a[44:47], a[252:255], v[180:183], a[44:47]
  s_waitcnt lgkmcnt(0)
  v_mfma_f32_16x16x32_bf16 a[24:27], a[240:243], v[184:187], a[24:27]
  ds_read_b64_tr_b16 a[248:249], v0 offset:24576
  s_add_u32 s46, s35, 24576
  buffer_store_dwordx4 v[56:59], v9, s[24:27], s46 offen sc1
  v_mfma_f32_16x16x32_bf16 a[24:27], a[244:247], v[208:211], a[24:27]
  ds_read_b64_tr_b16 a[250:251], v0 offset:26624
  v_mfma_f32_16x16x32_bf16 a[28:31], a[240:243], v[188:191], a[28:31]
  ds_read_b64_tr_b16 a[252:253], v0 offset:28672
  v_mfma_f32_16x16x32_bf16 a[28:31], a[244:247], v[212:215], a[28:31]
  ds_read_b64_tr_b16 a[254:255], v0 offset:30720
  v_mfma_f32_16x16x32_bf16 a[32:35], a[240:243], v[192:195], a[32:35]
  v_mfma_f32_16x16x32_bf16 a[32:35], a[244:247], v[216:219], a[32:35]
  v_mfma_f32_16x16x32_bf16 a[36:39], a[240:243], v[196:199], a[36:39]
  v_mfma_f32_16x16x32_bf16 a[36:39], a[244:247], v[220:223], a[36:39]
  v_mfma_f32_16x16x32_bf16 a[40:43], a[240:243], v[200:203], a[40:43]
  v_mfma_f32_16x16x32_bf16 a[40:43], a[244:247], v[224:227], a[40:43]
  v_mfma_f32_16x16x32_bf16 a[44:47], a[240:243], v[204:207], a[44:47]
  v_mfma_f32_16x16x32_bf16 a[44:47], a[244:247], v[228:231], a[44:47]
  s_waitcnt lgkmcnt(0)
  buffer_store_dwordx4 v[60:63], v9, s[24:27], s46 offen offset:3072 sc1
  v_mfma_f32_16x16x32_bf16 a[144:147], a[248:251], v[160:163], a[144:147]
  ds_read_b64_tr_b16 a[240:241], v0 offset:32768
  v_mfma_f32_16x16x32_bf16 a[144:147], a[252:255], v[184:187], a[144:147]
  ds_read_b64_tr_b16 a[242:243], v0 offset:34816
  v_mfma_f32_16x16x32_bf16 a[148:151], a[248:251], v[164:167], a[148:151]
  v_xor_b32 v0, 32, v0
  v_mfma_f32_16x16x32_bf16 a[148:151], a[252:255], v[188:191], a[148:151]
  ds_read_b64_tr_b16 a[244:245], v0 offset:24576
  v_mfma_f32_16x16x32_bf16 a[152:155], a[248:251], v[168:171], a[152:155]
  ds_read_b64_tr_b16 a[246:247], v0 offset:26624
  v_mfma_f32_16x16x32_bf16 a[152:155], a[252:255], v[192:195], a[152:155]
  v_mfma_f32_16x16x32_bf16 a[156:159], a[248:251], v[172:175], a[156:159]
  v_mfma_f32_16x16x32_bf16 a[156:159], a[252:255], v[196:199], a[156:159]
  v_mfma_f32_16x16x32_bf16 a[160:163], a[248:251], v[176:179], a[160:163]
  v_mfma_f32_16x16x32_bf16 a[160:163], a[252:255], v[200:203], a[160:163]
  v_mfma_f32_16x16x32_bf16 a[164:167], a[248:251], v[180:183], a[164:167]
  s_add_u32 s46, s35, 30720
  buffer_store_dwordx4 v[104:107], v9, s[24:27], s46 offen sc1
  v_mfma_f32_16x16x32_bf16 a[164:167], a[252:255], v[204:207], a[164:167]
  s_waitcnt lgkmcnt(0)
  v_mfma_f32_16x16x32_bf16 a[144:147], a[240:243], v[208:211], a[144:147]
  ds_read_b64_tr_b16 a[248:249], v0 offset:28672
  v_mfma_f32_16x16x32_bf16 a[168:171], a[244:247], v[160:163], a[168:171]
  ds_read_b64_tr_b16 a[250:251], v0 offset:30720
  v_mfma_f32_16x16x32_bf16 a[148:151], a[240:243], v[212:215], a[148:151]
  ds_read_b64_tr_b16 a[252:253], v0 offset:32768
  v_mfma_f32_16x16x32_bf16 a[172:175], a[244:247], v[164:167], a[172:175]
  ds_read_b64_tr_b16 a[254:255], v0 offset:34816
  v_mfma_f32_16x16x32_bf16 a[152:155], a[240:243], v[216:219], a[152:155]
  v_xor_b32 v0, 96, v0
  v_mfma_f32_16x16x32_bf16 a[176:179], a[244:247], v[168:171], a[176:179]
  v_mfma_f32_16x16x32_bf16 a[156:159], a[240:243], v[220:223], a[156:159]
  v_mfma_f32_16x16x32_bf16 a[180:183], a[244:247], v[172:175], a[180:183]
  v_mfma_f32_16x16x32_bf16 a[160:163], a[240:243], v[224:227], a[160:163]
  v_mfma_f32_16x16x32_bf16 a[184:187], a[244:247], v[176:179], a[184:187]
  buffer_store_dwordx4 v[108:111], v9, s[24:27], s46 offen offset:3072 sc1
  v_mfma_f32_16x16x32_bf16 a[164:167], a[240:243], v[228:231], a[164:167]
  v_mfma_f32_16x16x32_bf16 a[188:191], a[244:247], v[180:183], a[188:191]
  s_waitcnt lgkmcnt(0)
  ds_read_b64_tr_b16 a[240:241], v0 offset:36864
  v_mfma_f32_16x16x32_bf16 a[168:171], a[248:251], v[184:187], a[168:171]
  ds_read_b64_tr_b16 a[242:243], v0 offset:38912
  v_mfma_f32_16x16x32_bf16 a[168:171], a[252:255], v[208:211], a[168:171]
  ds_read_b64_tr_b16 a[244:245], v0 offset:40960
  v_mfma_f32_16x16x32_bf16 a[172:175], a[248:251], v[188:191], a[172:175]
  ds_read_b64_tr_b16 a[246:247], v0 offset:43008
  v_mfma_f32_16x16x32_bf16 a[172:175], a[252:255], v[212:215], a[172:175]
  v_mfma_f32_16x16x32_bf16 a[176:179], a[248:251], v[192:195], a[176:179]
  v_mfma_f32_16x16x32_bf16 a[176:179], a[252:255], v[216:219], a[176:179]
  v_mfma_f32_16x16x32_bf16 a[180:183], a[248:251], v[196:199], a[180:183]
  v_mfma_f32_16x16x32_bf16 a[180:183], a[252:255], v[220:223], a[180:183]
  v_mfma_f32_16x16x32_bf16 a[184:187], a[248:251], v[200:203], a[184:187]
  v_mfma_f32_16x16x32_bf16 a[184:187], a[252:255], v[224:227], a[184:187]
  v_mfma_f32_16x16x32_bf16 a[188:191], a[248:251], v[204:207], a[188:191]
  v_mfma_f32_16x16x32_bf16 a[188:191], a[252:255], v[228:231], a[188:191]
  s_waitcnt lgkmcnt(0)
  v_mfma_f32_16x16x32_bf16 a[0:3], a[240:243], v[232:235], a[0:3]
  ds_read_b64_tr_b16 a[248:249], v0 offset:45056
  v_mfma_f32_16x16x32_bf16 a[0:3], a[244:247], v[16:19], a[0:3]
  ds_read_b64_tr_b16 a[250:251], v0 offset:47104
  v_mfma_f32_16x16x32_bf16 a[4:7], a[240:243], v[236:239], a[4:7]
  v_xor_b32 v0, 32, v0
  v_mfma_f32_16x16x32_bf16 a[4:7], a[244:247], v[20:23], a[4:7]
  ds_read_b64_tr_b16 a[252:253], v0 offset:36864
  v_mfma_f32_16x16x32_bf16 a[8:11], a[240:243], v[240:243], a[8:11]
  ds_read_b64_tr_b16 a[254:255], v0 offset:38912
  v_mfma_f32_16x16x32_bf16 a[8:11], a[244:247], v[24:27], a[8:11]
  v_mfma_f32_16x16x32_bf16 a[12:15], a[240:243], v[244:247], a[12:15]
  v_mfma_f32_16x16x32_bf16 a[12:15], a[244:247], v[28:31], a[12:15]
  v_mfma_f32_16x16x32_bf16 a[16:19], a[240:243], v[248:251], a[16:19]
  v_mfma_f32_16x16x32_bf16 a[16:19], a[244:247], v[32:35], a[16:19]
  v_mfma_f32_16x16x32_bf16 a[20:23], a[240:243], v[252:255], a[20:23]
  v_mfma_f32_16x16x32_bf16 a[20:23], a[244:247], v[36:39], a[20:23]
  s_waitcnt lgkmcnt(0)
  v_mfma_f32_16x16x32_bf16 a[0:3], a[248:251], v[64:67], a[0:3]
  ds_read_b64_tr_b16 a[240:241], v0 offset:40960
  v_mfma_f32_16x16x32_bf16 a[24:27], a[252:255], v[232:235], a[24:27]
  ds_read_b64_tr_b16 a[242:243], v0 offset:43008
  v_mfma_f32_16x16x32_bf16 a[4:7], a[248:251], v[68:71], a[4:7]
  ds_read_b64_tr_b16 a[244:245], v0 offset:45056
  v_mfma_f32_16x16x32_bf16 a[28:31], a[252:255], v[236:239], a[28:31]
  ds_read_b64_tr_b16 a[246:247], v0 offset:47104
  v_mfma_f32_16x16x32_bf16 a[8:11], a[248:251], v[72:75], a[8:11]
  v_xor_b32 v0, 96, v0
  v_mfma_f32_16x16x32_bf16 a[32:35], a[252:255], v[240:243], a[32:35]
  v_mfma_f32_16x16x32_bf16 a[12:15], a[248:251], v[76:79], a[12:15]
  v_mfma_f32_16x16x32_bf16 a[36:39], a[252:255], v[244:247], a[36:39]
  v_mfma_f32_16x16x32_bf16 a[16:19], a[248:251], v[80:83], a[16:19]
  v_mfma_f32_16x16x32_bf16 a[40:43], a[252:255], v[248:251], a[40:43]
  v_mfma_f32_16x16x32_bf16 a[20:23], a[248:251], v[84:87], a[20:23]
  v_mfma_f32_16x16x32_bf16 a[44:47], a[252:255], v[252:255], a[44:47]
  s_waitcnt lgkmcnt(0)
  v_mfma_f32_16x16x32_bf16 a[24:27], a[240:243], v[16:19], a[24:27]
  ds_read_b64_tr_b16 a[248:249], v0 offset:36864
  v_mfma_f32_16x16x32_bf16 a[24:27], a[244:247], v[64:67], a[24:27]
  ds_read_b64_tr_b16 a[250:251], v0 offset:38912
  v_mfma_f32_16x16x32_bf16 a[28:31], a[240:243], v[20:23], a[28:31]
  ds_read_b64_tr_b16 a[252:253], v0 offset:40960
  v_mfma_f32_16x16x32_bf16 a[28:31], a[244:247], v[68:71], a[28:31]
  ds_read_b64_tr_b16 a[254:255], v0 offset:43008
  v_mfma_f32_16x16x32_bf16 a[32:35], a[240:243], v[24:27], a[32:35]
  v_mfma_f32_16x16x32_bf16 a[32:35], a[244:247], v[72:75], a[32:35]
  v_mfma_f32_16x16x32_bf16 a[36:39], a[240:243], v[28:31], a[36:39]
  v_mfma_f32_16x16x32_bf16 a[36:39], a[244:247], v[76:79], a[36:39]
  v_mfma_f32_16x16x32_bf16 a[40:43], a[240:243], v[32:35], a[40:43]
  v_mfma_f32_16x16x32_bf16 a[40:43], a[244:247], v[80:83], a[40:43]
  v_mfma_f32_16x16x32_bf16 a[44:47], a[240:243], v[36:39], a[44:47]
  v_mfma_f32_16x16x32_bf16 a[44:47], a[244:247], v[84:87], a[44:47]
  s_waitcnt lgkmcnt(0)
  v_mfma_f32_16x16x32_bf16 a[144:147], a[248:251], v[232:235], a[144:147]
  ds_read_b64_tr_b16 a[240:241], v0 offset:45056
  v_mfma_f32_16x16x32_bf16 a[144:147], a[252:255], v[16:19], a[144:147]
  ds_read_b64_tr_b16 a[242:243], v0 offset:47104
  v_mfma_f32_16x16x32_bf16 a[148:151], a[248:251], v[236:239], a[148:151]
  v_xor_b32 v0, 32, v0
  v_mfma_f32_16x16x32_bf16 a[148:151], a[252:255], v[20:23], a[148:151]
  ds_read_b64_tr_b16 a[244:245], v0 offset:36864
  v_mfma_f32_16x16x32_bf16 a[152:155], a[248:251], v[240:243], a[152:155]
  ds_read_b64_tr_b16 a[246:247], v0 offset:38912
  v_accvgpr_read_b32 v40, a0
  v_mfma_f32_16x16x32_bf16 a[152:155], a[252:255], v[24:27], a[152:155]
  v_accvgpr_read_b32 v41, a1
  v_accvgpr_read_b32 v42, a2
  v_mfma_f32_16x16x32_bf16 a[156:159], a[248:251], v[244:247], a[156:159]
  v_accvgpr_read_b32 v43, a3
  v_mul_f32 v40, v10, v40
  v_mfma_f32_16x16x32_bf16 a[156:159], a[252:255], v[28:31], a[156:159]
  v_mul_f32 v41, v10, v41
  v_mul_f32 v42, v10, v42
  v_mul_f32 v43, v10, v43
  v_mfma_f32_16x16x32_bf16 a[160:163], a[248:251], v[248:251], a[160:163]
  v_cvt_pk_bf16_f32 v40, v40, v41
  v_cvt_pk_bf16_f32 v41, v42, v43
  v_mfma_f32_16x16x32_bf16 a[160:163], a[252:255], v[32:35], a[160:163]
  v_accvgpr_read_b32 v42, a4
  v_accvgpr_read_b32 v43, a5
  v_mfma_f32_16x16x32_bf16 a[164:167], a[248:251], v[252:255], a[164:167]
  v_accvgpr_read_b32 v44, a6
  v_accvgpr_read_b32 v45, a7
  v_mfma_f32_16x16x32_bf16 a[164:167], a[252:255], v[36:39], a[164:167]
  s_waitcnt lgkmcnt(0)
  v_mul_f32 v42, v11, v42
  v_mul_f32 v43, v11, v43
  v_mfma_f32_16x16x32_bf16 a[144:147], a[240:243], v[64:67], a[144:147]
  ds_read_b64_tr_b16 a[248:249], v0 offset:40960
  v_mul_f32 v44, v11, v44
  v_mfma_f32_16x16x32_bf16 a[168:171], a[244:247], v[232:235], a[168:171]
  ds_read_b64_tr_b16 a[250:251], v0 offset:43008
  v_mul_f32 v45, v11, v45
  v_mfma_f32_16x16x32_bf16 a[148:151], a[240:243], v[68:71], a[148:151]
  ds_read_b64_tr_b16 a[252:253], v0 offset:45056
  v_cvt_pk_bf16_f32 v42, v42, v43
  v_cvt_pk_bf16_f32 v43, v44, v45
  v_mfma_f32_16x16x32_bf16 a[172:175], a[244:247], v[236:239], a[172:175]
  ds_read_b64_tr_b16 a[254:255], v0 offset:47104
  v_accvgpr_read_b32 v44, a24
  v_mfma_f32_16x16x32_bf16 a[152:155], a[240:243], v[72:75], a[152:155]
  v_xor_b32 v0, 96, v0
  v_accvgpr_read_b32 v45, a25
  v_mfma_f32_16x16x32_bf16 a[176:179], a[244:247], v[240:243], a[176:179]
  v_accvgpr_read_b32 v46, a26
  v_accvgpr_read_b32 v47, a27
  v_mfma_f32_16x16x32_bf16 a[156:159], a[240:243], v[76:79], a[156:159]
  v_mul_f32 v44, v10, v44
  v_mul_f32 v45, v10, v45
  v_mfma_f32_16x16x32_bf16 a[180:183], a[244:247], v[244:247], a[180:183]
  v_mul_f32 v46, v10, v46
  v_mul_f32 v47, v10, v47
  v_mfma_f32_16x16x32_bf16 a[160:163], a[240:243], v[80:83], a[160:163]
  v_cvt_pk_bf16_f32 v44, v44, v45
  v_cvt_pk_bf16_f32 v45, v46, v47
  v_accvgpr_read_b32 v46, a28
  v_mfma_f32_16x16x32_bf16 a[184:187], a[244:247], v[248:251], a[184:187]
  v_accvgpr_read_b32 v47, a29
  v_accvgpr_read_b32 v3, a31
  v_mfma_f32_16x16x32_bf16 a[164:167], a[240:243], v[84:87], a[164:167]
  v_add_u32 v0, 49152, v0
  v_mul_f32 v46, v11, v46
  v_mfma_f32_16x16x32_bf16 a[188:191], a[244:247], v[252:255], a[188:191]
  s_waitcnt vmcnt(12) lgkmcnt(0)
  s_barrier
  ds_read_b64_tr_b16 a[240:241], v0 offset:0
  v_mfma_f32_16x16x32_bf16 a[168:171], a[248:251], v[16:19], a[168:171]
  ds_read_b64_tr_b16 a[242:243], v0 offset:2048
  v_mul_f32 v47, v11, v47
  v_mfma_f32_16x16x32_bf16 a[168:171], a[252:255], v[64:67], a[168:171]
  ds_read_b64_tr_b16 a[244:245], v0 offset:4096
  v_mul_f32 v3, v11, v3
  v_mfma_f32_16x16x32_bf16 a[172:175], a[248:251], v[20:23], a[172:175]
  ds_read_b64_tr_b16 a[246:247], v0 offset:6144
  v_cvt_pk_bf16_f32 v46, v46, v47
  v_mfma_f32_16x16x32_bf16 a[172:175], a[252:255], v[68:71], a[172:175]
  v_accvgpr_read_b32 v47, a30
  v_mul_f32 v47, v11, v47
  v_mfma_f32_16x16x32_bf16 a[176:179], a[248:251], v[24:27], a[176:179]
  v_cvt_pk_bf16_f32 v47, v47, v3
  v_accvgpr_read_b32 v48, a8
  v_accvgpr_read_b32 v49, a9
  v_mfma_f32_16x16x32_bf16 a[176:179], a[252:255], v[72:75], a[176:179]
  v_accvgpr_read_b32 v50, a10
  v_accvgpr_read_b32 v51, a11
  v_mfma_f32_16x16x32_bf16 a[180:183], a[248:251], v[28:31], a[180:183]
  v_mul_f32 v48, v12, v48
  v_mul_f32 v49, v12, v49
  v_mfma_f32_16x16x32_bf16 a[180:183], a[252:255], v[76:79], a[180:183]
  v_mul_f32 v50, v12, v50
  v_mul_f32 v51, v12, v51
  v_mfma_f32_16x16x32_bf16 a[184:187], a[248:251], v[32:35], a[184:187]
  v_cvt_pk_bf16_f32 v48, v48, v49
  v_cvt_pk_bf16_f32 v49, v50, v51
  v_mfma_f32_16x16x32_bf16 a[184:187], a[252:255], v[80:83], a[184:187]
  v_accvgpr_read_b32 v50, a12
  v_accvgpr_read_b32 v51, a13
  v_mfma_f32_16x16x32_bf16 a[188:191], a[248:251], v[36:39], a[188:191]
  v_accvgpr_read_b32 v52, a14
  v_accvgpr_read_b32 v53, a15
  v_mfma_f32_16x16x32_bf16 a[188:191], a[252:255], v[84:87], a[188:191]
  s_waitcnt lgkmcnt(0)
  v_mul_f32 v50, v13, v50
  v_mul_f32 v51, v13, v51
  v_mul_f32 v52, v13, v52
  v_mfma_f32_16x16x32_bf16 a[192:195], a[240:243], a[48:51], 0
  ds_read_b64_tr_b16 a[248:249], v0 offset:8192
  v_mul_f32 v53, v13, v53
  v_mfma_f32_16x16x32_bf16 a[192:195], a[244:247], a[72:75], a[192:195]
  ds_read_b64_tr_b16 a[250:251], v0 offset:10240
  v_cvt_pk_bf16_f32 v50, v50, v51
  v_mfma_f32_16x16x32_bf16 a[196:199], a[240:243], a[52:55], 0
L_pad_17:
  s_cbranch_execz L_padret2
  v_xor_b32 v0, 32, v0
  v_cvt_pk_bf16_f32 v51, v52, v53
  v_mfma_f32_16x16x32_bf16 a[196:199], a[244:247], a[76:79], a[196:199]
  ds_read_b64_tr_b16 a[252:253], v0 offset:0
  v_accvgpr_read_b32 v52, a32
  v_mfma_f32_16x16x32_bf16 a[200:203], a[240:243], a[56:59], 0
  ds_read_b64_tr_b16 a[254:255], v0 offset:2048
  v_accvgpr_read_b32 v53, a33
  v_mfma_f32_16x16x32_bf16 a[200:203], a[244:247], a[80:83], a[200:203]
  v_accvgpr_read_b32 v54, a34
  v_accvgpr_read_b32 v55, a35
  v_mul_f32 v52, v12, v52
  v_mfma_f32_16x16x32_bf16 a[204:207], a[240:243], a[60:63], 0
  v_mul_f32 v53, v12, v53
  v_mul_f32 v54, v12, v54
  v_mfma_f32_16x16x32_bf16 a[204:207], a[244:247], a[84:87], a[204:207]
  v_mul_f32 v55, v12, v55
  v_cvt_pk_bf16_f32 v52, v52, v53
  v_mfma_f32_16x16x32_bf16 a[208:211], a[240:243], a[64:67], 0
  v_cvt_pk_bf16_f32 v53, v54, v55
  v_accvgpr_read_b32 v54, a36
  v_mfma_f32_16x16x32_bf16 a[208:211], a[244:247], a[88:91], a[208:211]
  v_accvgpr_read_b32 v55, a37
  v_accvgpr_read_b32 v3, a39
  v_mfma_f32_16x16x32_bf16 a[212:215], a[240:243], a[68:71], 0
  v_mul_f32 v54, v13, v54
  v_mul_f32 v55, v13, v55
  v_mfma_f32_16x16x32_bf16 a[212:215], a[244:247], a[92:95], a[212:215]
  s_waitcnt lgkmcnt(0)
  v_mul_f32 v3, v13, v3
  v_cvt_pk_bf16_f32 v54, v54, v55
  v_mfma_f32_16x16x32_bf16 a[192:195], a[248:251], a[96:99], a[192:195]
  ds_read_b64_tr_b16 a[240:241], v0 offset:4096
  v_accvgpr_read_b32 v55, a38
  v_mul_f32 v55, v13, v55
  v_mfma_f32_16x16x32_bf16 a[216:219], a[252:255], a[48:51], 0
  ds_read_b64_tr_b16 a[242:243], v0 offset:6144
  v_cvt_pk_bf16_f32 v55, v55, v3
  v_mfma_f32_16x16x32_bf16 a[196:199], a[248:251], a[100:103], a[196:199]
  ds_read_b64_tr_b16 a[244:245], v0 offset:8192
  v_accvgpr_read_b32 v56, a16
  v_mfma_f32_16x16x32_bf16 a[220:223], a[252:255], a[52:55], 0
  ds_read_b64_tr_b16 a[246:247], v0 offset:10240
  v_accvgpr_read_b32 v57, a17
  v_mfma_f32_16x16x32_bf16 a[200:203], a[248:251], a[104:107], a[200:203]
  v_xor_b32 v0, 96, v0
  v_accvgpr_read_b32 v58, a18
  v_mfma_f32_16x16x32_bf16 a[224:227], a[252:255], a[56:59], 0
  v_accvgpr_read_b32 v59, a19
  v_mul_f32 v56, v14, v56
  v_mfma_f32_16x16x32_bf16 a[204:207], a[248:251], a[108:111], a[204:207]
  v_mul_f32 v57, v14, v57
  v_mul_f32 v58, v14, v58
  v_mul_f32 v59, v14, v59
  v_mfma_f32_16x16x32_bf16 a[228:231], a[252:255], a[60:63], 0
  v_cvt_pk_bf16_f32 v56, v56, v57
  v_cvt_pk_bf16_f32 v57, v58, v59
  v_mfma_f32_16x16x32_bf16 a[208:211], a[248:251], a[112:115], a[208:211]
  v_accvgpr_read_b32 v58, a20
  v_accvgpr_read_b32 v59, a21
  v_mfma_f32_16x16x32_bf16 a[232:235], a[252:255], a[64:67], 0
  v_accvgpr_read_b32 v60, a22
  v_accvgpr_read_b32 v61, a23
  v_mfma_f32_16x16x32_bf16 a[212:215], a[248:251], a[116:119], a[212:215]
  v_mul_f32 v58, v15, v58
  v_mul_f32 v59, v15, v59
  v_mfma_f32_16x16x32_bf16 a[236:239], a[252:255], a[68:71], 0
  s_waitcnt lgkmcnt(0)
  v_mul_f32 v60, v15, v60
  v_mul_f32 v61, v15, v61
  v_mfma_f32_16x16x32_bf16 a[216:219], a[240:243], a[72:75], a[216:219]
  ds_read_b64_tr_b16 a[248:249], v0 offset:0
  v_cvt_pk_bf16_f32 v58, v58, v59
  v_mfma_f32_16x16x32_bf16 a[216:219], a[244:247], a[96:99], a[216:219]
  ds_read_b64_tr_b16 a[250:251], v0 offset:2048
  v_cvt_pk_bf16_f32 v59, v60, v61
  v_accvgpr_read_b32 v60, a40
  v_mfma_f32_16x16x32_bf16 a[220:223], a[240:243], a[76:79], a[220:223]
  ds_read_b64_tr_b16 a[252:253], v0 offset:4096
  v_accvgpr_read_b32 v61, a41
  v_mfma_f32_16x16x32_bf16 a[220:223], a[244:247], a[100:103], a[220:223]
  ds_read_b64_tr_b16 a[254:255], v0 offset:6144
  v_accvgpr_read_b32 v62, a42
  v_mfma_f32_16x16x32_bf16 a[224:227], a[240:243], a[80:83], a[224:227]
  v_accvgpr_read_b32 v63, a43
  v_mul_f32 v60, v14, v60
  v_mfma_f32_16x16x32_bf16 a[224:227], a[244:247], a[104:107], a[224:227]
  v_mul_f32 v61, v14, v61
  v_mul_f32 v62, v14, v62
  v_mfma_f32_16x16x32_bf16 a[228:231], a[240:243], a[84:87], a[228:231]
  v_mul_f32 v63, v14, v63
  v_cvt_pk_bf16_f32 v60, v60, v61
  v_mfma_f32_16x16x32_bf16 a[228:231], a[244:247], a[108:111], a[228:231]
  v_cvt_pk_bf16_f32 v61, v62, v63
  v_accvgpr_read_b32 v62, a44
  v_mfma_f32_16x16x32_bf16 a[232:235], a[240:243], a[88:91], a[232:235]
  v_accvgpr_read_b32 v63, a45
  v_accvgpr_read_b32 v3, a47
  v_mul_f32 v62, v15, v62
  v_mfma_f32_16x16x32_bf16 a[232:235], a[244:247], a[112:115], a[232:235]
  v_mul_f32 v63, v15, v63
  v_mul_f32 v3, v15, v3
  v_mfma_f32_16x16x32_bf16 a[236:239], a[240:243], a[92:95], a[236:239]
  v_cvt_pk_bf16_f32 v62, v62, v63
  v_accvgpr_read_b32 v63, a46
  v_mfma_f32_16x16x32_bf16 a[236:239], a[244:247], a[116:119], a[236:239]
  s_waitcnt lgkmcnt(0)
  v_mul_f32 v63, v15, v63
  v_cvt_pk_bf16_f32 v63, v63, v3
  v_mfma_f32_16x16x32_bf16 a[0:3], a[248:251], a[48:51], 0
  ds_read_b64_tr_b16 a[240:241], v0 offset:8192
  v_accvgpr_read_b32 v88, a144
  v_mfma_f32_16x16x32_bf16 a[0:3], a[252:255], a[72:75], a[0:3]
  ds_read_b64_tr_b16 a[242:243], v0 offset:10240
  v_accvgpr_read_b32 v89, a145
  v_mfma_f32_16x16x32_bf16 a[4:7], a[248:251], a[52:55], 0
  v_xor_b32 v0, 32, v0
  v_accvgpr_read_b32 v90, a146
  v_mfma_f32_16x16x32_bf16 a[4:7], a[252:255], a[76:79], a[4:7]
  ds_read_b64_tr_b16 a[244:245], v0 offset:0
  v_accvgpr_read_b32 v91, a147
  v_mfma_f32_16x16x32_bf16 a[8:11], a[248:251], a[56:59], 0
  ds_read_b64_tr_b16 a[246:247], v0 offset:2048
  v_mul_f32 v88, v10, v88
  v_mfma_f32_16x16x32_bf16 a[8:11], a[252:255], a[80:83], a[8:11]
  v_mul_f32 v89, v10, v89
  v_mul_f32 v90, v10, v90
  v_mfma_f32_16x16x32_bf16 a[12:15], a[248:251], a[60:63], 0
  v_mul_f32 v91, v10, v91
  v_cvt_pk_bf16_f32 v88, v88, v89
  v_mfma_f32_16x16x32_bf16 a[12:15], a[252:255], a[84:87], a[12:15]
  v_cvt_pk_bf16_f32 v89, v90, v91
  v_mfma_f32_16x16x32_bf16 a[16:19], a[248:251], a[64:67], 0
  v_accvgpr_read_b32 v90, a148
  v_accvgpr_read_b32 v91, a149
  v_mfma_f32_16x16x32_bf16 a[16:19], a[252:255], a[88:91], a[16:19]
  v_accvgpr_read_b32 v92, a150
  v_accvgpr_read_b32 v93, a151
  v_mfma_f32_16x16x32_bf16 a[20:23], a[248:251], a[68:71], 0
  v_mul_f32 v90, v11, v90
  v_mul_f32 v91, v11, v91
  v_mfma_f32_16x16x32_bf16 a[20:23], a[252:255], a[92:95], a[20:23]
  s_waitcnt lgkmcnt(0)
  v_mul_f32 v92, v11, v92
  v_mul_f32 v93, v11, v93
  v_mfma_f32_16x16x32_bf16 a[0:3], a[240:243], a[96:99], a[0:3]
  ds_read_b64_tr_b16 a[248:249], v0 offset:4096
  v_cvt_pk_bf16_f32 v90, v90, v91
  v_mfma_f32_16x16x32_bf16 a[24:27], a[244:247], a[48:51], 0
  ds_read_b64_tr_b16 a[250:251], v0 offset:6144
  v_cvt_pk_bf16_f32 v91, v92, v93
  v_mfma_f32_16x16x32_bf16 a[4:7], a[240:243], a[100:103], a[4:7]
  ds_read_b64_tr_b16 a[252:253], v0 offset:8192
  v_accvgpr_read_b32 v92, a168
  v_mfma_f32_16x16x32_bf16 a[28:31], a[244:247], a[52:55], 0
  ds_read_b64_tr_b16 a[254:255], v0 offset:10240
  v_accvgpr_read_b32 v93, a169
  v_mfma_f32_16x16x32_bf16 a[8:11], a[240:243], a[104:107], a[8:11]
  v_xor_b32 v0, 96, v0
  v_accvgpr_read_b32 v94, a170
  v_mfma_f32_16x16x32_bf16 a[32:35], a[244:247], a[56:59], 0
  v_accvgpr_read_b32 v95, a171
  v_mul_f32 v92, v10, v92
  v_mfma_f32_16x16x32_bf16 a[12:15], a[240:243], a[108:111], a[12:15]
  v_mul_f32 v93, v10, v93
  v_mul_f32 v94, v10, v94
  v_mfma_f32_16x16x32_bf16 a[36:39], a[244:247], a[60:63], 0
  v_mul_f32 v95, v10, v95
  v_cvt_pk_bf16_f32 v92, v92, v93
  v_mfma_f32_16x16x32_bf16 a[16:19], a[240:243], a[112:115], a[16:19]
  v_cvt_pk_bf16_f32 v93, v94, v95
  v_accvgpr_read_b32 v94, a172
  v_mfma_f32_16x16x32_bf16 a[40:43], a[244:247], a[64:67], 0
  v_accvgpr_read_b32 v95, a173
  v_mfma_f32_16x16x32_bf16 a[20:23], a[240:243], a[116:119], a[20:23]
  v_accvgpr_read_b32 v3, a175
  v_mul_f32 v94, v11, v94
  v_mfma_f32_16x16x32_bf16 a[44:47], a[244:247], a[68:71], 0
  s_waitcnt lgkmcnt(0)
  ds_read_b64_tr_b16 a[240:241], v0 offset:12288
  v_mul_f32 v95, v11, v95
  v_mfma_f32_16x16x32_bf16 a[24:27], a[248:251], a[72:75], a[24:27]
  ds_read_b64_tr_b16 a[242:243], v0 offset:14336
  v_mul_f32 v3, v11, v3
  v_mfma_f32_16x16x32_bf16 a[24:27], a[252:255], a[96:99], a[24:27]
  ds_read_b64_tr_b16 a[244:245], v0 offset:16384
  v_cvt_pk_bf16_f32 v94, v94, v95
  v_mfma_f32_16x16x32_bf16 a[28:31], a[248:251], a[76:79], a[28:31]
  ds_read_b64_tr_b16 a[246:247], v0 offset:18432
  v_accvgpr_read_b32 v95, a174
  v_mfma_f32_16x16x32_bf16 a[28:31], a[252:255], a[100:103], a[28:31]
  v_mul_f32 v95, v11, v95
  v_cvt_pk_bf16_f32 v95, v95, v3
  v_mfma_f32_16x16x32_bf16 a[32:35], a[248:251], a[80:83], a[32:35]
  ds_write_b64 v7, v[40:41] offset:0
  v_mfma_f32_16x16x32_bf16 a[32:35], a[252:255], a[104:107], a[32:35]
  ds_write_b64 v7, v[42:43] offset:2048
  v_xor_b32 v7, 32, v7
  v_mfma_f32_16x16x32_bf16 a[36:39], a[248:251], a[84:87], a[36:39]
  ds_write_b64 v7, v[44:45] offset:0
  v_mfma_f32_16x16x32_bf16 a[36:39], a[252:255], a[108:111], a[36:39]
  ds_write_b64 v7, v[46:47] offset:2048
  v_xor_b32 v7, 96, v7
  v_mfma_f32_16x16x32_bf16 a[40:43], a[248:251], a[88:91], a[40:43]
  ds_write_b64 v7, v[88:89] offset:0
  v_mfma_f32_16x16x32_bf16 a[40:43], a[252:255], a[112:115], a[40:43]
  ds_write_b64 v7, v[90:91] offset:2048
  v_xor_b32 v7, 32, v7
  v_mfma_f32_16x16x32_bf16 a[44:47], a[248:251], a[92:95], a[44:47]
  ds_write_b64 v7, v[92:93] offset:0
  v_mfma_f32_16x16x32_bf16 a[44:47], a[252:255], a[116:119], a[44:47]
  s_waitcnt lgkmcnt(7)
  ds_write_b64 v7, v[94:95] offset:2048
  v_xor_b32 v7, 96, v7
  v_mfma_f32_16x16x32_bf16 a[192:195], a[240:243], a[120:123], a[192:195]
  ds_read_b64_tr_b16 a[248:249], v0 offset:20480
  ds_read_b128 v[40:43], v8 offset:0
  v_mfma_f32_16x16x32_bf16 a[192:195], a[244:247], v[112:115], a[192:195]
  ds_read_b64_tr_b16 a[250:251], v0 offset:22528
  ds_read_b128 v[44:47], v8 offset:1024
  v_mfma_f32_16x16x32_bf16 a[196:199], a[240:243], a[124:127], a[196:199]
  v_xor_b32 v0, 32, v0
  v_mfma_f32_16x16x32_bf16 a[196:199], a[244:247], v[116:119], a[196:199]
  ds_read_b64_tr_b16 a[252:253], v0 offset:12288
  ds_read_b128 v[88:91], v8 offset:2048
  ds_read_b128 v[92:95], v8 offset:3072
  v_mfma_f32_16x16x32_bf16 a[200:203], a[240:243], a[128:131], a[200:203]
  ds_read_b64_tr_b16 a[254:255], v0 offset:14336
  v_accvgpr_read_b32 v96, a152
  v_mfma_f32_16x16x32_bf16 a[200:203], a[244:247], v[120:123], a[200:203]
  v_accvgpr_read_b32 v97, a153
  v_accvgpr_read_b32 v98, a154
  v_mfma_f32_16x16x32_bf16 a[204:207], a[240:243], a[132:135], a[204:207]
  v_accvgpr_read_b32 v99, a155
  v_mul_f32 v96, v12, v96
  v_mfma_f32_16x16x32_bf16 a[204:207], a[244:247], v[124:127], a[204:207]
  v_mul_f32 v97, v12, v97
  v_mul_f32 v98, v12, v98
  v_mfma_f32_16x16x32_bf16 a[208:211], a[240:243], a[136:139], a[208:211]
  s_add_u32 s47, s35, 128
  s_waitcnt lgkmcnt(6)
  buffer_store_dwordx4 v[40:43], v9, s[24:27], s47 offen sc1
  v_mfma_f32_16x16x32_bf16 a[208:211], a[244:247], v[128:131], a[208:211]
  v_mul_f32 v99, v12, v99
  v_cvt_pk_bf16_f32 v96, v96, v97
  v_mfma_f32_16x16x32_bf16 a[212:215], a[240:243], a[140:143], a[212:215]
  v_cvt_pk_bf16_f32 v97, v98, v99
  v_accvgpr_read_b32 v98, a156
  v_mfma_f32_16x16x32_bf16 a[212:215], a[244:247], v[132:135], a[212:215]
  s_waitcnt lgkmcnt(0)
  v_accvgpr_read_b32 v99, a157
  v_accvgpr_read_b32 v100, a158
  v_mfma_f32_16x16x32_bf16 a[192:195], a[248:251], v[136:139], a[192:195]
  ds_read_b64_tr_b16 a[240:241], v0 offset:16384
  v_accvgpr_read_b32 v101, a159
  v_mfma_f32_16x16x32_bf16 a[216:219], a[252:255], a[120:123], a[216:219]
  ds_read_b64_tr_b16 a[242:243], v0 offset:18432
  v_mul_f32 v98, v13, v98
  v_mul_f32 v99, v13, v99
  v_mfma_f32_16x16x32_bf16 a[196:199], a[248:251], v[140:143], a[196:199]
  ds_read_b64_tr_b16 a[244:245], v0 offset:20480
  v_mul_f32 v100, v13, v100
  v_mfma_f32_16x16x32_bf16 a[220:223], a[252:255], a[124:127], a[220:223]
  ds_read_b64_tr_b16 a[246:247], v0 offset:22528
  v_mul_f32 v101, v13, v101
  v_mfma_f32_16x16x32_bf16 a[200:203], a[248:251], v[144:147], a[200:203]
  v_xor_b32 v0, 96, v0
  v_cvt_pk_bf16_f32 v98, v98, v99
  v_mfma_f32_16x16x32_bf16 a[224:227], a[252:255], a[128:131], a[224:227]
  v_cvt_pk_bf16_f32 v99, v100, v101
  v_accvgpr_read_b32 v100, a176
  v_mfma_f32_16x16x32_bf16 a[204:207], a[248:251], v[148:151], a[204:207]
  v_accvgpr_read_b32 v101, a177
  v_accvgpr_read_b32 v102, a178
  v_mfma_f32_16x16x32_bf16 a[228:231], a[252:255], a[132:135], a[228:231]
  buffer_store_dwordx4 v[44:47], v9, s[24:27], s47 offen offset:3072 sc1
  v_mfma_f32_16x16x32_bf16 a[208:211], a[248:251], v[152:155], a[208:211]
  v_accvgpr_read_b32 v103, a179
  v_mul_f32 v100, v12, v100
  v_mfma_f32_16x16x32_bf16 a[232:235], a[252:255], a[136:139], a[232:235]
  v_mul_f32 v101, v12, v101
  v_mul_f32 v102, v12, v102
  v_mfma_f32_16x16x32_bf16 a[212:215], a[248:251], v[156:159], a[212:215]
  v_mul_f32 v103, v12, v103
  v_cvt_pk_bf16_f32 v100, v100, v101
  v_mfma_f32_16x16x32_bf16 a[236:239], a[252:255], a[140:143], a[236:239]
  s_waitcnt lgkmcnt(0)
  v_cvt_pk_bf16_f32 v101, v102, v103
  v_accvgpr_read_b32 v102, a180
  v_mfma_f32_16x16x32_bf16 a[216:219], a[240:243], v[112:115], a[216:219]
  ds_read_b64_tr_b16 a[248:249], v0 offset:12288
  v_accvgpr_read_b32 v103, a181
  v_mfma_f32_16x16x32_bf16 a[216:219], a[244:247], v[136:139], a[216:219]
  ds_read_b64_tr_b16 a[250:251], v0 offset:14336
  v_accvgpr_read_b32 v3, a183
  v_mfma_f32_16x16x32_bf16 a[220:223], a[240:243], v[116:119], a[220:223]
  ds_read_b64_tr_b16 a[252:253], v0 offset:16384
  v_mul_f32 v102, v13, v102
  v_mfma_f32_16x16x32_bf16 a[220:223], a[244:247], v[140:143], a[220:223]
  ds_read_b64_tr_b16 a[254:255], v0 offset:18432
  v_mul_f32 v103, v13, v103
  v_mfma_f32_16x16x32_bf16 a[224:227], a[240:243], v[120:123], a[224:227]
  v_mul_f32 v3, v13, v3
  v_cvt_pk_bf16_f32 v102, v102, v103
  v_mfma_f32_16x16x32_bf16 a[224:227], a[244:247], v[144:147], a[224:227]
  v_accvgpr_read_b32 v103, a182
  v_mul_f32 v103, v13, v103
  v_cvt_pk_bf16_f32 v103, v103, v3
  v_mfma_f32_16x16x32_bf16 a[228:231], a[240:243], v[124:127], a[228:231]
  s_add_u32 s47, s35, 6272
  buffer_store_dwordx4 v[88:91], v9, s[24:27], s47 offen sc1
  v_mfma_f32_16x16x32_bf16 a[228:231], a[244:247], v[148:151], a[228:231]
  ds_write_b64 v7, v[48:49] offset:0
  v_mfma_f32_16x16x32_bf16 a[232:235], a[240:243], v[128:131], a[232:235]
  ds_write_b64 v7, v[50:51] offset:2048
  v_xor_b32 v7, 32, v7
  v_mfma_f32_16x16x32_bf16 a[232:235], a[244:247], v[152:155], a[232:235]
  ds_write_b64 v7, v[52:53] offset:0
  v_mfma_f32_16x16x32_bf16 a[236:239], a[240:243], v[132:135], a[236:239]
  ds_write_b64 v7, v[54:55] offset:2048
  v_xor_b32 v7, 96, v7
  v_mfma_f32_16x16x32_bf16 a[236:239], a[244:247], v[156:159], a[236:239]
  s_waitcnt lgkmcnt(4)
  ds_write_b64 v7, v[96:97] offset:0
  v_mfma_f32_16x16x32_bf16 a[0:3], a[248:251], a[120:123], a[0:3]
  ds_read_b64_tr_b16 a[240:241], v0 offset:20480
  ds_write_b64 v7, v[98:99] offset:2048
  v_mfma_f32_16x16x32_bf16 a[0:3], a[252:255], v[112:115], a[0:3]
  ds_read_b64_tr_b16 a[242:243], v0 offset:22528
  v_xor_b32 v7, 32, v7
  v_mfma_f32_16x16x32_bf16 a[4:7], a[248:251], a[124:127], a[4:7]
  v_xor_b32 v0, 32, v0
  v_mfma_f32_16x16x32_bf16 a[4:7], a[252:255], v[116:119], a[4:7]
  ds_read_b64_tr_b16 a[244:245], v0 offset:12288
  ds_write_b64 v7, v[100:101] offset:0
  ds_write_b64 v7, v[102:103] offset:2048
  v_mfma_f32_16x16x32_bf16 a[8:11], a[248:251], a[128:131], a[8:11]
  ds_read_b64_tr_b16 a[246:247], v0 offset:14336
  v_xor_b32 v7, 96, v7
  v_mfma_f32_16x16x32_bf16 a[8:11], a[252:255], v[120:123], a[8:11]
  buffer_store_dwordx4 v[92:95], v9, s[24:27], s47 offen offset:3072 sc1
  v_mfma_f32_16x16x32_bf16 a[12:15], a[248:251], a[132:135], a[12:15]
  ds_read_b128 v[48:51], v8 offset:0
  ds_read_b128 v[52:55], v8 offset:1024
  v_mfma_f32_16x16x32_bf16 a[12:15], a[252:255], v[124:127], a[12:15]
  ds_read_b128 v[96:99], v8 offset:2048
  ds_read_b128 v[100:103], v8 offset:3072
  v_mfma_f32_16x16x32_bf16 a[16:19], a[248:251], a[136:139], a[16:19]
  v_accvgpr_read_b32 v104, a160
  v_accvgpr_read_b32 v105, a161
  v_accvgpr_read_b32 v106, a162
  v_mfma_f32_16x16x32_bf16 a[16:19], a[252:255], v[128:131], a[16:19]
  v_accvgpr_read_b32 v107, a163
  v_mul_f32 v104, v14, v104
  v_mul_f32 v105, v14, v105
  v_mfma_f32_16x16x32_bf16 a[20:23], a[248:251], a[140:143], a[20:23]
  v_mul_f32 v106, v14, v106
  v_mul_f32 v107, v14, v107
  v_cvt_pk_bf16_f32 v104, v104, v105
  v_mfma_f32_16x16x32_bf16 a[20:23], a[252:255], v[132:135], a[20:23]
  s_waitcnt lgkmcnt(4)
  v_cvt_pk_bf16_f32 v105, v106, v107
  v_accvgpr_read_b32 v106, a164
  v_accvgpr_read_b32 v107, a165
  v_mfma_f32_16x16x32_bf16 a[0:3], a[240:243], v[136:139], a[0:3]
  ds_read_b64_tr_b16 a[248:249], v0 offset:16384
  v_accvgpr_read_b32 v108, a166
  v_accvgpr_read_b32 v109, a167
  v_mfma_f32_16x16x32_bf16 a[24:27], a[244:247], a[120:123], a[24:27]
  ds_read_b64_tr_b16 a[250:251], v0 offset:18432
  v_mul_f32 v106, v15, v106
  v_mul_f32 v107, v15, v107
  v_mfma_f32_16x16x32_bf16 a[4:7], a[240:243], v[140:143], a[4:7]
  ds_read_b64_tr_b16 a[252:253], v0 offset:20480
  v_mul_f32 v108, v15, v108
  v_mul_f32 v109, v15, v109
  v_cvt_pk_bf16_f32 v106, v106, v107
  v_mfma_f32_16x16x32_bf16 a[28:31], a[244:247], a[124:127], a[28:31]
  ds_read_b64_tr_b16 a[254:255], v0 offset:22528
  v_cvt_pk_bf16_f32 v107, v108, v109
  v_accvgpr_read_b32 v108, a184
  v_mfma_f32_16x16x32_bf16 a[8:11], a[240:243], v[144:147], a[8:11]
  v_xor_b32 v0, 96, v0
  s_add_u32 s47, s35, 12416
  s_waitcnt lgkmcnt(7)
  buffer_store_dwordx4 v[48:51], v9, s[24:27], s47 offen sc1
  v_mfma_f32_16x16x32_bf16 a[32:35], a[244:247], a[128:131], a[32:35]
  ds_read_b64_tr_b16 a[48:49], v0 offset:24576
  ds_read_b64_tr_b16 a[50:51], v0 offset:26624
  v_accvgpr_read_b32 v109, a185
  v_mfma_f32_16x16x32_bf16 a[12:15], a[240:243], v[148:151], a[12:15]
  ds_read_b64_tr_b16 a[52:53], v0 offset:28672
  ds_read_b64_tr_b16 a[54:55], v0 offset:30720
  v_accvgpr_read_b32 v110, a186
  v_mfma_f32_16x16x32_bf16 a[36:39], a[244:247], a[132:135], a[36:39]
  ds_read_b64_tr_b16 a[56:57], v0 offset:32768
  ds_read_b64_tr_b16 a[58:59], v0 offset:34816
  v_accvgpr_read_b32 v111, a187
  v_mfma_f32_16x16x32_bf16 a[16:19], a[240:243], v[152:155], a[16:19]
  v_xor_b32 v0, 32, v0
  ds_read_b64_tr_b16 a[60:61], v0 offset:24576
  v_mul_f32 v108, v14, v108
  v_mfma_f32_16x16x32_bf16 a[40:43], a[244:247], a[136:139], a[40:43]
  ds_read_b64_tr_b16 a[62:63], v0 offset:26624
  ds_read_b64_tr_b16 a[64:65], v0 offset:28672
  v_mul_f32 v109, v14, v109
  v_mfma_f32_16x16x32_bf16 a[20:23], a[240:243], v[156:159], a[20:23]
  ds_read_b64_tr_b16 a[66:67], v0 offset:30720
  ds_read_b64_tr_b16 a[68:69], v0 offset:32768
  v_mul_f32 v110, v14, v110
  v_mfma_f32_16x16x32_bf16 a[44:47], a[244:247], a[140:143], a[44:47]
  s_waitcnt lgkmcnt(11)
  ds_read_b64_tr_b16 a[70:71], v0 offset:34816
  v_xor_b32 v0, 96, v0
  v_mul_f32 v111, v14, v111
  v_cvt_pk_bf16_f32 v108, v108, v109
  v_mfma_f32_16x16x32_bf16 a[24:27], a[248:251], v[112:115], a[24:27]
  ds_read_b64_tr_b16 a[72:73], v0 offset:24576
  ds_read_b64_tr_b16 a[74:75], v0 offset:26624
  v_cvt_pk_bf16_f32 v109, v110, v111
  v_mfma_f32_16x16x32_bf16 a[24:27], a[252:255], v[136:139], a[24:27]
  ds_read_b64_tr_b16 a[76:77], v0 offset:28672
  ds_read_b64_tr_b16 a[78:79], v0 offset:30720
  v_accvgpr_read_b32 v110, a188
  v_mfma_f32_16x16x32_bf16 a[28:31], a[248:251], v[116:119], a[28:31]
  ds_read_b64_tr_b16 a[80:81], v0 offset:32768
  ds_read_b64_tr_b16 a[82:83], v0 offset:34816
  v_accvgpr_read_b32 v111, a189
  v_mfma_f32_16x16x32_bf16 a[28:31], a[252:255], v[140:143], a[28:31]
  v_xor_b32 v0, 32, v0
  ds_read_b64_tr_b16 a[84:85], v0 offset:24576
  buffer_store_dwordx4 v[52:55], v9, s[24:27], s47 offen offset:3072 sc1
  v_mfma_f32_16x16x32_bf16 a[32:35], a[248:251], v[120:123], a[32:35]
  ds_read_b64_tr_b16 a[86:87], v0 offset:26624
  ds_read_b64_tr_b16 a[88:89], v0 offset:28672
  v_accvgpr_read_b32 v3, a191
  v_mfma_f32_16x16x32_bf16 a[32:35], a[252:255], v[144:147], a[32:35]
  ds_read_b64_tr_b16 a[90:91], v0 offset:30720
  ds_read_b64_tr_b16 a[92:93], v0 offset:32768
  v_mul_f32 v110, v15, v110
  v_mfma_f32_16x16x32_bf16 a[36:39], a[248:251], v[124:127], a[36:39]
  ds_read_b64_tr_b16 a[94:95], v0 offset:34816
  v_xor_b32 v0, 96, v0
  v_mul_f32 v111, v15, v111
  v_mfma_f32_16x16x32_bf16 a[36:39], a[252:255], v[148:151], a[36:39]
  ds_read_b64_tr_b16 a[96:97], v0 offset:36864
  ds_read_b64_tr_b16 a[98:99], v0 offset:38912
  v_mul_f32 v3, v15, v3
  v_cvt_pk_bf16_f32 v110, v110, v111
  v_mfma_f32_16x16x32_bf16 a[40:43], a[248:251], v[128:131], a[40:43]
  ds_read_b64_tr_b16 a[100:101], v0 offset:40960
  ds_read_b64_tr_b16 a[102:103], v0 offset:43008
  v_accvgpr_read_b32 v111, a190
  v_mfma_f32_16x16x32_bf16 a[40:43], a[252:255], v[152:155], a[40:43]
  ds_read_b64_tr_b16 a[104:105], v0 offset:45056
  ds_read_b64_tr_b16 a[106:107], v0 offset:47104
  v_mul_f32 v111, v15, v111
  v_mfma_f32_16x16x32_bf16 a[44:47], a[248:251], v[132:135], a[44:47]
  v_xor_b32 v0, 32, v0
  ds_read_b64_tr_b16 a[108:109], v0 offset:36864
  v_cvt_pk_bf16_f32 v111, v111, v3
  v_mfma_f32_16x16x32_bf16 a[44:47], a[252:255], v[156:159], a[44:47]
  s_waitcnt lgkmcnt(15)
  ds_read_b64_tr_b16 a[110:111], v0 offset:38912
  ds_read_b64_tr_b16 a[112:113], v0 offset:40960
  ds_write_b64 v7, v[56:57] offset:0
  v_mfma_f32_16x16x32_bf16 a[192:195], a[48:51], v[160:163], a[192:195]
  ds_read_b64_tr_b16 a[114:115], v0 offset:43008
  ds_read_b64_tr_b16 a[116:117], v0 offset:45056
  ds_write_b64 v7, v[58:59] offset:2048
  v_mfma_f32_16x16x32_bf16 a[192:195], a[52:55], v[184:187], a[192:195]
  ds_read_b64_tr_b16 a[118:119], v0 offset:47104
  v_xor_b32 v0, 96, v0
  v_mfma_f32_16x16x32_bf16 a[192:195], a[56:59], v[208:211], a[192:195]
  s_waitcnt lgkmcnt(10)
  ds_read_b64_tr_b16 a[120:121], v0 offset:36864
  ds_read_b64_tr_b16 a[122:123], v0 offset:38912
  s_add_u32 s47, s35, 18560
  buffer_store_dwordx4 v[96:99], v9, s[24:27], s47 offen sc1
  v_mfma_f32_16x16x32_bf16 a[192:195], a[96:99], v[232:235], a[192:195]
  ds_read_b64_tr_b16 a[124:125], v0 offset:40960
  ds_read_b64_tr_b16 a[126:127], v0 offset:43008
  v_xor_b32 v7, 32, v7
  v_mfma_f32_16x16x32_bf16 a[192:195], a[100:103], v[16:19], a[192:195]
  s_waitcnt lgkmcnt(12)
  ds_read_b64_tr_b16 a[128:129], v0 offset:45056
  ds_read_b64_tr_b16 a[130:131], v0 offset:47104
  ds_write_b64 v7, v[60:61] offset:0
  v_mfma_f32_16x16x32_bf16 a[192:195], a[104:107], v[64:67], a[192:195]
  v_xor_b32 v0, 32, v0
  ds_read_b64_tr_b16 a[132:133], v0 offset:36864
  v_mfma_f32_16x16x32_bf16 a[196:199], a[48:51], v[164:167], a[196:199]
  ds_read_b64_tr_b16 a[134:135], v0 offset:38912
  ds_read_b64_tr_b16 a[136:137], v0 offset:40960
  ds_write_b64 v7, v[62:63] offset:2048
  v_xor_b32 v7, 96, v7
  v_mfma_f32_16x16x32_bf16 a[196:199], a[52:55], v[188:191], a[196:199]
  ds_read_b64_tr_b16 a[138:139], v0 offset:43008
  ds_read_b64_tr_b16 a[140:141], v0 offset:45056
  ds_write_b64 v7, v[104:105] offset:0
  v_mfma_f32_16x16x32_bf16 a[196:199], a[56:59], v[212:215], a[196:199]
  ds_read_b64_tr_b16 a[142:143], v0 offset:47104
  v_xor_b32 v0, 96, v0
  v_mfma_f32_16x16x32_bf16 a[196:199], a[96:99], v[236:239], a[196:199]
  ds_write_b64 v7, v[106:107] offset:2048
  v_xor_b32 v7, 32, v7
  v_mfma_f32_16x16x32_bf16 a[196:199], a[100:103], v[20:23], a[196:199]
  ds_write_b64 v7, v[108:109] offset:0
  ds_write_b64 v7, v[110:111] offset:2048
  v_xor_b32 v7, 96, v7
  v_mfma_f32_16x16x32_bf16 a[196:199], a[104:107], v[68:71], a[196:199]
  ds_read_b128 v[56:59], v8 offset:0
  ds_read_b128 v[60:63], v8 offset:1024
  ds_read_b128 v[104:107], v8 offset:2048
  ds_read_b128 v[108:111], v8 offset:3072
  v_mfma_f32_16x16x32_bf16 a[216:219], a[60:63], v[160:163], a[216:219]
  v_mfma_f32_16x16x32_bf16 a[216:219], a[64:67], v[184:187], a[216:219]
  buffer_store_dwordx4 v[100:103], v9, s[24:27], s47 offen offset:3072 sc1
  v_mfma_f32_16x16x32_bf16 a[216:219], a[68:71], v[208:211], a[216:219]
  s_waitcnt lgkmcnt(15)
  v_mfma_f32_16x16x32_bf16 a[216:219], a[108:111], v[232:235], a[216:219]
  v_mfma_f32_16x16x32_bf16 a[216:219], a[112:115], v[16:19], a[216:219]
  v_mfma_f32_16x16x32_bf16 a[216:219], a[116:119], v[64:67], a[216:219]
  v_mfma_f32_16x16x32_bf16 a[220:223], a[60:63], v[164:167], a[220:223]
  v_mfma_f32_16x16x32_bf16 a[220:223], a[64:67], v[188:191], a[220:223]
  v_mfma_f32_16x16x32_bf16 a[220:223], a[68:71], v[212:215], a[220:223]
  v_mfma_f32_16x16x32_bf16 a[220:223], a[108:111], v[236:239], a[220:223]
  v_mfma_f32_16x16x32_bf16 a[220:223], a[112:115], v[20:23], a[220:223]
  v_mfma_f32_16x16x32_bf16 a[220:223], a[116:119], v[68:71], a[220:223]
  v_mfma_f32_16x16x32_bf16 a[0:3], a[72:75], v[160:163], a[0:3]
  s_add_u32 s47, s35, 24704
  s_waitcnt lgkmcnt(3)
  buffer_store_dwordx4 v[56:59], v9, s[24:27], s47 offen sc1
  v_mfma_f32_16x16x32_bf16 a[0:3], a[76:79], v[184:187], a[0:3]
  v_mfma_f32_16x16x32_bf16 a[0:3], a[80:83], v[208:211], a[0:3]
  v_mfma_f32_16x16x32_bf16 a[0:3], a[120:123], v[232:235], a[0:3]
  v_mfma_f32_16x16x32_bf16 a[0:3], a[124:127], v[16:19], a[0:3]
  v_mfma_f32_16x16x32_bf16 a[0:3], a[128:131], v[64:67], a[0:3]
  v_accvgpr_read_b32 v112, a192
  v_accvgpr_read_b32 v113, a193
  v_mfma_f32_16x16x32_bf16 a[4:7], a[72:75], v[164:167], a[4:7]
  v_accvgpr_read_b32 v114, a194
  v_accvgpr_read_b32 v115, a195
  v_mfma_f32_16x16x32_bf16 a[4:7], a[76:79], v[188:191], a[4:7]
  v_mul_f32 v112, v10, v112
  v_mul_f32 v113, v10, v113
  v_mfma_f32_16x16x32_bf16 a[4:7], a[80:83], v[212:215], a[4:7]
  v_mul_f32 v114, v10, v114
  v_mul_f32 v115, v10, v115
  v_mfma_f32_16x16x32_bf16 a[4:7], a[120:123], v[236:239], a[4:7]
  v_cvt_pk_bf16_f32 v112, v112, v113
  v_cvt_pk_bf16_f32 v113, v114, v115
  v_mfma_f32_16x16x32_bf16 a[4:7], a[124:127], v[20:23], a[4:7]
  v_accvgpr_read_b32 v114, a196
  v_mfma_f32_16x16x32_bf16 a[4:7], a[128:131], v[68:71], a[4:7]
  s_waitcnt lgkmcnt(2)
  buffer_store_dwordx4 v[60:63], v9, s[24:27], s47 offen offset:3072 sc1
  v_mfma_f32_16x16x32_bf16 a[24:27], a[84:87], v[160:163], a[24:27]
  v_accvgpr_read_b32 v115, a197
  v_accvgpr_read_b32 v116, a198
  v_mfma_f32_16x16x32_bf16 a[24:27], a[88:91], v[184:187], a[24:27]
  v_accvgpr_read_b32 v117, a199
  v_mul_f32 v114, v11, v114
  v_mfma_f32_16x16x32_bf16 a[24:27], a[92:95], v[208:211], a[24:27]
  v_mul_f32 v115, v11, v115
  v_mul_f32 v116, v11, v116
  v_mfma_f32_16x16x32_bf16 a[24:27], a[132:135], v[232:235], a[24:27]
L_pad_18:
  s_cbranch_execz L_padret2
  v_mul_f32 v117, v11, v117
  v_cvt_pk_bf16_f32 v114, v114, v115
  v_mfma_f32_16x16x32_bf16 a[24:27], a[136:139], v[16:19], a[24:27]
  v_cvt_pk_bf16_f32 v115, v116, v117
  v_accvgpr_read_b32 v116, a216
  v_mfma_f32_16x16x32_bf16 a[24:27], a[140:143], v[64:67], a[24:27]
  v_accvgpr_read_b32 v117, a217
  v_accvgpr_read_b32 v118, a218
  v_mfma_f32_16x16x32_bf16 a[28:31], a[84:87], v[164:167], a[28:31]
  v_accvgpr_read_b32 v119, a219
  v_mul_f32 v116, v10, v116
  v_mfma_f32_16x16x32_bf16 a[28:31], a[88:91], v[188:191], a[28:31]
  v_mul_f32 v117, v10, v117
  v_mul_f32 v118, v10, v118
  v_mfma_f32_16x16x32_bf16 a[28:31], a[92:95], v[212:215], a[28:31]
  v_mul_f32 v119, v10, v119
  v_cvt_pk_bf16_f32 v116, v116, v117
  v_mfma_f32_16x16x32_bf16 a[28:31], a[132:135], v[236:239], a[28:31]
  v_cvt_pk_bf16_f32 v117, v118, v119
  v_mfma_f32_16x16x32_bf16 a[28:31], a[136:139], v[20:23], a[28:31]
  s_add_u32 s47, s35, 30848
  s_waitcnt lgkmcnt(1)
  buffer_store_dwordx4 v[104:107], v9, s[24:27], s47 offen sc1
  v_mfma_f32_16x16x32_bf16 a[28:31], a[140:143], v[68:71], a[28:31]
  v_accvgpr_read_b32 v118, a220
  v_accvgpr_read_b32 v119, a221
  v_mfma_f32_16x16x32_bf16 a[200:203], a[48:51], v[168:171], a[200:203]
  v_accvgpr_read_b32 v3, a223
  v_mul_f32 v118, v11, v118
  v_mfma_f32_16x16x32_bf16 a[200:203], a[52:55], v[192:195], a[200:203]
  v_mul_f32 v119, v11, v119
  v_mul_f32 v3, v11, v3
  v_mfma_f32_16x16x32_bf16 a[200:203], a[56:59], v[216:219], a[200:203]
  v_cvt_pk_bf16_f32 v118, v118, v119
  v_accvgpr_read_b32 v119, a222
  v_mfma_f32_16x16x32_bf16 a[200:203], a[96:99], v[240:243], a[200:203]
  v_mul_f32 v119, v11, v119
  v_cvt_pk_bf16_f32 v119, v119, v3
  v_mfma_f32_16x16x32_bf16 a[200:203], a[100:103], v[24:27], a[200:203]
  v_accvgpr_read_b32 v136, a0
  v_accvgpr_read_b32 v137, a1
  v_mfma_f32_16x16x32_bf16 a[200:203], a[104:107], v[72:75], a[200:203]
  v_accvgpr_read_b32 v138, a2
  v_accvgpr_read_b32 v139, a3
  v_mul_f32 v136, v10, v136
  v_mfma_f32_16x16x32_bf16 a[204:207], a[48:51], v[172:175], a[204:207]
  v_mul_f32 v137, v10, v137
  v_mul_f32 v138, v10, v138
  v_mfma_f32_16x16x32_bf16 a[204:207], a[52:55], v[196:199], a[204:207]
  v_mul_f32 v139, v10, v139
  v_cvt_pk_bf16_f32 v136, v136, v137
  v_cvt_pk_bf16_f32 v137, v138, v139
  v_mfma_f32_16x16x32_bf16 a[204:207], a[56:59], v[220:223], a[204:207]
  v_accvgpr_read_b32 v138, a4
  v_accvgpr_read_b32 v139, a5
  v_mfma_f32_16x16x32_bf16 a[204:207], a[96:99], v[244:247], a[204:207]
  s_waitcnt lgkmcnt(0)
  buffer_store_dwordx4 v[108:111], v9, s[24:27], s47 offen offset:3072 sc1
  v_mfma_f32_16x16x32_bf16 a[204:207], a[100:103], v[28:31], a[204:207]
  v_accvgpr_read_b32 v140, a6
  v_accvgpr_read_b32 v141, a7
  v_mul_f32 v138, v11, v138
  v_mfma_f32_16x16x32_bf16 a[204:207], a[104:107], v[76:79], a[204:207]
  v_mul_f32 v139, v11, v139
  v_mul_f32 v140, v11, v140
  v_mfma_f32_16x16x32_bf16 a[224:227], a[60:63], v[168:171], a[224:227]
  v_mul_f32 v141, v11, v141
  v_cvt_pk_bf16_f32 v138, v138, v139
  v_cvt_pk_bf16_f32 v139, v140, v141
  v_mfma_f32_16x16x32_bf16 a[224:227], a[64:67], v[192:195], a[224:227]
  v_accvgpr_read_b32 v140, a24
  v_accvgpr_read_b32 v141, a25
  v_mfma_f32_16x16x32_bf16 a[224:227], a[68:71], v[216:219], a[224:227]
  v_accvgpr_read_b32 v142, a26
  v_accvgpr_read_b32 v143, a27
  v_mul_f32 v140, v10, v140
  v_mfma_f32_16x16x32_bf16 a[224:227], a[108:111], v[240:243], a[224:227]
  v_mul_f32 v141, v10, v141
  v_mul_f32 v142, v10, v142
  v_mfma_f32_16x16x32_bf16 a[224:227], a[112:115], v[24:27], a[224:227]
  v_mul_f32 v143, v10, v143
  v_cvt_pk_bf16_f32 v140, v140, v141
  v_cvt_pk_bf16_f32 v141, v142, v143
  v_mfma_f32_16x16x32_bf16 a[224:227], a[116:119], v[72:75], a[224:227]
  v_accvgpr_read_b32 v142, a28
  v_accvgpr_read_b32 v143, a29
  v_mfma_f32_16x16x32_bf16 a[228:231], a[60:63], v[172:175], a[228:231]
  v_accvgpr_read_b32 v3, a31
  v_mul_f32 v142, v11, v142
  v_mul_f32 v143, v11, v143
  v_mfma_f32_16x16x32_bf16 a[228:231], a[64:67], v[196:199], a[228:231]
  v_mul_f32 v3, v11, v3
  v_cvt_pk_bf16_f32 v142, v142, v143
  v_mfma_f32_16x16x32_bf16 a[228:231], a[68:71], v[220:223], a[228:231]
  v_accvgpr_read_b32 v143, a30
  v_mul_f32 v143, v11, v143
  v_mfma_f32_16x16x32_bf16 a[228:231], a[108:111], v[244:247], a[228:231]
  v_cvt_pk_bf16_f32 v143, v143, v3
  v_mfma_f32_16x16x32_bf16 a[228:231], a[112:115], v[28:31], a[228:231]
  ds_write_b64 v7, v[112:113] offset:0
  ds_write_b64 v7, v[114:115] offset:2048
  v_xor_b32 v7, 32, v7
  v_mfma_f32_16x16x32_bf16 a[228:231], a[116:119], v[76:79], a[228:231]
  ds_write_b64 v7, v[116:117] offset:0
  ds_write_b64 v7, v[118:119] offset:2048
  v_mfma_f32_16x16x32_bf16 a[8:11], a[72:75], v[168:171], a[8:11]
  v_xor_b32 v7, 96, v7
  v_mfma_f32_16x16x32_bf16 a[8:11], a[76:79], v[192:195], a[8:11]
  ds_write_b64 v7, v[136:137] offset:0
  ds_write_b64 v7, v[138:139] offset:2048
  v_xor_b32 v7, 32, v7
  v_mfma_f32_16x16x32_bf16 a[8:11], a[80:83], v[216:219], a[8:11]
  ds_write_b64 v7, v[140:141] offset:0
  ds_write_b64 v7, v[142:143] offset:2048
  v_mfma_f32_16x16x32_bf16 a[8:11], a[120:123], v[240:243], a[8:11]
  v_xor_b32 v7, 96, v7
  v_mfma_f32_16x16x32_bf16 a[8:11], a[124:127], v[24:27], a[8:11]
  ds_read_b128 v[112:115], v8 offset:0
  ds_read_b128 v[116:119], v8 offset:1024
  ds_read_b128 v[136:139], v8 offset:2048
  ds_read_b128 v[140:143], v8 offset:3072
  v_mfma_f32_16x16x32_bf16 a[8:11], a[128:131], v[72:75], a[8:11]
  v_accvgpr_read_b32 v120, a200
  v_accvgpr_read_b32 v121, a201
  v_mfma_f32_16x16x32_bf16 a[12:15], a[72:75], v[172:175], a[12:15]
  v_accvgpr_read_b32 v122, a202
  v_accvgpr_read_b32 v123, a203
  v_mfma_f32_16x16x32_bf16 a[12:15], a[76:79], v[196:199], a[12:15]
  v_mul_f32 v120, v12, v120
  v_mul_f32 v121, v12, v121
  v_mfma_f32_16x16x32_bf16 a[12:15], a[80:83], v[220:223], a[12:15]
  v_mul_f32 v122, v12, v122
  v_mul_f32 v123, v12, v123
  v_mfma_f32_16x16x32_bf16 a[12:15], a[120:123], v[244:247], a[12:15]
  v_cvt_pk_bf16_f32 v120, v120, v121
  v_cvt_pk_bf16_f32 v121, v122, v123
  v_accvgpr_read_b32 v122, a204
  v_mfma_f32_16x16x32_bf16 a[12:15], a[124:127], v[28:31], a[12:15]
  s_add_u32 s46, s35, 256
  s_waitcnt lgkmcnt(3)
  buffer_store_dwordx4 v[112:115], v9, s[24:27], s46 offen sc1
  v_mfma_f32_16x16x32_bf16 a[12:15], a[128:131], v[76:79], a[12:15]
  v_accvgpr_read_b32 v123, a205
  v_accvgpr_read_b32 v124, a206
  v_mfma_f32_16x16x32_bf16 a[32:35], a[84:87], v[168:171], a[32:35]
  v_accvgpr_read_b32 v125, a207
  v_mul_f32 v122, v13, v122
  v_mfma_f32_16x16x32_bf16 a[32:35], a[88:91], v[192:195], a[32:35]
  s_waitcnt lgkmcnt(2)
  buffer_store_dwordx4 v[116:119], v9, s[24:27], s46 offen offset:3072 sc1
  v_mfma_f32_16x16x32_bf16 a[32:35], a[92:95], v[216:219], a[32:35]
  v_mul_f32 v123, v13, v123
  v_mul_f32 v124, v13, v124
  v_mfma_f32_16x16x32_bf16 a[32:35], a[132:135], v[240:243], a[32:35]
  v_mul_f32 v125, v13, v125
  v_cvt_pk_bf16_f32 v122, v122, v123
  v_mfma_f32_16x16x32_bf16 a[32:35], a[136:139], v[24:27], a[32:35]
  s_add_u32 s46, s35, 6400
  s_waitcnt lgkmcnt(1)
  buffer_store_dwordx4 v[136:139], v9, s[24:27], s46 offen sc1
  v_mfma_f32_16x16x32_bf16 a[32:35], a[140:143], v[72:75], a[32:35]
  v_cvt_pk_bf16_f32 v123, v124, v125
  v_accvgpr_read_b32 v124, a224
  v_mfma_f32_16x16x32_bf16 a[36:39], a[84:87], v[172:175], a[36:39]
  v_accvgpr_read_b32 v125, a225
  v_accvgpr_read_b32 v126, a226
  v_mfma_f32_16x16x32_bf16 a[36:39], a[88:91], v[196:199], a[36:39]
  s_waitcnt lgkmcnt(0)
  buffer_store_dwordx4 v[140:143], v9, s[24:27], s46 offen offset:3072 sc1
  v_mfma_f32_16x16x32_bf16 a[36:39], a[92:95], v[220:223], a[36:39]
  v_accvgpr_read_b32 v127, a227
  v_mul_f32 v124, v12, v124
  v_mfma_f32_16x16x32_bf16 a[36:39], a[132:135], v[244:247], a[36:39]
  v_mul_f32 v125, v12, v125
  v_mul_f32 v126, v12, v126
  v_mfma_f32_16x16x32_bf16 a[36:39], a[136:139], v[28:31], a[36:39]
  v_mul_f32 v127, v12, v127
  v_cvt_pk_bf16_f32 v124, v124, v125
  v_mfma_f32_16x16x32_bf16 a[36:39], a[140:143], v[76:79], a[36:39]
  v_cvt_pk_bf16_f32 v125, v126, v127
  v_accvgpr_read_b32 v126, a228
  v_accvgpr_read_b32 v127, a229
  v_mfma_f32_16x16x32_bf16 a[208:211], a[48:51], v[176:179], a[208:211]
  v_accvgpr_read_b32 v3, a231
  v_mul_f32 v126, v13, v126
  v_mfma_f32_16x16x32_bf16 a[208:211], a[52:55], v[200:203], a[208:211]
  v_mul_f32 v127, v13, v127
  v_mul_f32 v3, v13, v3
  v_mfma_f32_16x16x32_bf16 a[208:211], a[56:59], v[224:227], a[208:211]
  v_cvt_pk_bf16_f32 v126, v126, v127
  v_accvgpr_read_b32 v127, a230
  v_mfma_f32_16x16x32_bf16 a[208:211], a[96:99], v[248:251], a[208:211]
  v_mul_f32 v127, v13, v127
  v_cvt_pk_bf16_f32 v127, v127, v3
  v_mfma_f32_16x16x32_bf16 a[208:211], a[100:103], v[32:35], a[208:211]
  v_accvgpr_read_b32 v144, a8
  v_accvgpr_read_b32 v145, a9
  v_mfma_f32_16x16x32_bf16 a[208:211], a[104:107], v[80:83], a[208:211]
  v_accvgpr_read_b32 v146, a10
  v_accvgpr_read_b32 v147, a11
  v_mul_f32 v144, v12, v144
  v_mfma_f32_16x16x32_bf16 a[212:215], a[48:51], v[180:183], a[212:215]
  v_mul_f32 v145, v12, v145
  v_mul_f32 v146, v12, v146
  v_mfma_f32_16x16x32_bf16 a[212:215], a[52:55], v[204:207], a[212:215]
  v_mul_f32 v147, v12, v147
  v_cvt_pk_bf16_f32 v144, v144, v145
  v_mfma_f32_16x16x32_bf16 a[212:215], a[56:59], v[228:231], a[212:215]
  v_cvt_pk_bf16_f32 v145, v146, v147
  v_accvgpr_read_b32 v146, a12
  v_accvgpr_read_b32 v147, a13
  v_mfma_f32_16x16x32_bf16 a[212:215], a[96:99], v[252:255], a[212:215]
  v_accvgpr_read_b32 v148, a14
  v_accvgpr_read_b32 v149, a15
  v_mfma_f32_16x16x32_bf16 a[212:215], a[100:103], v[36:39], a[212:215]
  v_mul_f32 v146, v13, v146
  v_mul_f32 v147, v13, v147
  v_mul_f32 v148, v13, v148
  v_mfma_f32_16x16x32_bf16 a[212:215], a[104:107], v[84:87], a[212:215]
  v_mul_f32 v149, v13, v149
  v_cvt_pk_bf16_f32 v146, v146, v147
  v_mfma_f32_16x16x32_bf16 a[232:235], a[60:63], v[176:179], a[232:235]
  v_cvt_pk_bf16_f32 v147, v148, v149
  v_accvgpr_read_b32 v148, a32
  v_mfma_f32_16x16x32_bf16 a[232:235], a[64:67], v[200:203], a[232:235]
  v_accvgpr_read_b32 v149, a33
  v_accvgpr_read_b32 v150, a34
  v_accvgpr_read_b32 v151, a35
  v_mfma_f32_16x16x32_bf16 a[232:235], a[68:71], v[224:227], a[232:235]
  v_mul_f32 v148, v12, v148
  v_mul_f32 v149, v12, v149
  v_mfma_f32_16x16x32_bf16 a[232:235], a[108:111], v[248:251], a[232:235]
  v_mul_f32 v150, v12, v150
  v_mul_f32 v151, v12, v151
  v_mfma_f32_16x16x32_bf16 a[232:235], a[112:115], v[32:35], a[232:235]
  v_cvt_pk_bf16_f32 v148, v148, v149
  v_cvt_pk_bf16_f32 v149, v150, v151
  v_accvgpr_read_b32 v150, a36
  v_mfma_f32_16x16x32_bf16 a[232:235], a[116:119], v[80:83], a[232:235]
  v_accvgpr_read_b32 v151, a37
  v_accvgpr_read_b32 v3, a39
  v_mfma_f32_16x16x32_bf16 a[236:239], a[60:63], v[180:183], a[236:239]
  v_mul_f32 v150, v13, v150
  v_mul_f32 v151, v13, v151
  v_mul_f32 v3, v13, v3
  v_mfma_f32_16x16x32_bf16 a[236:239], a[64:67], v[204:207], a[236:239]
  v_cvt_pk_bf16_f32 v150, v150, v151
  v_accvgpr_read_b32 v151, a38
  v_mfma_f32_16x16x32_bf16 a[236:239], a[68:71], v[228:231], a[236:239]
  v_mul_f32 v151, v13, v151
  v_cvt_pk_bf16_f32 v151, v151, v3
  v_mfma_f32_16x16x32_bf16 a[236:239], a[108:111], v[252:255], a[236:239]
  ds_write_b64 v7, v[120:121] offset:0
  ds_write_b64 v7, v[122:123] offset:2048
  v_mfma_f32_16x16x32_bf16 a[236:239], a[112:115], v[36:39], a[236:239]
  v_xor_b32 v7, 32, v7
  v_mfma_f32_16x16x32_bf16 a[236:239], a[116:119], v[84:87], a[236:239]
  ds_write_b64 v7, v[124:125] offset:0
  ds_write_b64 v7, v[126:127] offset:2048
  v_xor_b32 v7, 96, v7
  v_mfma_f32_16x16x32_bf16 a[16:19], a[72:75], v[176:179], a[16:19]
  ds_write_b64 v7, v[144:145] offset:0
  v_mfma_f32_16x16x32_bf16 a[16:19], a[76:79], v[200:203], a[16:19]
  ds_write_b64 v7, v[146:147] offset:2048
  v_xor_b32 v7, 32, v7
  v_mfma_f32_16x16x32_bf16 a[16:19], a[80:83], v[224:227], a[16:19]
  ds_write_b64 v7, v[148:149] offset:0
  ds_write_b64 v7, v[150:151] offset:2048
  v_mfma_f32_16x16x32_bf16 a[16:19], a[120:123], v[248:251], a[16:19]
  v_xor_b32 v7, 96, v7
  v_mfma_f32_16x16x32_bf16 a[16:19], a[124:127], v[32:35], a[16:19]
  ds_read_b128 v[120:123], v8 offset:0
  ds_read_b128 v[124:127], v8 offset:1024
  ds_read_b128 v[144:147], v8 offset:2048
  ds_read_b128 v[148:151], v8 offset:3072
  v_mfma_f32_16x16x32_bf16 a[16:19], a[128:131], v[80:83], a[16:19]
  v_accvgpr_read_b32 v128, a208
  v_accvgpr_read_b32 v129, a209
  v_accvgpr_read_b32 v130, a210
  v_accvgpr_read_b32 v131, a211
  v_mfma_f32_16x16x32_bf16 a[20:23], a[72:75], v[180:183], a[20:23]
  v_mul_f32 v128, v14, v128
  v_mul_f32 v129, v14, v129
  v_mul_f32 v130, v14, v130
  v_mul_f32 v131, v14, v131
  v_mfma_f32_16x16x32_bf16 a[20:23], a[76:79], v[204:207], a[20:23]
  v_cvt_pk_bf16_f32 v128, v128, v129
  v_cvt_pk_bf16_f32 v129, v130, v131
  v_accvgpr_read_b32 v130, a212
  v_accvgpr_read_b32 v131, a213
  v_mfma_f32_16x16x32_bf16 a[20:23], a[80:83], v[228:231], a[20:23]
  v_accvgpr_read_b32 v132, a214
  v_accvgpr_read_b32 v133, a215
  v_mul_f32 v130, v15, v130
  v_mul_f32 v131, v15, v131
  v_mul_f32 v132, v15, v132
  v_mfma_f32_16x16x32_bf16 a[20:23], a[120:123], v[252:255], a[20:23]
  v_mul_f32 v133, v15, v133
  v_cvt_pk_bf16_f32 v130, v130, v131
  v_cvt_pk_bf16_f32 v131, v132, v133
  v_accvgpr_read_b32 v132, a232
  v_mfma_f32_16x16x32_bf16 a[20:23], a[124:127], v[36:39], a[20:23]
  s_add_u32 s46, s35, 12544
  s_waitcnt lgkmcnt(3)
  buffer_store_dwordx4 v[120:123], v9, s[24:27], s46 offen sc1
  v_mfma_f32_16x16x32_bf16 a[20:23], a[128:131], v[84:87], a[20:23]
  v_accvgpr_read_b32 v133, a233
  v_accvgpr_read_b32 v134, a234
  v_accvgpr_read_b32 v135, a235
  v_mul_f32 v132, v14, v132
  v_mul_f32 v133, v14, v133
  v_mfma_f32_16x16x32_bf16 a[40:43], a[84:87], v[176:179], a[40:43]
  v_mul_f32 v134, v14, v134
  v_mul_f32 v135, v14, v135
  v_cvt_pk_bf16_f32 v132, v132, v133
  v_cvt_pk_bf16_f32 v133, v134, v135
  v_mfma_f32_16x16x32_bf16 a[40:43], a[88:91], v[200:203], a[40:43]
  s_waitcnt lgkmcnt(2)
  buffer_store_dwordx4 v[124:127], v9, s[24:27], s46 offen offset:3072 sc1
  v_accvgpr_read_b32 v134, a236
  v_mfma_f32_16x16x32_bf16 a[40:43], a[92:95], v[224:227], a[40:43]
  v_accvgpr_read_b32 v135, a237
  v_accvgpr_read_b32 v3, a239
  v_mul_f32 v134, v15, v134
  v_mul_f32 v135, v15, v135
  v_mfma_f32_16x16x32_bf16 a[40:43], a[132:135], v[248:251], a[40:43]
  v_mul_f32 v3, v15, v3
  v_cvt_pk_bf16_f32 v134, v134, v135
  v_accvgpr_read_b32 v135, a238
  v_mul_f32 v135, v15, v135
  v_mfma_f32_16x16x32_bf16 a[40:43], a[136:139], v[32:35], a[40:43]
  s_add_u32 s46, s35, 18688
  s_waitcnt lgkmcnt(1)
  buffer_store_dwordx4 v[144:147], v9, s[24:27], s46 offen sc1
  v_cvt_pk_bf16_f32 v135, v135, v3
  v_mfma_f32_16x16x32_bf16 a[40:43], a[140:143], v[80:83], a[40:43]
  v_accvgpr_read_b32 v152, a16
  v_accvgpr_read_b32 v153, a17
  v_accvgpr_read_b32 v154, a18
  v_mfma_f32_16x16x32_bf16 a[44:47], a[84:87], v[180:183], a[44:47]
  v_accvgpr_read_b32 v155, a19
  v_mul_f32 v152, v14, v152
  v_mul_f32 v153, v14, v153
  v_mul_f32 v154, v14, v154
  v_mfma_f32_16x16x32_bf16 a[44:47], a[88:91], v[204:207], a[44:47]
  s_waitcnt lgkmcnt(0)
  buffer_store_dwordx4 v[148:151], v9, s[24:27], s46 offen offset:3072 sc1
  v_mfma_f32_16x16x32_bf16 a[44:47], a[92:95], v[228:231], a[44:47]
  v_mul_f32 v155, v14, v155
  v_cvt_pk_bf16_f32 v152, v152, v153
  v_cvt_pk_bf16_f32 v153, v154, v155
  v_mfma_f32_16x16x32_bf16 a[44:47], a[132:135], v[252:255], a[44:47]
  v_accvgpr_read_b32 v154, a20
  v_accvgpr_read_b32 v155, a21
  v_accvgpr_read_b32 v156, a22
  v_mfma_f32_16x16x32_bf16 a[44:47], a[136:139], v[36:39], a[44:47]
  v_accvgpr_read_b32 v157, a23
  v_mul_f32 v154, v15, v154
  v_mul_f32 v155, v15, v155
  v_mul_f32 v156, v15, v156
  v_mfma_f32_16x16x32_bf16 a[44:47], a[140:143], v[84:87], a[44:47]
  v_mul_f32 v157, v15, v157
  v_cvt_pk_bf16_f32 v154, v154, v155
  v_cvt_pk_bf16_f32 v155, v156, v157
  v_accvgpr_read_b32 v156, a40
  v_accvgpr_read_b32 v157, a41
  v_accvgpr_read_b32 v158, a42
  v_accvgpr_read_b32 v159, a43
  v_mul_f32 v156, v14, v156
  v_mul_f32 v157, v14, v157
  v_mul_f32 v158, v14, v158
  v_mul_f32 v159, v14, v159
  v_cvt_pk_bf16_f32 v156, v156, v157
  v_cvt_pk_bf16_f32 v157, v158, v159
  v_accvgpr_read_b32 v158, a44
  v_accvgpr_read_b32 v159, a45
  v_accvgpr_read_b32 v3, a47
  v_mul_f32 v158, v15, v158
  v_mul_f32 v159, v15, v159
  v_mul_f32 v3, v15, v3
  v_cvt_pk_bf16_f32 v158, v158, v159
  v_accvgpr_read_b32 v159, a46
  v_mul_f32 v159, v15, v159
  v_cvt_pk_bf16_f32 v159, v159, v3
  ds_write_b64 v7, v[128:129] offset:0
  ds_write_b64 v7, v[130:131] offset:2048
  v_xor_b32 v7, 32, v7
  ds_write_b64 v7, v[132:133] offset:0
  ds_write_b64 v7, v[134:135] offset:2048
  v_xor_b32 v7, 96, v7
  ds_write_b64 v7, v[152:153] offset:0
  ds_write_b64 v7, v[154:155] offset:2048
  v_xor_b32 v7, 32, v7
  ds_write_b64 v7, v[156:157] offset:0
  ds_write_b64 v7, v[158:159] offset:2048
  v_xor_b32 v7, 96, v7
  ds_read_b128 v[128:131], v8 offset:0
  ds_read_b128 v[132:135], v8 offset:1024
  ds_read_b128 v[152:155], v8 offset:2048
  ds_read_b128 v[156:159], v8 offset:3072
  s_add_u32 s46, s35, 24832
  s_waitcnt lgkmcnt(3)
  buffer_store_dwordx4 v[128:131], v9, s[24:27], s46 offen sc1
  s_waitcnt lgkmcnt(2)
  buffer_store_dwordx4 v[132:135], v9, s[24:27], s46 offen offset:3072 sc1
  s_add_u32 s46, s35, 30976
  s_waitcnt lgkmcnt(1)
  buffer_store_dwordx4 v[152:155], v9, s[24:27], s46 offen sc1
  s_waitcnt lgkmcnt(0)
  buffer_store_dwordx4 v[156:159], v9, s[24:27], s46 offen offset:3072 sc1
L_end:
  s_endpgm
L_slow_0_1:
  s_movk_i32 s41, 1
  s_call_b64 s[44:45], L_slowsub_0_1
  s_branch L_back_0_1
L_slow_0_2:
  s_movk_i32 s41, 2
  s_call_b64 s[44:45], L_slowsub_0_0
  s_branch L_back_0_2
L_slow_0_3:
  s_movk_i32 s41, 3
  s_call_b64 s[44:45], L_slowsub_0_1
  s_branch L_back_0_3
L_slow_0_4:
  s_movk_i32 s41, 4
  s_call_b64 s[44:45], L_slowsub_0_0
  s_branch L_back_0_4
L_slow_0_5:
  s_movk_i32 s41, 5
  s_call_b64 s[44:45], L_slowsub_0_1
  s_branch L_back_0_5
L_slow_0_6:
  s_movk_i32 s41, 6
  s_call_b64 s[44:45], L_slowsub_0_0
  s_branch L_back_0_6
L_slow_0_7:
  s_movk_i32 s41, 7
  s_call_b64 s[44:45], L_slowsub_0_1
  s_branch L_back_0_7
L_slow_0_8:
  s_movk_i32 s41, 8
  s_call_b64 s[44:45], L_slowsub_0_0
  s_branch L_back_0_8
L_slow_0_9:
  s_movk_i32 s41, 9
  s_call_b64 s[44:45], L_slowsub_0_1
  s_branch L_back_0_9
L_slow_0_10:
  s_movk_i32 s41, 10
  s_call_b64 s[44:45], L_slowsub_0_0
  s_branch L_back_0_10
L_slow_0_11:
  s_movk_i32 s41, 10
  s_call_b64 s[44:45], L_slowsub_0_2
  s_branch L_back_0_11
L_slowsub_0_0:
  s_nop 15
  s_mov_b32 s10, 0xffff0000
  v_max3_f32 v3, v16, v17, v18
  v_max3_f32 v3, v3, v19, v20
  v_max3_f32 v3, v3, v21, v22
  v_max_f32 v3, v3, v23
  v_mov_b32 v1, v3
  s_nop 1
  v_permlane32_swap_b32 v3, v1
  v_max_f32 v3, v3, v1
  v_mov_b32 v1, v3
  s_nop 1
  v_permlane16_swap_b32 v3, v1
  v_max_f32 v3, v3, v1
  v_ceil_f32 v3, v3
  v_max_f32 v3, 0, v3
  v_add_f32 v4, v4, v3
  v_sub_f32 v16, v16, v3
  v_sub_f32 v17, v17, v3
  v_sub_f32 v18, v18, v3
  v_sub_f32 v19, v19, v3
  v_sub_f32 v20, v20, v3
  v_sub_f32 v21, v21, v3
  v_sub_f32 v22, v22, v3
  v_sub_f32 v23, v23, v3
  v_min_f32 v3, 0x43800000, v3
  v_cvt_i32_f32 v3, v3
  v_sub_u32 v3, 0, v3
  v_ldexp_f32 v3, 1.0, v3
  s_call_b64 s[42:43], L_resc_0_0
  v_max3_f32 v3, v24, v25, v26
  v_max3_f32 v3, v3, v27, v28
  v_max3_f32 v3, v3, v29, v30
  v_max_f32 v3, v3, v31
  v_mov_b32 v1, v3
  s_nop 1
  v_permlane32_swap_b32 v3, v1
  v_max_f32 v3, v3, v1
  v_mov_b32 v1, v3
  s_nop 1
  v_permlane16_swap_b32 v3, v1
  v_max_f32 v3, v3, v1
  v_ceil_f32 v3, v3
  v_max_f32 v3, 0, v3
  v_add_f32 v5, v5, v3
  v_sub_f32 v24, v24, v3
  v_sub_f32 v25, v25, v3
  v_sub_f32 v26, v26, v3
  v_sub_f32 v27, v27, v3
  v_sub_f32 v28, v28, v3
  v_sub_f32 v29, v29, v3
  v_sub_f32 v30, v30, v3
  v_sub_f32 v31, v31, v3
  v_min_f32 v3, 0x43800000, v3
  v_cvt_i32_f32 v3, v3
  v_sub_u32 v3, 0, v3
  v_ldexp_f32 v3, 1.0, v3
  s_call_b64 s[42:43], L_resc_0_1
  v_max3_f32 v3, v32, v33, v34
  v_max3_f32 v3, v3, v35, v36
  v_max3_f32 v3, v3, v37, v38
  v_max_f32 v3, v3, v39
  v_mov_b32 v1, v3
  s_nop 1
  v_permlane32_swap_b32 v3, v1
  v_max_f32 v3, v3, v1
  v_mov_b32 v1, v3
  s_nop 1
  v_permlane16_swap_b32 v3, v1
  v_max_f32 v3, v3, v1
  v_ceil_f32 v3, v3
  v_max_f32 v3, 0, v3
  v_add_f32 v6, v6, v3
  v_sub_f32 v32, v32, v3
  v_sub_f32 v33, v33, v3
  v_sub_f32 v34, v34, v3
  v_sub_f32 v35, v35, v3
  v_sub_f32 v36, v36, v3
  v_sub_f32 v37, v37, v3
  v_sub_f32 v38, v38, v3
  v_sub_f32 v39, v39, v3
  v_min_f32 v3, 0x43800000, v3
  v_cvt_i32_f32 v3, v3
  v_sub_u32 v3, 0, v3
  v_ldexp_f32 v3, 1.0, v3
  s_call_b64 s[42:43], L_resc_0_2
  v_max3_f32 v3, v40, v41, v42
  v_max3_f32 v3, v3, v43, v44
  v_max3_f32 v3, v3, v45, v46
  v_max_f32 v3, v3, v47
  v_mov_b32 v1, v3
  s_nop 1
  v_permlane32_swap_b32 v3, v1
  v_max_f32 v3, v3, v1
  v_mov_b32 v1, v3
  s_nop 1
  v_permlane16_swap_b32 v3, v1
  v_max_f32 v3, v3, v1
  v_ceil_f32 v3, v3
  v_max_f32 v3, 0, v3
  v_add_f32 v7, v7, v3
  v_sub_f32 v40, v40, v3
  v_sub_f32 v41, v41, v3
  v_sub_f32 v42, v42, v3
  v_sub_f32 v43, v43, v3
  v_sub_f32 v44, v44, v3
  v_sub_f32 v45, v45, v3
  v_sub_f32 v46, v46, v3
  v_sub_f32 v47, v47, v3
  v_min_f32 v3, 0x43800000, v3
  v_cvt_i32_f32 v3, v3
  v_sub_u32 v3, 0, v3
  v_ldexp_f32 v3, 1.0, v3
  s_call_b64 s[42:43], L_resc_0_3
  v_max3_f32 v3, v48, v49, v50
  v_max3_f32 v3, v3, v51, v52
  v_max3_f32 v3, v3, v53, v54
  v_max_f32 v3, v3, v55
  v_mov_b32 v1, v3
  s_nop 1
  v_permlane32_swap_b32 v3, v1
  v_max_f32 v3, v3, v1
  v_mov_b32 v1, v3
  s_nop 1
  v_permlane16_swap_b32 v3, v1
  v_max_f32 v3, v3, v1
  v_ceil_f32 v3, v3
  v_max_f32 v3, 0, v3
  v_add_f32 v8, v8, v3
  v_sub_f32 v48, v48, v3
  v_sub_f32 v49, v49, v3
  v_sub_f32 v50, v50, v3
  v_sub_f32 v51, v51, v3
  v_sub_f32 v52, v52, v3
  v_sub_f32 v53, v53, v3
  v_sub_f32 v54, v54, v3
  v_sub_f32 v55, v55, v3
  v_min_f32 v3, 0x43800000, v3
  v_cvt_i32_f32 v3, v3
  v_sub_u32 v3, 0, v3
  v_ldexp_f32 v3, 1.0, v3
  s_call_b64 s[42:43], L_resc_0_4
  v_max3_f32 v3, v56, v57, v58
  v_max3_f32 v3, v3, v59, v60
  v_max3_f32 v3, v3, v61, v62
  v_max_f32 v3, v3, v63
  v_mov_b32 v1, v3
  s_nop 1
  v_permlane32_swap_b32 v3, v1
  v_max_f32 v3, v3, v1
  v_mov_b32 v1, v3
  s_nop 1
  v_permlane16_swap_b32 v3, v1
  v_max_f32 v3, v3, v1
  v_ceil_f32 v3, v3
  v_max_f32 v3, 0, v3
  v_add_f32 v9, v9, v3
  v_sub_f32 v56, v56, v3
  v_sub_f32 v57, v57, v3
  v_sub_f32 v58, v58, v3
  v_sub_f32 v59, v59, v3
  v_sub_f32 v60, v60, v3
  v_sub_f32 v61, v61, v3
  v_sub_f32 v62, v62, v3
  v_sub_f32 v63, v63, v3
  v_min_f32 v3, 0x43800000, v3
  v_cvt_i32_f32 v3, v3
  v_sub_u32 v3, 0, v3
  v_ldexp_f32 v3, 1.0, v3
  s_call_b64 s[42:43], L_resc_0_5
  v_mbcnt_lo_u32_b32 v3, -1, 0
  v_mbcnt_hi_u32_b32 v3, -1, v3
  v_lshrrev_b32 v1, 3, v3
  v_mul_u32_u24 v2, 384, v1
  v_and_b32 v1, 6, v1
  v_and_b32 v3, 7, v3
  v_xor_b32 v3, v3, v1
  v_lshl_add_u32 v2, v3, 4, v2
  v_xor_b32 v1, 64, v0
  s_nop 3
  s_setpc_b64 s[44:45]
L_slowsub_0_1:
  s_nop 15
  s_mov_b32 s10, 0xffff0000
  v_max3_f32 v3, v64, v65, v66
  v_max3_f32 v3, v3, v67, v68
  v_max3_f32 v3, v3, v69, v70
  v_max_f32 v3, v3, v71
  v_mov_b32 v1, v3
  s_nop 1
  v_permlane32_swap_b32 v3, v1
  v_max_f32 v3, v3, v1
  v_mov_b32 v1, v3
  s_nop 1
  v_permlane16_swap_b32 v3, v1
  v_max_f32 v3, v3, v1
  v_ceil_f32 v3, v3
  v_max_f32 v3, 0, v3
  v_add_f32 v4, v4, v3
  v_sub_f32 v64, v64, v3
  v_sub_f32 v65, v65, v3
  v_sub_f32 v66, v66, v3
  v_sub_f32 v67, v67, v3
  v_sub_f32 v68, v68, v3
  v_sub_f32 v69, v69, v3
  v_sub_f32 v70, v70, v3
  v_sub_f32 v71, v71, v3
  v_min_f32 v3, 0x43800000, v3
  v_cvt_i32_f32 v3, v3
  v_sub_u32 v3, 0, v3
  v_ldexp_f32 v3, 1.0, v3
  s_call_b64 s[42:43], L_resc_0_0
  v_max3_f32 v3, v72, v73, v74
  v_max3_f32 v3, v3, v75, v76
  v_max3_f32 v3, v3, v77, v78
  v_max_f32 v3, v3, v79
  v_mov_b32 v1, v3
  s_nop 1
  v_permlane32_swap_b32 v3, v1
  v_max_f32 v3, v3, v1
  v_mov_b32 v1, v3
  s_nop 1
  v_permlane16_swap_b32 v3, v1
  v_max_f32 v3, v3, v1
  v_ceil_f32 v3, v3
  v_max_f32 v3, 0, v3
  v_add_f32 v5, v5, v3
  v_sub_f32 v72, v72, v3
  v_sub_f32 v73, v73, v3
  v_sub_f32 v74, v74, v3
  v_sub_f32 v75, v75, v3
  v_sub_f32 v76, v76, v3
  v_sub_f32 v77, v77, v3
  v_sub_f32 v78, v78, v3
  v_sub_f32 v79, v79, v3
  v_min_f32 v3, 0x43800000, v3
  v_cvt_i32_f32 v3, v3
  v_sub_u32 v3, 0, v3
  v_ldexp_f32 v3, 1.0, v3
  s_call_b64 s[42:43], L_resc_0_1
  v_max3_f32 v3, v80, v81, v82
  v_max3_f32 v3, v3, v83, v84
  v_max3_f32 v3, v3, v85, v86
  v_max_f32 v3, v3, v87
  v_mov_b32 v1, v3
  s_nop 1
  v_permlane32_swap_b32 v3, v1
  v_max_f32 v3, v3, v1
  v_mov_b32 v1, v3
  s_nop 1
  v_permlane16_swap_b32 v3, v1
  v_max_f32 v3, v3, v1
  v_ceil_f32 v3, v3
  v_max_f32 v3, 0, v3
  v_add_f32 v6, v6, v3
  v_sub_f32 v80, v80, v3
  v_sub_f32 v81, v81, v3
  v_sub_f32 v82, v82, v3
  v_sub_f32 v83, v83, v3
  v_sub_f32 v84, v84, v3
  v_sub_f32 v85, v85, v3
  v_sub_f32 v86, v86, v3
  v_sub_f32 v87, v87, v3
  v_min_f32 v3, 0x43800000, v3
  v_cvt_i32_f32 v3, v3
  v_sub_u32 v3, 0, v3
  v_ldexp_f32 v3, 1.0, v3
  s_call_b64 s[42:43], L_resc_0_2
  v_max3_f32 v3, v88, v89, v90
  v_max3_f32 v3, v3, v91, v92
  v_max3_f32 v3, v3, v93, v94
  v_max_f32 v3, v3, v95
  v_mov_b32 v1, v3
  s_nop 1
  v_permlane32_swap_b32 v3, v1
  v_max_f32 v3, v3, v1
  v_mov_b32 v1, v3
  s_nop 1
  v_permlane16_swap_b32 v3, v1
  v_max_f32 v3, v3, v1
  v_ceil_f32 v3, v3
  v_max_f32 v3, 0, v3
  v_add_f32 v7, v7, v3
  v_sub_f32 v88, v88, v3
  v_sub_f32 v89, v89, v3
  v_sub_f32 v90, v90, v3
  v_sub_f32 v91, v91, v3
  v_sub_f32 v92, v92, v3
  v_sub_f32 v93, v93, v3
  v_sub_f32 v94, v94, v3
  v_sub_f32 v95, v95, v3
  v_min_f32 v3, 0x43800000, v3
  v_cvt_i32_f32 v3, v3
  v_sub_u32 v3, 0, v3
  v_ldexp_f32 v3, 1.0, v3
  s_call_b64 s[42:43], L_resc_0_3
  v_max3_f32 v3, v96, v97, v98
  v_max3_f32 v3, v3, v99, v100
  v_max3_f32 v3, v3, v101, v102
  v_max_f32 v3, v3, v103
  v_mov_b32 v1, v3
  s_nop 1
  v_permlane32_swap_b32 v3, v1
  v_max_f32 v3, v3, v1
  v_mov_b32 v1, v3
  s_nop 1
  v_permlane16_swap_b32 v3, v1
  v_max_f32 v3, v3, v1
  v_ceil_f32 v3, v3
  v_max_f32 v3, 0, v3
  v_add_f32 v8, v8, v3
  v_sub_f32 v96, v96, v3
  v_sub_f32 v97, v97, v3
  v_sub_f32 v98, v98, v3
  v_sub_f32 v99, v99, v3
  v_sub_f32 v100, v100, v3
  v_sub_f32 v101, v101, v3
  v_sub_f32 v102, v102, v3
  v_sub_f32 v103, v103, v3
  v_min_f32 v3, 0x43800000, v3
  v_cvt_i32_f32 v3, v3
  v_sub_u32 v3, 0, v3
  v_ldexp_f32 v3, 1.0, v3
  s_call_b64 s[42:43], L_resc_0_4
  v_max3_f32 v3, v104, v105, v106
  v_max3_f32 v3, v3, v107, v108
  v_max3_f32 v3, v3, v109, v110
  v_max_f32 v3, v3, v111
  v_mov_b32 v1, v3
  s_nop 1
  v_permlane32_swap_b32 v3, v1
  v_max_f32 v3, v3, v1
  v_mov_b32 v1, v3
  s_nop 1
  v_permlane16_swap_b32 v3, v1
  v_max_f32 v3, v3, v1
  v_ceil_f32 v3, v3
  v_max_f32 v3, 0, v3
  v_add_f32 v9, v9, v3
  v_sub_f32 v104, v104, v3
  v_sub_f32 v105, v105, v3
  v_sub_f32 v106, v106, v3
  v_sub_f32 v107, v107, v3
  v_sub_f32 v108, v108, v3
  v_sub_f32 v109, v109, v3
  v_sub_f32 v110, v110, v3
  v_sub_f32 v111, v111, v3
  v_min_f32 v3, 0x43800000, v3
  v_cvt_i32_f32 v3, v3
  v_sub_u32 v3, 0, v3
  v_ldexp_f32 v3, 1.0, v3
  s_call_b64 s[42:43], L_resc_0_5
  v_mbcnt_lo_u32_b32 v3, -1, 0
  v_mbcnt_hi_u32_b32 v3, -1, v3
  v_lshrrev_b32 v1, 3, v3
  v_mul_u32_u24 v2, 384, v1
  v_and_b32 v1, 6, v1
  v_and_b32 v3, 7, v3
  v_xor_b32 v3, v3, v1
  v_lshl_add_u32 v2, v3, 4, v2
  v_xor_b32 v1, 64, v0
  s_nop 3
  s_setpc_b64 s[44:45]
L_slowsub_0_2:
  s_nop 15
  s_mov_b32 s10, 0xffff0000
  v_max3_f32 v3, v64, v65, v66
  v_max3_f32 v3, v3, v67, v68
  v_max3_f32 v3, v3, v69, v70
  v_max_f32 v3, v3, v71
  v_mov_b32 v1, v3
  s_nop 1
  v_permlane32_swap_b32 v3, v1
  v_max_f32 v3, v3, v1
  v_mov_b32 v1, v3
  s_nop 1
  v_permlane16_swap_b32 v3, v1
  v_max_f32 v3, v3, v1
  v_ceil_f32 v3, v3
  v_max_f32 v3, 0, v3
  v_add_f32 v4, v4, v3
  v_sub_f32 v64, v64, v3
  v_sub_f32 v65, v65, v3
  v_sub_f32 v66, v66, v3
  v_sub_f32 v67, v67, v3
  v_sub_f32 v68, v68, v3
  v_sub_f32 v69, v69, v3
  v_sub_f32 v70, v70, v3
  v_sub_f32 v71, v71, v3
  v_min_f32 v3, 0x43800000, v3
  v_cvt_i32_f32 v3, v3
  v_sub_u32 v3, 0, v3
  v_ldexp_f32 v3, 1.0, v3
  v_lshlrev_b32 v1, 16, v16
  v_and_b32 v2, s10, v16
  v_mul_f32 v1, v1, v3
  v_mul_f32 v2, v2, v3
  v_cvt_pk_bf16_f32 v16, v1, v2
  v_lshlrev_b32 v1, 16, v17
  v_and_b32 v2, s10, v17
  v_mul_f32 v1, v1, v3
  v_mul_f32 v2, v2, v3
  v_cvt_pk_bf16_f32 v17, v1, v2
  v_lshlrev_b32 v1, 16, v18
  v_and_b32 v2, s10, v18
  v_mul_f32 v1, v1, v3
  v_mul_f32 v2, v2, v3
  v_cvt_pk_bf16_f32 v18, v1, v2
  v_lshlrev_b32 v1, 16, v19
  v_and_b32 v2, s10, v19
  v_mul_f32 v1, v1, v3
  v_mul_f32 v2, v2, v3
  v_cvt_pk_bf16_f32 v19, v1, v2
  v_accvgpr_read_b32 v1, a0
  v_mul_f32 v1, v1, v3
  v_accvgpr_write_b32 a0, v1
  v_accvgpr_read_b32 v1, a1
  v_mul_f32 v1, v1, v3
  v_accvgpr_write_b32 a1, v1
  v_accvgpr_read_b32 v1, a2
  v_mul_f32 v1, v1, v3
  v_accvgpr_write_b32 a2, v1
  v_accvgpr_read_b32 v1, a3
  v_mul_f32 v1, v1, v3
  v_accvgpr_write_b32 a3, v1
  v_accvgpr_read_b32 v1, a24
  v_mul_f32 v1, v1, v3
  v_accvgpr_write_b32 a24, v1
  v_accvgpr_read_b32 v1, a25
  v_mul_f32 v1, v1, v3
  v_accvgpr_write_b32 a25, v1
  v_accvgpr_read_b32 v1, a26
  v_mul_f32 v1, v1, v3
  v_accvgpr_write_b32 a26, v1
  v_accvgpr_read_b32 v1, a27
  v_mul_f32 v1, v1, v3
  v_accvgpr_write_b32 a27, v1
  s_call_b64 s[42:43], L_resc_0_0
  v_max3_f32 v3, v72, v73, v74
  v_max3_f32 v3, v3, v75, v76
  v_max3_f32 v3, v3, v77, v78
  v_max_f32 v3, v3, v79
  v_mov_b32 v1, v3
  s_nop 1
  v_permlane32_swap_b32 v3, v1
  v_max_f32 v3, v3, v1
  v_mov_b32 v1, v3
  s_nop 1
  v_permlane16_swap_b32 v3, v1
  v_max_f32 v3, v3, v1
  v_ceil_f32 v3, v3
  v_max_f32 v3, 0, v3
  v_add_f32 v5, v5, v3
  v_sub_f32 v72, v72, v3
  v_sub_f32 v73, v73, v3
  v_sub_f32 v74, v74, v3
  v_sub_f32 v75, v75, v3
  v_sub_f32 v76, v76, v3
  v_sub_f32 v77, v77, v3
  v_sub_f32 v78, v78, v3
  v_sub_f32 v79, v79, v3
  v_min_f32 v3, 0x43800000, v3
  v_cvt_i32_f32 v3, v3
  v_sub_u32 v3, 0, v3
  v_ldexp_f32 v3, 1.0, v3
  v_lshlrev_b32 v1, 16, v20
  v_and_b32 v2, s10, v20
  v_mul_f32 v1, v1, v3
  v_mul_f32 v2, v2, v3
  v_cvt_pk_bf16_f32 v20, v1, v2
  v_lshlrev_b32 v1, 16, v21
  v_and_b32 v2, s10, v21
  v_mul_f32 v1, v1, v3
  v_mul_f32 v2, v2, v3
  v_cvt_pk_bf16_f32 v21, v1, v2
  v_lshlrev_b32 v1, 16, v22
  v_and_b32 v2, s10, v22
  v_mul_f32 v1, v1, v3
  v_mul_f32 v2, v2, v3
  v_cvt_pk_bf16_f32 v22, v1, v2
  v_lshlrev_b32 v1, 16, v23
  v_and_b32 v2, s10, v23
  v_mul_f32 v1, v1, v3
  v_mul_f32 v2, v2, v3
  v_cvt_pk_bf16_f32 v23, v1, v2
  v_accvgpr_read_b32 v1, a4
  v_mul_f32 v1, v1, v3
  v_accvgpr_write_b32 a4, v1
  v_accvgpr_read_b32 v1, a5
  v_mul_f32 v1, v1, v3
  v_accvgpr_write_b32 a5, v1
  v_accvgpr_read_b32 v1, a6
  v_mul_f32 v1, v1, v3
  v_accvgpr_write_b32 a6, v1
  v_accvgpr_read_b32 v1, a7
  v_mul_f32 v1, v1, v3
  v_accvgpr_write_b32 a7, v1
  v_accvgpr_read_b32 v1, a28
  v_mul_f32 v1, v1, v3
  v_accvgpr_write_b32 a28, v1
  v_accvgpr_read_b32 v1, a29
  v_mul_f32 v1, v1, v3
  v_accvgpr_write_b32 a29, v1
  v_accvgpr_read_b32 v1, a30
  v_mul_f32 v1, v1, v3
  v_accvgpr_write_b32 a30, v1
  v_accvgpr_read_b32 v1, a31
  v_mul_f32 v1, v1, v3
  v_accvgpr_write_b32 a31, v1
  s_call_b64 s[42:43], L_resc_0_1
  v_max3_f32 v3, v80, v81, v82
  v_max3_f32 v3, v3, v83, v84
  v_max3_f32 v3, v3, v85, v86
  v_max_f32 v3, v3, v87
  v_mov_b32 v1, v3
  s_nop 1
  v_permlane32_swap_b32 v3, v1
  v_max_f32 v3, v3, v1
  v_mov_b32 v1, v3
  s_nop 1
  v_permlane16_swap_b32 v3, v1
  v_max_f32 v3, v3, v1
  v_ceil_f32 v3, v3
  v_max_f32 v3, 0, v3
  v_add_f32 v6, v6, v3
  v_sub_f32 v80, v80, v3
  v_sub_f32 v81, v81, v3
  v_sub_f32 v82, v82, v3
  v_sub_f32 v83, v83, v3
  v_sub_f32 v84, v84, v3
  v_sub_f32 v85, v85, v3
  v_sub_f32 v86, v86, v3
  v_sub_f32 v87, v87, v3
  v_sub_f32 v32, v32, v3
  v_sub_f32 v33, v33, v3
  v_sub_f32 v34, v34, v3
  v_sub_f32 v35, v35, v3
  v_sub_f32 v36, v36, v3
  v_sub_f32 v37, v37, v3
  v_sub_f32 v38, v38, v3
  v_sub_f32 v39, v39, v3
  v_min_f32 v3, 0x43800000, v3
  v_cvt_i32_f32 v3, v3
  v_sub_u32 v3, 0, v3
  v_ldexp_f32 v3, 1.0, v3
  v_accvgpr_read_b32 v1, a8
  v_mul_f32 v1, v1, v3
  v_accvgpr_write_b32 a8, v1
  v_accvgpr_read_b32 v1, a9
  v_mul_f32 v1, v1, v3
  v_accvgpr_write_b32 a9, v1
  v_accvgpr_read_b32 v1, a10
  v_mul_f32 v1, v1, v3
  v_accvgpr_write_b32 a10, v1
  v_accvgpr_read_b32 v1, a11
  v_mul_f32 v1, v1, v3
  v_accvgpr_write_b32 a11, v1
  v_accvgpr_read_b32 v1, a32
  v_mul_f32 v1, v1, v3
  v_accvgpr_write_b32 a32, v1
  v_accvgpr_read_b32 v1, a33
  v_mul_f32 v1, v1, v3
  v_accvgpr_write_b32 a33, v1
  v_accvgpr_read_b32 v1, a34
  v_mul_f32 v1, v1, v3
  v_accvgpr_write_b32 a34, v1
  v_accvgpr_read_b32 v1, a35
  v_mul_f32 v1, v1, v3
  v_accvgpr_write_b32 a35, v1
  s_call_b64 s[42:43], L_resc_0_2
  v_max3_f32 v3, v88, v89, v90
  v_max3_f32 v3, v3, v91, v92
  v_max3_f32 v3, v3, v93, v94
  v_max_f32 v3, v3, v95
  v_mov_b32 v1, v3
  s_nop 1
  v_permlane32_swap_b32 v3, v1
  v_max_f32 v3, v3, v1
  v_mov_b32 v1, v3
  s_nop 1
  v_permlane16_swap_b32 v3, v1
  v_max_f32 v3, v3, v1
  v_ceil_f32 v3, v3
  v_max_f32 v3, 0, v3
  v_add_f32 v7, v7, v3
  v_sub_f32 v88, v88, v3
  v_sub_f32 v89, v89, v3
  v_sub_f32 v90, v90, v3
  v_sub_f32 v91, v91, v3
  v_sub_f32 v92, v92, v3
  v_sub_f32 v93, v93, v3
  v_sub_f32 v94, v94, v3
  v_sub_f32 v95, v95, v3
  v_sub_f32 v40, v40, v3
  v_sub_f32 v41, v41, v3
  v_sub_f32 v42, v42, v3
  v_sub_f32 v43, v43, v3
  v_sub_f32 v44, v44, v3
  v_sub_f32 v45, v45, v3
  v_sub_f32 v46, v46, v3
  v_sub_f32 v47, v47, v3
  v_min_f32 v3, 0x43800000, v3
  v_cvt_i32_f32 v3, v3
  v_sub_u32 v3, 0, v3
  v_ldexp_f32 v3, 1.0, v3
  v_accvgpr_read_b32 v1, a12
  v_mul_f32 v1, v1, v3
  v_accvgpr_write_b32 a12, v1
  v_accvgpr_read_b32 v1, a13
  v_mul_f32 v1, v1, v3
  v_accvgpr_write_b32 a13, v1
  v_accvgpr_read_b32 v1, a14
  v_mul_f32 v1, v1, v3
  v_accvgpr_write_b32 a14, v1
  v_accvgpr_read_b32 v1, a15
  v_mul_f32 v1, v1, v3
  v_accvgpr_write_b32 a15, v1
  v_accvgpr_read_b32 v1, a36
  v_mul_f32 v1, v1, v3
  v_accvgpr_write_b32 a36, v1
  v_accvgpr_read_b32 v1, a37
  v_mul_f32 v1, v1, v3
  v_accvgpr_write_b32 a37, v1
  v_accvgpr_read_b32 v1, a38
  v_mul_f32 v1, v1, v3
  v_accvgpr_write_b32 a38, v1
  v_accvgpr_read_b32 v1, a39
  v_mul_f32 v1, v1, v3
  v_accvgpr_write_b32 a39, v1
  s_call_b64 s[42:43], L_resc_0_3
  v_max3_f32 v3, v96, v97, v98
  v_max3_f32 v3, v3, v99, v100
  v_max3_f32 v3, v3, v101, v102
  v_max_f32 v3, v3, v103
  v_mov_b32 v1, v3
  s_nop 1
  v_permlane32_swap_b32 v3, v1
  v_max_f32 v3, v3, v1
  v_mov_b32 v1, v3
  s_nop 1
  v_permlane16_swap_b32 v3, v1
  v_max_f32 v3, v3, v1
  v_ceil_f32 v3, v3
  v_max_f32 v3, 0, v3
  v_add_f32 v8, v8, v3
  v_sub_f32 v96, v96, v3
  v_sub_f32 v97, v97, v3
  v_sub_f32 v98, v98, v3
  v_sub_f32 v99, v99, v3
  v_sub_f32 v100, v100, v3
  v_sub_f32 v101, v101, v3
  v_sub_f32 v102, v102, v3
  v_sub_f32 v103, v103, v3
  v_sub_f32 v48, v48, v3
  v_sub_f32 v49, v49, v3
  v_sub_f32 v50, v50, v3
  v_sub_f32 v51, v51, v3
  v_sub_f32 v52, v52, v3
  v_sub_f32 v53, v53, v3
  v_sub_f32 v54, v54, v3
  v_sub_f32 v55, v55, v3
  v_min_f32 v3, 0x43800000, v3
  v_cvt_i32_f32 v3, v3
  v_sub_u32 v3, 0, v3
  v_ldexp_f32 v3, 1.0, v3
  v_accvgpr_read_b32 v1, a16
  v_mul_f32 v1, v1, v3
  v_accvgpr_write_b32 a16, v1
  v_accvgpr_read_b32 v1, a17
  v_mul_f32 v1, v1, v3
  v_accvgpr_write_b32 a17, v1
  v_accvgpr_read_b32 v1, a18
  v_mul_f32 v1, v1, v3
  v_accvgpr_write_b32 a18, v1
  v_accvgpr_read_b32 v1, a19
  v_mul_f32 v1, v1, v3
  v_accvgpr_write_b32 a19, v1
  v_accvgpr_read_b32 v1, a40
  v_mul_f32 v1, v1, v3
  v_accvgpr_write_b32 a40, v1
  v_accvgpr_read_b32 v1, a41
  v_mul_f32 v1, v1, v3
  v_accvgpr_write_b32 a41, v1
  v_accvgpr_read_b32 v1, a42
  v_mul_f32 v1, v1, v3
  v_accvgpr_write_b32 a42, v1
  v_accvgpr_read_b32 v1, a43
  v_mul_f32 v1, v1, v3
  v_accvgpr_write_b32 a43, v1
  s_call_b64 s[42:43], L_resc_0_4
  v_max3_f32 v3, v104, v105, v106
  v_max3_f32 v3, v3, v107, v108
  v_max3_f32 v3, v3, v109, v110
  v_max_f32 v3, v3, v111
  v_mov_b32 v1, v3
  s_nop 1
  v_permlane32_swap_b32 v3, v1
  v_max_f32 v3, v3, v1
  v_mov_b32 v1, v3
  s_nop 1
  v_permlane16_swap_b32 v3, v1
  v_max_f32 v3, v3, v1
  v_ceil_f32 v3, v3
  v_max_f32 v3, 0, v3
  v_add_f32 v9, v9, v3
  v_sub_f32 v104, v104, v3
  v_sub_f32 v105, v105, v3
  v_sub_f32 v106, v106, v3
  v_sub_f32 v107, v107, v3
  v_sub_f32 v108, v108, v3
  v_sub_f32 v109, v109, v3
  v_sub_f32 v110, v110, v3
  v_sub_f32 v111, v111, v3
  v_sub_f32 v56, v56, v3
  v_sub_f32 v57, v57, v3
  v_sub_f32 v58, v58, v3
  v_sub_f32 v59, v59, v3
  v_sub_f32 v60, v60, v3
  v_sub_f32 v61, v61, v3
  v_sub_f32 v62, v62, v3
  v_sub_f32 v63, v63, v3
  v_min_f32 v3, 0x43800000, v3
  v_cvt_i32_f32 v3, v3
  v_sub_u32 v3, 0, v3
  v_ldexp_f32 v3, 1.0, v3
  v_accvgpr_read_b32 v1, a20
  v_mul_f32 v1, v1, v3
  v_accvgpr_write_b32 a20, v1
  v_accvgpr_read_b32 v1, a21
  v_mul_f32 v1, v1, v3
  v_accvgpr_write_b32 a21, v1
  v_accvgpr_read_b32 v1, a22
  v_mul_f32 v1, v1, v3
  v_accvgpr_write_b32 a22, v1
  v_accvgpr_read_b32 v1, a23
  v_mul_f32 v1, v1, v3
  v_accvgpr_write_b32 a23, v1
  v_accvgpr_read_b32 v1, a44
  v_mul_f32 v1, v1, v3
  v_accvgpr_write_b32 a44, v1
  v_accvgpr_read_b32 v1, a45
  v_mul_f32 v1, v1, v3
  v_accvgpr_write_b32 a45, v1
  v_accvgpr_read_b32 v1, a46
  v_mul_f32 v1, v1, v3
  v_accvgpr_write_b32 a46, v1
  v_accvgpr_read_b32 v1, a47
  v_mul_f32 v1, v1, v3
  v_accvgpr_write_b32 a47, v1
  s_call_b64 s[42:43], L_resc_0_5
  v_mbcnt_lo_u32_b32 v3, -1, 0
  v_mbcnt_hi_u32_b32 v3, -1, v3
  v_lshrrev_b32 v1, 3, v3
  v_mul_u32_u24 v2, 384, v1
  v_and_b32 v1, 6, v1
  v_and_b32 v3, 7, v3
  v_xor_b32 v3, v3, v1
  v_lshl_add_u32 v2, v3, 4, v2
  v_xor_b32 v1, 64, v0
  s_nop 3
  s_setpc_b64 s[44:45]
L_resc_0_0:
  s_cmp_le_u32 s41, 0
  s_cbranch_scc1 L_resc_done_0_0
  v_accvgpr_read_b32 v2, a144
  v_lshlrev_b32 v1, 16, v2
  v_and_b32 v2, s10, v2
  v_mul_f32 v1, v1, v3
  v_mul_f32 v2, v2, v3
  v_cvt_pk_bf16_f32 v1, v1, v2
  v_accvgpr_write_b32 a144, v1
  v_accvgpr_read_b32 v2, a145
  v_lshlrev_b32 v1, 16, v2
  v_and_b32 v2, s10, v2
  v_mul_f32 v1, v1, v3
  v_mul_f32 v2, v2, v3
  v_cvt_pk_bf16_f32 v1, v1, v2
  v_accvgpr_write_b32 a145, v1
  v_accvgpr_read_b32 v2, a146
  v_lshlrev_b32 v1, 16, v2
  v_and_b32 v2, s10, v2
  v_mul_f32 v1, v1, v3
  v_mul_f32 v2, v2, v3
  v_cvt_pk_bf16_f32 v1, v1, v2
  v_accvgpr_write_b32 a146, v1
  v_accvgpr_read_b32 v2, a147
  v_lshlrev_b32 v1, 16, v2
  v_and_b32 v2, s10, v2
  v_mul_f32 v1, v1, v3
  v_mul_f32 v2, v2, v3
  v_cvt_pk_bf16_f32 v1, v1, v2
  v_accvgpr_write_b32 a147, v1
  s_cmp_le_u32 s41, 1
  s_cbranch_scc1 L_resc_done_0_0
  v_accvgpr_read_b32 v2, a168
  v_lshlrev_b32 v1, 16, v2
  v_and_b32 v2, s10, v2
  v_mul_f32 v1, v1, v3
  v_mul_f32 v2, v2, v3
  v_cvt_pk_bf16_f32 v1, v1, v2
  v_accvgpr_write_b32 a168, v1
  v_accvgpr_read_b32 v2, a169
  v_lshlrev_b32 v1, 16, v2
  v_and_b32 v2, s10, v2
  v_mul_f32 v1, v1, v3
  v_mul_f32 v2, v2, v3
  v_cvt_pk_bf16_f32 v1, v1, v2
  v_accvgpr_write_b32 a169, v1
  v_accvgpr_read_b32 v2, a170
  v_lshlrev_b32 v1, 16, v2
  v_and_b32 v2, s10, v2
  v_mul_f32 v1, v1, v3
  v_mul_f32 v2, v2, v3
  v_cvt_pk_bf16_f32 v1, v1, v2
  v_accvgpr_write_b32 a170, v1
  v_accvgpr_read_b32 v2, a171
  v_lshlrev_b32 v1, 16, v2
  v_and_b32 v2, s10, v2
  v_mul_f32 v1, v1, v3
  v_mul_f32 v2, v2, v3
  v_cvt_pk_bf16_f32 v1, v1, v2
  v_accvgpr_write_b32 a171, v1
  s_cmp_le_u32 s41, 2
  s_cbranch_scc1 L_resc_done_0_0
  v_accvgpr_read_b32 v2, a192
  v_lshlrev_b32 v1, 16, v2
  v_and_b32 v2, s10, v2
  v_mul_f32 v1, v1, v3
  v_mul_f32 v2, v2, v3
  v_cvt_pk_bf16_f32 v1, v1, v2
  v_accvgpr_write_b32 a192, v1
  v_accvgpr_read_b32 v2, a193
  v_lshlrev_b32 v1, 16, v2
  v_and_b32 v2, s10, v2
  v_mul_f32 v1, v1, v3
  v_mul_f32 v2, v2, v3
  v_cvt_pk_bf16_f32 v1, v1, v2
  v_accvgpr_write_b32 a193, v1
  v_accvgpr_read_b32 v2, a194
  v_lshlrev_b32 v1, 16, v2
  v_and_b32 v2, s10, v2
  v_mul_f32 v1, v1, v3
  v_mul_f32 v2, v2, v3
  v_cvt_pk_bf16_f32 v1, v1, v2
  v_accvgpr_write_b32 a194, v1
  v_accvgpr_read_b32 v2, a195
  v_lshlrev_b32 v1, 16, v2
  v_and_b32 v2, s10, v2
  v_mul_f32 v1, v1, v3
  v_mul_f32 v2, v2, v3
  v_cvt_pk_bf16_f32 v1, v1, v2
  v_accvgpr_write_b32 a195, v1
  s_cmp_le_u32 s41, 3
  s_cbranch_scc1 L_resc_done_0_0
  v_accvgpr_read_b32 v2, a216
  v_lshlrev_b32 v1, 16, v2
  v_and_b32 v2, s10, v2
  v_mul_f32 v1, v1, v3
  v_mul_f32 v2, v2, v3
  v_cvt_pk_bf16_f32 v1, v1, v2
  v_accvgpr_write_b32 a216, v1
  v_accvgpr_read_b32 v2, a217
  v_lshlrev_b32 v1, 16, v2
  v_and_b32 v2, s10, v2
  v_mul_f32 v1, v1, v3
  v_mul_f32 v2, v2, v3
  v_cvt_pk_bf16_f32 v1, v1, v2
  v_accvgpr_write_b32 a217, v1
  v_accvgpr_read_b32 v2, a218
  v_lshlrev_b32 v1, 16, v2
  v_and_b32 v2, s10, v2
  v_mul_f32 v1, v1, v3
  v_mul_f32 v2, v2, v3
  v_cvt_pk_bf16_f32 v1, v1, v2
  v_accvgpr_write_b32 a218, v1
  v_accvgpr_read_b32 v2, a219
  v_lshlrev_b32 v1, 16, v2
  v_and_b32 v2, s10, v2
  v_mul_f32 v1, v1, v3
  v_mul_f32 v2, v2, v3
  v_cvt_pk_bf16_f32 v1, v1, v2
  v_accvgpr_write_b32 a219, v1
  s_cmp_le_u32 s41, 4
  s_cbranch_scc1 L_resc_done_0_0
  v_lshlrev_b32 v1, 16, v112
  v_and_b32 v2, s10, v112
  v_mul_f32 v1, v1, v3
  v_mul_f32 v2, v2, v3
  v_cvt_pk_bf16_f32 v112, v1, v2
  v_lshlrev_b32 v1, 16, v113
  v_and_b32 v2, s10, v113
  v_mul_f32 v1, v1, v3
  v_mul_f32 v2, v2, v3
  v_cvt_pk_bf16_f32 v113, v1, v2
  v_lshlrev_b32 v1, 16, v114
  v_and_b32 v2, s10, v114
  v_mul_f32 v1, v1, v3
  v_mul_f32 v2, v2, v3
  v_cvt_pk_bf16_f32 v114, v1, v2
  v_lshlrev_b32 v1, 16, v115
  v_and_b32 v2, s10, v115
  v_mul_f32 v1, v1, v3
  v_mul_f32 v2, v2, v3
  v_cvt_pk_bf16_f32 v115, v1, v2
  s_cmp_le_u32 s41, 5
  s_cbranch_scc1 L_resc_done_0_0
  v_lshlrev_b32 v1, 16, v136
  v_and_b32 v2, s10, v136
  v_mul_f32 v1, v1, v3
  v_mul_f32 v2, v2, v3
  v_cvt_pk_bf16_f32 v136, v1, v2
  v_lshlrev_b32 v1, 16, v137
  v_and_b32 v2, s10, v137
  v_mul_f32 v1, v1, v3
  v_mul_f32 v2, v2, v3
  v_cvt_pk_bf16_f32 v137, v1, v2
  v_lshlrev_b32 v1, 16, v138
  v_and_b32 v2, s10, v138
  v_mul_f32 v1, v1, v3
  v_mul_f32 v2, v2, v3
  v_cvt_pk_bf16_f32 v138, v1, v2
  v_lshlrev_b32 v1, 16, v139
  v_and_b32 v2, s10, v139
  v_mul_f32 v1, v1, v3
  v_mul_f32 v2, v2, v3
  v_cvt_pk_bf16_f32 v139, v1, v2
  s_cmp_le_u32 s41, 6
  s_cbranch_scc1 L_resc_done_0_0
  v_lshlrev_b32 v1, 16, v160
  v_and_b32 v2, s10, v160
  v_mul_f32 v1, v1, v3
  v_mul_f32 v2, v2, v3
  v_cvt_pk_bf16_f32 v160, v1, v2
  v_lshlrev_b32 v1, 16, v161
  v_and_b32 v2, s10, v161
  v_mul_f32 v1, v1, v3
  v_mul_f32 v2, v2, v3
  v_cvt_pk_bf16_f32 v161, v1, v2
  v_lshlrev_b32 v1, 16, v162
  v_and_b32 v2, s10, v162
  v_mul_f32 v1, v1, v3
  v_mul_f32 v2, v2, v3
  v_cvt_pk_bf16_f32 v162, v1, v2
  v_lshlrev_b32 v1, 16, v163
  v_and_b32 v2, s10, v163
  v_mul_f32 v1, v1, v3
  v_mul_f32 v2, v2, v3
  v_cvt_pk_bf16_f32 v163, v1, v2
  s_cmp_le_u32 s41, 7
  s_cbranch_scc1 L_resc_done_0_0
  v_lshlrev_b32 v1, 16, v184
  v_and_b32 v2, s10, v184
  v_mul_f32 v1, v1, v3
  v_mul_f32 v2, v2, v3
  v_cvt_pk_bf16_f32 v184, v1, v2
  v_lshlrev_b32 v1, 16, v185
  v_and_b32 v2, s10, v185
  v_mul_f32 v1, v1, v3
  v_mul_f32 v2, v2, v3
  v_cvt_pk_bf16_f32 v185, v1, v2
  v_lshlrev_b32 v1, 16, v186
  v_and_b32 v2, s10, v186
  v_mul_f32 v1, v1, v3
  v_mul_f32 v2, v2, v3
  v_cvt_pk_bf16_f32 v186, v1, v2
  v_lshlrev_b32 v1, 16, v187
  v_and_b32 v2, s10, v187
  v_mul_f32 v1, v1, v3
  v_mul_f32 v2, v2, v3
  v_cvt_pk_bf16_f32 v187, v1, v2
  s_cmp_le_u32 s41, 8
  s_cbranch_scc1 L_resc_done_0_0
  v_lshlrev_b32 v1, 16, v208
  v_and_b32 v2, s10, v208
  v_mul_f32 v1, v1, v3
  v_mul_f32 v2, v2, v3
  v_cvt_pk_bf16_f32 v208, v1, v2
  v_lshlrev_b32 v1, 16, v209
  v_and_b32 v2, s10, v209
  v_mul_f32 v1, v1, v3
  v_mul_f32 v2, v2, v3
  v_cvt_pk_bf16_f32 v209, v1, v2
  v_lshlrev_b32 v1, 16, v210
  v_and_b32 v2, s10, v210
  v_mul_f32 v1, v1, v3
  v_mul_f32 v2, v2, v3
  v_cvt_pk_bf16_f32 v210, v1, v2
  v_lshlrev_b32 v1, 16, v211
  v_and_b32 v2, s10, v211
  v_mul_f32 v1, v1, v3
  v_mul_f32 v2, v2, v3
  v_cvt_pk_bf16_f32 v211, v1, v2
  s_cmp_le_u32 s41, 9
  s_cbranch_scc1 L_resc_done_0_0
  v_lshlrev_b32 v1, 16, v232
  v_and_b32 v2, s10, v232
  v_mul_f32 v1, v1, v3
  v_mul_f32 v2, v2, v3
  v_cvt_pk_bf16_f32 v232, v1, v2
  v_lshlrev_b32 v1, 16, v233
  v_and_b32 v2, s10, v233
  v_mul_f32 v1, v1, v3
  v_mul_f32 v2, v2, v3
  v_cvt_pk_bf16_f32 v233, v1, v2
  v_lshlrev_b32 v1, 16, v234
  v_and_b32 v2, s10, v234
  v_mul_f32 v1, v1, v3
  v_mul_f32 v2, v2, v3
  v_cvt_pk_bf16_f32 v234, v1, v2
  v_lshlrev_b32 v1, 16, v235
  v_and_b32 v2, s10, v235
  v_mul_f32 v1, v1, v3
  v_mul_f32 v2, v2, v3
  v_cvt_pk_bf16_f32 v235, v1, v2
L_resc_done_0_0:
  s_setpc_b64 s[42:43]
L_resc_0_1:
  s_cmp_le_u32 s41, 0
  s_cbranch_scc1 L_resc_done_0_1
  v_accvgpr_read_b32 v2, a148
  v_lshlrev_b32 v1, 16, v2
  v_and_b32 v2, s10, v2
  v_mul_f32 v1, v1, v3
  v_mul_f32 v2, v2, v3
  v_cvt_pk_bf16_f32 v1, v1, v2
  v_accvgpr_write_b32 a148, v1
  v_accvgpr_read_b32 v2, a149
  v_lshlrev_b32 v1, 16, v2
  v_and_b32 v2, s10, v2
  v_mul_f32 v1, v1, v3
  v_mul_f32 v2, v2, v3
  v_cvt_pk_bf16_f32 v1, v1, v2
  v_accvgpr_write_b32 a149, v1
  v_accvgpr_read_b32 v2, a150
  v_lshlrev_b32 v1, 16, v2
  v_and_b32 v2, s10, v2
  v_mul_f32 v1, v1, v3
  v_mul_f32 v2, v2, v3
  v_cvt_pk_bf16_f32 v1, v1, v2
  v_accvgpr_write_b32 a150, v1
  v_accvgpr_read_b32 v2, a151
  v_lshlrev_b32 v1, 16, v2
  v_and_b32 v2, s10, v2
  v_mul_f32 v1, v1, v3
  v_mul_f32 v2, v2, v3
  v_cvt_pk_bf16_f32 v1, v1, v2
  v_accvgpr_write_b32 a151, v1
  s_cmp_le_u32 s41, 1
  s_cbranch_scc1 L_resc_done_0_1
  v_accvgpr_read_b32 v2, a172
  v_lshlrev_b32 v1, 16, v2
  v_and_b32 v2, s10, v2
  v_mul_f32 v1, v1, v3
  v_mul_f32 v2, v2, v3
  v_cvt_pk_bf16_f32 v1, v1, v2
  v_accvgpr_write_b32 a172, v1
  v_accvgpr_read_b32 v2, a173
  v_lshlrev_b32 v1, 16, v2
  v_and_b32 v2, s10, v2
  v_mul_f32 v1, v1, v3
  v_mul_f32 v2, v2, v3
  v_cvt_pk_bf16_f32 v1, v1, v2
  v_accvgpr_write_b32 a173, v1
  v_accvgpr_read_b32 v2, a174
  v_lshlrev_b32 v1, 16, v2
  v_and_b32 v2, s10, v2
  v_mul_f32 v1, v1, v3
  v_mul_f32 v2, v2, v3
  v_cvt_pk_bf16_f32 v1, v1, v2
  v_accvgpr_write_b32 a174, v1
  v_accvgpr_read_b32 v2, a175
  v_lshlrev_b32 v1, 16, v2
  v_and_b32 v2, s10, v2
  v_mul_f32 v1, v1, v3
  v_mul_f32 v2, v2, v3
  v_cvt_pk_bf16_f32 v1, v1, v2
  v_accvgpr_write_b32 a175, v1
  s_cmp_le_u32 s41, 2
  s_cbranch_scc1 L_resc_done_0_1
  v_accvgpr_read_b32 v2, a196
  v_lshlrev_b32 v1, 16, v2
  v_and_b32 v2, s10, v2
  v_mul_f32 v1, v1, v3
  v_mul_f32 v2, v2, v3
  v_cvt_pk_bf16_f32 v1, v1, v2
  v_accvgpr_write_b32 a196, v1
  v_accvgpr_read_b32 v2, a197
  v_lshlrev_b32 v1, 16, v2
  v_and_b32 v2, s10, v2
  v_mul_f32 v1, v1, v3
  v_mul_f32 v2, v2, v3
  v_cvt_pk_bf16_f32 v1, v1, v2
  v_accvgpr_write_b32 a197, v1
  v_accvgpr_read_b32 v2, a198
  v_lshlrev_b32 v1, 16, v2
  v_and_b32 v2, s10, v2
  v_mul_f32 v1, v1, v3
  v_mul_f32 v2, v2, v3
  v_cvt_pk_bf16_f32 v1, v1, v2
  v_accvgpr_write_b32 a198, v1
  v_accvgpr_read_b32 v2, a199
  v_lshlrev_b32 v1, 16, v2
  v_and_b32 v2, s10, v2
  v_mul_f32 v1, v1, v3
  v_mul_f32 v2, v2, v3
  v_cvt_pk_bf16_f32 v1, v1, v2
  v_accvgpr_write_b32 a199, v1
  s_cmp_le_u32 s41, 3
  s_cbranch_scc1 L_resc_done_0_1
  v_accvgpr_read_b32 v2, a220
  v_lshlrev_b32 v1, 16, v2
  v_and_b32 v2, s10, v2
  v_mul_f32 v1, v1, v3
  v_mul_f32 v2, v2, v3
  v_cvt_pk_bf16_f32 v1, v1, v2
  v_accvgpr_write_b32 a220, v1
  v_accvgpr_read_b32 v2, a221
  v_lshlrev_b32 v1, 16, v2
  v_and_b32 v2, s10, v2
  v_mul_f32 v1, v1, v3
  v_mul_f32 v2, v2, v3
  v_cvt_pk_bf16_f32 v1, v1, v2
  v_accvgpr_write_b32 a221, v1
  v_accvgpr_read_b32 v2, a222
  v_lshlrev_b32 v1, 16, v2
  v_and_b32 v2, s10, v2
  v_mul_f32 v1, v1, v3
  v_mul_f32 v2, v2, v3
  v_cvt_pk_bf16_f32 v1, v1, v2
  v_accvgpr_write_b32 a222, v1
  v_accvgpr_read_b32 v2, a223
  v_lshlrev_b32 v1, 16, v2
  v_and_b32 v2, s10, v2
  v_mul_f32 v1, v1, v3
  v_mul_f32 v2, v2, v3
  v_cvt_pk_bf16_f32 v1, v1, v2
  v_accvgpr_write_b32 a223, v1
  s_cmp_le_u32 s41, 4
  s_cbranch_scc1 L_resc_done_0_1
  v_lshlrev_b32 v1, 16, v116
  v_and_b32 v2, s10, v116
  v_mul_f32 v1, v1, v3
  v_mul_f32 v2, v2, v3
  v_cvt_pk_bf16_f32 v116, v1, v2
  v_lshlrev_b32 v1, 16, v117
  v_and_b32 v2, s10, v117
  v_mul_f32 v1, v1, v3
  v_mul_f32 v2, v2, v3
  v_cvt_pk_bf16_f32 v117, v1, v2
  v_lshlrev_b32 v1, 16, v118
  v_and_b32 v2, s10, v118
  v_mul_f32 v1, v1, v3
  v_mul_f32 v2, v2, v3
  v_cvt_pk_bf16_f32 v118, v1, v2
  v_lshlrev_b32 v1, 16, v119
  v_and_b32 v2, s10, v119
  v_mul_f32 v1, v1, v3
  v_mul_f32 v2, v2, v3
  v_cvt_pk_bf16_f32 v119, v1, v2
  s_cmp_le_u32 s41, 5
  s_cbranch_scc1 L_resc_done_0_1
  v_lshlrev_b32 v1, 16, v140
  v_and_b32 v2, s10, v140
  v_mul_f32 v1, v1, v3
  v_mul_f32 v2, v2, v3
  v_cvt_pk_bf16_f32 v140, v1, v2
  v_lshlrev_b32 v1, 16, v141
  v_and_b32 v2, s10, v141
  v_mul_f32 v1, v1, v3
  v_mul_f32 v2, v2, v3
  v_cvt_pk_bf16_f32 v141, v1, v2
  v_lshlrev_b32 v1, 16, v142
  v_and_b32 v2, s10, v142
  v_mul_f32 v1, v1, v3
  v_mul_f32 v2, v2, v3
  v_cvt_pk_bf16_f32 v142, v1, v2
  v_lshlrev_b32 v1, 16, v143
  v_and_b32 v2, s10, v143
  v_mul_f32 v1, v1, v3
  v_mul_f32 v2, v2, v3
  v_cvt_pk_bf16_f32 v143, v1, v2
  s_cmp_le_u32 s41, 6
  s_cbranch_scc1 L_resc_done_0_1
  v_lshlrev_b32 v1, 16, v164
  v_and_b32 v2, s10, v164
  v_mul_f32 v1, v1, v3
  v_mul_f32 v2, v2, v3
  v_cvt_pk_bf16_f32 v164, v1, v2
  v_lshlrev_b32 v1, 16, v165
  v_and_b32 v2, s10, v165
  v_mul_f32 v1, v1, v3
  v_mul_f32 v2, v2, v3
  v_cvt_pk_bf16_f32 v165, v1, v2
  v_lshlrev_b32 v1, 16, v166
  v_and_b32 v2, s10, v166
  v_mul_f32 v1, v1, v3
  v_mul_f32 v2, v2, v3
  v_cvt_pk_bf16_f32 v166, v1, v2
  v_lshlrev_b32 v1, 16, v167
  v_and_b32 v2, s10, v167
  v_mul_f32 v1, v1, v3
  v_mul_f32 v2, v2, v3
  v_cvt_pk_bf16_f32 v167, v1, v2
  s_cmp_le_u32 s41, 7
  s_cbranch_scc1 L_resc_done_0_1
  v_lshlrev_b32 v1, 16, v188
  v_and_b32 v2, s10, v188
  v_mul_f32 v1, v1, v3
  v_mul_f32 v2, v2, v3
  v_cvt_pk_bf16_f32 v188, v1, v2
  v_lshlrev_b32 v1, 16, v189
  v_and_b32 v2, s10, v189
  v_mul_f32 v1, v1, v3
  v_mul_f32 v2, v2, v3
  v_cvt_pk_bf16_f32 v189, v1, v2
  v_lshlrev_b32 v1, 16, v190
  v_and_b32 v2, s10, v190
  v_mul_f32 v1, v1, v3
  v_mul_f32 v2, v2, v3
  v_cvt_pk_bf16_f32 v190, v1, v2
  v_lshlrev_b32 v1, 16, v191
  v_and_b32 v2, s10, v191
  v_mul_f32 v1, v1, v3
  v_mul_f32 v2, v2, v3
  v_cvt_pk_bf16_f32 v191, v1, v2
  s_cmp_le_u32 s41, 8
  s_cbranch_scc1 L_resc_done_0_1
  v_lshlrev_b32 v1, 16, v212
  v_and_b32 v2, s10, v212
  v_mul_f32 v1, v1, v3
  v_mul_f32 v2, v2, v3
  v_cvt_pk_bf16_f32 v212, v1, v2
  v_lshlrev_b32 v1, 16, v213
  v_and_b32 v2, s10, v213
  v_mul_f32 v1, v1, v3
  v_mul_f32 v2, v2, v3
  v_cvt_pk_bf16_f32 v213, v1, v2
  v_lshlrev_b32 v1, 16, v214
  v_and_b32 v2, s10, v214
  v_mul_f32 v1, v1, v3
  v_mul_f32 v2, v2, v3
  v_cvt_pk_bf16_f32 v214, v1, v2
  v_lshlrev_b32 v1, 16, v215
  v_and_b32 v2, s10, v215
  v_mul_f32 v1, v1, v3
  v_mul_f32 v2, v2, v3
  v_cvt_pk_bf16_f32 v215, v1, v2
  s_cmp_le_u32 s41, 9
  s_cbranch_scc1 L_resc_done_0_1
  v_lshlrev_b32 v1, 16, v236
  v_and_b32 v2, s10, v236
  v_mul_f32 v1, v1, v3
  v_mul_f32 v2, v2, v3
  v_cvt_pk_bf16_f32 v236, v1, v2
  v_lshlrev_b32 v1, 16, v237
  v_and_b32 v2, s10, v237
  v_mul_f32 v1, v1, v3
  v_mul_f32 v2, v2, v3
  v_cvt_pk_bf16_f32 v237, v1, v2
  v_lshlrev_b32 v1, 16, v238
  v_and_b32 v2, s10, v238
  v_mul_f32 v1, v1, v3
  v_mul_f32 v2, v2, v3
  v_cvt_pk_bf16_f32 v238, v1, v2
  v_lshlrev_b32 v1, 16, v239
  v_and_b32 v2, s10, v239
  v_mul_f32 v1, v1, v3
  v_mul_f32 v2, v2, v3
  v_cvt_pk_bf16_f32 v239, v1, v2
L_resc_done_0_1:
  s_setpc_b64 s[42:43]
L_resc_0_2:
  s_cmp_le_u32 s41, 0
  s_cbranch_scc1 L_resc_done_0_2
  v_accvgpr_read_b32 v2, a152
  v_lshlrev_b32 v1, 16, v2
  v_and_b32 v2, s10, v2
  v_mul_f32 v1, v1, v3
  v_mul_f32 v2, v2, v3
  v_cvt_pk_bf16_f32 v1, v1, v2
  v_accvgpr_write_b32 a152, v1
  v_accvgpr_read_b32 v2, a153
  v_lshlrev_b32 v1, 16, v2
  v_and_b32 v2, s10, v2
  v_mul_f32 v1, v1, v3
  v_mul_f32 v2, v2, v3
  v_cvt_pk_bf16_f32 v1, v1, v2
  v_accvgpr_write_b32 a153, v1
  v_accvgpr_read_b32 v2, a154
  v_lshlrev_b32 v1, 16, v2
  v_and_b32 v2, s10, v2
  v_mul_f32 v1, v1, v3
  v_mul_f32 v2, v2, v3
  v_cvt_pk_bf16_f32 v1, v1, v2
  v_accvgpr_write_b32 a154, v1
  v_accvgpr_read_b32 v2, a155
  v_lshlrev_b32 v1, 16, v2
  v_and_b32 v2, s10, v2
  v_mul_f32 v1, v1, v3
  v_mul_f32 v2, v2, v3
  v_cvt_pk_bf16_f32 v1, v1, v2
  v_accvgpr_write_b32 a155, v1
  s_cmp_le_u32 s41, 1
  s_cbranch_scc1 L_resc_done_0_2
  v_accvgpr_read_b32 v2, a176
  v_lshlrev_b32 v1, 16, v2
  v_and_b32 v2, s10, v2
  v_mul_f32 v1, v1, v3
  v_mul_f32 v2, v2, v3
  v_cvt_pk_bf16_f32 v1, v1, v2
  v_accvgpr_write_b32 a176, v1
  v_accvgpr_read_b32 v2, a177
  v_lshlrev_b32 v1, 16, v2
  v_and_b32 v2, s10, v2
  v_mul_f32 v1, v1, v3
  v_mul_f32 v2, v2, v3
  v_cvt_pk_bf16_f32 v1, v1, v2
  v_accvgpr_write_b32 a177, v1
  v_accvgpr_read_b32 v2, a178
  v_lshlrev_b32 v1, 16, v2
  v_and_b32 v2, s10, v2
  v_mul_f32 v1, v1, v3
  v_mul_f32 v2, v2, v3
  v_cvt_pk_bf16_f32 v1, v1, v2
  v_accvgpr_write_b32 a178, v1
  v_accvgpr_read_b32 v2, a179
  v_lshlrev_b32 v1, 16, v2
  v_and_b32 v2, s10, v2
  v_mul_f32 v1, v1, v3
  v_mul_f32 v2, v2, v3
  v_cvt_pk_bf16_f32 v1, v1, v2
  v_accvgpr_write_b32 a179, v1
  s_cmp_le_u32 s41, 2
  s_cbranch_scc1 L_resc_done_0_2
  v_accvgpr_read_b32 v2, a200
  v_lshlrev_b32 v1, 16, v2
  v_and_b32 v2, s10, v2
  v_mul_f32 v1, v1, v3
  v_mul_f32 v2, v2, v3
  v_cvt_pk_bf16_f32 v1, v1, v2
  v_accvgpr_write_b32 a200, v1
  v_accvgpr_read_b32 v2, a201
  v_lshlrev_b32 v1, 16, v2
  v_and_b32 v2, s10, v2
  v_mul_f32 v1, v1, v3
  v_mul_f32 v2, v2, v3
  v_cvt_pk_bf16_f32 v1, v1, v2
  v_accvgpr_write_b32 a201, v1
  v_accvgpr_read_b32 v2, a202
  v_lshlrev_b32 v1, 16, v2
  v_and_b32 v2, s10, v2
  v_mul_f32 v1, v1, v3
  v_mul_f32 v2, v2, v3
  v_cvt_pk_bf16_f32 v1, v1, v2
  v_accvgpr_write_b32 a202, v1
  v_accvgpr_read_b32 v2, a203
  v_lshlrev_b32 v1, 16, v2
  v_and_b32 v2, s10, v2
  v_mul_f32 v1, v1, v3
  v_mul_f32 v2, v2, v3
  v_cvt_pk_bf16_f32 v1, v1, v2
  v_accvgpr_write_b32 a203, v1
  s_cmp_le_u32 s41, 3
  s_cbranch_scc1 L_resc_done_0_2
  v_accvgpr_read_b32 v2, a224
  v_lshlrev_b32 v1, 16, v2
  v_and_b32 v2, s10, v2
  v_mul_f32 v1, v1, v3
  v_mul_f32 v2, v2, v3
  v_cvt_pk_bf16_f32 v1, v1, v2
  v_accvgpr_write_b32 a224, v1
  v_accvgpr_read_b32 v2, a225
  v_lshlrev_b32 v1, 16, v2
  v_and_b32 v2, s10, v2
  v_mul_f32 v1, v1, v3
  v_mul_f32 v2, v2, v3
  v_cvt_pk_bf16_f32 v1, v1, v2
  v_accvgpr_write_b32 a225, v1
  v_accvgpr_read_b32 v2, a226
  v_lshlrev_b32 v1, 16, v2
  v_and_b32 v2, s10, v2
  v_mul_f32 v1, v1, v3
  v_mul_f32 v2, v2, v3
  v_cvt_pk_bf16_f32 v1, v1, v2
  v_accvgpr_write_b32 a226, v1
  v_accvgpr_read_b32 v2, a227
  v_lshlrev_b32 v1, 16, v2
  v_and_b32 v2, s10, v2
  v_mul_f32 v1, v1, v3
  v_mul_f32 v2, v2, v3
  v_cvt_pk_bf16_f32 v1, v1, v2
  v_accvgpr_write_b32 a227, v1
  s_cmp_le_u32 s41, 4
  s_cbranch_scc1 L_resc_done_0_2
  v_lshlrev_b32 v1, 16, v120
  v_and_b32 v2, s10, v120
  v_mul_f32 v1, v1, v3
  v_mul_f32 v2, v2, v3
  v_cvt_pk_bf16_f32 v120, v1, v2
  v_lshlrev_b32 v1, 16, v121
  v_and_b32 v2, s10, v121
  v_mul_f32 v1, v1, v3
  v_mul_f32 v2, v2, v3
  v_cvt_pk_bf16_f32 v121, v1, v2
  v_lshlrev_b32 v1, 16, v122
  v_and_b32 v2, s10, v122
  v_mul_f32 v1, v1, v3
  v_mul_f32 v2, v2, v3
  v_cvt_pk_bf16_f32 v122, v1, v2
  v_lshlrev_b32 v1, 16, v123
  v_and_b32 v2, s10, v123
  v_mul_f32 v1, v1, v3
  v_mul_f32 v2, v2, v3
  v_cvt_pk_bf16_f32 v123, v1, v2
  s_cmp_le_u32 s41, 5
  s_cbranch_scc1 L_resc_done_0_2
  v_lshlrev_b32 v1, 16, v144
  v_and_b32 v2, s10, v144
  v_mul_f32 v1, v1, v3
  v_mul_f32 v2, v2, v3
  v_cvt_pk_bf16_f32 v144, v1, v2
  v_lshlrev_b32 v1, 16, v145
  v_and_b32 v2, s10, v145
  v_mul_f32 v1, v1, v3
  v_mul_f32 v2, v2, v3
  v_cvt_pk_bf16_f32 v145, v1, v2
  v_lshlrev_b32 v1, 16, v146
  v_and_b32 v2, s10, v146
  v_mul_f32 v1, v1, v3
  v_mul_f32 v2, v2, v3
  v_cvt_pk_bf16_f32 v146, v1, v2
  v_lshlrev_b32 v1, 16, v147
  v_and_b32 v2, s10, v147
  v_mul_f32 v1, v1, v3
  v_mul_f32 v2, v2, v3
  v_cvt_pk_bf16_f32 v147, v1, v2
  s_cmp_le_u32 s41, 6
  s_cbranch_scc1 L_resc_done_0_2
  v_lshlrev_b32 v1, 16, v168
  v_and_b32 v2, s10, v168
  v_mul_f32 v1, v1, v3
  v_mul_f32 v2, v2, v3
  v_cvt_pk_bf16_f32 v168, v1, v2
  v_lshlrev_b32 v1, 16, v169
  v_and_b32 v2, s10, v169
  v_mul_f32 v1, v1, v3
  v_mul_f32 v2, v2, v3
  v_cvt_pk_bf16_f32 v169, v1, v2
  v_lshlrev_b32 v1, 16, v170
  v_and_b32 v2, s10, v170
  v_mul_f32 v1, v1, v3
  v_mul_f32 v2, v2, v3
  v_cvt_pk_bf16_f32 v170, v1, v2
  v_lshlrev_b32 v1, 16, v171
  v_and_b32 v2, s10, v171
  v_mul_f32 v1, v1, v3
  v_mul_f32 v2, v2, v3
  v_cvt_pk_bf16_f32 v171, v1, v2
  s_cmp_le_u32 s41, 7
  s_cbranch_scc1 L_resc_done_0_2
  v_lshlrev_b32 v1, 16, v192
  v_and_b32 v2, s10, v192
  v_mul_f32 v1, v1, v3
  v_mul_f32 v2, v2, v3
  v_cvt_pk_bf16_f32 v192, v1, v2
  v_lshlrev_b32 v1, 16, v193
  v_and_b32 v2, s10, v193
  v_mul_f32 v1, v1, v3
  v_mul_f32 v2, v2, v3
  v_cvt_pk_bf16_f32 v193, v1, v2
  v_lshlrev_b32 v1, 16, v194
  v_and_b32 v2, s10, v194
  v_mul_f32 v1, v1, v3
  v_mul_f32 v2, v2, v3
  v_cvt_pk_bf16_f32 v194, v1, v2
  v_lshlrev_b32 v1, 16, v195
  v_and_b32 v2, s10, v195
  v_mul_f32 v1, v1, v3
  v_mul_f32 v2, v2, v3
  v_cvt_pk_bf16_f32 v195, v1, v2
  s_cmp_le_u32 s41, 8
  s_cbranch_scc1 L_resc_done_0_2
  v_lshlrev_b32 v1, 16, v216
  v_and_b32 v2, s10, v216
  v_mul_f32 v1, v1, v3
  v_mul_f32 v2, v2, v3
  v_cvt_pk_bf16_f32 v216, v1, v2
  v_lshlrev_b32 v1, 16, v217
  v_and_b32 v2, s10, v217
  v_mul_f32 v1, v1, v3
  v_mul_f32 v2, v2, v3
  v_cvt_pk_bf16_f32 v217, v1, v2
  v_lshlrev_b32 v1, 16, v218
  v_and_b32 v2, s10, v218
  v_mul_f32 v1, v1, v3
  v_mul_f32 v2, v2, v3
  v_cvt_pk_bf16_f32 v218, v1, v2
  v_lshlrev_b32 v1, 16, v219
  v_and_b32 v2, s10, v219
  v_mul_f32 v1, v1, v3
  v_mul_f32 v2, v2, v3
  v_cvt_pk_bf16_f32 v219, v1, v2
  s_cmp_le_u32 s41, 9
  s_cbranch_scc1 L_resc_done_0_2
  v_lshlrev_b32 v1, 16, v240
  v_and_b32 v2, s10, v240
  v_mul_f32 v1, v1, v3
  v_mul_f32 v2, v2, v3
  v_cvt_pk_bf16_f32 v240, v1, v2
  v_lshlrev_b32 v1, 16, v241
  v_and_b32 v2, s10, v241
  v_mul_f32 v1, v1, v3
  v_mul_f32 v2, v2, v3
  v_cvt_pk_bf16_f32 v241, v1, v2
  v_lshlrev_b32 v1, 16, v242
  v_and_b32 v2, s10, v242
  v_mul_f32 v1, v1, v3
  v_mul_f32 v2, v2, v3
  v_cvt_pk_bf16_f32 v242, v1, v2
  v_lshlrev_b32 v1, 16, v243
  v_and_b32 v2, s10, v243
  v_mul_f32 v1, v1, v3
  v_mul_f32 v2, v2, v3
  v_cvt_pk_bf16_f32 v243, v1, v2
L_resc_done_0_2:
  s_setpc_b64 s[42:43]
L_resc_0_3:
  s_cmp_le_u32 s41, 0
  s_cbranch_scc1 L_resc_done_0_3
  v_accvgpr_read_b32 v2, a156
  v_lshlrev_b32 v1, 16, v2
  v_and_b32 v2, s10, v2
  v_mul_f32 v1, v1, v3
  v_mul_f32 v2, v2, v3
  v_cvt_pk_bf16_f32 v1, v1, v2
  v_accvgpr_write_b32 a156, v1
  v_accvgpr_read_b32 v2, a157
  v_lshlrev_b32 v1, 16, v2
  v_and_b32 v2, s10, v2
  v_mul_f32 v1, v1, v3
  v_mul_f32 v2, v2, v3
  v_cvt_pk_bf16_f32 v1, v1, v2
  v_accvgpr_write_b32 a157, v1
  v_accvgpr_read_b32 v2, a158
  v_lshlrev_b32 v1, 16, v2
  v_and_b32 v2, s10, v2
  v_mul_f32 v1, v1, v3
  v_mul_f32 v2, v2, v3
  v_cvt_pk_bf16_f32 v1, v1, v2
  v_accvgpr_write_b32 a158, v1
  v_accvgpr_read_b32 v2, a159
  v_lshlrev_b32 v1, 16, v2
  v_and_b32 v2, s10, v2
  v_mul_f32 v1, v1, v3
  v_mul_f32 v2, v2, v3
  v_cvt_pk_bf16_f32 v1, v1, v2
  v_accvgpr_write_b32 a159, v1
  s_cmp_le_u32 s41, 1
  s_cbranch_scc1 L_resc_done_0_3
  v_accvgpr_read_b32 v2, a180
  v_lshlrev_b32 v1, 16, v2
  v_and_b32 v2, s10, v2
  v_mul_f32 v1, v1, v3
  v_mul_f32 v2, v2, v3
  v_cvt_pk_bf16_f32 v1, v1, v2
  v_accvgpr_write_b32 a180, v1
  v_accvgpr_read_b32 v2, a181
  v_lshlrev_b32 v1, 16, v2
  v_and_b32 v2, s10, v2
  v_mul_f32 v1, v1, v3
  v_mul_f32 v2, v2, v3
  v_cvt_pk_bf16_f32 v1, v1, v2
  v_accvgpr_write_b32 a181, v1
  v_accvgpr_read_b32 v2, a182
  v_lshlrev_b32 v1, 16, v2
  v_and_b32 v2, s10, v2
  v_mul_f32 v1, v1, v3
  v_mul_f32 v2, v2, v3
  v_cvt_pk_bf16_f32 v1, v1, v2
  v_accvgpr_write_b32 a182, v1
  v_accvgpr_read_b32 v2, a183
  v_lshlrev_b32 v1, 16, v2
  v_and_b32 v2, s10, v2
  v_mul_f32 v1, v1, v3
  v_mul_f32 v2, v2, v3
  v_cvt_pk_bf16_f32 v1, v1, v2
  v_accvgpr_write_b32 a183, v1
  s_cmp_le_u32 s41, 2
  s_cbranch_scc1 L_resc_done_0_3
  v_accvgpr_read_b32 v2, a204
  v_lshlrev_b32 v1, 16, v2
  v_and_b32 v2, s10, v2
  v_mul_f32 v1, v1, v3
  v_mul_f32 v2, v2, v3
  v_cvt_pk_bf16_f32 v1, v1, v2
  v_accvgpr_write_b32 a204, v1
  v_accvgpr_read_b32 v2, a205
  v_lshlrev_b32 v1, 16, v2
  v_and_b32 v2, s10, v2
  v_mul_f32 v1, v1, v3
  v_mul_f32 v2, v2, v3
  v_cvt_pk_bf16_f32 v1, v1, v2
  v_accvgpr_write_b32 a205, v1
  v_accvgpr_read_b32 v2, a206
  v_lshlrev_b32 v1, 16, v2
  v_and_b32 v2, s10, v2
  v_mul_f32 v1, v1, v3
  v_mul_f32 v2, v2, v3
  v_cvt_pk_bf16_f32 v1, v1, v2
  v_accvgpr_write_b32 a206, v1
  v_accvgpr_read_b32 v2, a207
  v_lshlrev_b32 v1, 16, v2
  v_and_b32 v2, s10, v2
  v_mul_f32 v1, v1, v3
  v_mul_f32 v2, v2, v3
  v_cvt_pk_bf16_f32 v1, v1, v2
  v_accvgpr_write_b32 a207, v1
  s_cmp_le_u32 s41, 3
  s_cbranch_scc1 L_resc_done_0_3
  v_accvgpr_read_b32 v2, a228
  v_lshlrev_b32 v1, 16, v2
  v_and_b32 v2, s10, v2
  v_mul_f32 v1, v1, v3
  v_mul_f32 v2, v2, v3
  v_cvt_pk_bf16_f32 v1, v1, v2
  v_accvgpr_write_b32 a228, v1
  v_accvgpr_read_b32 v2, a229
  v_lshlrev_b32 v1, 16, v2
  v_and_b32 v2, s10, v2
  v_mul_f32 v1, v1, v3
  v_mul_f32 v2, v2, v3
  v_cvt_pk_bf16_f32 v1, v1, v2
  v_accvgpr_write_b32 a229, v1
  v_accvgpr_read_b32 v2, a230
  v_lshlrev_b32 v1, 16, v2
  v_and_b32 v2, s10, v2
  v_mul_f32 v1, v1, v3
  v_mul_f32 v2, v2, v3
  v_cvt_pk_bf16_f32 v1, v1, v2
  v_accvgpr_write_b32 a230, v1
  v_accvgpr_read_b32 v2, a231
  v_lshlrev_b32 v1, 16, v2
  v_and_b32 v2, s10, v2
  v_mul_f32 v1, v1, v3
  v_mul_f32 v2, v2, v3
  v_cvt_pk_bf16_f32 v1, v1, v2
  v_accvgpr_write_b32 a231, v1
  s_cmp_le_u32 s41, 4
  s_cbranch_scc1 L_resc_done_0_3
  v_lshlrev_b32 v1, 16, v124
  v_and_b32 v2, s10, v124
  v_mul_f32 v1, v1, v3
  v_mul_f32 v2, v2, v3
  v_cvt_pk_bf16_f32 v124, v1, v2
  v_lshlrev_b32 v1, 16, v125
  v_and_b32 v2, s10, v125
  v_mul_f32 v1, v1, v3
  v_mul_f32 v2, v2, v3
  v_cvt_pk_bf16_f32 v125, v1, v2
  v_lshlrev_b32 v1, 16, v126
  v_and_b32 v2, s10, v126
  v_mul_f32 v1, v1, v3
  v_mul_f32 v2, v2, v3
  v_cvt_pk_bf16_f32 v126, v1, v2
  v_lshlrev_b32 v1, 16, v127
  v_and_b32 v2, s10, v127
  v_mul_f32 v1, v1, v3
  v_mul_f32 v2, v2, v3
  v_cvt_pk_bf16_f32 v127, v1, v2
  s_cmp_le_u32 s41, 5
  s_cbranch_scc1 L_resc_done_0_3
  v_lshlrev_b32 v1, 16, v148
  v_and_b32 v2, s10, v148
  v_mul_f32 v1, v1, v3
  v_mul_f32 v2, v2, v3
  v_cvt_pk_bf16_f32 v148, v1, v2
  v_lshlrev_b32 v1, 16, v149
  v_and_b32 v2, s10, v149
  v_mul_f32 v1, v1, v3
  v_mul_f32 v2, v2, v3
  v_cvt_pk_bf16_f32 v149, v1, v2
  v_lshlrev_b32 v1, 16, v150
  v_and_b32 v2, s10, v150
  v_mul_f32 v1, v1, v3
  v_mul_f32 v2, v2, v3
  v_cvt_pk_bf16_f32 v150, v1, v2
  v_lshlrev_b32 v1, 16, v151
  v_and_b32 v2, s10, v151
  v_mul_f32 v1, v1, v3
  v_mul_f32 v2, v2, v3
  v_cvt_pk_bf16_f32 v151, v1, v2
  s_cmp_le_u32 s41, 6
  s_cbranch_scc1 L_resc_done_0_3
  v_lshlrev_b32 v1, 16, v172
  v_and_b32 v2, s10, v172
  v_mul_f32 v1, v1, v3
  v_mul_f32 v2, v2, v3
  v_cvt_pk_bf16_f32 v172, v1, v2
  v_lshlrev_b32 v1, 16, v173
  v_and_b32 v2, s10, v173
  v_mul_f32 v1, v1, v3
  v_mul_f32 v2, v2, v3
  v_cvt_pk_bf16_f32 v173, v1, v2
  v_lshlrev_b32 v1, 16, v174
  v_and_b32 v2, s10, v174
  v_mul_f32 v1, v1, v3
  v_mul_f32 v2, v2, v3
  v_cvt_pk_bf16_f32 v174, v1, v2
  v_lshlrev_b32 v1, 16, v175
  v_and_b32 v2, s10, v175
  v_mul_f32 v1, v1, v3
  v_mul_f32 v2, v2, v3
  v_cvt_pk_bf16_f32 v175, v1, v2
  s_cmp_le_u32 s41, 7
  s_cbranch_scc1 L_resc_done_0_3
  v_lshlrev_b32 v1, 16, v196
  v_and_b32 v2, s10, v196
  v_mul_f32 v1, v1, v3
  v_mul_f32 v2, v2, v3
  v_cvt_pk_bf16_f32 v196, v1, v2
  v_lshlrev_b32 v1, 16, v197
  v_and_b32 v2, s10, v197
  v_mul_f32 v1, v1, v3
  v_mul_f32 v2, v2, v3
  v_cvt_pk_bf16_f32 v197, v1, v2
  v_lshlrev_b32 v1, 16, v198
  v_and_b32 v2, s10, v198
  v_mul_f32 v1, v1, v3
  v_mul_f32 v2, v2, v3
  v_cvt_pk_bf16_f32 v198, v1, v2
  v_lshlrev_b32 v1, 16, v199
  v_and_b32 v2, s10, v199
  v_mul_f32 v1, v1, v3
  v_mul_f32 v2, v2, v3
  v_cvt_pk_bf16_f32 v199, v1, v2
  s_cmp_le_u32 s41, 8
  s_cbranch_scc1 L_resc_done_0_3
  v_lshlrev_b32 v1, 16, v220
  v_and_b32 v2, s10, v220
  v_mul_f32 v1, v1, v3
  v_mul_f32 v2, v2, v3
  v_cvt_pk_bf16_f32 v220, v1, v2
  v_lshlrev_b32 v1, 16, v221
  v_and_b32 v2, s10, v221
  v_mul_f32 v1, v1, v3
  v_mul_f32 v2, v2, v3
  v_cvt_pk_bf16_f32 v221, v1, v2
  v_lshlrev_b32 v1, 16, v222
  v_and_b32 v2, s10, v222
  v_mul_f32 v1, v1, v3
  v_mul_f32 v2, v2, v3
  v_cvt_pk_bf16_f32 v222, v1, v2
  v_lshlrev_b32 v1, 16, v223
  v_and_b32 v2, s10, v223
  v_mul_f32 v1, v1, v3
  v_mul_f32 v2, v2, v3
  v_cvt_pk_bf16_f32 v223, v1, v2
  s_cmp_le_u32 s41, 9
  s_cbranch_scc1 L_resc_done_0_3
  v_lshlrev_b32 v1, 16, v244
  v_and_b32 v2, s10, v244
  v_mul_f32 v1, v1, v3
  v_mul_f32 v2, v2, v3
  v_cvt_pk_bf16_f32 v244, v1, v2
  v_lshlrev_b32 v1, 16, v245
  v_and_b32 v2, s10, v245
  v_mul_f32 v1, v1, v3
  v_mul_f32 v2, v2, v3
  v_cvt_pk_bf16_f32 v245, v1, v2
  v_lshlrev_b32 v1, 16, v246
  v_and_b32 v2, s10, v246
  v_mul_f32 v1, v1, v3
  v_mul_f32 v2, v2, v3
  v_cvt_pk_bf16_f32 v246, v1, v2
  v_lshlrev_b32 v1, 16, v247
  v_and_b32 v2, s10, v247
  v_mul_f32 v1, v1, v3
  v_mul_f32 v2, v2, v3
  v_cvt_pk_bf16_f32 v247, v1, v2
L_resc_done_0_3:
  s_setpc_b64 s[42:43]
L_resc_0_4:
  s_cmp_le_u32 s41, 0
  s_cbranch_scc1 L_resc_done_0_4
  v_accvgpr_read_b32 v2, a160
  v_lshlrev_b32 v1, 16, v2
  v_and_b32 v2, s10, v2
  v_mul_f32 v1, v1, v3
  v_mul_f32 v2, v2, v3
  v_cvt_pk_bf16_f32 v1, v1, v2
  v_accvgpr_write_b32 a160, v1
  v_accvgpr_read_b32 v2, a161
  v_lshlrev_b32 v1, 16, v2
  v_and_b32 v2, s10, v2
  v_mul_f32 v1, v1, v3
  v_mul_f32 v2, v2, v3
  v_cvt_pk_bf16_f32 v1, v1, v2
  v_accvgpr_write_b32 a161, v1
  v_accvgpr_read_b32 v2, a162
  v_lshlrev_b32 v1, 16, v2
  v_and_b32 v2, s10, v2
  v_mul_f32 v1, v1, v3
  v_mul_f32 v2, v2, v3
  v_cvt_pk_bf16_f32 v1, v1, v2
  v_accvgpr_write_b32 a162, v1
  v_accvgpr_read_b32 v2, a163
  v_lshlrev_b32 v1, 16, v2
  v_and_b32 v2, s10, v2
  v_mul_f32 v1, v1, v3
  v_mul_f32 v2, v2, v3
  v_cvt_pk_bf16_f32 v1, v1, v2
  v_accvgpr_write_b32 a163, v1
  s_cmp_le_u32 s41, 1
  s_cbranch_scc1 L_resc_done_0_4
  v_accvgpr_read_b32 v2, a184
  v_lshlrev_b32 v1, 16, v2
  v_and_b32 v2, s10, v2
  v_mul_f32 v1, v1, v3
  v_mul_f32 v2, v2, v3
  v_cvt_pk_bf16_f32 v1, v1, v2
  v_accvgpr_write_b32 a184, v1
  v_accvgpr_read_b32 v2, a185
  v_lshlrev_b32 v1, 16, v2
  v_and_b32 v2, s10, v2
  v_mul_f32 v1, v1, v3
  v_mul_f32 v2, v2, v3
  v_cvt_pk_bf16_f32 v1, v1, v2
  v_accvgpr_write_b32 a185, v1
  v_accvgpr_read_b32 v2, a186
  v_lshlrev_b32 v1, 16, v2
  v_and_b32 v2, s10, v2
  v_mul_f32 v1, v1, v3
  v_mul_f32 v2, v2, v3
  v_cvt_pk_bf16_f32 v1, v1, v2
  v_accvgpr_write_b32 a186, v1
  v_accvgpr_read_b32 v2, a187
  v_lshlrev_b32 v1, 16, v2
  v_and_b32 v2, s10, v2
  v_mul_f32 v1, v1, v3
  v_mul_f32 v2, v2, v3
  v_cvt_pk_bf16_f32 v1, v1, v2
  v_accvgpr_write_b32 a187, v1
  s_cmp_le_u32 s41, 2
  s_cbranch_scc1 L_resc_done_0_4
  v_accvgpr_read_b32 v2, a208
  v_lshlrev_b32 v1, 16, v2
  v_and_b32 v2, s10, v2
  v_mul_f32 v1, v1, v3
  v_mul_f32 v2, v2, v3
  v_cvt_pk_bf16_f32 v1, v1, v2
  v_accvgpr_write_b32 a208, v1
  v_accvgpr_read_b32 v2, a209
  v_lshlrev_b32 v1, 16, v2
  v_and_b32 v2, s10, v2
  v_mul_f32 v1, v1, v3
  v_mul_f32 v2, v2, v3
  v_cvt_pk_bf16_f32 v1, v1, v2
  v_accvgpr_write_b32 a209, v1
  v_accvgpr_read_b32 v2, a210
  v_lshlrev_b32 v1, 16, v2
  v_and_b32 v2, s10, v2
  v_mul_f32 v1, v1, v3
  v_mul_f32 v2, v2, v3
  v_cvt_pk_bf16_f32 v1, v1, v2
  v_accvgpr_write_b32 a210, v1
  v_accvgpr_read_b32 v2, a211
  v_lshlrev_b32 v1, 16, v2
  v_and_b32 v2, s10, v2
  v_mul_f32 v1, v1, v3
  v_mul_f32 v2, v2, v3
  v_cvt_pk_bf16_f32 v1, v1, v2
  v_accvgpr_write_b32 a211, v1
  s_cmp_le_u32 s41, 3
  s_cbranch_scc1 L_resc_done_0_4
  v_accvgpr_read_b32 v2, a232
  v_lshlrev_b32 v1, 16, v2
  v_and_b32 v2, s10, v2
  v_mul_f32 v1, v1, v3
  v_mul_f32 v2, v2, v3
  v_cvt_pk_bf16_f32 v1, v1, v2
  v_accvgpr_write_b32 a232, v1
  v_accvgpr_read_b32 v2, a233
  v_lshlrev_b32 v1, 16, v2
  v_and_b32 v2, s10, v2
  v_mul_f32 v1, v1, v3
  v_mul_f32 v2, v2, v3
  v_cvt_pk_bf16_f32 v1, v1, v2
  v_accvgpr_write_b32 a233, v1
  v_accvgpr_read_b32 v2, a234
  v_lshlrev_b32 v1, 16, v2
  v_and_b32 v2, s10, v2
  v_mul_f32 v1, v1, v3
  v_mul_f32 v2, v2, v3
  v_cvt_pk_bf16_f32 v1, v1, v2
  v_accvgpr_write_b32 a234, v1
  v_accvgpr_read_b32 v2, a235
  v_lshlrev_b32 v1, 16, v2
  v_and_b32 v2, s10, v2
  v_mul_f32 v1, v1, v3
  v_mul_f32 v2, v2, v3
  v_cvt_pk_bf16_f32 v1, v1, v2
  v_accvgpr_write_b32 a235, v1
  s_cmp_le_u32 s41, 4
  s_cbranch_scc1 L_resc_done_0_4
  v_lshlrev_b32 v1, 16, v128
  v_and_b32 v2, s10, v128
  v_mul_f32 v1, v1, v3
  v_mul_f32 v2, v2, v3
  v_cvt_pk_bf16_f32 v128, v1, v2
  v_lshlrev_b32 v1, 16, v129
  v_and_b32 v2, s10, v129
  v_mul_f32 v1, v1, v3
  v_mul_f32 v2, v2, v3
  v_cvt_pk_bf16_f32 v129, v1, v2
  v_lshlrev_b32 v1, 16, v130
  v_and_b32 v2, s10, v130
  v_mul_f32 v1, v1, v3
  v_mul_f32 v2, v2, v3
  v_cvt_pk_bf16_f32 v130, v1, v2
  v_lshlrev_b32 v1, 16, v131
  v_and_b32 v2, s10, v131
  v_mul_f32 v1, v1, v3
  v_mul_f32 v2, v2, v3
  v_cvt_pk_bf16_f32 v131, v1, v2
  s_cmp_le_u32 s41, 5
  s_cbranch_scc1 L_resc_done_0_4
  v_lshlrev_b32 v1, 16, v152
  v_and_b32 v2, s10, v152
  v_mul_f32 v1, v1, v3
  v_mul_f32 v2, v2, v3
  v_cvt_pk_bf16_f32 v152, v1, v2
  v_lshlrev_b32 v1, 16, v153
  v_and_b32 v2, s10, v153
  v_mul_f32 v1, v1, v3
  v_mul_f32 v2, v2, v3
  v_cvt_pk_bf16_f32 v153, v1, v2
  v_lshlrev_b32 v1, 16, v154
  v_and_b32 v2, s10, v154
  v_mul_f32 v1, v1, v3
  v_mul_f32 v2, v2, v3
  v_cvt_pk_bf16_f32 v154, v1, v2
  v_lshlrev_b32 v1, 16, v155
  v_and_b32 v2, s10, v155
  v_mul_f32 v1, v1, v3
  v_mul_f32 v2, v2, v3
  v_cvt_pk_bf16_f32 v155, v1, v2
  s_cmp_le_u32 s41, 6
  s_cbranch_scc1 L_resc_done_0_4
  v_lshlrev_b32 v1, 16, v176
  v_and_b32 v2, s10, v176
  v_mul_f32 v1, v1, v3
  v_mul_f32 v2, v2, v3
  v_cvt_pk_bf16_f32 v176, v1, v2
  v_lshlrev_b32 v1, 16, v177
  v_and_b32 v2, s10, v177
  v_mul_f32 v1, v1, v3
  v_mul_f32 v2, v2, v3
  v_cvt_pk_bf16_f32 v177, v1, v2
  v_lshlrev_b32 v1, 16, v178
  v_and_b32 v2, s10, v178
  v_mul_f32 v1, v1, v3
  v_mul_f32 v2, v2, v3
  v_cvt_pk_bf16_f32 v178, v1, v2
  v_lshlrev_b32 v1, 16, v179
  v_and_b32 v2, s10, v179
  v_mul_f32 v1, v1, v3
  v_mul_f32 v2, v2, v3
  v_cvt_pk_bf16_f32 v179, v1, v2
  s_cmp_le_u32 s41, 7
  s_cbranch_scc1 L_resc_done_0_4
  v_lshlrev_b32 v1, 16, v200
  v_and_b32 v2, s10, v200
  v_mul_f32 v1, v1, v3
  v_mul_f32 v2, v2, v3
  v_cvt_pk_bf16_f32 v200, v1, v2
  v_lshlrev_b32 v1, 16, v201
  v_and_b32 v2, s10, v201
  v_mul_f32 v1, v1, v3
  v_mul_f32 v2, v2, v3
  v_cvt_pk_bf16_f32 v201, v1, v2
  v_lshlrev_b32 v1, 16, v202
  v_and_b32 v2, s10, v202
  v_mul_f32 v1, v1, v3
  v_mul_f32 v2, v2, v3
  v_cvt_pk_bf16_f32 v202, v1, v2
  v_lshlrev_b32 v1, 16, v203
  v_and_b32 v2, s10, v203
  v_mul_f32 v1, v1, v3
  v_mul_f32 v2, v2, v3
  v_cvt_pk_bf16_f32 v203, v1, v2
  s_cmp_le_u32 s41, 8
  s_cbranch_scc1 L_resc_done_0_4
  v_lshlrev_b32 v1, 16, v224
  v_and_b32 v2, s10, v224
  v_mul_f32 v1, v1, v3
  v_mul_f32 v2, v2, v3
  v_cvt_pk_bf16_f32 v224, v1, v2
  v_lshlrev_b32 v1, 16, v225
  v_and_b32 v2, s10, v225
  v_mul_f32 v1, v1, v3
  v_mul_f32 v2, v2, v3
  v_cvt_pk_bf16_f32 v225, v1, v2
  v_lshlrev_b32 v1, 16, v226
  v_and_b32 v2, s10, v226
  v_mul_f32 v1, v1, v3
  v_mul_f32 v2, v2, v3
  v_cvt_pk_bf16_f32 v226, v1, v2
  v_lshlrev_b32 v1, 16, v227
  v_and_b32 v2, s10, v227
  v_mul_f32 v1, v1, v3
  v_mul_f32 v2, v2, v3
  v_cvt_pk_bf16_f32 v227, v1, v2
  s_cmp_le_u32 s41, 9
  s_cbranch_scc1 L_resc_done_0_4
  v_lshlrev_b32 v1, 16, v248
  v_and_b32 v2, s10, v248
  v_mul_f32 v1, v1, v3
  v_mul_f32 v2, v2, v3
  v_cvt_pk_bf16_f32 v248, v1, v2
  v_lshlrev_b32 v1, 16, v249
  v_and_b32 v2, s10, v249
  v_mul_f32 v1, v1, v3
  v_mul_f32 v2, v2, v3
  v_cvt_pk_bf16_f32 v249, v1, v2
  v_lshlrev_b32 v1, 16, v250
  v_and_b32 v2, s10, v250
  v_mul_f32 v1, v1, v3
  v_mul_f32 v2, v2, v3
  v_cvt_pk_bf16_f32 v250, v1, v2
  v_lshlrev_b32 v1, 16, v251
  v_and_b32 v2, s10, v251
  v_mul_f32 v1, v1, v3
  v_mul_f32 v2, v2, v3
  v_cvt_pk_bf16_f32 v251, v1, v2
L_resc_done_0_4:
  s_setpc_b64 s[42:43]
L_resc_0_5:
  s_cmp_le_u32 s41, 0
  s_cbranch_scc1 L_resc_done_0_5
  v_accvgpr_read_b32 v2, a164
  v_lshlrev_b32 v1, 16, v2
  v_and_b32 v2, s10, v2
  v_mul_f32 v1, v1, v3
  v_mul_f32 v2, v2, v3
  v_cvt_pk_bf16_f32 v1, v1, v2
  v_accvgpr_write_b32 a164, v1
  v_accvgpr_read_b32 v2, a165
  v_lshlrev_b32 v1, 16, v2
  v_and_b32 v2, s10, v2
  v_mul_f32 v1, v1, v3
  v_mul_f32 v2, v2, v3
  v_cvt_pk_bf16_f32 v1, v1, v2
  v_accvgpr_write_b32 a165, v1
  v_accvgpr_read_b32 v2, a166
  v_lshlrev_b32 v1, 16, v2
  v_and_b32 v2, s10, v2
  v_mul_f32 v1, v1, v3
  v_mul_f32 v2, v2, v3
  v_cvt_pk_bf16_f32 v1, v1, v2
  v_accvgpr_write_b32 a166, v1
  v_accvgpr_read_b32 v2, a167
  v_lshlrev_b32 v1, 16, v2
  v_and_b32 v2, s10, v2
  v_mul_f32 v1, v1, v3
  v_mul_f32 v2, v2, v3
  v_cvt_pk_bf16_f32 v1, v1, v2
  v_accvgpr_write_b32 a167, v1
  s_cmp_le_u32 s41, 1
  s_cbranch_scc1 L_resc_done_0_5
  v_accvgpr_read_b32 v2, a188
  v_lshlrev_b32 v1, 16, v2
  v_and_b32 v2, s10, v2
  v_mul_f32 v1, v1, v3
  v_mul_f32 v2, v2, v3
  v_cvt_pk_bf16_f32 v1, v1, v2
  v_accvgpr_write_b32 a188, v1
  v_accvgpr_read_b32 v2, a189
  v_lshlrev_b32 v1, 16, v2
  v_and_b32 v2, s10, v2
  v_mul_f32 v1, v1, v3
  v_mul_f32 v2, v2, v3
  v_cvt_pk_bf16_f32 v1, v1, v2
  v_accvgpr_write_b32 a189, v1
  v_accvgpr_read_b32 v2, a190
  v_lshlrev_b32 v1, 16, v2
  v_and_b32 v2, s10, v2
  v_mul_f32 v1, v1, v3
  v_mul_f32 v2, v2, v3
  v_cvt_pk_bf16_f32 v1, v1, v2
  v_accvgpr_write_b32 a190, v1
  v_accvgpr_read_b32 v2, a191
  v_lshlrev_b32 v1, 16, v2
  v_and_b32 v2, s10, v2
  v_mul_f32 v1, v1, v3
  v_mul_f32 v2, v2, v3
  v_cvt_pk_bf16_f32 v1, v1, v2
  v_accvgpr_write_b32 a191, v1
  s_cmp_le_u32 s41, 2
  s_cbranch_scc1 L_resc_done_0_5
  v_accvgpr_read_b32 v2, a212
  v_lshlrev_b32 v1, 16, v2
  v_and_b32 v2, s10, v2
  v_mul_f32 v1, v1, v3
  v_mul_f32 v2, v2, v3
  v_cvt_pk_bf16_f32 v1, v1, v2
  v_accvgpr_write_b32 a212, v1
  v_accvgpr_read_b32 v2, a213
  v_lshlrev_b32 v1, 16, v2
  v_and_b32 v2, s10, v2
  v_mul_f32 v1, v1, v3
  v_mul_f32 v2, v2, v3
  v_cvt_pk_bf16_f32 v1, v1, v2
  v_accvgpr_write_b32 a213, v1
  v_accvgpr_read_b32 v2, a214
  v_lshlrev_b32 v1, 16, v2
  v_and_b32 v2, s10, v2
  v_mul_f32 v1, v1, v3
  v_mul_f32 v2, v2, v3
  v_cvt_pk_bf16_f32 v1, v1, v2
  v_accvgpr_write_b32 a214, v1
  v_accvgpr_read_b32 v2, a215
  v_lshlrev_b32 v1, 16, v2
  v_and_b32 v2, s10, v2
  v_mul_f32 v1, v1, v3
  v_mul_f32 v2, v2, v3
  v_cvt_pk_bf16_f32 v1, v1, v2
  v_accvgpr_write_b32 a215, v1
  s_cmp_le_u32 s41, 3
  s_cbranch_scc1 L_resc_done_0_5
  v_accvgpr_read_b32 v2, a236
  v_lshlrev_b32 v1, 16, v2
  v_and_b32 v2, s10, v2
  v_mul_f32 v1, v1, v3
  v_mul_f32 v2, v2, v3
  v_cvt_pk_bf16_f32 v1, v1, v2
  v_accvgpr_write_b32 a236, v1
  v_accvgpr_read_b32 v2, a237
  v_lshlrev_b32 v1, 16, v2
  v_and_b32 v2, s10, v2
  v_mul_f32 v1, v1, v3
  v_mul_f32 v2, v2, v3
  v_cvt_pk_bf16_f32 v1, v1, v2
  v_accvgpr_write_b32 a237, v1
  v_accvgpr_read_b32 v2, a238
  v_lshlrev_b32 v1, 16, v2
  v_and_b32 v2, s10, v2
  v_mul_f32 v1, v1, v3
  v_mul_f32 v2, v2, v3
  v_cvt_pk_bf16_f32 v1, v1, v2
  v_accvgpr_write_b32 a238, v1
  v_accvgpr_read_b32 v2, a239
  v_lshlrev_b32 v1, 16, v2
  v_and_b32 v2, s10, v2
  v_mul_f32 v1, v1, v3
  v_mul_f32 v2, v2, v3
  v_cvt_pk_bf16_f32 v1, v1, v2
  v_accvgpr_write_b32 a239, v1
  s_cmp_le_u32 s41, 4
  s_cbranch_scc1 L_resc_done_0_5
  v_lshlrev_b32 v1, 16, v132
  v_and_b32 v2, s10, v132
  v_mul_f32 v1, v1, v3
  v_mul_f32 v2, v2, v3
  v_cvt_pk_bf16_f32 v132, v1, v2
  v_lshlrev_b32 v1, 16, v133
  v_and_b32 v2, s10, v133
  v_mul_f32 v1, v1, v3
  v_mul_f32 v2, v2, v3
  v_cvt_pk_bf16_f32 v133, v1, v2
  v_lshlrev_b32 v1, 16, v134
  v_and_b32 v2, s10, v134
  v_mul_f32 v1, v1, v3
  v_mul_f32 v2, v2, v3
  v_cvt_pk_bf16_f32 v134, v1, v2
  v_lshlrev_b32 v1, 16, v135
  v_and_b32 v2, s10, v135
  v_mul_f32 v1, v1, v3
  v_mul_f32 v2, v2, v3
  v_cvt_pk_bf16_f32 v135, v1, v2
  s_cmp_le_u32 s41, 5
  s_cbranch_scc1 L_resc_done_0_5
  v_lshlrev_b32 v1, 16, v156
  v_and_b32 v2, s10, v156
  v_mul_f32 v1, v1, v3
  v_mul_f32 v2, v2, v3
  v_cvt_pk_bf16_f32 v156, v1, v2
  v_lshlrev_b32 v1, 16, v157
  v_and_b32 v2, s10, v157
  v_mul_f32 v1, v1, v3
  v_mul_f32 v2, v2, v3
  v_cvt_pk_bf16_f32 v157, v1, v2
  v_lshlrev_b32 v1, 16, v158
  v_and_b32 v2, s10, v158
  v_mul_f32 v1, v1, v3
  v_mul_f32 v2, v2, v3
  v_cvt_pk_bf16_f32 v158, v1, v2
  v_lshlrev_b32 v1, 16, v159
  v_and_b32 v2, s10, v159
  v_mul_f32 v1, v1, v3
  v_mul_f32 v2, v2, v3
  v_cvt_pk_bf16_f32 v159, v1, v2
  s_cmp_le_u32 s41, 6
  s_cbranch_scc1 L_resc_done_0_5
  v_lshlrev_b32 v1, 16, v180
  v_and_b32 v2, s10, v180
  v_mul_f32 v1, v1, v3
  v_mul_f32 v2, v2, v3
  v_cvt_pk_bf16_f32 v180, v1, v2
  v_lshlrev_b32 v1, 16, v181
  v_and_b32 v2, s10, v181
  v_mul_f32 v1, v1, v3
  v_mul_f32 v2, v2, v3
  v_cvt_pk_bf16_f32 v181, v1, v2
  v_lshlrev_b32 v1, 16, v182
  v_and_b32 v2, s10, v182
  v_mul_f32 v1, v1, v3
  v_mul_f32 v2, v2, v3
  v_cvt_pk_bf16_f32 v182, v1, v2
  v_lshlrev_b32 v1, 16, v183
  v_and_b32 v2, s10, v183
  v_mul_f32 v1, v1, v3
  v_mul_f32 v2, v2, v3
  v_cvt_pk_bf16_f32 v183, v1, v2
  s_cmp_le_u32 s41, 7
  s_cbranch_scc1 L_resc_done_0_5
  v_lshlrev_b32 v1, 16, v204
  v_and_b32 v2, s10, v204
  v_mul_f32 v1, v1, v3
  v_mul_f32 v2, v2, v3
  v_cvt_pk_bf16_f32 v204, v1, v2
  v_lshlrev_b32 v1, 16, v205
  v_and_b32 v2, s10, v205
  v_mul_f32 v1, v1, v3
  v_mul_f32 v2, v2, v3
  v_cvt_pk_bf16_f32 v205, v1, v2
  v_lshlrev_b32 v1, 16, v206
  v_and_b32 v2, s10, v206
  v_mul_f32 v1, v1, v3
  v_mul_f32 v2, v2, v3
  v_cvt_pk_bf16_f32 v206, v1, v2
  v_lshlrev_b32 v1, 16, v207
  v_and_b32 v2, s10, v207
  v_mul_f32 v1, v1, v3
  v_mul_f32 v2, v2, v3
  v_cvt_pk_bf16_f32 v207, v1, v2
  s_cmp_le_u32 s41, 8
  s_cbranch_scc1 L_resc_done_0_5
  v_lshlrev_b32 v1, 16, v228
  v_and_b32 v2, s10, v228
  v_mul_f32 v1, v1, v3
  v_mul_f32 v2, v2, v3
  v_cvt_pk_bf16_f32 v228, v1, v2
  v_lshlrev_b32 v1, 16, v229
  v_and_b32 v2, s10, v229
  v_mul_f32 v1, v1, v3
  v_mul_f32 v2, v2, v3
  v_cvt_pk_bf16_f32 v229, v1, v2
  v_lshlrev_b32 v1, 16, v230
  v_and_b32 v2, s10, v230
  v_mul_f32 v1, v1, v3
  v_mul_f32 v2, v2, v3
  v_cvt_pk_bf16_f32 v230, v1, v2
  v_lshlrev_b32 v1, 16, v231
  v_and_b32 v2, s10, v231
  v_mul_f32 v1, v1, v3
  v_mul_f32 v2, v2, v3
  v_cvt_pk_bf16_f32 v231, v1, v2
  s_cmp_le_u32 s41, 9
  s_cbranch_scc1 L_resc_done_0_5
  v_lshlrev_b32 v1, 16, v252
  v_and_b32 v2, s10, v252
  v_mul_f32 v1, v1, v3
  v_mul_f32 v2, v2, v3
  v_cvt_pk_bf16_f32 v252, v1, v2
  v_lshlrev_b32 v1, 16, v253
  v_and_b32 v2, s10, v253
  v_mul_f32 v1, v1, v3
  v_mul_f32 v2, v2, v3
  v_cvt_pk_bf16_f32 v253, v1, v2
  v_lshlrev_b32 v1, 16, v254
  v_and_b32 v2, s10, v254
  v_mul_f32 v1, v1, v3
  v_mul_f32 v2, v2, v3
  v_cvt_pk_bf16_f32 v254, v1, v2
  v_lshlrev_b32 v1, 16, v255
  v_and_b32 v2, s10, v255
  v_mul_f32 v1, v1, v3
  v_mul_f32 v2, v2, v3
  v_cvt_pk_bf16_f32 v255, v1, v2
L_resc_done_0_5:
  s_setpc_b64 s[42:43]
L_slow_1_1:
  s_movk_i32 s41, 1
  s_call_b64 s[44:45], L_slowsub_1_1
  s_branch L_back_1_1
L_slow_1_2:
  s_movk_i32 s41, 2
  s_call_b64 s[44:45], L_slowsub_1_0
  s_branch L_back_1_2
L_slow_1_3:
  s_movk_i32 s41, 3
  s_call_b64 s[44:45], L_slowsub_1_1
  s_branch L_back_1_3
L_slow_1_4:
  s_movk_i32 s41, 4
  s_call_b64 s[44:45], L_slowsub_1_0
  s_branch L_back_1_4
L_slow_1_5:
  s_movk_i32 s41, 5
  s_call_b64 s[44:45], L_slowsub_1_1
  s_branch L_back_1_5
L_slow_1_6:
  s_movk_i32 s41, 6
  s_call_b64 s[44:45], L_slowsub_1_0
  s_branch L_back_1_6
L_slow_1_7:
  s_movk_i32 s41, 7
  s_call_b64 s[44:45], L_slowsub_1_1
  s_branch L_back_1_7
L_slow_1_8:
  s_movk_i32 s41, 8
  s_call_b64 s[44:45], L_slowsub_1_0
  s_branch L_back_1_8
L_slow_1_9:
  s_movk_i32 s41, 9
  s_call_b64 s[44:45], L_slowsub_1_1
  s_branch L_back_1_9
L_slow_1_10:
  s_movk_i32 s41, 10
  s_call_b64 s[44:45], L_slowsub_1_0
  s_branch L_back_1_10
L_slow_1_11:
  s_movk_i32 s41, 10
  s_call_b64 s[44:45], L_slowsub_1_2
  s_branch L_back_1_11
L_slowsub_1_0:
  s_nop 15
  s_mov_b32 s10, 0xffff0000
  v_max3_f32 v3, v16, v17, v18
  v_max3_f32 v3, v3, v19, v20
  v_max3_f32 v3, v3, v21, v22
  v_max_f32 v3, v3, v23
  v_mov_b32 v1, v3
  s_nop 1
  v_permlane32_swap_b32 v3, v1
  v_max_f32 v3, v3, v1
  v_mov_b32 v1, v3
  s_nop 1
  v_permlane16_swap_b32 v3, v1
  v_max_f32 v3, v3, v1
  v_ceil_f32 v3, v3
  v_max_f32 v3, 0, v3
  v_add_f32 v4, v4, v3
  v_sub_f32 v16, v16, v3
  v_sub_f32 v17, v17, v3
  v_sub_f32 v18, v18, v3
  v_sub_f32 v19, v19, v3
  v_sub_f32 v20, v20, v3
  v_sub_f32 v21, v21, v3
  v_sub_f32 v22, v22, v3
  v_sub_f32 v23, v23, v3
  v_min_f32 v3, 0x43800000, v3
  v_cvt_i32_f32 v3, v3
  v_sub_u32 v3, 0, v3
  v_ldexp_f32 v3, 1.0, v3
  s_call_b64 s[42:43], L_resc_1_0
  v_max3_f32 v3, v24, v25, v26
  v_max3_f32 v3, v3, v27, v28
  v_max3_f32 v3, v3, v29, v30
  v_max_f32 v3, v3, v31
  v_mov_b32 v1, v3
  s_nop 1
  v_permlane32_swap_b32 v3, v1
  v_max_f32 v3, v3, v1
  v_mov_b32 v1, v3
  s_nop 1
  v_permlane16_swap_b32 v3, v1
  v_max_f32 v3, v3, v1
  v_ceil_f32 v3, v3
  v_max_f32 v3, 0, v3
  v_add_f32 v5, v5, v3
  v_sub_f32 v24, v24, v3
  v_sub_f32 v25, v25, v3
  v_sub_f32 v26, v26, v3
  v_sub_f32 v27, v27, v3
  v_sub_f32 v28, v28, v3
  v_sub_f32 v29, v29, v3
  v_sub_f32 v30, v30, v3
  v_sub_f32 v31, v31, v3
  v_min_f32 v3, 0x43800000, v3
  v_cvt_i32_f32 v3, v3
  v_sub_u32 v3, 0, v3
  v_ldexp_f32 v3, 1.0, v3
  s_call_b64 s[42:43], L_resc_1_1
  v_max3_f32 v3, v32, v33, v34
  v_max3_f32 v3, v3, v35, v36
  v_max3_f32 v3, v3, v37, v38
  v_max_f32 v3, v3, v39
  v_mov_b32 v1, v3
  s_nop 1
  v_permlane32_swap_b32 v3, v1
  v_max_f32 v3, v3, v1
  v_mov_b32 v1, v3
  s_nop 1
  v_permlane16_swap_b32 v3, v1
  v_max_f32 v3, v3, v1
  v_ceil_f32 v3, v3
  v_max_f32 v3, 0, v3
  v_add_f32 v6, v6, v3
  v_sub_f32 v32, v32, v3
  v_sub_f32 v33, v33, v3
  v_sub_f32 v34, v34, v3
  v_sub_f32 v35, v35, v3
  v_sub_f32 v36, v36, v3
  v_sub_f32 v37, v37, v3
  v_sub_f32 v38, v38, v3
  v_sub_f32 v39, v39, v3
  v_min_f32 v3, 0x43800000, v3
  v_cvt_i32_f32 v3, v3
  v_sub_u32 v3, 0, v3
  v_ldexp_f32 v3, 1.0, v3
  s_call_b64 s[42:43], L_resc_1_2
  v_max3_f32 v3, v40, v41, v42
  v_max3_f32 v3, v3, v43, v44
  v_max3_f32 v3, v3, v45, v46
  v_max_f32 v3, v3, v47
  v_mov_b32 v1, v3
  s_nop 1
  v_permlane32_swap_b32 v3, v1
  v_max_f32 v3, v3, v1
  v_mov_b32 v1, v3
  s_nop 1
  v_permlane16_swap_b32 v3, v1
  v_max_f32 v3, v3, v1
  v_ceil_f32 v3, v3
  v_max_f32 v3, 0, v3
  v_add_f32 v7, v7, v3
  v_sub_f32 v40, v40, v3
  v_sub_f32 v41, v41, v3
  v_sub_f32 v42, v42, v3
  v_sub_f32 v43, v43, v3
  v_sub_f32 v44, v44, v3
  v_sub_f32 v45, v45, v3
  v_sub_f32 v46, v46, v3
  v_sub_f32 v47, v47, v3
  v_min_f32 v3, 0x43800000, v3
  v_cvt_i32_f32 v3, v3
  v_sub_u32 v3, 0, v3
  v_ldexp_f32 v3, 1.0, v3
  s_call_b64 s[42:43], L_resc_1_3
  v_max3_f32 v3, v48, v49, v50
  v_max3_f32 v3, v3, v51, v52
  v_max3_f32 v3, v3, v53, v54
  v_max_f32 v3, v3, v55
  v_mov_b32 v1, v3
  s_nop 1
  v_permlane32_swap_b32 v3, v1
  v_max_f32 v3, v3, v1
  v_mov_b32 v1, v3
  s_nop 1
  v_permlane16_swap_b32 v3, v1
  v_max_f32 v3, v3, v1
  v_ceil_f32 v3, v3
  v_max_f32 v3, 0, v3
  v_add_f32 v8, v8, v3
  v_sub_f32 v48, v48, v3
  v_sub_f32 v49, v49, v3
  v_sub_f32 v50, v50, v3
  v_sub_f32 v51, v51, v3
  v_sub_f32 v52, v52, v3
  v_sub_f32 v53, v53, v3
  v_sub_f32 v54, v54, v3
  v_sub_f32 v55, v55, v3
  v_min_f32 v3, 0x43800000, v3
  v_cvt_i32_f32 v3, v3
  v_sub_u32 v3, 0, v3
  v_ldexp_f32 v3, 1.0, v3
  s_call_b64 s[42:43], L_resc_1_4
  v_max3_f32 v3, v56, v57, v58
  v_max3_f32 v3, v3, v59, v60
  v_max3_f32 v3, v3, v61, v62
  v_max_f32 v3, v3, v63
  v_mov_b32 v1, v3
  s_nop 1
  v_permlane32_swap_b32 v3, v1
  v_max_f32 v3, v3, v1
  v_mov_b32 v1, v3
  s_nop 1
  v_permlane16_swap_b32 v3, v1
  v_max_f32 v3, v3, v1
  v_ceil_f32 v3, v3
  v_max_f32 v3, 0, v3
  v_add_f32 v9, v9, v3
  v_sub_f32 v56, v56, v3
  v_sub_f32 v57, v57, v3
  v_sub_f32 v58, v58, v3
  v_sub_f32 v59, v59, v3
  v_sub_f32 v60, v60, v3
  v_sub_f32 v61, v61, v3
  v_sub_f32 v62, v62, v3
  v_sub_f32 v63, v63, v3
  v_min_f32 v3, 0x43800000, v3
  v_cvt_i32_f32 v3, v3
  v_sub_u32 v3, 0, v3
  v_ldexp_f32 v3, 1.0, v3
  s_call_b64 s[42:43], L_resc_1_5
  v_mbcnt_lo_u32_b32 v3, -1, 0
  v_mbcnt_hi_u32_b32 v3, -1, v3
  v_lshrrev_b32 v1, 3, v3
  v_mul_u32_u24 v2, 384, v1
  v_and_b32 v1, 6, v1
  v_and_b32 v3, 7, v3
  v_xor_b32 v3, v3, v1
  v_lshl_add_u32 v2, v3, 4, v2
  v_xor_b32 v1, 64, v0
  s_nop 3
  s_setpc_b64 s[44:45]
L_slowsub_1_1:
  s_nop 15
  s_mov_b32 s10, 0xffff0000
  v_max3_f32 v3, v64, v65, v66
  v_max3_f32 v3, v3, v67, v68
  v_max3_f32 v3, v3, v69, v70
  v_max_f32 v3, v3, v71
  v_mov_b32 v1, v3
  s_nop 1
  v_permlane32_swap_b32 v3, v1
  v_max_f32 v3, v3, v1
  v_mov_b32 v1, v3
  s_nop 1
  v_permlane16_swap_b32 v3, v1
  v_max_f32 v3, v3, v1
  v_ceil_f32 v3, v3
  v_max_f32 v3, 0, v3
  v_add_f32 v4, v4, v3
  v_sub_f32 v64, v64, v3
  v_sub_f32 v65, v65, v3
  v_sub_f32 v66, v66, v3
  v_sub_f32 v67, v67, v3
  v_sub_f32 v68, v68, v3
  v_sub_f32 v69, v69, v3
  v_sub_f32 v70, v70, v3
  v_sub_f32 v71, v71, v3
  v_min_f32 v3, 0x43800000, v3
  v_cvt_i32_f32 v3, v3
  v_sub_u32 v3, 0, v3
  v_ldexp_f32 v3, 1.0, v3
  s_call_b64 s[42:43], L_resc_1_0
  v_max3_f32 v3, v72, v73, v74
  v_max3_f32 v3, v3, v75, v76
  v_max3_f32 v3, v3, v77, v78
  v_max_f32 v3, v3, v79
  v_mov_b32 v1, v3
  s_nop 1
  v_permlane32_swap_b32 v3, v1
  v_max_f32 v3, v3, v1
  v_mov_b32 v1, v3
  s_nop 1
  v_permlane16_swap_b32 v3, v1
  v_max_f32 v3, v3, v1
  v_ceil_f32 v3, v3
  v_max_f32 v3, 0, v3
  v_add_f32 v5, v5, v3
  v_sub_f32 v72, v72, v3
  v_sub_f32 v73, v73, v3
  v_sub_f32 v74, v74, v3
  v_sub_f32 v75, v75, v3
  v_sub_f32 v76, v76, v3
  v_sub_f32 v77, v77, v3
  v_sub_f32 v78, v78, v3
  v_sub_f32 v79, v79, v3
  v_min_f32 v3, 0x43800000, v3
  v_cvt_i32_f32 v3, v3
  v_sub_u32 v3, 0, v3
  v_ldexp_f32 v3, 1.0, v3
  s_call_b64 s[42:43], L_resc_1_1
  v_max3_f32 v3, v80, v81, v82
  v_max3_f32 v3, v3, v83, v84
  v_max3_f32 v3, v3, v85, v86
  v_max_f32 v3, v3, v87
  v_mov_b32 v1, v3
  s_nop 1
  v_permlane32_swap_b32 v3, v1
  v_max_f32 v3, v3, v1
  v_mov_b32 v1, v3
  s_nop 1
  v_permlane16_swap_b32 v3, v1
  v_max_f32 v3, v3, v1
  v_ceil_f32 v3, v3
  v_max_f32 v3, 0, v3
  v_add_f32 v6, v6, v3
  v_sub_f32 v80, v80, v3
  v_sub_f32 v81, v81, v3
  v_sub_f32 v82, v82, v3
  v_sub_f32 v83, v83, v3
  v_sub_f32 v84, v84, v3
  v_sub_f32 v85, v85, v3
  v_sub_f32 v86, v86, v3
  v_sub_f32 v87, v87, v3
  v_min_f32 v3, 0x43800000, v3
  v_cvt_i32_f32 v3, v3
  v_sub_u32 v3, 0, v3
  v_ldexp_f32 v3, 1.0, v3
  s_call_b64 s[42:43], L_resc_1_2
  v_max3_f32 v3, v88, v89, v90
  v_max3_f32 v3, v3, v91, v92
  v_max3_f32 v3, v3, v93, v94
  v_max_f32 v3, v3, v95
  v_mov_b32 v1, v3
  s_nop 1
  v_permlane32_swap_b32 v3, v1
  v_max_f32 v3, v3, v1
  v_mov_b32 v1, v3
  s_nop 1
  v_permlane16_swap_b32 v3, v1
  v_max_f32 v3, v3, v1
  v_ceil_f32 v3, v3
  v_max_f32 v3, 0, v3
  v_add_f32 v7, v7, v3
  v_sub_f32 v88, v88, v3
  v_sub_f32 v89, v89, v3
  v_sub_f32 v90, v90, v3
  v_sub_f32 v91, v91, v3
  v_sub_f32 v92, v92, v3
  v_sub_f32 v93, v93, v3
  v_sub_f32 v94, v94, v3
  v_sub_f32 v95, v95, v3
  v_min_f32 v3, 0x43800000, v3
  v_cvt_i32_f32 v3, v3
  v_sub_u32 v3, 0, v3
  v_ldexp_f32 v3, 1.0, v3
  s_call_b64 s[42:43], L_resc_1_3
  v_max3_f32 v3, v96, v97, v98
  v_max3_f32 v3, v3, v99, v100
  v_max3_f32 v3, v3, v101, v102
  v_max_f32 v3, v3, v103
  v_mov_b32 v1, v3
  s_nop 1
  v_permlane32_swap_b32 v3, v1
  v_max_f32 v3, v3, v1
  v_mov_b32 v1, v3
  s_nop 1
  v_permlane16_swap_b32 v3, v1
  v_max_f32 v3, v3, v1
  v_ceil_f32 v3, v3
  v_max_f32 v3, 0, v3
  v_add_f32 v8, v8, v3
  v_sub_f32 v96, v96, v3
  v_sub_f32 v97, v97, v3
  v_sub_f32 v98, v98, v3
  v_sub_f32 v99, v99, v3
  v_sub_f32 v100, v100, v3
  v_sub_f32 v101, v101, v3
  v_sub_f32 v102, v102, v3
  v_sub_f32 v103, v103, v3
  v_min_f32 v3, 0x43800000, v3
  v_cvt_i32_f32 v3, v3
  v_sub_u32 v3, 0, v3
  v_ldexp_f32 v3, 1.0, v3
  s_call_b64 s[42:43], L_resc_1_4
  v_max3_f32 v3, v104, v105, v106
  v_max3_f32 v3, v3, v107, v108
  v_max3_f32 v3, v3, v109, v110
  v_max_f32 v3, v3, v111
  v_mov_b32 v1, v3
  s_nop 1
  v_permlane32_swap_b32 v3, v1
  v_max_f32 v3, v3, v1
  v_mov_b32 v1, v3
  s_nop 1
  v_permlane16_swap_b32 v3, v1
  v_max_f32 v3, v3, v1
  v_ceil_f32 v3, v3
  v_max_f32 v3, 0, v3
  v_add_f32 v9, v9, v3
  v_sub_f32 v104, v104, v3
  v_sub_f32 v105, v105, v3
  v_sub_f32 v106, v106, v3
  v_sub_f32 v107, v107, v3
  v_sub_f32 v108, v108, v3
  v_sub_f32 v109, v109, v3
  v_sub_f32 v110, v110, v3
  v_sub_f32 v111, v111, v3
  v_min_f32 v3, 0x43800000, v3
  v_cvt_i32_f32 v3, v3
  v_sub_u32 v3, 0, v3
  v_ldexp_f32 v3, 1.0, v3
  s_call_b64 s[42:43], L_resc_1_5
  v_mbcnt_lo_u32_b32 v3, -1, 0
  v_mbcnt_hi_u32_b32 v3, -1, v3
  v_lshrrev_b32 v1, 3, v3
  v_mul_u32_u24 v2, 384, v1
  v_and_b32 v1, 6, v1
  v_and_b32 v3, 7, v3
  v_xor_b32 v3, v3, v1
  v_lshl_add_u32 v2, v3, 4, v2
  v_xor_b32 v1, 64, v0
  s_nop 3
  s_setpc_b64 s[44:45]
L_slowsub_1_2:
  s_nop 15
  s_mov_b32 s10, 0xffff0000
  v_max3_f32 v3, v64, v65, v66
  v_max3_f32 v3, v3, v67, v68
  v_max3_f32 v3, v3, v69, v70
  v_max_f32 v3, v3, v71
  v_mov_b32 v1, v3
  s_nop 1
  v_permlane32_swap_b32 v3, v1
  v_max_f32 v3, v3, v1
  v_mov_b32 v1, v3
  s_nop 1
  v_permlane16_swap_b32 v3, v1
  v_max_f32 v3, v3, v1
  v_ceil_f32 v3, v3
  v_max_f32 v3, 0, v3
  v_add_f32 v4, v4, v3
  v_sub_f32 v64, v64, v3
  v_sub_f32 v65, v65, v3
  v_sub_f32 v66, v66, v3
  v_sub_f32 v67, v67, v3
  v_sub_f32 v68, v68, v3
  v_sub_f32 v69, v69, v3
  v_sub_f32 v70, v70, v3
  v_sub_f32 v71, v71, v3
  v_min_f32 v3, 0x43800000, v3
  v_cvt_i32_f32 v3, v3
  v_sub_u32 v3, 0, v3
  v_ldexp_f32 v3, 1.0, v3
  v_lshlrev_b32 v1, 16, v16
  v_and_b32 v2, s10, v16
  v_mul_f32 v1, v1, v3
  v_mul_f32 v2, v2, v3
  v_cvt_pk_bf16_f32 v16, v1, v2
  v_lshlrev_b32 v1, 16, v17
  v_and_b32 v2, s10, v17
  v_mul_f32 v1, v1, v3
  v_mul_f32 v2, v2, v3
  v_cvt_pk_bf16_f32 v17, v1, v2
  v_lshlrev_b32 v1, 16, v18
  v_and_b32 v2, s10, v18
  v_mul_f32 v1, v1, v3
  v_mul_f32 v2, v2, v3
  v_cvt_pk_bf16_f32 v18, v1, v2
  v_lshlrev_b32 v1, 16, v19
  v_and_b32 v2, s10, v19
  v_mul_f32 v1, v1, v3
  v_mul_f32 v2, v2, v3
  v_cvt_pk_bf16_f32 v19, v1, v2
  v_accvgpr_read_b32 v1, a144
  v_mul_f32 v1, v1, v3
  v_accvgpr_write_b32 a144, v1
  v_accvgpr_read_b32 v1, a145
  v_mul_f32 v1, v1, v3
  v_accvgpr_write_b32 a145, v1
  v_accvgpr_read_b32 v1, a146
  v_mul_f32 v1, v1, v3
  v_accvgpr_write_b32 a146, v1
  v_accvgpr_read_b32 v1, a147
  v_mul_f32 v1, v1, v3
  v_accvgpr_write_b32 a147, v1
  v_accvgpr_read_b32 v1, a168
  v_mul_f32 v1, v1, v3
  v_accvgpr_write_b32 a168, v1
  v_accvgpr_read_b32 v1, a169
  v_mul_f32 v1, v1, v3
  v_accvgpr_write_b32 a169, v1
  v_accvgpr_read_b32 v1, a170
  v_mul_f32 v1, v1, v3
  v_accvgpr_write_b32 a170, v1
  v_accvgpr_read_b32 v1, a171
  v_mul_f32 v1, v1, v3
  v_accvgpr_write_b32 a171, v1
  s_call_b64 s[42:43], L_resc_1_0
  v_max3_f32 v3, v72, v73, v74
  v_max3_f32 v3, v3, v75, v76
  v_max3_f32 v3, v3, v77, v78
  v_max_f32 v3, v3, v79
  v_mov_b32 v1, v3
  s_nop 1
  v_permlane32_swap_b32 v3, v1
  v_max_f32 v3, v3, v1
  v_mov_b32 v1, v3
  s_nop 1
  v_permlane16_swap_b32 v3, v1
  v_max_f32 v3, v3, v1
  v_ceil_f32 v3, v3
  v_max_f32 v3, 0, v3
  v_add_f32 v5, v5, v3
  v_sub_f32 v72, v72, v3
  v_sub_f32 v73, v73, v3
  v_sub_f32 v74, v74, v3
  v_sub_f32 v75, v75, v3
  v_sub_f32 v76, v76, v3
  v_sub_f32 v77, v77, v3
  v_sub_f32 v78, v78, v3
  v_sub_f32 v79, v79, v3
  v_min_f32 v3, 0x43800000, v3
  v_cvt_i32_f32 v3, v3
  v_sub_u32 v3, 0, v3
  v_ldexp_f32 v3, 1.0, v3
  v_lshlrev_b32 v1, 16, v20
  v_and_b32 v2, s10, v20
  v_mul_f32 v1, v1, v3
  v_mul_f32 v2, v2, v3
  v_cvt_pk_bf16_f32 v20, v1, v2
  v_lshlrev_b32 v1, 16, v21
  v_and_b32 v2, s10, v21
  v_mul_f32 v1, v1, v3
  v_mul_f32 v2, v2, v3
  v_cvt_pk_bf16_f32 v21, v1, v2
  v_lshlrev_b32 v1, 16, v22
  v_and_b32 v2, s10, v22
  v_mul_f32 v1, v1, v3
  v_mul_f32 v2, v2, v3
  v_cvt_pk_bf16_f32 v22, v1, v2
  v_lshlrev_b32 v1, 16, v23
  v_and_b32 v2, s10, v23
  v_mul_f32 v1, v1, v3
  v_mul_f32 v2, v2, v3
  v_cvt_pk_bf16_f32 v23, v1, v2
  v_accvgpr_read_b32 v1, a148
  v_mul_f32 v1, v1, v3
  v_accvgpr_write_b32 a148, v1
  v_accvgpr_read_b32 v1, a149
  v_mul_f32 v1, v1, v3
  v_accvgpr_write_b32 a149, v1
  v_accvgpr_read_b32 v1, a150
  v_mul_f32 v1, v1, v3
  v_accvgpr_write_b32 a150, v1
  v_accvgpr_read_b32 v1, a151
  v_mul_f32 v1, v1, v3
  v_accvgpr_write_b32 a151, v1
  v_accvgpr_read_b32 v1, a172
  v_mul_f32 v1, v1, v3
  v_accvgpr_write_b32 a172, v1
  v_accvgpr_read_b32 v1, a173
  v_mul_f32 v1, v1, v3
  v_accvgpr_write_b32 a173, v1
  v_accvgpr_read_b32 v1, a174
  v_mul_f32 v1, v1, v3
  v_accvgpr_write_b32 a174, v1
  v_accvgpr_read_b32 v1, a175
  v_mul_f32 v1, v1, v3
  v_accvgpr_write_b32 a175, v1
  s_call_b64 s[42:43], L_resc_1_1
  v_max3_f32 v3, v80, v81, v82
  v_max3_f32 v3, v3, v83, v84
  v_max3_f32 v3, v3, v85, v86
  v_max_f32 v3, v3, v87
  v_mov_b32 v1, v3
  s_nop 1
  v_permlane32_swap_b32 v3, v1
  v_max_f32 v3, v3, v1
  v_mov_b32 v1, v3
  s_nop 1
  v_permlane16_swap_b32 v3, v1
  v_max_f32 v3, v3, v1
  v_ceil_f32 v3, v3
  v_max_f32 v3, 0, v3
  v_add_f32 v6, v6, v3
  v_sub_f32 v80, v80, v3
  v_sub_f32 v81, v81, v3
  v_sub_f32 v82, v82, v3
  v_sub_f32 v83, v83, v3
  v_sub_f32 v84, v84, v3
  v_sub_f32 v85, v85, v3
  v_sub_f32 v86, v86, v3
  v_sub_f32 v87, v87, v3
  v_sub_f32 v32, v32, v3
  v_sub_f32 v33, v33, v3
  v_sub_f32 v34, v34, v3
  v_sub_f32 v35, v35, v3
  v_sub_f32 v36, v36, v3
  v_sub_f32 v37, v37, v3
  v_sub_f32 v38, v38, v3
  v_sub_f32 v39, v39, v3
  v_min_f32 v3, 0x43800000, v3
  v_cvt_i32_f32 v3, v3
  v_sub_u32 v3, 0, v3
  v_ldexp_f32 v3, 1.0, v3
  v_accvgpr_read_b32 v1, a152
  v_mul_f32 v1, v1, v3
  v_accvgpr_write_b32 a152, v1
  v_accvgpr_read_b32 v1, a153
  v_mul_f32 v1, v1, v3
  v_accvgpr_write_b32 a153, v1
  v_accvgpr_read_b32 v1, a154
  v_mul_f32 v1, v1, v3
  v_accvgpr_write_b32 a154, v1
  v_accvgpr_read_b32 v1, a155
  v_mul_f32 v1, v1, v3
  v_accvgpr_write_b32 a155, v1
  v_accvgpr_read_b32 v1, a176
  v_mul_f32 v1, v1, v3
  v_accvgpr_write_b32 a176, v1
  v_accvgpr_read_b32 v1, a177
  v_mul_f32 v1, v1, v3
  v_accvgpr_write_b32 a177, v1
  v_accvgpr_read_b32 v1, a178
  v_mul_f32 v1, v1, v3
  v_accvgpr_write_b32 a178, v1
  v_accvgpr_read_b32 v1, a179
  v_mul_f32 v1, v1, v3
  v_accvgpr_write_b32 a179, v1
  s_call_b64 s[42:43], L_resc_1_2
  v_max3_f32 v3, v88, v89, v90
  v_max3_f32 v3, v3, v91, v92
  v_max3_f32 v3, v3, v93, v94
  v_max_f32 v3, v3, v95
  v_mov_b32 v1, v3
  s_nop 1
  v_permlane32_swap_b32 v3, v1
  v_max_f32 v3, v3, v1
  v_mov_b32 v1, v3
  s_nop 1
  v_permlane16_swap_b32 v3, v1
  v_max_f32 v3, v3, v1
  v_ceil_f32 v3, v3
  v_max_f32 v3, 0, v3
  v_add_f32 v7, v7, v3
  v_sub_f32 v88, v88, v3
  v_sub_f32 v89, v89, v3
  v_sub_f32 v90, v90, v3
  v_sub_f32 v91, v91, v3
  v_sub_f32 v92, v92, v3
  v_sub_f32 v93, v93, v3
  v_sub_f32 v94, v94, v3
  v_sub_f32 v95, v95, v3
  v_sub_f32 v40, v40, v3
  v_sub_f32 v41, v41, v3
  v_sub_f32 v42, v42, v3
  v_sub_f32 v43, v43, v3
  v_sub_f32 v44, v44, v3
  v_sub_f32 v45, v45, v3
  v_sub_f32 v46, v46, v3
  v_sub_f32 v47, v47, v3
  v_min_f32 v3, 0x43800000, v3
  v_cvt_i32_f32 v3, v3
  v_sub_u32 v3, 0, v3
  v_ldexp_f32 v3, 1.0, v3
  v_accvgpr_read_b32 v1, a156
  v_mul_f32 v1, v1, v3
  v_accvgpr_write_b32 a156, v1
  v_accvgpr_read_b32 v1, a157
  v_mul_f32 v1, v1, v3
  v_accvgpr_write_b32 a157, v1
  v_accvgpr_read_b32 v1, a158
  v_mul_f32 v1, v1, v3
  v_accvgpr_write_b32 a158, v1
  v_accvgpr_read_b32 v1, a159
  v_mul_f32 v1, v1, v3
  v_accvgpr_write_b32 a159, v1
  v_accvgpr_read_b32 v1, a180
  v_mul_f32 v1, v1, v3
  v_accvgpr_write_b32 a180, v1
  v_accvgpr_read_b32 v1, a181
  v_mul_f32 v1, v1, v3
  v_accvgpr_write_b32 a181, v1
  v_accvgpr_read_b32 v1, a182
  v_mul_f32 v1, v1, v3
  v_accvgpr_write_b32 a182, v1
  v_accvgpr_read_b32 v1, a183
  v_mul_f32 v1, v1, v3
  v_accvgpr_write_b32 a183, v1
  s_call_b64 s[42:43], L_resc_1_3
  v_max3_f32 v3, v96, v97, v98
  v_max3_f32 v3, v3, v99, v100
  v_max3_f32 v3, v3, v101, v102
  v_max_f32 v3, v3, v103
  v_mov_b32 v1, v3
  s_nop 1
  v_permlane32_swap_b32 v3, v1
  v_max_f32 v3, v3, v1
  v_mov_b32 v1, v3
  s_nop 1
  v_permlane16_swap_b32 v3, v1
  v_max_f32 v3, v3, v1
  v_ceil_f32 v3, v3
  v_max_f32 v3, 0, v3
  v_add_f32 v8, v8, v3
  v_sub_f32 v96, v96, v3
  v_sub_f32 v97, v97, v3
  v_sub_f32 v98, v98, v3
  v_sub_f32 v99, v99, v3
  v_sub_f32 v100, v100, v3
  v_sub_f32 v101, v101, v3
  v_sub_f32 v102, v102, v3
  v_sub_f32 v103, v103, v3
  v_sub_f32 v48, v48, v3
  v_sub_f32 v49, v49, v3
  v_sub_f32 v50, v50, v3
  v_sub_f32 v51, v51, v3
  v_sub_f32 v52, v52, v3
  v_sub_f32 v53, v53, v3
  v_sub_f32 v54, v54, v3
  v_sub_f32 v55, v55, v3
  v_min_f32 v3, 0x43800000, v3
  v_cvt_i32_f32 v3, v3
  v_sub_u32 v3, 0, v3
  v_ldexp_f32 v3, 1.0, v3
  v_accvgpr_read_b32 v1, a160
  v_mul_f32 v1, v1, v3
  v_accvgpr_write_b32 a160, v1
  v_accvgpr_read_b32 v1, a161
  v_mul_f32 v1, v1, v3
  v_accvgpr_write_b32 a161, v1
  v_accvgpr_read_b32 v1, a162
  v_mul_f32 v1, v1, v3
  v_accvgpr_write_b32 a162, v1
  v_accvgpr_read_b32 v1, a163
  v_mul_f32 v1, v1, v3
  v_accvgpr_write_b32 a163, v1
  v_accvgpr_read_b32 v1, a184
  v_mul_f32 v1, v1, v3
  v_accvgpr_write_b32 a184, v1
  v_accvgpr_read_b32 v1, a185
  v_mul_f32 v1, v1, v3
  v_accvgpr_write_b32 a185, v1
  v_accvgpr_read_b32 v1, a186
  v_mul_f32 v1, v1, v3
  v_accvgpr_write_b32 a186, v1
  v_accvgpr_read_b32 v1, a187
  v_mul_f32 v1, v1, v3
  v_accvgpr_write_b32 a187, v1
  s_call_b64 s[42:43], L_resc_1_4
  v_max3_f32 v3, v104, v105, v106
  v_max3_f32 v3, v3, v107, v108
  v_max3_f32 v3, v3, v109, v110
  v_max_f32 v3, v3, v111
  v_mov_b32 v1, v3
  s_nop 1
  v_permlane32_swap_b32 v3, v1
  v_max_f32 v3, v3, v1
  v_mov_b32 v1, v3
  s_nop 1
  v_permlane16_swap_b32 v3, v1
  v_max_f32 v3, v3, v1
  v_ceil_f32 v3, v3
  v_max_f32 v3, 0, v3
  v_add_f32 v9, v9, v3
  v_sub_f32 v104, v104, v3
  v_sub_f32 v105, v105, v3
  v_sub_f32 v106, v106, v3
  v_sub_f32 v107, v107, v3
  v_sub_f32 v108, v108, v3
  v_sub_f32 v109, v109, v3
  v_sub_f32 v110, v110, v3
  v_sub_f32 v111, v111, v3
  v_sub_f32 v56, v56, v3
  v_sub_f32 v57, v57, v3
  v_sub_f32 v58, v58, v3
  v_sub_f32 v59, v59, v3
  v_sub_f32 v60, v60, v3
  v_sub_f32 v61, v61, v3
  v_sub_f32 v62, v62, v3
  v_sub_f32 v63, v63, v3
  v_min_f32 v3, 0x43800000, v3
  v_cvt_i32_f32 v3, v3
  v_sub_u32 v3, 0, v3
  v_ldexp_f32 v3, 1.0, v3
  v_accvgpr_read_b32 v1, a164
  v_mul_f32 v1, v1, v3
  v_accvgpr_write_b32 a164, v1
  v_accvgpr_read_b32 v1, a165
  v_mul_f32 v1, v1, v3
  v_accvgpr_write_b32 a165, v1
  v_accvgpr_read_b32 v1, a166
  v_mul_f32 v1, v1, v3
  v_accvgpr_write_b32 a166, v1
  v_accvgpr_read_b32 v1, a167
  v_mul_f32 v1, v1, v3
  v_accvgpr_write_b32 a167, v1
  v_accvgpr_read_b32 v1, a188
  v_mul_f32 v1, v1, v3
  v_accvgpr_write_b32 a188, v1
  v_accvgpr_read_b32 v1, a189
  v_mul_f32 v1, v1, v3
  v_accvgpr_write_b32 a189, v1
  v_accvgpr_read_b32 v1, a190
  v_mul_f32 v1, v1, v3
  v_accvgpr_write_b32 a190, v1
  v_accvgpr_read_b32 v1, a191
  v_mul_f32 v1, v1, v3
  v_accvgpr_write_b32 a191, v1
  s_call_b64 s[42:43], L_resc_1_5
  v_mbcnt_lo_u32_b32 v3, -1, 0
  v_mbcnt_hi_u32_b32 v3, -1, v3
  v_lshrrev_b32 v1, 3, v3
  v_mul_u32_u24 v2, 384, v1
  v_and_b32 v1, 6, v1
  v_and_b32 v3, 7, v3
  v_xor_b32 v3, v3, v1
  v_lshl_add_u32 v2, v3, 4, v2
  v_xor_b32 v1, 64, v0
  s_nop 3
  s_setpc_b64 s[44:45]
L_resc_1_0:
  s_cmp_le_u32 s41, 0
  s_cbranch_scc1 L_resc_done_1_0
  v_accvgpr_read_b32 v2, a48
  v_lshlrev_b32 v1, 16, v2
  v_and_b32 v2, s10, v2
  v_mul_f32 v1, v1, v3
  v_mul_f32 v2, v2, v3
  v_cvt_pk_bf16_f32 v1, v1, v2
  v_accvgpr_write_b32 a48, v1
  v_accvgpr_read_b32 v2, a49
  v_lshlrev_b32 v1, 16, v2
  v_and_b32 v2, s10, v2
  v_mul_f32 v1, v1, v3
  v_mul_f32 v2, v2, v3
  v_cvt_pk_bf16_f32 v1, v1, v2
  v_accvgpr_write_b32 a49, v1
  v_accvgpr_read_b32 v2, a50
  v_lshlrev_b32 v1, 16, v2
  v_and_b32 v2, s10, v2
  v_mul_f32 v1, v1, v3
  v_mul_f32 v2, v2, v3
  v_cvt_pk_bf16_f32 v1, v1, v2
  v_accvgpr_write_b32 a50, v1
  v_accvgpr_read_b32 v2, a51
  v_lshlrev_b32 v1, 16, v2
  v_and_b32 v2, s10, v2
  v_mul_f32 v1, v1, v3
  v_mul_f32 v2, v2, v3
  v_cvt_pk_bf16_f32 v1, v1, v2
  v_accvgpr_write_b32 a51, v1
  s_cmp_le_u32 s41, 1
  s_cbranch_scc1 L_resc_done_1_0
  v_accvgpr_read_b32 v2, a72
  v_lshlrev_b32 v1, 16, v2
  v_and_b32 v2, s10, v2
  v_mul_f32 v1, v1, v3
  v_mul_f32 v2, v2, v3
  v_cvt_pk_bf16_f32 v1, v1, v2
  v_accvgpr_write_b32 a72, v1
  v_accvgpr_read_b32 v2, a73
  v_lshlrev_b32 v1, 16, v2
  v_and_b32 v2, s10, v2
  v_mul_f32 v1, v1, v3
  v_mul_f32 v2, v2, v3
  v_cvt_pk_bf16_f32 v1, v1, v2
  v_accvgpr_write_b32 a73, v1
  v_accvgpr_read_b32 v2, a74
  v_lshlrev_b32 v1, 16, v2
  v_and_b32 v2, s10, v2
  v_mul_f32 v1, v1, v3
  v_mul_f32 v2, v2, v3
  v_cvt_pk_bf16_f32 v1, v1, v2
  v_accvgpr_write_b32 a74, v1
  v_accvgpr_read_b32 v2, a75
  v_lshlrev_b32 v1, 16, v2
  v_and_b32 v2, s10, v2
  v_mul_f32 v1, v1, v3
  v_mul_f32 v2, v2, v3
  v_cvt_pk_bf16_f32 v1, v1, v2
  v_accvgpr_write_b32 a75, v1
  s_cmp_le_u32 s41, 2
  s_cbranch_scc1 L_resc_done_1_0
  v_accvgpr_read_b32 v2, a96
  v_lshlrev_b32 v1, 16, v2
  v_and_b32 v2, s10, v2
  v_mul_f32 v1, v1, v3
  v_mul_f32 v2, v2, v3
  v_cvt_pk_bf16_f32 v1, v1, v2
  v_accvgpr_write_b32 a96, v1
  v_accvgpr_read_b32 v2, a97
  v_lshlrev_b32 v1, 16, v2
  v_and_b32 v2, s10, v2
  v_mul_f32 v1, v1, v3
  v_mul_f32 v2, v2, v3
  v_cvt_pk_bf16_f32 v1, v1, v2
  v_accvgpr_write_b32 a97, v1
  v_accvgpr_read_b32 v2, a98
  v_lshlrev_b32 v1, 16, v2
  v_and_b32 v2, s10, v2
  v_mul_f32 v1, v1, v3
  v_mul_f32 v2, v2, v3
  v_cvt_pk_bf16_f32 v1, v1, v2
  v_accvgpr_write_b32 a98, v1
  v_accvgpr_read_b32 v2, a99
  v_lshlrev_b32 v1, 16, v2
  v_and_b32 v2, s10, v2
  v_mul_f32 v1, v1, v3
  v_mul_f32 v2, v2, v3
  v_cvt_pk_bf16_f32 v1, v1, v2
  v_accvgpr_write_b32 a99, v1
  s_cmp_le_u32 s41, 3
  s_cbranch_scc1 L_resc_done_1_0
  v_accvgpr_read_b32 v2, a120
  v_lshlrev_b32 v1, 16, v2
  v_and_b32 v2, s10, v2
  v_mul_f32 v1, v1, v3
  v_mul_f32 v2, v2, v3
  v_cvt_pk_bf16_f32 v1, v1, v2
  v_accvgpr_write_b32 a120, v1
  v_accvgpr_read_b32 v2, a121
  v_lshlrev_b32 v1, 16, v2
  v_and_b32 v2, s10, v2
  v_mul_f32 v1, v1, v3
  v_mul_f32 v2, v2, v3
  v_cvt_pk_bf16_f32 v1, v1, v2
  v_accvgpr_write_b32 a121, v1
  v_accvgpr_read_b32 v2, a122
  v_lshlrev_b32 v1, 16, v2
  v_and_b32 v2, s10, v2
  v_mul_f32 v1, v1, v3
  v_mul_f32 v2, v2, v3
  v_cvt_pk_bf16_f32 v1, v1, v2
  v_accvgpr_write_b32 a122, v1
  v_accvgpr_read_b32 v2, a123
  v_lshlrev_b32 v1, 16, v2
  v_and_b32 v2, s10, v2
  v_mul_f32 v1, v1, v3
  v_mul_f32 v2, v2, v3
  v_cvt_pk_bf16_f32 v1, v1, v2
  v_accvgpr_write_b32 a123, v1
  s_cmp_le_u32 s41, 4
  s_cbranch_scc1 L_resc_done_1_0
  v_lshlrev_b32 v1, 16, v112
  v_and_b32 v2, s10, v112
  v_mul_f32 v1, v1, v3
  v_mul_f32 v2, v2, v3
  v_cvt_pk_bf16_f32 v112, v1, v2
  v_lshlrev_b32 v1, 16, v113
  v_and_b32 v2, s10, v113
  v_mul_f32 v1, v1, v3
  v_mul_f32 v2, v2, v3
  v_cvt_pk_bf16_f32 v113, v1, v2
  v_lshlrev_b32 v1, 16, v114
  v_and_b32 v2, s10, v114
  v_mul_f32 v1, v1, v3
  v_mul_f32 v2, v2, v3
  v_cvt_pk_bf16_f32 v114, v1, v2
  v_lshlrev_b32 v1, 16, v115
  v_and_b32 v2, s10, v115
  v_mul_f32 v1, v1, v3
  v_mul_f32 v2, v2, v3
  v_cvt_pk_bf16_f32 v115, v1, v2
  s_cmp_le_u32 s41, 5
  s_cbranch_scc1 L_resc_done_1_0
  v_lshlrev_b32 v1, 16, v136
  v_and_b32 v2, s10, v136
  v_mul_f32 v1, v1, v3
  v_mul_f32 v2, v2, v3
  v_cvt_pk_bf16_f32 v136, v1, v2
  v_lshlrev_b32 v1, 16, v137
  v_and_b32 v2, s10, v137
  v_mul_f32 v1, v1, v3
  v_mul_f32 v2, v2, v3
  v_cvt_pk_bf16_f32 v137, v1, v2
  v_lshlrev_b32 v1, 16, v138
  v_and_b32 v2, s10, v138
  v_mul_f32 v1, v1, v3
  v_mul_f32 v2, v2, v3
  v_cvt_pk_bf16_f32 v138, v1, v2
  v_lshlrev_b32 v1, 16, v139
  v_and_b32 v2, s10, v139
  v_mul_f32 v1, v1, v3
  v_mul_f32 v2, v2, v3
  v_cvt_pk_bf16_f32 v139, v1, v2
  s_cmp_le_u32 s41, 6
  s_cbranch_scc1 L_resc_done_1_0
  v_lshlrev_b32 v1, 16, v160
  v_and_b32 v2, s10, v160
  v_mul_f32 v1, v1, v3
  v_mul_f32 v2, v2, v3
  v_cvt_pk_bf16_f32 v160, v1, v2
  v_lshlrev_b32 v1, 16, v161
  v_and_b32 v2, s10, v161
  v_mul_f32 v1, v1, v3
  v_mul_f32 v2, v2, v3
  v_cvt_pk_bf16_f32 v161, v1, v2
  v_lshlrev_b32 v1, 16, v162
  v_and_b32 v2, s10, v162
  v_mul_f32 v1, v1, v3
  v_mul_f32 v2, v2, v3
  v_cvt_pk_bf16_f32 v162, v1, v2
  v_lshlrev_b32 v1, 16, v163
  v_and_b32 v2, s10, v163
  v_mul_f32 v1, v1, v3
  v_mul_f32 v2, v2, v3
  v_cvt_pk_bf16_f32 v163, v1, v2
  s_cmp_le_u32 s41, 7
  s_cbranch_scc1 L_resc_done_1_0
  v_lshlrev_b32 v1, 16, v184
  v_and_b32 v2, s10, v184
  v_mul_f32 v1, v1, v3
  v_mul_f32 v2, v2, v3
  v_cvt_pk_bf16_f32 v184, v1, v2
  v_lshlrev_b32 v1, 16, v185
  v_and_b32 v2, s10, v185
  v_mul_f32 v1, v1, v3
  v_mul_f32 v2, v2, v3
  v_cvt_pk_bf16_f32 v185, v1, v2
  v_lshlrev_b32 v1, 16, v186
  v_and_b32 v2, s10, v186
  v_mul_f32 v1, v1, v3
  v_mul_f32 v2, v2, v3
  v_cvt_pk_bf16_f32 v186, v1, v2
  v_lshlrev_b32 v1, 16, v187
  v_and_b32 v2, s10, v187
  v_mul_f32 v1, v1, v3
  v_mul_f32 v2, v2, v3
  v_cvt_pk_bf16_f32 v187, v1, v2
  s_cmp_le_u32 s41, 8
  s_cbranch_scc1 L_resc_done_1_0
  v_lshlrev_b32 v1, 16, v208
  v_and_b32 v2, s10, v208
  v_mul_f32 v1, v1, v3
  v_mul_f32 v2, v2, v3
  v_cvt_pk_bf16_f32 v208, v1, v2
  v_lshlrev_b32 v1, 16, v209
  v_and_b32 v2, s10, v209
  v_mul_f32 v1, v1, v3
  v_mul_f32 v2, v2, v3
  v_cvt_pk_bf16_f32 v209, v1, v2
  v_lshlrev_b32 v1, 16, v210
  v_and_b32 v2, s10, v210
  v_mul_f32 v1, v1, v3
  v_mul_f32 v2, v2, v3
  v_cvt_pk_bf16_f32 v210, v1, v2
  v_lshlrev_b32 v1, 16, v211
  v_and_b32 v2, s10, v211
  v_mul_f32 v1, v1, v3
  v_mul_f32 v2, v2, v3
  v_cvt_pk_bf16_f32 v211, v1, v2
  s_cmp_le_u32 s41, 9
  s_cbranch_scc1 L_resc_done_1_0
  v_lshlrev_b32 v1, 16, v232
  v_and_b32 v2, s10, v232
  v_mul_f32 v1, v1, v3
  v_mul_f32 v2, v2, v3
  v_cvt_pk_bf16_f32 v232, v1, v2
  v_lshlrev_b32 v1, 16, v233
  v_and_b32 v2, s10, v233
  v_mul_f32 v1, v1, v3
  v_mul_f32 v2, v2, v3
  v_cvt_pk_bf16_f32 v233, v1, v2
  v_lshlrev_b32 v1, 16, v234
  v_and_b32 v2, s10, v234
  v_mul_f32 v1, v1, v3
  v_mul_f32 v2, v2, v3
  v_cvt_pk_bf16_f32 v234, v1, v2
  v_lshlrev_b32 v1, 16, v235
  v_and_b32 v2, s10, v235
  v_mul_f32 v1, v1, v3
  v_mul_f32 v2, v2, v3
  v_cvt_pk_bf16_f32 v235, v1, v2
L_resc_done_1_0:
  s_setpc_b64 s[42:43]
L_resc_1_1:
  s_cmp_le_u32 s41, 0
  s_cbranch_scc1 L_resc_done_1_1
  v_accvgpr_read_b32 v2, a52
  v_lshlrev_b32 v1, 16, v2
  v_and_b32 v2, s10, v2
  v_mul_f32 v1, v1, v3
  v_mul_f32 v2, v2, v3
  v_cvt_pk_bf16_f32 v1, v1, v2
  v_accvgpr_write_b32 a52, v1
  v_accvgpr_read_b32 v2, a53
  v_lshlrev_b32 v1, 16, v2
  v_and_b32 v2, s10, v2
  v_mul_f32 v1, v1, v3
  v_mul_f32 v2, v2, v3
  v_cvt_pk_bf16_f32 v1, v1, v2
  v_accvgpr_write_b32 a53, v1
  v_accvgpr_read_b32 v2, a54
  v_lshlrev_b32 v1, 16, v2
  v_and_b32 v2, s10, v2
  v_mul_f32 v1, v1, v3
  v_mul_f32 v2, v2, v3
  v_cvt_pk_bf16_f32 v1, v1, v2
  v_accvgpr_write_b32 a54, v1
  v_accvgpr_read_b32 v2, a55
  v_lshlrev_b32 v1, 16, v2
  v_and_b32 v2, s10, v2
  v_mul_f32 v1, v1, v3
  v_mul_f32 v2, v2, v3
  v_cvt_pk_bf16_f32 v1, v1, v2
  v_accvgpr_write_b32 a55, v1
  s_cmp_le_u32 s41, 1
  s_cbranch_scc1 L_resc_done_1_1
  v_accvgpr_read_b32 v2, a76
  v_lshlrev_b32 v1, 16, v2
  v_and_b32 v2, s10, v2
  v_mul_f32 v1, v1, v3
  v_mul_f32 v2, v2, v3
  v_cvt_pk_bf16_f32 v1, v1, v2
  v_accvgpr_write_b32 a76, v1
  v_accvgpr_read_b32 v2, a77
  v_lshlrev_b32 v1, 16, v2
  v_and_b32 v2, s10, v2
  v_mul_f32 v1, v1, v3
  v_mul_f32 v2, v2, v3
  v_cvt_pk_bf16_f32 v1, v1, v2
  v_accvgpr_write_b32 a77, v1
  v_accvgpr_read_b32 v2, a78
  v_lshlrev_b32 v1, 16, v2
  v_and_b32 v2, s10, v2
  v_mul_f32 v1, v1, v3
  v_mul_f32 v2, v2, v3
  v_cvt_pk_bf16_f32 v1, v1, v2
  v_accvgpr_write_b32 a78, v1
  v_accvgpr_read_b32 v2, a79
  v_lshlrev_b32 v1, 16, v2
  v_and_b32 v2, s10, v2
  v_mul_f32 v1, v1, v3
  v_mul_f32 v2, v2, v3
  v_cvt_pk_bf16_f32 v1, v1, v2
  v_accvgpr_write_b32 a79, v1
  s_cmp_le_u32 s41, 2
  s_cbranch_scc1 L_resc_done_1_1
  v_accvgpr_read_b32 v2, a100
  v_lshlrev_b32 v1, 16, v2
  v_and_b32 v2, s10, v2
  v_mul_f32 v1, v1, v3
  v_mul_f32 v2, v2, v3
  v_cvt_pk_bf16_f32 v1, v1, v2
  v_accvgpr_write_b32 a100, v1
  v_accvgpr_read_b32 v2, a101
  v_lshlrev_b32 v1, 16, v2
  v_and_b32 v2, s10, v2
  v_mul_f32 v1, v1, v3
  v_mul_f32 v2, v2, v3
  v_cvt_pk_bf16_f32 v1, v1, v2
  v_accvgpr_write_b32 a101, v1
  v_accvgpr_read_b32 v2, a102
  v_lshlrev_b32 v1, 16, v2
  v_and_b32 v2, s10, v2
  v_mul_f32 v1, v1, v3
  v_mul_f32 v2, v2, v3
  v_cvt_pk_bf16_f32 v1, v1, v2
  v_accvgpr_write_b32 a102, v1
  v_accvgpr_read_b32 v2, a103
  v_lshlrev_b32 v1, 16, v2
  v_and_b32 v2, s10, v2
  v_mul_f32 v1, v1, v3
  v_mul_f32 v2, v2, v3
  v_cvt_pk_bf16_f32 v1, v1, v2
  v_accvgpr_write_b32 a103, v1
  s_cmp_le_u32 s41, 3
  s_cbranch_scc1 L_resc_done_1_1
  v_accvgpr_read_b32 v2, a124
  v_lshlrev_b32 v1, 16, v2
  v_and_b32 v2, s10, v2
  v_mul_f32 v1, v1, v3
  v_mul_f32 v2, v2, v3
  v_cvt_pk_bf16_f32 v1, v1, v2
  v_accvgpr_write_b32 a124, v1
  v_accvgpr_read_b32 v2, a125
  v_lshlrev_b32 v1, 16, v2
  v_and_b32 v2, s10, v2
  v_mul_f32 v1, v1, v3
  v_mul_f32 v2, v2, v3
  v_cvt_pk_bf16_f32 v1, v1, v2
  v_accvgpr_write_b32 a125, v1
  v_accvgpr_read_b32 v2, a126
  v_lshlrev_b32 v1, 16, v2
  v_and_b32 v2, s10, v2
  v_mul_f32 v1, v1, v3
  v_mul_f32 v2, v2, v3
  v_cvt_pk_bf16_f32 v1, v1, v2
  v_accvgpr_write_b32 a126, v1
  v_accvgpr_read_b32 v2, a127
  v_lshlrev_b32 v1, 16, v2
  v_and_b32 v2, s10, v2
  v_mul_f32 v1, v1, v3
  v_mul_f32 v2, v2, v3
  v_cvt_pk_bf16_f32 v1, v1, v2
  v_accvgpr_write_b32 a127, v1
  s_cmp_le_u32 s41, 4
  s_cbranch_scc1 L_resc_done_1_1
  v_lshlrev_b32 v1, 16, v116
  v_and_b32 v2, s10, v116
  v_mul_f32 v1, v1, v3
  v_mul_f32 v2, v2, v3
  v_cvt_pk_bf16_f32 v116, v1, v2
  v_lshlrev_b32 v1, 16, v117
  v_and_b32 v2, s10, v117
  v_mul_f32 v1, v1, v3
  v_mul_f32 v2, v2, v3
  v_cvt_pk_bf16_f32 v117, v1, v2
  v_lshlrev_b32 v1, 16, v118
  v_and_b32 v2, s10, v118
  v_mul_f32 v1, v1, v3
  v_mul_f32 v2, v2, v3
  v_cvt_pk_bf16_f32 v118, v1, v2
  v_lshlrev_b32 v1, 16, v119
  v_and_b32 v2, s10, v119
  v_mul_f32 v1, v1, v3
  v_mul_f32 v2, v2, v3
  v_cvt_pk_bf16_f32 v119, v1, v2
  s_cmp_le_u32 s41, 5
  s_cbranch_scc1 L_resc_done_1_1
  v_lshlrev_b32 v1, 16, v140
  v_and_b32 v2, s10, v140
  v_mul_f32 v1, v1, v3
  v_mul_f32 v2, v2, v3
  v_cvt_pk_bf16_f32 v140, v1, v2
  v_lshlrev_b32 v1, 16, v141
  v_and_b32 v2, s10, v141
  v_mul_f32 v1, v1, v3
  v_mul_f32 v2, v2, v3
  v_cvt_pk_bf16_f32 v141, v1, v2
  v_lshlrev_b32 v1, 16, v142
  v_and_b32 v2, s10, v142
  v_mul_f32 v1, v1, v3
  v_mul_f32 v2, v2, v3
  v_cvt_pk_bf16_f32 v142, v1, v2
  v_lshlrev_b32 v1, 16, v143
  v_and_b32 v2, s10, v143
  v_mul_f32 v1, v1, v3
  v_mul_f32 v2, v2, v3
  v_cvt_pk_bf16_f32 v143, v1, v2
  s_cmp_le_u32 s41, 6
  s_cbranch_scc1 L_resc_done_1_1
  v_lshlrev_b32 v1, 16, v164
  v_and_b32 v2, s10, v164
  v_mul_f32 v1, v1, v3
  v_mul_f32 v2, v2, v3
  v_cvt_pk_bf16_f32 v164, v1, v2
  v_lshlrev_b32 v1, 16, v165
  v_and_b32 v2, s10, v165
  v_mul_f32 v1, v1, v3
  v_mul_f32 v2, v2, v3
  v_cvt_pk_bf16_f32 v165, v1, v2
  v_lshlrev_b32 v1, 16, v166
  v_and_b32 v2, s10, v166
  v_mul_f32 v1, v1, v3
  v_mul_f32 v2, v2, v3
  v_cvt_pk_bf16_f32 v166, v1, v2
  v_lshlrev_b32 v1, 16, v167
  v_and_b32 v2, s10, v167
  v_mul_f32 v1, v1, v3
  v_mul_f32 v2, v2, v3
  v_cvt_pk_bf16_f32 v167, v1, v2
  s_cmp_le_u32 s41, 7
  s_cbranch_scc1 L_resc_done_1_1
  v_lshlrev_b32 v1, 16, v188
  v_and_b32 v2, s10, v188
  v_mul_f32 v1, v1, v3
  v_mul_f32 v2, v2, v3
  v_cvt_pk_bf16_f32 v188, v1, v2
  v_lshlrev_b32 v1, 16, v189
  v_and_b32 v2, s10, v189
  v_mul_f32 v1, v1, v3
  v_mul_f32 v2, v2, v3
  v_cvt_pk_bf16_f32 v189, v1, v2
  v_lshlrev_b32 v1, 16, v190
  v_and_b32 v2, s10, v190
  v_mul_f32 v1, v1, v3
  v_mul_f32 v2, v2, v3
  v_cvt_pk_bf16_f32 v190, v1, v2
  v_lshlrev_b32 v1, 16, v191
  v_and_b32 v2, s10, v191
  v_mul_f32 v1, v1, v3
  v_mul_f32 v2, v2, v3
  v_cvt_pk_bf16_f32 v191, v1, v2
  s_cmp_le_u32 s41, 8
  s_cbranch_scc1 L_resc_done_1_1
  v_lshlrev_b32 v1, 16, v212
  v_and_b32 v2, s10, v212
  v_mul_f32 v1, v1, v3
  v_mul_f32 v2, v2, v3
  v_cvt_pk_bf16_f32 v212, v1, v2
  v_lshlrev_b32 v1, 16, v213
  v_and_b32 v2, s10, v213
  v_mul_f32 v1, v1, v3
  v_mul_f32 v2, v2, v3
  v_cvt_pk_bf16_f32 v213, v1, v2
  v_lshlrev_b32 v1, 16, v214
  v_and_b32 v2, s10, v214
  v_mul_f32 v1, v1, v3
  v_mul_f32 v2, v2, v3
  v_cvt_pk_bf16_f32 v214, v1, v2
  v_lshlrev_b32 v1, 16, v215
  v_and_b32 v2, s10, v215
  v_mul_f32 v1, v1, v3
  v_mul_f32 v2, v2, v3
  v_cvt_pk_bf16_f32 v215, v1, v2
  s_cmp_le_u32 s41, 9
  s_cbranch_scc1 L_resc_done_1_1
  v_lshlrev_b32 v1, 16, v236
  v_and_b32 v2, s10, v236
  v_mul_f32 v1, v1, v3
  v_mul_f32 v2, v2, v3
  v_cvt_pk_bf16_f32 v236, v1, v2
  v_lshlrev_b32 v1, 16, v237
  v_and_b32 v2, s10, v237
  v_mul_f32 v1, v1, v3
  v_mul_f32 v2, v2, v3
  v_cvt_pk_bf16_f32 v237, v1, v2
  v_lshlrev_b32 v1, 16, v238
  v_and_b32 v2, s10, v238
  v_mul_f32 v1, v1, v3
  v_mul_f32 v2, v2, v3
  v_cvt_pk_bf16_f32 v238, v1, v2
  v_lshlrev_b32 v1, 16, v239
  v_and_b32 v2, s10, v239
  v_mul_f32 v1, v1, v3
  v_mul_f32 v2, v2, v3
  v_cvt_pk_bf16_f32 v239, v1, v2
L_resc_done_1_1:
  s_setpc_b64 s[42:43]
L_resc_1_2:
  s_cmp_le_u32 s41, 0
  s_cbranch_scc1 L_resc_done_1_2
  v_accvgpr_read_b32 v2, a56
  v_lshlrev_b32 v1, 16, v2
  v_and_b32 v2, s10, v2
  v_mul_f32 v1, v1, v3
  v_mul_f32 v2, v2, v3
  v_cvt_pk_bf16_f32 v1, v1, v2
  v_accvgpr_write_b32 a56, v1
  v_accvgpr_read_b32 v2, a57
  v_lshlrev_b32 v1, 16, v2
  v_and_b32 v2, s10, v2
  v_mul_f32 v1, v1, v3
  v_mul_f32 v2, v2, v3
  v_cvt_pk_bf16_f32 v1, v1, v2
  v_accvgpr_write_b32 a57, v1
  v_accvgpr_read_b32 v2, a58
  v_lshlrev_b32 v1, 16, v2
  v_and_b32 v2, s10, v2
  v_mul_f32 v1, v1, v3
  v_mul_f32 v2, v2, v3
  v_cvt_pk_bf16_f32 v1, v1, v2
  v_accvgpr_write_b32 a58, v1
  v_accvgpr_read_b32 v2, a59
  v_lshlrev_b32 v1, 16, v2
  v_and_b32 v2, s10, v2
  v_mul_f32 v1, v1, v3
  v_mul_f32 v2, v2, v3
  v_cvt_pk_bf16_f32 v1, v1, v2
  v_accvgpr_write_b32 a59, v1
  s_cmp_le_u32 s41, 1
  s_cbranch_scc1 L_resc_done_1_2
  v_accvgpr_read_b32 v2, a80
  v_lshlrev_b32 v1, 16, v2
  v_and_b32 v2, s10, v2
  v_mul_f32 v1, v1, v3
  v_mul_f32 v2, v2, v3
  v_cvt_pk_bf16_f32 v1, v1, v2
  v_accvgpr_write_b32 a80, v1
  v_accvgpr_read_b32 v2, a81
  v_lshlrev_b32 v1, 16, v2
  v_and_b32 v2, s10, v2
  v_mul_f32 v1, v1, v3
  v_mul_f32 v2, v2, v3
  v_cvt_pk_bf16_f32 v1, v1, v2
  v_accvgpr_write_b32 a81, v1
  v_accvgpr_read_b32 v2, a82
  v_lshlrev_b32 v1, 16, v2
  v_and_b32 v2, s10, v2
  v_mul_f32 v1, v1, v3
  v_mul_f32 v2, v2, v3
  v_cvt_pk_bf16_f32 v1, v1, v2
  v_accvgpr_write_b32 a82, v1
  v_accvgpr_read_b32 v2, a83
  v_lshlrev_b32 v1, 16, v2
  v_and_b32 v2, s10, v2
  v_mul_f32 v1, v1, v3
  v_mul_f32 v2, v2, v3
  v_cvt_pk_bf16_f32 v1, v1, v2
  v_accvgpr_write_b32 a83, v1
  s_cmp_le_u32 s41, 2
  s_cbranch_scc1 L_resc_done_1_2
  v_accvgpr_read_b32 v2, a104
  v_lshlrev_b32 v1, 16, v2
  v_and_b32 v2, s10, v2
  v_mul_f32 v1, v1, v3
  v_mul_f32 v2, v2, v3
  v_cvt_pk_bf16_f32 v1, v1, v2
  v_accvgpr_write_b32 a104, v1
  v_accvgpr_read_b32 v2, a105
  v_lshlrev_b32 v1, 16, v2
  v_and_b32 v2, s10, v2
  v_mul_f32 v1, v1, v3
  v_mul_f32 v2, v2, v3
  v_cvt_pk_bf16_f32 v1, v1, v2
  v_accvgpr_write_b32 a105, v1
  v_accvgpr_read_b32 v2, a106
  v_lshlrev_b32 v1, 16, v2
  v_and_b32 v2, s10, v2
  v_mul_f32 v1, v1, v3
  v_mul_f32 v2, v2, v3
  v_cvt_pk_bf16_f32 v1, v1, v2
  v_accvgpr_write_b32 a106, v1
  v_accvgpr_read_b32 v2, a107
  v_lshlrev_b32 v1, 16, v2
  v_and_b32 v2, s10, v2
  v_mul_f32 v1, v1, v3
  v_mul_f32 v2, v2, v3
  v_cvt_pk_bf16_f32 v1, v1, v2
  v_accvgpr_write_b32 a107, v1
  s_cmp_le_u32 s41, 3
  s_cbranch_scc1 L_resc_done_1_2
  v_accvgpr_read_b32 v2, a128
  v_lshlrev_b32 v1, 16, v2
  v_and_b32 v2, s10, v2
  v_mul_f32 v1, v1, v3
  v_mul_f32 v2, v2, v3
  v_cvt_pk_bf16_f32 v1, v1, v2
  v_accvgpr_write_b32 a128, v1
  v_accvgpr_read_b32 v2, a129
  v_lshlrev_b32 v1, 16, v2
  v_and_b32 v2, s10, v2
  v_mul_f32 v1, v1, v3
  v_mul_f32 v2, v2, v3
  v_cvt_pk_bf16_f32 v1, v1, v2
  v_accvgpr_write_b32 a129, v1
  v_accvgpr_read_b32 v2, a130
  v_lshlrev_b32 v1, 16, v2
  v_and_b32 v2, s10, v2
  v_mul_f32 v1, v1, v3
  v_mul_f32 v2, v2, v3
  v_cvt_pk_bf16_f32 v1, v1, v2
  v_accvgpr_write_b32 a130, v1
  v_accvgpr_read_b32 v2, a131
  v_lshlrev_b32 v1, 16, v2
  v_and_b32 v2, s10, v2
  v_mul_f32 v1, v1, v3
  v_mul_f32 v2, v2, v3
  v_cvt_pk_bf16_f32 v1, v1, v2
  v_accvgpr_write_b32 a131, v1
  s_cmp_le_u32 s41, 4
  s_cbranch_scc1 L_resc_done_1_2
  v_lshlrev_b32 v1, 16, v120
  v_and_b32 v2, s10, v120
  v_mul_f32 v1, v1, v3
  v_mul_f32 v2, v2, v3
  v_cvt_pk_bf16_f32 v120, v1, v2
  v_lshlrev_b32 v1, 16, v121
  v_and_b32 v2, s10, v121
  v_mul_f32 v1, v1, v3
  v_mul_f32 v2, v2, v3
  v_cvt_pk_bf16_f32 v121, v1, v2
  v_lshlrev_b32 v1, 16, v122
  v_and_b32 v2, s10, v122
  v_mul_f32 v1, v1, v3
  v_mul_f32 v2, v2, v3
  v_cvt_pk_bf16_f32 v122, v1, v2
  v_lshlrev_b32 v1, 16, v123
  v_and_b32 v2, s10, v123
  v_mul_f32 v1, v1, v3
  v_mul_f32 v2, v2, v3
  v_cvt_pk_bf16_f32 v123, v1, v2
  s_cmp_le_u32 s41, 5
  s_cbranch_scc1 L_resc_done_1_2
  v_lshlrev_b32 v1, 16, v144
  v_and_b32 v2, s10, v144
  v_mul_f32 v1, v1, v3
  v_mul_f32 v2, v2, v3
  v_cvt_pk_bf16_f32 v144, v1, v2
  v_lshlrev_b32 v1, 16, v145
  v_and_b32 v2, s10, v145
  v_mul_f32 v1, v1, v3
  v_mul_f32 v2, v2, v3
  v_cvt_pk_bf16_f32 v145, v1, v2
  v_lshlrev_b32 v1, 16, v146
  v_and_b32 v2, s10, v146
  v_mul_f32 v1, v1, v3
  v_mul_f32 v2, v2, v3
  v_cvt_pk_bf16_f32 v146, v1, v2
  v_lshlrev_b32 v1, 16, v147
  v_and_b32 v2, s10, v147
  v_mul_f32 v1, v1, v3
  v_mul_f32 v2, v2, v3
  v_cvt_pk_bf16_f32 v147, v1, v2
  s_cmp_le_u32 s41, 6
  s_cbranch_scc1 L_resc_done_1_2
  v_lshlrev_b32 v1, 16, v168
  v_and_b32 v2, s10, v168
  v_mul_f32 v1, v1, v3
  v_mul_f32 v2, v2, v3
  v_cvt_pk_bf16_f32 v168, v1, v2
  v_lshlrev_b32 v1, 16, v169
  v_and_b32 v2, s10, v169
  v_mul_f32 v1, v1, v3
  v_mul_f32 v2, v2, v3
  v_cvt_pk_bf16_f32 v169, v1, v2
  v_lshlrev_b32 v1, 16, v170
  v_and_b32 v2, s10, v170
  v_mul_f32 v1, v1, v3
  v_mul_f32 v2, v2, v3
  v_cvt_pk_bf16_f32 v170, v1, v2
  v_lshlrev_b32 v1, 16, v171
  v_and_b32 v2, s10, v171
  v_mul_f32 v1, v1, v3
  v_mul_f32 v2, v2, v3
  v_cvt_pk_bf16_f32 v171, v1, v2
  s_cmp_le_u32 s41, 7
  s_cbranch_scc1 L_resc_done_1_2
  v_lshlrev_b32 v1, 16, v192
  v_and_b32 v2, s10, v192
  v_mul_f32 v1, v1, v3
  v_mul_f32 v2, v2, v3
  v_cvt_pk_bf16_f32 v192, v1, v2
  v_lshlrev_b32 v1, 16, v193
  v_and_b32 v2, s10, v193
  v_mul_f32 v1, v1, v3
  v_mul_f32 v2, v2, v3
  v_cvt_pk_bf16_f32 v193, v1, v2
  v_lshlrev_b32 v1, 16, v194
  v_and_b32 v2, s10, v194
  v_mul_f32 v1, v1, v3
  v_mul_f32 v2, v2, v3
  v_cvt_pk_bf16_f32 v194, v1, v2
  v_lshlrev_b32 v1, 16, v195
  v_and_b32 v2, s10, v195
  v_mul_f32 v1, v1, v3
  v_mul_f32 v2, v2, v3
  v_cvt_pk_bf16_f32 v195, v1, v2
  s_cmp_le_u32 s41, 8
  s_cbranch_scc1 L_resc_done_1_2
  v_lshlrev_b32 v1, 16, v216
  v_and_b32 v2, s10, v216
  v_mul_f32 v1, v1, v3
  v_mul_f32 v2, v2, v3
  v_cvt_pk_bf16_f32 v216, v1, v2
  v_lshlrev_b32 v1, 16, v217
  v_and_b32 v2, s10, v217
  v_mul_f32 v1, v1, v3
  v_mul_f32 v2, v2, v3
  v_cvt_pk_bf16_f32 v217, v1, v2
  v_lshlrev_b32 v1, 16, v218
  v_and_b32 v2, s10, v218
  v_mul_f32 v1, v1, v3
  v_mul_f32 v2, v2, v3
  v_cvt_pk_bf16_f32 v218, v1, v2
  v_lshlrev_b32 v1, 16, v219
  v_and_b32 v2, s10, v219
  v_mul_f32 v1, v1, v3
  v_mul_f32 v2, v2, v3
  v_cvt_pk_bf16_f32 v219, v1, v2
  s_cmp_le_u32 s41, 9
  s_cbranch_scc1 L_resc_done_1_2
  v_lshlrev_b32 v1, 16, v240
  v_and_b32 v2, s10, v240
  v_mul_f32 v1, v1, v3
  v_mul_f32 v2, v2, v3
  v_cvt_pk_bf16_f32 v240, v1, v2
  v_lshlrev_b32 v1, 16, v241
  v_and_b32 v2, s10, v241
  v_mul_f32 v1, v1, v3
  v_mul_f32 v2, v2, v3
  v_cvt_pk_bf16_f32 v241, v1, v2
  v_lshlrev_b32 v1, 16, v242
  v_and_b32 v2, s10, v242
  v_mul_f32 v1, v1, v3
  v_mul_f32 v2, v2, v3
  v_cvt_pk_bf16_f32 v242, v1, v2
  v_lshlrev_b32 v1, 16, v243
  v_and_b32 v2, s10, v243
  v_mul_f32 v1, v1, v3
  v_mul_f32 v2, v2, v3
  v_cvt_pk_bf16_f32 v243, v1, v2
L_resc_done_1_2:
  s_setpc_b64 s[42:43]
L_resc_1_3:
  s_cmp_le_u32 s41, 0
  s_cbranch_scc1 L_resc_done_1_3
  v_accvgpr_read_b32 v2, a60
  v_lshlrev_b32 v1, 16, v2
  v_and_b32 v2, s10, v2
  v_mul_f32 v1, v1, v3
  v_mul_f32 v2, v2, v3
  v_cvt_pk_bf16_f32 v1, v1, v2
  v_accvgpr_write_b32 a60, v1
  v_accvgpr_read_b32 v2, a61
  v_lshlrev_b32 v1, 16, v2
  v_and_b32 v2, s10, v2
  v_mul_f32 v1, v1, v3
  v_mul_f32 v2, v2, v3
  v_cvt_pk_bf16_f32 v1, v1, v2
  v_accvgpr_write_b32 a61, v1
  v_accvgpr_read_b32 v2, a62
  v_lshlrev_b32 v1, 16, v2
  v_and_b32 v2, s10, v2
  v_mul_f32 v1, v1, v3
  v_mul_f32 v2, v2, v3
  v_cvt_pk_bf16_f32 v1, v1, v2
  v_accvgpr_write_b32 a62, v1
  v_accvgpr_read_b32 v2, a63
  v_lshlrev_b32 v1, 16, v2
  v_and_b32 v2, s10, v2
  v_mul_f32 v1, v1, v3
  v_mul_f32 v2, v2, v3
  v_cvt_pk_bf16_f32 v1, v1, v2
  v_accvgpr_write_b32 a63, v1
  s_cmp_le_u32 s41, 1
  s_cbranch_scc1 L_resc_done_1_3
  v_accvgpr_read_b32 v2, a84
  v_lshlrev_b32 v1, 16, v2
  v_and_b32 v2, s10, v2
  v_mul_f32 v1, v1, v3
  v_mul_f32 v2, v2, v3
  v_cvt_pk_bf16_f32 v1, v1, v2
  v_accvgpr_write_b32 a84, v1
  v_accvgpr_read_b32 v2, a85
  v_lshlrev_b32 v1, 16, v2
  v_and_b32 v2, s10, v2
  v_mul_f32 v1, v1, v3
  v_mul_f32 v2, v2, v3
  v_cvt_pk_bf16_f32 v1, v1, v2
  v_accvgpr_write_b32 a85, v1
  v_accvgpr_read_b32 v2, a86
  v_lshlrev_b32 v1, 16, v2
  v_and_b32 v2, s10, v2
  v_mul_f32 v1, v1, v3
  v_mul_f32 v2, v2, v3
  v_cvt_pk_bf16_f32 v1, v1, v2
  v_accvgpr_write_b32 a86, v1
  v_accvgpr_read_b32 v2, a87
  v_lshlrev_b32 v1, 16, v2
  v_and_b32 v2, s10, v2
  v_mul_f32 v1, v1, v3
  v_mul_f32 v2, v2, v3
  v_cvt_pk_bf16_f32 v1, v1, v2
  v_accvgpr_write_b32 a87, v1
  s_cmp_le_u32 s41, 2
  s_cbranch_scc1 L_resc_done_1_3
  v_accvgpr_read_b32 v2, a108
  v_lshlrev_b32 v1, 16, v2
  v_and_b32 v2, s10, v2
  v_mul_f32 v1, v1, v3
  v_mul_f32 v2, v2, v3
  v_cvt_pk_bf16_f32 v1, v1, v2
  v_accvgpr_write_b32 a108, v1
  v_accvgpr_read_b32 v2, a109
  v_lshlrev_b32 v1, 16, v2
  v_and_b32 v2, s10, v2
  v_mul_f32 v1, v1, v3
  v_mul_f32 v2, v2, v3
  v_cvt_pk_bf16_f32 v1, v1, v2
  v_accvgpr_write_b32 a109, v1
  v_accvgpr_read_b32 v2, a110
  v_lshlrev_b32 v1, 16, v2
  v_and_b32 v2, s10, v2
  v_mul_f32 v1, v1, v3
  v_mul_f32 v2, v2, v3
  v_cvt_pk_bf16_f32 v1, v1, v2
  v_accvgpr_write_b32 a110, v1
  v_accvgpr_read_b32 v2, a111
  v_lshlrev_b32 v1, 16, v2
  v_and_b32 v2, s10, v2
  v_mul_f32 v1, v1, v3
  v_mul_f32 v2, v2, v3
  v_cvt_pk_bf16_f32 v1, v1, v2
  v_accvgpr_write_b32 a111, v1
  s_cmp_le_u32 s41, 3
  s_cbranch_scc1 L_resc_done_1_3
  v_accvgpr_read_b32 v2, a132
  v_lshlrev_b32 v1, 16, v2
  v_and_b32 v2, s10, v2
  v_mul_f32 v1, v1, v3
  v_mul_f32 v2, v2, v3
  v_cvt_pk_bf16_f32 v1, v1, v2
  v_accvgpr_write_b32 a132, v1
  v_accvgpr_read_b32 v2, a133
  v_lshlrev_b32 v1, 16, v2
  v_and_b32 v2, s10, v2
  v_mul_f32 v1, v1, v3
  v_mul_f32 v2, v2, v3
  v_cvt_pk_bf16_f32 v1, v1, v2
  v_accvgpr_write_b32 a133, v1
  v_accvgpr_read_b32 v2, a134
  v_lshlrev_b32 v1, 16, v2
  v_and_b32 v2, s10, v2
  v_mul_f32 v1, v1, v3
  v_mul_f32 v2, v2, v3
  v_cvt_pk_bf16_f32 v1, v1, v2
  v_accvgpr_write_b32 a134, v1
  v_accvgpr_read_b32 v2, a135
  v_lshlrev_b32 v1, 16, v2
  v_and_b32 v2, s10, v2
  v_mul_f32 v1, v1, v3
  v_mul_f32 v2, v2, v3
  v_cvt_pk_bf16_f32 v1, v1, v2
  v_accvgpr_write_b32 a135, v1
  s_cmp_le_u32 s41, 4
  s_cbranch_scc1 L_resc_done_1_3
  v_lshlrev_b32 v1, 16, v124
  v_and_b32 v2, s10, v124
  v_mul_f32 v1, v1, v3
  v_mul_f32 v2, v2, v3
  v_cvt_pk_bf16_f32 v124, v1, v2
  v_lshlrev_b32 v1, 16, v125
  v_and_b32 v2, s10, v125
  v_mul_f32 v1, v1, v3
  v_mul_f32 v2, v2, v3
  v_cvt_pk_bf16_f32 v125, v1, v2
  v_lshlrev_b32 v1, 16, v126
  v_and_b32 v2, s10, v126
  v_mul_f32 v1, v1, v3
  v_mul_f32 v2, v2, v3
  v_cvt_pk_bf16_f32 v126, v1, v2
  v_lshlrev_b32 v1, 16, v127
  v_and_b32 v2, s10, v127
  v_mul_f32 v1, v1, v3
  v_mul_f32 v2, v2, v3
  v_cvt_pk_bf16_f32 v127, v1, v2
  s_cmp_le_u32 s41, 5
  s_cbranch_scc1 L_resc_done_1_3
  v_lshlrev_b32 v1, 16, v148
  v_and_b32 v2, s10, v148
  v_mul_f32 v1, v1, v3
  v_mul_f32 v2, v2, v3
  v_cvt_pk_bf16_f32 v148, v1, v2
  v_lshlrev_b32 v1, 16, v149
  v_and_b32 v2, s10, v149
  v_mul_f32 v1, v1, v3
  v_mul_f32 v2, v2, v3
  v_cvt_pk_bf16_f32 v149, v1, v2
  v_lshlrev_b32 v1, 16, v150
  v_and_b32 v2, s10, v150
  v_mul_f32 v1, v1, v3
  v_mul_f32 v2, v2, v3
  v_cvt_pk_bf16_f32 v150, v1, v2
  v_lshlrev_b32 v1, 16, v151
  v_and_b32 v2, s10, v151
  v_mul_f32 v1, v1, v3
  v_mul_f32 v2, v2, v3
  v_cvt_pk_bf16_f32 v151, v1, v2
  s_cmp_le_u32 s41, 6
  s_cbranch_scc1 L_resc_done_1_3
  v_lshlrev_b32 v1, 16, v172
  v_and_b32 v2, s10, v172
  v_mul_f32 v1, v1, v3
  v_mul_f32 v2, v2, v3
  v_cvt_pk_bf16_f32 v172, v1, v2
  v_lshlrev_b32 v1, 16, v173
  v_and_b32 v2, s10, v173
  v_mul_f32 v1, v1, v3
  v_mul_f32 v2, v2, v3
  v_cvt_pk_bf16_f32 v173, v1, v2
  v_lshlrev_b32 v1, 16, v174
  v_and_b32 v2, s10, v174
  v_mul_f32 v1, v1, v3
  v_mul_f32 v2, v2, v3
  v_cvt_pk_bf16_f32 v174, v1, v2
  v_lshlrev_b32 v1, 16, v175
  v_and_b32 v2, s10, v175
  v_mul_f32 v1, v1, v3
  v_mul_f32 v2, v2, v3
  v_cvt_pk_bf16_f32 v175, v1, v2
  s_cmp_le_u32 s41, 7
  s_cbranch_scc1 L_resc_done_1_3
  v_lshlrev_b32 v1, 16, v196
  v_and_b32 v2, s10, v196
  v_mul_f32 v1, v1, v3
  v_mul_f32 v2, v2, v3
  v_cvt_pk_bf16_f32 v196, v1, v2
  v_lshlrev_b32 v1, 16, v197
  v_and_b32 v2, s10, v197
  v_mul_f32 v1, v1, v3
  v_mul_f32 v2, v2, v3
  v_cvt_pk_bf16_f32 v197, v1, v2
  v_lshlrev_b32 v1, 16, v198
  v_and_b32 v2, s10, v198
  v_mul_f32 v1, v1, v3
  v_mul_f32 v2, v2, v3
  v_cvt_pk_bf16_f32 v198, v1, v2
  v_lshlrev_b32 v1, 16, v199
  v_and_b32 v2, s10, v199
  v_mul_f32 v1, v1, v3
  v_mul_f32 v2, v2, v3
  v_cvt_pk_bf16_f32 v199, v1, v2
  s_cmp_le_u32 s41, 8
  s_cbranch_scc1 L_resc_done_1_3
  v_lshlrev_b32 v1, 16, v220
  v_and_b32 v2, s10, v220
  v_mul_f32 v1, v1, v3
  v_mul_f32 v2, v2, v3
  v_cvt_pk_bf16_f32 v220, v1, v2
  v_lshlrev_b32 v1, 16, v221
  v_and_b32 v2, s10, v221
  v_mul_f32 v1, v1, v3
  v_mul_f32 v2, v2, v3
  v_cvt_pk_bf16_f32 v221, v1, v2
  v_lshlrev_b32 v1, 16, v222
  v_and_b32 v2, s10, v222
  v_mul_f32 v1, v1, v3
  v_mul_f32 v2, v2, v3
  v_cvt_pk_bf16_f32 v222, v1, v2
  v_lshlrev_b32 v1, 16, v223
  v_and_b32 v2, s10, v223
  v_mul_f32 v1, v1, v3
  v_mul_f32 v2, v2, v3
  v_cvt_pk_bf16_f32 v223, v1, v2
  s_cmp_le_u32 s41, 9
  s_cbranch_scc1 L_resc_done_1_3
  v_lshlrev_b32 v1, 16, v244
  v_and_b32 v2, s10, v244
  v_mul_f32 v1, v1, v3
  v_mul_f32 v2, v2, v3
  v_cvt_pk_bf16_f32 v244, v1, v2
  v_lshlrev_b32 v1, 16, v245
  v_and_b32 v2, s10, v245
  v_mul_f32 v1, v1, v3
  v_mul_f32 v2, v2, v3
  v_cvt_pk_bf16_f32 v245, v1, v2
  v_lshlrev_b32 v1, 16, v246
  v_and_b32 v2, s10, v246
  v_mul_f32 v1, v1, v3
  v_mul_f32 v2, v2, v3
  v_cvt_pk_bf16_f32 v246, v1, v2
  v_lshlrev_b32 v1, 16, v247
  v_and_b32 v2, s10, v247
  v_mul_f32 v1, v1, v3
  v_mul_f32 v2, v2, v3
  v_cvt_pk_bf16_f32 v247, v1, v2
L_resc_done_1_3:
  s_setpc_b64 s[42:43]
L_resc_1_4:
  s_cmp_le_u32 s41, 0
  s_cbranch_scc1 L_resc_done_1_4
  v_accvgpr_read_b32 v2, a64
  v_lshlrev_b32 v1, 16, v2
  v_and_b32 v2, s10, v2
  v_mul_f32 v1, v1, v3
  v_mul_f32 v2, v2, v3
  v_cvt_pk_bf16_f32 v1, v1, v2
  v_accvgpr_write_b32 a64, v1
  v_accvgpr_read_b32 v2, a65
  v_lshlrev_b32 v1, 16, v2
  v_and_b32 v2, s10, v2
  v_mul_f32 v1, v1, v3
  v_mul_f32 v2, v2, v3
  v_cvt_pk_bf16_f32 v1, v1, v2
  v_accvgpr_write_b32 a65, v1
  v_accvgpr_read_b32 v2, a66
  v_lshlrev_b32 v1, 16, v2
  v_and_b32 v2, s10, v2
  v_mul_f32 v1, v1, v3
  v_mul_f32 v2, v2, v3
  v_cvt_pk_bf16_f32 v1, v1, v2
  v_accvgpr_write_b32 a66, v1
  v_accvgpr_read_b32 v2, a67
  v_lshlrev_b32 v1, 16, v2
  v_and_b32 v2, s10, v2
  v_mul_f32 v1, v1, v3
  v_mul_f32 v2, v2, v3
  v_cvt_pk_bf16_f32 v1, v1, v2
  v_accvgpr_write_b32 a67, v1
  s_cmp_le_u32 s41, 1
  s_cbranch_scc1 L_resc_done_1_4
  v_accvgpr_read_b32 v2, a88
  v_lshlrev_b32 v1, 16, v2
  v_and_b32 v2, s10, v2
  v_mul_f32 v1, v1, v3
  v_mul_f32 v2, v2, v3
  v_cvt_pk_bf16_f32 v1, v1, v2
  v_accvgpr_write_b32 a88, v1
  v_accvgpr_read_b32 v2, a89
  v_lshlrev_b32 v1, 16, v2
  v_and_b32 v2, s10, v2
  v_mul_f32 v1, v1, v3
  v_mul_f32 v2, v2, v3
  v_cvt_pk_bf16_f32 v1, v1, v2
  v_accvgpr_write_b32 a89, v1
  v_accvgpr_read_b32 v2, a90
  v_lshlrev_b32 v1, 16, v2
  v_and_b32 v2, s10, v2
  v_mul_f32 v1, v1, v3
  v_mul_f32 v2, v2, v3
  v_cvt_pk_bf16_f32 v1, v1, v2
  v_accvgpr_write_b32 a90, v1
  v_accvgpr_read_b32 v2, a91
  v_lshlrev_b32 v1, 16, v2
  v_and_b32 v2, s10, v2
  v_mul_f32 v1, v1, v3
  v_mul_f32 v2, v2, v3
  v_cvt_pk_bf16_f32 v1, v1, v2
  v_accvgpr_write_b32 a91, v1
  s_cmp_le_u32 s41, 2
  s_cbranch_scc1 L_resc_done_1_4
  v_accvgpr_read_b32 v2, a112
  v_lshlrev_b32 v1, 16, v2
  v_and_b32 v2, s10, v2
  v_mul_f32 v1, v1, v3
  v_mul_f32 v2, v2, v3
  v_cvt_pk_bf16_f32 v1, v1, v2
  v_accvgpr_write_b32 a112, v1
  v_accvgpr_read_b32 v2, a113
  v_lshlrev_b32 v1, 16, v2
  v_and_b32 v2, s10, v2
  v_mul_f32 v1, v1, v3
  v_mul_f32 v2, v2, v3
  v_cvt_pk_bf16_f32 v1, v1, v2
  v_accvgpr_write_b32 a113, v1
  v_accvgpr_read_b32 v2, a114
  v_lshlrev_b32 v1, 16, v2
  v_and_b32 v2, s10, v2
  v_mul_f32 v1, v1, v3
  v_mul_f32 v2, v2, v3
  v_cvt_pk_bf16_f32 v1, v1, v2
  v_accvgpr_write_b32 a114, v1
  v_accvgpr_read_b32 v2, a115
  v_lshlrev_b32 v1, 16, v2
  v_and_b32 v2, s10, v2
  v_mul_f32 v1, v1, v3
  v_mul_f32 v2, v2, v3
  v_cvt_pk_bf16_f32 v1, v1, v2
  v_accvgpr_write_b32 a115, v1
  s_cmp_le_u32 s41, 3
  s_cbranch_scc1 L_resc_done_1_4
  v_accvgpr_read_b32 v2, a136
  v_lshlrev_b32 v1, 16, v2
  v_and_b32 v2, s10, v2
  v_mul_f32 v1, v1, v3
  v_mul_f32 v2, v2, v3
  v_cvt_pk_bf16_f32 v1, v1, v2
  v_accvgpr_write_b32 a136, v1
  v_accvgpr_read_b32 v2, a137
  v_lshlrev_b32 v1, 16, v2
  v_and_b32 v2, s10, v2
  v_mul_f32 v1, v1, v3
  v_mul_f32 v2, v2, v3
  v_cvt_pk_bf16_f32 v1, v1, v2
  v_accvgpr_write_b32 a137, v1
  v_accvgpr_read_b32 v2, a138
  v_lshlrev_b32 v1, 16, v2
  v_and_b32 v2, s10, v2
  v_mul_f32 v1, v1, v3
  v_mul_f32 v2, v2, v3
  v_cvt_pk_bf16_f32 v1, v1, v2
  v_accvgpr_write_b32 a138, v1
  v_accvgpr_read_b32 v2, a139
  v_lshlrev_b32 v1, 16, v2
  v_and_b32 v2, s10, v2
  v_mul_f32 v1, v1, v3
  v_mul_f32 v2, v2, v3
  v_cvt_pk_bf16_f32 v1, v1, v2
  v_accvgpr_write_b32 a139, v1
  s_cmp_le_u32 s41, 4
  s_cbranch_scc1 L_resc_done_1_4
  v_lshlrev_b32 v1, 16, v128
  v_and_b32 v2, s10, v128
  v_mul_f32 v1, v1, v3
  v_mul_f32 v2, v2, v3
  v_cvt_pk_bf16_f32 v128, v1, v2
  v_lshlrev_b32 v1, 16, v129
  v_and_b32 v2, s10, v129
  v_mul_f32 v1, v1, v3
  v_mul_f32 v2, v2, v3
  v_cvt_pk_bf16_f32 v129, v1, v2
  v_lshlrev_b32 v1, 16, v130
  v_and_b32 v2, s10, v130
  v_mul_f32 v1, v1, v3
  v_mul_f32 v2, v2, v3
  v_cvt_pk_bf16_f32 v130, v1, v2
  v_lshlrev_b32 v1, 16, v131
  v_and_b32 v2, s10, v131
  v_mul_f32 v1, v1, v3
  v_mul_f32 v2, v2, v3
  v_cvt_pk_bf16_f32 v131, v1, v2
  s_cmp_le_u32 s41, 5
  s_cbranch_scc1 L_resc_done_1_4
  v_lshlrev_b32 v1, 16, v152
  v_and_b32 v2, s10, v152
  v_mul_f32 v1, v1, v3
  v_mul_f32 v2, v2, v3
  v_cvt_pk_bf16_f32 v152, v1, v2
  v_lshlrev_b32 v1, 16, v153
  v_and_b32 v2, s10, v153
  v_mul_f32 v1, v1, v3
  v_mul_f32 v2, v2, v3
  v_cvt_pk_bf16_f32 v153, v1, v2
  v_lshlrev_b32 v1, 16, v154
  v_and_b32 v2, s10, v154
  v_mul_f32 v1, v1, v3
  v_mul_f32 v2, v2, v3
  v_cvt_pk_bf16_f32 v154, v1, v2
  v_lshlrev_b32 v1, 16, v155
  v_and_b32 v2, s10, v155
  v_mul_f32 v1, v1, v3
  v_mul_f32 v2, v2, v3
  v_cvt_pk_bf16_f32 v155, v1, v2
  s_cmp_le_u32 s41, 6
  s_cbranch_scc1 L_resc_done_1_4
  v_lshlrev_b32 v1, 16, v176
  v_and_b32 v2, s10, v176
  v_mul_f32 v1, v1, v3
  v_mul_f32 v2, v2, v3
  v_cvt_pk_bf16_f32 v176, v1, v2
  v_lshlrev_b32 v1, 16, v177
  v_and_b32 v2, s10, v177
  v_mul_f32 v1, v1, v3
  v_mul_f32 v2, v2, v3
  v_cvt_pk_bf16_f32 v177, v1, v2
  v_lshlrev_b32 v1, 16, v178
  v_and_b32 v2, s10, v178
  v_mul_f32 v1, v1, v3
  v_mul_f32 v2, v2, v3
  v_cvt_pk_bf16_f32 v178, v1, v2
  v_lshlrev_b32 v1, 16, v179
  v_and_b32 v2, s10, v179
  v_mul_f32 v1, v1, v3
  v_mul_f32 v2, v2, v3
  v_cvt_pk_bf16_f32 v179, v1, v2
  s_cmp_le_u32 s41, 7
  s_cbranch_scc1 L_resc_done_1_4
  v_lshlrev_b32 v1, 16, v200
  v_and_b32 v2, s10, v200
  v_mul_f32 v1, v1, v3
  v_mul_f32 v2, v2, v3
  v_cvt_pk_bf16_f32 v200, v1, v2
  v_lshlrev_b32 v1, 16, v201
  v_and_b32 v2, s10, v201
  v_mul_f32 v1, v1, v3
  v_mul_f32 v2, v2, v3
  v_cvt_pk_bf16_f32 v201, v1, v2
  v_lshlrev_b32 v1, 16, v202
  v_and_b32 v2, s10, v202
  v_mul_f32 v1, v1, v3
  v_mul_f32 v2, v2, v3
  v_cvt_pk_bf16_f32 v202, v1, v2
  v_lshlrev_b32 v1, 16, v203
  v_and_b32 v2, s10, v203
  v_mul_f32 v1, v1, v3
  v_mul_f32 v2, v2, v3
  v_cvt_pk_bf16_f32 v203, v1, v2
  s_cmp_le_u32 s41, 8
  s_cbranch_scc1 L_resc_done_1_4
  v_lshlrev_b32 v1, 16, v224
  v_and_b32 v2, s10, v224
  v_mul_f32 v1, v1, v3
  v_mul_f32 v2, v2, v3
  v_cvt_pk_bf16_f32 v224, v1, v2
  v_lshlrev_b32 v1, 16, v225
  v_and_b32 v2, s10, v225
  v_mul_f32 v1, v1, v3
  v_mul_f32 v2, v2, v3
  v_cvt_pk_bf16_f32 v225, v1, v2
  v_lshlrev_b32 v1, 16, v226
  v_and_b32 v2, s10, v226
  v_mul_f32 v1, v1, v3
  v_mul_f32 v2, v2, v3
  v_cvt_pk_bf16_f32 v226, v1, v2
  v_lshlrev_b32 v1, 16, v227
  v_and_b32 v2, s10, v227
  v_mul_f32 v1, v1, v3
  v_mul_f32 v2, v2, v3
  v_cvt_pk_bf16_f32 v227, v1, v2
  s_cmp_le_u32 s41, 9
  s_cbranch_scc1 L_resc_done_1_4
  v_lshlrev_b32 v1, 16, v248
  v_and_b32 v2, s10, v248
  v_mul_f32 v1, v1, v3
  v_mul_f32 v2, v2, v3
  v_cvt_pk_bf16_f32 v248, v1, v2
  v_lshlrev_b32 v1, 16, v249
  v_and_b32 v2, s10, v249
  v_mul_f32 v1, v1, v3
  v_mul_f32 v2, v2, v3
  v_cvt_pk_bf16_f32 v249, v1, v2
  v_lshlrev_b32 v1, 16, v250
  v_and_b32 v2, s10, v250
  v_mul_f32 v1, v1, v3
  v_mul_f32 v2, v2, v3
  v_cvt_pk_bf16_f32 v250, v1, v2
  v_lshlrev_b32 v1, 16, v251
  v_and_b32 v2, s10, v251
  v_mul_f32 v1, v1, v3
  v_mul_f32 v2, v2, v3
  v_cvt_pk_bf16_f32 v251, v1, v2
L_resc_done_1_4:
  s_setpc_b64 s[42:43]
L_resc_1_5:
  s_cmp_le_u32 s41, 0
  s_cbranch_scc1 L_resc_done_1_5
  v_accvgpr_read_b32 v2, a68
  v_lshlrev_b32 v1, 16, v2
  v_and_b32 v2, s10, v2
  v_mul_f32 v1, v1, v3
  v_mul_f32 v2, v2, v3
  v_cvt_pk_bf16_f32 v1, v1, v2
  v_accvgpr_write_b32 a68, v1
  v_accvgpr_read_b32 v2, a69
  v_lshlrev_b32 v1, 16, v2
  v_and_b32 v2, s10, v2
  v_mul_f32 v1, v1, v3
  v_mul_f32 v2, v2, v3
  v_cvt_pk_bf16_f32 v1, v1, v2
  v_accvgpr_write_b32 a69, v1
  v_accvgpr_read_b32 v2, a70
  v_lshlrev_b32 v1, 16, v2
  v_and_b32 v2, s10, v2
  v_mul_f32 v1, v1, v3
  v_mul_f32 v2, v2, v3
  v_cvt_pk_bf16_f32 v1, v1, v2
  v_accvgpr_write_b32 a70, v1
  v_accvgpr_read_b32 v2, a71
  v_lshlrev_b32 v1, 16, v2
  v_and_b32 v2, s10, v2
  v_mul_f32 v1, v1, v3
  v_mul_f32 v2, v2, v3
  v_cvt_pk_bf16_f32 v1, v1, v2
  v_accvgpr_write_b32 a71, v1
  s_cmp_le_u32 s41, 1
  s_cbranch_scc1 L_resc_done_1_5
  v_accvgpr_read_b32 v2, a92
  v_lshlrev_b32 v1, 16, v2
  v_and_b32 v2, s10, v2
  v_mul_f32 v1, v1, v3
  v_mul_f32 v2, v2, v3
  v_cvt_pk_bf16_f32 v1, v1, v2
  v_accvgpr_write_b32 a92, v1
  v_accvgpr_read_b32 v2, a93
  v_lshlrev_b32 v1, 16, v2
  v_and_b32 v2, s10, v2
  v_mul_f32 v1, v1, v3
  v_mul_f32 v2, v2, v3
  v_cvt_pk_bf16_f32 v1, v1, v2
  v_accvgpr_write_b32 a93, v1
  v_accvgpr_read_b32 v2, a94
  v_lshlrev_b32 v1, 16, v2
  v_and_b32 v2, s10, v2
  v_mul_f32 v1, v1, v3
  v_mul_f32 v2, v2, v3
  v_cvt_pk_bf16_f32 v1, v1, v2
  v_accvgpr_write_b32 a94, v1
  v_accvgpr_read_b32 v2, a95
  v_lshlrev_b32 v1, 16, v2
  v_and_b32 v2, s10, v2
  v_mul_f32 v1, v1, v3
  v_mul_f32 v2, v2, v3
  v_cvt_pk_bf16_f32 v1, v1, v2
  v_accvgpr_write_b32 a95, v1
  s_cmp_le_u32 s41, 2
  s_cbranch_scc1 L_resc_done_1_5
  v_accvgpr_read_b32 v2, a116
  v_lshlrev_b32 v1, 16, v2
  v_and_b32 v2, s10, v2
  v_mul_f32 v1, v1, v3
  v_mul_f32 v2, v2, v3
  v_cvt_pk_bf16_f32 v1, v1, v2
  v_accvgpr_write_b32 a116, v1
  v_accvgpr_read_b32 v2, a117
  v_lshlrev_b32 v1, 16, v2
  v_and_b32 v2, s10, v2
  v_mul_f32 v1, v1, v3
  v_mul_f32 v2, v2, v3
  v_cvt_pk_bf16_f32 v1, v1, v2
  v_accvgpr_write_b32 a117, v1
  v_accvgpr_read_b32 v2, a118
  v_lshlrev_b32 v1, 16, v2
  v_and_b32 v2, s10, v2
  v_mul_f32 v1, v1, v3
  v_mul_f32 v2, v2, v3
  v_cvt_pk_bf16_f32 v1, v1, v2
  v_accvgpr_write_b32 a118, v1
  v_accvgpr_read_b32 v2, a119
  v_lshlrev_b32 v1, 16, v2
  v_and_b32 v2, s10, v2
  v_mul_f32 v1, v1, v3
  v_mul_f32 v2, v2, v3
  v_cvt_pk_bf16_f32 v1, v1, v2
  v_accvgpr_write_b32 a119, v1
  s_cmp_le_u32 s41, 3
  s_cbranch_scc1 L_resc_done_1_5
  v_accvgpr_read_b32 v2, a140
  v_lshlrev_b32 v1, 16, v2
  v_and_b32 v2, s10, v2
  v_mul_f32 v1, v1, v3
  v_mul_f32 v2, v2, v3
  v_cvt_pk_bf16_f32 v1, v1, v2
  v_accvgpr_write_b32 a140, v1
  v_accvgpr_read_b32 v2, a141
  v_lshlrev_b32 v1, 16, v2
  v_and_b32 v2, s10, v2
  v_mul_f32 v1, v1, v3
  v_mul_f32 v2, v2, v3
  v_cvt_pk_bf16_f32 v1, v1, v2
  v_accvgpr_write_b32 a141, v1
  v_accvgpr_read_b32 v2, a142
  v_lshlrev_b32 v1, 16, v2
  v_and_b32 v2, s10, v2
  v_mul_f32 v1, v1, v3
  v_mul_f32 v2, v2, v3
  v_cvt_pk_bf16_f32 v1, v1, v2
  v_accvgpr_write_b32 a142, v1
  v_accvgpr_read_b32 v2, a143
  v_lshlrev_b32 v1, 16, v2
  v_and_b32 v2, s10, v2
  v_mul_f32 v1, v1, v3
  v_mul_f32 v2, v2, v3
  v_cvt_pk_bf16_f32 v1, v1, v2
  v_accvgpr_write_b32 a143, v1
  s_cmp_le_u32 s41, 4
  s_cbranch_scc1 L_resc_done_1_5
  v_lshlrev_b32 v1, 16, v132
  v_and_b32 v2, s10, v132
  v_mul_f32 v1, v1, v3
  v_mul_f32 v2, v2, v3
  v_cvt_pk_bf16_f32 v132, v1, v2
  v_lshlrev_b32 v1, 16, v133
  v_and_b32 v2, s10, v133
  v_mul_f32 v1, v1, v3
  v_mul_f32 v2, v2, v3
  v_cvt_pk_bf16_f32 v133, v1, v2
  v_lshlrev_b32 v1, 16, v134
  v_and_b32 v2, s10, v134
  v_mul_f32 v1, v1, v3
  v_mul_f32 v2, v2, v3
  v_cvt_pk_bf16_f32 v134, v1, v2
  v_lshlrev_b32 v1, 16, v135
  v_and_b32 v2, s10, v135
  v_mul_f32 v1, v1, v3
  v_mul_f32 v2, v2, v3
  v_cvt_pk_bf16_f32 v135, v1, v2
  s_cmp_le_u32 s41, 5
  s_cbranch_scc1 L_resc_done_1_5
  v_lshlrev_b32 v1, 16, v156
  v_and_b32 v2, s10, v156
  v_mul_f32 v1, v1, v3
  v_mul_f32 v2, v2, v3
  v_cvt_pk_bf16_f32 v156, v1, v2
  v_lshlrev_b32 v1, 16, v157
  v_and_b32 v2, s10, v157
  v_mul_f32 v1, v1, v3
  v_mul_f32 v2, v2, v3
  v_cvt_pk_bf16_f32 v157, v1, v2
  v_lshlrev_b32 v1, 16, v158
  v_and_b32 v2, s10, v158
  v_mul_f32 v1, v1, v3
  v_mul_f32 v2, v2, v3
  v_cvt_pk_bf16_f32 v158, v1, v2
  v_lshlrev_b32 v1, 16, v159
  v_and_b32 v2, s10, v159
  v_mul_f32 v1, v1, v3
  v_mul_f32 v2, v2, v3
  v_cvt_pk_bf16_f32 v159, v1, v2
  s_cmp_le_u32 s41, 6
  s_cbranch_scc1 L_resc_done_1_5
  v_lshlrev_b32 v1, 16, v180
  v_and_b32 v2, s10, v180
  v_mul_f32 v1, v1, v3
  v_mul_f32 v2, v2, v3
  v_cvt_pk_bf16_f32 v180, v1, v2
  v_lshlrev_b32 v1, 16, v181
  v_and_b32 v2, s10, v181
  v_mul_f32 v1, v1, v3
  v_mul_f32 v2, v2, v3
  v_cvt_pk_bf16_f32 v181, v1, v2
  v_lshlrev_b32 v1, 16, v182
  v_and_b32 v2, s10, v182
  v_mul_f32 v1, v1, v3
  v_mul_f32 v2, v2, v3
  v_cvt_pk_bf16_f32 v182, v1, v2
  v_lshlrev_b32 v1, 16, v183
  v_and_b32 v2, s10, v183
  v_mul_f32 v1, v1, v3
  v_mul_f32 v2, v2, v3
  v_cvt_pk_bf16_f32 v183, v1, v2
  s_cmp_le_u32 s41, 7
  s_cbranch_scc1 L_resc_done_1_5
  v_lshlrev_b32 v1, 16, v204
  v_and_b32 v2, s10, v204
  v_mul_f32 v1, v1, v3
  v_mul_f32 v2, v2, v3
  v_cvt_pk_bf16_f32 v204, v1, v2
  v_lshlrev_b32 v1, 16, v205
  v_and_b32 v2, s10, v205
  v_mul_f32 v1, v1, v3
  v_mul_f32 v2, v2, v3
  v_cvt_pk_bf16_f32 v205, v1, v2
  v_lshlrev_b32 v1, 16, v206
  v_and_b32 v2, s10, v206
  v_mul_f32 v1, v1, v3
  v_mul_f32 v2, v2, v3
  v_cvt_pk_bf16_f32 v206, v1, v2
  v_lshlrev_b32 v1, 16, v207
  v_and_b32 v2, s10, v207
  v_mul_f32 v1, v1, v3
  v_mul_f32 v2, v2, v3
  v_cvt_pk_bf16_f32 v207, v1, v2
  s_cmp_le_u32 s41, 8
  s_cbranch_scc1 L_resc_done_1_5
  v_lshlrev_b32 v1, 16, v228
  v_and_b32 v2, s10, v228
  v_mul_f32 v1, v1, v3
  v_mul_f32 v2, v2, v3
  v_cvt_pk_bf16_f32 v228, v1, v2
  v_lshlrev_b32 v1, 16, v229
  v_and_b32 v2, s10, v229
  v_mul_f32 v1, v1, v3
  v_mul_f32 v2, v2, v3
  v_cvt_pk_bf16_f32 v229, v1, v2
  v_lshlrev_b32 v1, 16, v230
  v_and_b32 v2, s10, v230
  v_mul_f32 v1, v1, v3
  v_mul_f32 v2, v2, v3
  v_cvt_pk_bf16_f32 v230, v1, v2
  v_lshlrev_b32 v1, 16, v231
  v_and_b32 v2, s10, v231
  v_mul_f32 v1, v1, v3
  v_mul_f32 v2, v2, v3
  v_cvt_pk_bf16_f32 v231, v1, v2
  s_cmp_le_u32 s41, 9
  s_cbranch_scc1 L_resc_done_1_5
  v_lshlrev_b32 v1, 16, v252
  v_and_b32 v2, s10, v252
  v_mul_f32 v1, v1, v3
  v_mul_f32 v2, v2, v3
  v_cvt_pk_bf16_f32 v252, v1, v2
  v_lshlrev_b32 v1, 16, v253
  v_and_b32 v2, s10, v253
  v_mul_f32 v1, v1, v3
  v_mul_f32 v2, v2, v3
  v_cvt_pk_bf16_f32 v253, v1, v2
  v_lshlrev_b32 v1, 16, v254
  v_and_b32 v2, s10, v254
  v_mul_f32 v1, v1, v3
  v_mul_f32 v2, v2, v3
  v_cvt_pk_bf16_f32 v254, v1, v2
  v_lshlrev_b32 v1, 16, v255
  v_and_b32 v2, s10, v255
  v_mul_f32 v1, v1, v3
  v_mul_f32 v2, v2, v3
  v_cvt_pk_bf16_f32 v255, v1, v2
L_resc_done_1_5:
  s_setpc_b64 s[42:43]
.section .rodata,"a"
.p2align 6
.amdhsa_kernel standalone__gqa_softmax__near_ridge_kernel
  .amdhsa_next_free_vgpr 512
  .amdhsa_next_free_sgpr 64
  .amdhsa_accum_offset 256
  .amdhsa_group_segment_fixed_size 0
  .amdhsa_kernarg_size 48
  .amdhsa_user_sgpr_count 2
  .amdhsa_user_sgpr_kernarg_segment_ptr 1
  .amdhsa_system_sgpr_workgroup_id_x 1
.end_amdhsa_kernel
```
